```python
import torch

def _softmax(x, axis=-1):
    return torch.softmax(x, dim=axis)

def _gelu(x):
    return torch.nn.functional.gelu(x, approximate='tanh')

def _silu(x):
    return torch.nn.functional.silu(x)

def _sigmoid(x):
    return torch.sigmoid(x)

def _layernorm(x, axis=-1, eps=1e-05):
    m = x.mean(dim=axis, keepdim=True)
    v = x.var(dim=axis, keepdim=True, unbiased=False)
    return (x - m) / torch.sqrt(v + eps)

def _scatter_add(tgt, idx, src, axis=0):
    return tgt.clone().index_add_(axis, idx, src)

def _segment_sum(src, seg, n):
    out = torch.zeros((n,) + src.shape[1:], dtype=src.dtype)
    return out.index_add_(0, seg, src)

def _pad(x, pw):
    flat = tuple((v for pair in reversed(pw) for v in pair))
    return torch.nn.functional.pad(x, flat)
kernel_name = 'gated_mix__memory_aug_recurrent_mem_tr__swiglu_ffn__prompt'

def setup_inputs():

    _w = lambda a: (lambda t: t.to(torch.bfloat16) if t.is_floating_point() else t)(torch.as_tensor(a))

    def _A_setup():
        B, S, Dm = (1, 2048, 448)
        H, Dh = (16, 256)
        M, seg = (8, 32)
        seg = min(seg, S)
        S = S // seg * seg
        return {'x': _w((lambda *s: torch.randn(*s, dtype=torch.bfloat16) * 0.05)(B, S, Dm)), 'mem0': _w((lambda *s: torch.randn(*s, dtype=torch.bfloat16) * 0.4)(B, M, Dm)), 'Wq': _w((lambda *s: torch.randn(*s, dtype=torch.bfloat16) * 6.4)(Dm, H, Dh) * Dm ** (-0.5)), 'Wk': _w((lambda *s: torch.randn(*s, dtype=torch.bfloat16) * 6.4)(Dm, H, Dh) * Dm ** (-0.5)), 'Wv': _w((lambda *s: torch.randn(*s, dtype=torch.bfloat16) * 0.4)(Dm, H, Dh) * Dm ** (-0.5)), 'Wo': _w((lambda *s: torch.randn(*s, dtype=torch.bfloat16) * 0.4)(H, Dh, Dm) * (H * Dh) ** (-0.5)), 'seg_len': seg}
    _A_in = _A_setup()

    def _B_setup():
        B, S, D, F = (1, 2048, 448, 1792)
        return {'x': _w((lambda *s: torch.randn(*s, dtype=torch.bfloat16) * 0.05)(B, S, D)), 'w_gate': _w((lambda *s: torch.randn(*s, dtype=torch.bfloat16) * 0.05)(D, F)), 'w_up': _w((lambda *s: torch.randn(*s, dtype=torch.bfloat16) * 0.05)(D, F)), 'w_down': _w((lambda *s: torch.randn(*s, dtype=torch.bfloat16) * 0.05)(F, D))}
    _B_in = _B_setup()
    return {'A_x': _A_in['x'], 'A_mem0': _A_in['mem0'], 'A_Wq': _A_in['Wq'], 'A_Wk': _A_in['Wk'], 'A_Wv': _A_in['Wv'], 'A_Wo': _A_in['Wo'], 'A_seg_len': _A_in['seg_len'], 'B_x': _B_in['x'], 'B_w_gate': _B_in['w_gate'], 'B_w_up': _B_in['w_up'], 'B_w_down': _B_in['w_down'], 'gate_w': _w((lambda *s: torch.randn(*s, dtype=torch.bfloat16) * 0.05)(448) * 16.0)}

def reference(A_x, A_mem0, A_Wq, A_Wk, A_Wv, A_Wo, A_seg_len, B_x, B_w_gate, B_w_up, B_w_down, gate_w):

    def _A_ref(x, mem0, Wq, Wk, Wv, Wo, seg_len):
        B, S, Dm = x.shape
        H, Dh = (Wq.shape[1], Wq.shape[2])
        M = mem0.shape[1]
        scale = Dh ** (-0.5)
        n_seg = S // seg_len
        L = M + seg_len
        idx = torch.arange(L)
        mask = (idx[:, None] < M) | (idx[:, None] >= idx[None, :])
        mem = mem0
        outs = []
        for s in range(n_seg):
            xs = x[:, s * seg_len:(s + 1) * seg_len, :].clone()
            h = torch.concatenate([mem, xs], axis=1)
            q = torch.einsum('btd,dhe->bhte', h, Wq)
            k = torch.einsum('btd,dhe->bhte', h, Wk)
            v = torch.einsum('btd,dhe->bhte', h, Wv)
            scores = torch.einsum('bhqe,bhke->bhqk', q, k) * scale
            scores = torch.where(mask[None, None], scores, -1000000000.0)
            p = _softmax(scores, axis=-1)
            o = torch.einsum('bhqk,bhke->bhqe', p, v)
            o = torch.einsum('bhte,hed->btd', o, Wo)
            mem = o[:, :M, :].clone()
            outs.append(o[:, M:, :])
        return torch.concatenate(outs, axis=1)

    def _B_ref(x, w_gate, w_up, w_down):
        g = _silu(x @ w_gate)
        u = x @ w_up
        return g * u @ w_down
    x = A_x
    g = _sigmoid((x * gate_w).sum(-1, keepdims=True))
    a = _A_ref(x, A_mem0, A_Wq, A_Wk, A_Wv, A_Wo, A_seg_len)
    b = _B_ref(x, B_w_gate, B_w_up, B_w_down)
    return g * a + (1 - g) * b
```

```asm
; @launch grid=(256,1,1) block=(256,1,1) lds=163840
.amdgcn_target "amdgcn-amd-amdhsa--gfx950"
.text
.globl gated_mix__memory_aug_recurrent_mem_tr__swiglu_ffn__prompt_kernel
.p2align 8
.type gated_mix__memory_aug_recurrent_mem_tr__swiglu_ffn__prompt_kernel,@function
gated_mix__memory_aug_recurrent_mem_tr__swiglu_ffn__prompt_kernel:

CODE_BEGIN:
    s_cmp_ge_u32 s2, 256
    s_cbranch_scc1 MEGA_EXIT
    s_getpc_b64 s[6:7]
    s_lshr_b32 s3, s2, 3
    s_lshl_b32 s3, s3, 12
    v_subrev_u32 v1, 192, v0
    v_lshl_add_u32 v2, v1, 7, s3
    v_mov_b32 v3, CODE_BYTES
    v_cmp_gt_u32 vcc, 32, v1
    v_cmp_lt_u32 s[14:15], v2, v3
    s_nop 0
    s_and_b64 vcc, vcc, s[14:15]
    s_and_saveexec_b64 s[14:15], vcc
    s_cbranch_execz NOCPF
    global_load_dword v255, v2, s[6:7]
NOCPF:
    s_mov_b64 exec, s[14:15]
    s_load_dwordx2 s[8:9], s[0:1], 112
    s_mov_b32 s10, 268435456
    s_mov_b32 s11, 0x20000
    s_load_dwordx2 s[4:5], s[0:1], 104
    v_readfirstlane_b32 s13, v0
    s_nop 0
    s_lshr_b32 s13, s13, 6
    s_and_b32 s12, s2, 7
    s_lshl_b32 s12, s12, 5
    s_lshr_b32 s3, s2, 3
    s_add_u32 s12, s12, s3
    s_mov_b32 s83, s12
    s_waitcnt lgkmcnt(0)
    s_cmp_ge_u32 s12, 32
    s_cbranch_scc1 WORKER
    s_cmp_lg_u32 s12, 31
    s_cbranch_scc1 NOINIT
    v_lshlrev_b32 v2, 4, v0
    v_mov_b64 v[8:9], 0
    v_mov_b64 v[10:11], 0
    s_mov_b32 s18, 116449280
    s_mov_b32 s19, 116453376
    buffer_store_dwordx4 v[8:11], v2, s[8:11], s18 offen sc1
    buffer_store_dwordx4 v[8:11], v2, s[8:11], s19 offen sc1
    s_waitcnt vmcnt(0)
    s_barrier
    v_mov_b32 v12, 1
    s_mov_b64 exec, 1
    global_store_dword v8, v12, s[4:5] offset:192 sc1
    s_mov_b64 exec, -1
NOINIT:
    s_getreg_b32 s3, hwreg(HW_REG_XCC_ID)
    s_and_b32 s3, s3, 15
    s_mul_i32 s41, s3, s3
    s_lshl_b32 s41, s41, 16
    s_lshl_b32 s3, s3, 6
    s_add_u32 s41, s41, s3
    s_add_u32 s41, s41, 1
    s_cmp_lt_u32 s12, 16
    s_cbranch_scc1 ROLE_A
    s_mov_b32 s26, 0
    s_cmp_ge_u32 s12, 30
    s_cbranch_scc1 ROLE_P
    s_load_dwordx2 s[32:33], s[0:1], 8
    s_mov_b32 s34, 7168
    s_mov_b32 s35, 0x20000
    s_waitcnt lgkmcnt(0)
    s_branch ROLE_C
ROLE_A:
    v_and_b32 v1, 63, v0
    v_lshlrev_b32 v240, 4, v1
    s_lshl_b32 s52, s12, 2
    s_add_u32 s52, s52, s13
    s_load_dwordx2 s[44:45], s[0:1], 0
    s_mov_b32 s46, 1835008
    s_mov_b32 s47, 0x20000
    s_load_dwordx2 s[48:49], s[0:1], 88
    s_mov_b32 s50, 896
    s_mov_b32 s51, 0x20000
    v_mov_b64 v[232:233], 0
    v_mov_b64 v[234:235], 0
    v_min_u32 v243, 55, v1
    v_lshlrev_b32 v243, 4, v243
    s_mul_i32 s56, s52, 896
    s_add_u32 s56, s56, 116391936
    buffer_store_dwordx4 v[232:235], v243, s[8:11], s56 offen sc1
    v_lshrrev_b32 v242, 3, v1
    v_mul_u32_u24 v241, 896, v242
    v_bfe_u32 v242, v1, 4, 1
    v_lshlrev_b32 v242, 2, v242
    v_xor_b32 v242, v242, v1
    v_and_b32 v242, 7, v242
    v_lshl_add_u32 v241, v242, 4, v241
    v_lshrrev_b32 v242, 4, v1
    v_lshlrev_b32 v242, 4, v242
    s_mul_i32 s53, s52, 14336
    s_mul_i32 s54, s13, 28672
    s_add_u32 s54, s54, 32768
    v_bfe_u32 v243, v1, 3, 1
    v_mul_u32_u24 v244, 7168, v243
    v_and_b32 v243, 7, v1
    v_lshl_add_u32 v244, v243, 7, v244
    v_add_u32 v244, v244, v242
    v_bfe_u32 v243, v1, 1, 1
    v_lshl_add_u32 v244, v243, 6, v244
    v_add_u32 v244, s54, v244
    v_xor_b32 v245, 64, v244
    v_and_b32 v246, 15, v1
    v_lshlrev_b32 v246, 2, v246
    s_waitcnt lgkmcnt(0)
    s_mov_b32 s26, 0
    v_and_b32 v1, 63, v0
    v_lshlrev_b32 v2, 4, v1
    v_and_b32 v12, 8, v1
    v_cmp_eq_u32 vcc, 0, v12
    v_mov_b32 v13, 0xeeee
    v_mov_b32 v14, 0x4444
    v_cndmask_b32 v3, v13, v14, vcc
    v_add_u32 v11, 4096, v2
    v_mov_b64 v[8:9], 0
    v_and_b32 v12, 15, v1
    v_lshrrev_b32 v13, 4, v1
    v_lshrrev_b32 v14, 2, v12
    v_xor_b32 v15, v13, v14
    v_and_b32 v4, 3, v12
    v_lshl_add_u32 v4, v4, 2, v15
    v_and_b32 v15, 1, v14
    s_and_b32 s18, s13, 1
    v_xor_b32 v15, s18, v15
    v_lshl_add_u32 v4, v15, 4, v4
    v_lshlrev_b32 v4, 3, v4
    v_lshl_add_u32 v4, v14, 8, v4
    s_lshr_b32 s18, s13, 1
    s_lshl_b32 s18, s18, 10
    v_add_u32 v4, s18, v4
    v_and_b32 v14, 3, v12
    v_xor_b32 v14, v14, v13
    v_and_b32 v15, 12, v12
    v_add_u32 v14, v14, v15
    v_and_b32 v15, 1, v13
    v_lshl_add_u32 v14, v15, 4, v14
    v_lshlrev_b32 v14, 3, v14
    v_lshl_add_u32 v5, v13, 8, v14
    v_xor_b32 v6, 128, v5
    v_mov_b64 v[44:45], 0
    v_mov_b64 v[46:47], 0
    ds_write_b128 v2, v[44:47] offset:24576
    ds_write_b128 v2, v[44:47] offset:28672
    s_mov_b32 s22, 0
    s_cmp_eq_u32 s13, 1
    s_cbranch_scc1 DSP_3
    s_cmp_eq_u32 s13, 2
    s_cbranch_scc1 DSP_4
    s_cmp_eq_u32 s13, 3
    s_cbranch_scc1 DSP_5
DSP_2:
    v_bfe_u32 v14, v1, 4, 1
    v_lshlrev_b32 v14, 2, v14
    v_bfe_u32 v12, v1, 5, 1
    v_lshl_add_u32 v14, v12, 1, v14
    v_bfe_u32 v12, v1, 3, 1
    v_add_u32 v14, v14, v12
    v_and_b32 v15, 7, v1
    v_and_b32 v12, 1, v15
    v_cmp_eq_u32 s[36:37], 0, v12
    s_lshl_b32 s18, s12, 7
    s_add_u32 s18, s18, 8192
    v_lshl_add_u32 v8, v14, 4, s18
    v_lshl_add_u32 v8, v15, 1, v8
    s_and_b32 s18, s12, 7
    s_lshl_b32 s18, s18, 6
    s_lshr_b32 s19, s12, 3
    s_lshl_b32 s19, s19, 2
    s_add_u32 s18, s18, s19
    s_add_u32 s18, s18, 10240
    v_lshl_add_u32 v13, v14, 3, s18
    v_cndmask_b32 v8, v13, v8, s[36:37]
    v_and_b32 v12, 1, v14
    v_cmp_eq_u32 s[38:39], 0, v12
    v_cmp_eq_u32 s[42:43], 1, v12
    v_mov_b32 v54, -1
    s_mov_b32 s18, 75497472
    buffer_store_dword v54, v8, s[8:11], s18 offen sc1
    s_mov_b32 s18, 75628544
    buffer_store_dword v54, v8, s[8:11], s18 offen sc1
    s_mov_b32 s18, 75759616
    buffer_store_dword v54, v8, s[8:11], s18 offen sc1
    s_mov_b32 s18, 75890688
    buffer_store_dword v54, v8, s[8:11], s18 offen sc1
    s_lshr_b32 s18, s12, 2
    s_lshl_b32 s18, s18, 11
    s_and_b32 s19, s12, 1
    s_lshl_b32 s19, s19, 10
    s_add_u32 s18, s18, s19
    s_and_b32 s19, s12, 2
    s_lshl_b32 s19, s19, 6
    s_add_u32 s18, s18, s19
    s_add_u32 s18, s18, 12288
    v_lshrrev_b32 v12, 1, v15
    v_lshl_add_u32 v9, v12, 8, s18
    v_lshl_add_u32 v9, v14, 4, v9
    v_and_b32 v12, 1, v15
    v_lshl_add_u32 v9, v12, 3, v9
    v_lshrrev_b32 v55, 4, v1
    v_lshlrev_b32 v55, 7, v55
    v_and_b32 v12, 3, v15
    v_lshl_add_u32 v55, v12, 5, v55
    v_lshrrev_b32 v12, 2, v15
    v_lshl_add_u32 v55, v12, 3, v55
    v_and_b32 v12, 1, v14
    v_lshl_add_u32 v55, v12, 2, v55
    v_add_u32 v1, 28672, v55
    v_add_u32 v55, 28688, v55
    v_mov_b32 v10, 0
    v_mov_b32 v0, 0
    s_branch AJ_1
DSP_3:
    v_lshlrev_b32 v5, 3, v1
    v_mov_b32 v10, 4
    v_mov_b32 v0, 0
    s_branch AJ_1
DSP_4:
    v_lshlrev_b32 v5, 3, v1
    v_mov_b32 v10, 8
    v_mov_b32 v0, 0
    s_branch AJ_1
DSP_5:
    v_lshrrev_b32 v14, 3, v1
    v_and_b32 v15, 7, v1
    s_lshr_b32 s18, s12, 2
    s_lshl_b32 s18, s18, 11
    s_and_b32 s19, s12, 1
    s_lshl_b32 s19, s19, 10
    s_add_u32 s18, s18, s19
    s_and_b32 s19, s12, 2
    s_lshl_b32 s19, s19, 6
    s_add_u32 s18, s18, s19
    s_add_u32 s18, s18, 12288
    v_lshrrev_b32 v12, 1, v15
    v_lshl_add_u32 v8, v12, 8, s18
    v_lshl_add_u32 v8, v14, 4, v8
    v_and_b32 v12, 1, v15
    v_lshl_add_u32 v8, v12, 3, v8
    v_mov_b32 v54, -1
    v_mov_b32 v55, -1
    s_mov_b32 s18, 75497472
    buffer_store_dwordx2 v[54:55], v8, s[8:11], s18 offen sc1
    s_mov_b32 s18, 75628544
    buffer_store_dwordx2 v[54:55], v8, s[8:11], s18 offen sc1
    s_mov_b32 s18, 75759616
    buffer_store_dwordx2 v[54:55], v8, s[8:11], s18 offen sc1
    s_mov_b32 s18, 75890688
    buffer_store_dwordx2 v[54:55], v8, s[8:11], s18 offen sc1
    v_lshlrev_b32 v5, 3, v1
    v_mov_b32 v10, 12
    v_mov_b32 v0, 0
    s_branch AJ_1
AJ_1:
    s_add_u32 m0, s54, 0
    s_add_u32 s55, s53, 0
    buffer_load_dwordx4 v241, s[44:47], s55 offen lds
    s_add_u32 m0, s54, 1024
    s_add_u32 s55, s53, 128
    buffer_load_dwordx4 v241, s[44:47], s55 offen lds
    s_add_u32 m0, s54, 2048
    s_add_u32 s55, s53, 256
    buffer_load_dwordx4 v241, s[44:47], s55 offen lds
    s_add_u32 m0, s54, 3072
    s_add_u32 s55, s53, 384
    buffer_load_dwordx4 v241, s[44:47], s55 offen lds
    s_add_u32 m0, s54, 4096
    s_add_u32 s55, s53, 512
    buffer_load_dwordx4 v241, s[44:47], s55 offen lds
    s_add_u32 m0, s54, 5120
    s_add_u32 s55, s53, 640
    buffer_load_dwordx4 v241, s[44:47], s55 offen lds
    s_add_u32 m0, s54, 6144
    s_add_u32 s55, s53, 768
    buffer_load_dwordx4 v241, s[44:47], s55 offen lds
    s_add_u32 m0, s54, 7168
    s_add_u32 s55, s53, 7168
    buffer_load_dwordx4 v241, s[44:47], s55 offen lds
    s_add_u32 m0, s54, 8192
    s_add_u32 s55, s53, 7296
    buffer_load_dwordx4 v241, s[44:47], s55 offen lds
    s_add_u32 m0, s54, 9216
    s_add_u32 s55, s53, 7424
    buffer_load_dwordx4 v241, s[44:47], s55 offen lds
    s_add_u32 m0, s54, 10240
    s_add_u32 s55, s53, 7552
    buffer_load_dwordx4 v241, s[44:47], s55 offen lds
    s_add_u32 m0, s54, 11264
    s_add_u32 s55, s53, 7680
    buffer_load_dwordx4 v241, s[44:47], s55 offen lds
    s_add_u32 m0, s54, 12288
    s_add_u32 s55, s53, 7808
    buffer_load_dwordx4 v241, s[44:47], s55 offen lds
    s_add_u32 m0, s54, 13312
    s_add_u32 s55, s53, 7936
    buffer_load_dwordx4 v241, s[44:47], s55 offen lds
    buffer_load_dwordx4 v[176:179], v242, s[48:51], 0 offen offset:0
    buffer_load_dwordx4 v[180:183], v242, s[48:51], 0 offen offset:64
    buffer_load_dwordx4 v[184:187], v242, s[48:51], 0 offen offset:128
    buffer_load_dwordx4 v[188:191], v242, s[48:51], 0 offen offset:192
    buffer_load_dwordx4 v[192:195], v242, s[48:51], 0 offen offset:256
    buffer_load_dwordx4 v[196:199], v242, s[48:51], 0 offen offset:320
    buffer_load_dwordx4 v[200:203], v242, s[48:51], 0 offen offset:384
    buffer_load_dwordx4 v[204:207], v242, s[48:51], 0 offen offset:448
    buffer_load_dwordx4 v[208:211], v242, s[48:51], 0 offen offset:512
    buffer_load_dwordx4 v[212:215], v242, s[48:51], 0 offen offset:576
    buffer_load_dwordx4 v[216:219], v242, s[48:51], 0 offen offset:640
    buffer_load_dwordx4 v[220:223], v242, s[48:51], 0 offen offset:704
    buffer_load_dwordx4 v[224:227], v242, s[48:51], 0 offen offset:768
    buffer_load_dwordx4 v[228:231], v242, s[48:51], 0 offen offset:832
    s_add_u32 m0, s54, 14336
    s_add_u32 s55, s53, 917504
    buffer_load_dwordx4 v241, s[44:47], s55 offen lds
    s_add_u32 m0, s54, 15360
    s_add_u32 s55, s53, 917632
    buffer_load_dwordx4 v241, s[44:47], s55 offen lds
    s_add_u32 m0, s54, 16384
    s_add_u32 s55, s53, 917760
    buffer_load_dwordx4 v241, s[44:47], s55 offen lds
    s_add_u32 m0, s54, 17408
    s_add_u32 s55, s53, 917888
    buffer_load_dwordx4 v241, s[44:47], s55 offen lds
    s_add_u32 m0, s54, 18432
    s_add_u32 s55, s53, 918016
    buffer_load_dwordx4 v241, s[44:47], s55 offen lds
    s_add_u32 m0, s54, 19456
    s_add_u32 s55, s53, 918144
    buffer_load_dwordx4 v241, s[44:47], s55 offen lds
    s_add_u32 m0, s54, 20480
    s_add_u32 s55, s53, 918272
    buffer_load_dwordx4 v241, s[44:47], s55 offen lds
    s_add_u32 m0, s54, 21504
    s_add_u32 s55, s53, 924672
    buffer_load_dwordx4 v241, s[44:47], s55 offen lds
    s_add_u32 m0, s54, 22528
    s_add_u32 s55, s53, 924800
    buffer_load_dwordx4 v241, s[44:47], s55 offen lds
    s_add_u32 m0, s54, 23552
    s_add_u32 s55, s53, 924928
    buffer_load_dwordx4 v241, s[44:47], s55 offen lds
    s_add_u32 m0, s54, 24576
    s_add_u32 s55, s53, 925056
    buffer_load_dwordx4 v241, s[44:47], s55 offen lds
    s_add_u32 m0, s54, 25600
    s_add_u32 s55, s53, 925184
    buffer_load_dwordx4 v241, s[44:47], s55 offen lds
    s_add_u32 m0, s54, 26624
    s_add_u32 s55, s53, 925312
    buffer_load_dwordx4 v241, s[44:47], s55 offen lds
    s_add_u32 m0, s54, 27648
    s_add_u32 s55, s53, 925440
    buffer_load_dwordx4 v241, s[44:47], s55 offen lds
    s_waitcnt vmcnt(42) lgkmcnt(0)
    s_barrier
    v_mov_b32 v13, s41
    v_mov_b32 v15, 0
    s_cmp_lg_u32 s13, 0
    s_cbranch_scc1 TB0_6
    s_mov_b64 exec, 1
    global_atomic_add v15, v13, s[4:5] sc1
    s_mov_b64 exec, -1
TB0_6:
    s_mov_b32 s56, 3216550459
    s_waitcnt vmcnt(14)
    ds_read_b128 v[120:123], v244 offset:0
    ds_read_b128 v[124:127], v245 offset:0
    ds_read_b128 v[128:131], v244 offset:1024
    ds_read_b128 v[132:135], v245 offset:1024
    ds_read_b128 v[136:139], v244 offset:2048
    ds_read_b128 v[140:143], v245 offset:2048
    ds_read_b128 v[144:147], v244 offset:3072
    ds_read_b128 v[148:151], v245 offset:3072
    ds_read_b128 v[152:155], v244 offset:4096
    ds_read_b128 v[156:159], v245 offset:4096
    ds_read_b128 v[160:163], v244 offset:5120
    ds_read_b128 v[164:167], v245 offset:5120
    ds_read_b128 v[168:171], v244 offset:6144
    ds_read_b128 v[172:175], v245 offset:6144
    s_add_u32 s55, s53, 83886080
    s_waitcnt lgkmcnt(13)
    buffer_store_dwordx4 v[120:123], v240, s[8:11], s55 offen offset:0 sc1
    v_mfma_f32_16x16x32_bf16 v[248:251], v[176:179], v[120:123], 0
    s_waitcnt lgkmcnt(12)
    buffer_store_dwordx4 v[124:127], v240, s[8:11], s55 offen offset:1024 sc1
    v_mfma_f32_16x16x32_bf16 v[248:251], v[180:183], v[124:127], v[248:251]
    s_waitcnt lgkmcnt(11)
    buffer_store_dwordx4 v[128:131], v240, s[8:11], s55 offen offset:2048 sc1
    v_mfma_f32_16x16x32_bf16 v[248:251], v[184:187], v[128:131], v[248:251]
    s_waitcnt lgkmcnt(10)
    buffer_store_dwordx4 v[132:135], v240, s[8:11], s55 offen offset:3072 sc1
    v_mfma_f32_16x16x32_bf16 v[248:251], v[188:191], v[132:135], v[248:251]
    s_add_u32 s55, s55, 4096
    s_waitcnt lgkmcnt(9)
    buffer_store_dwordx4 v[136:139], v240, s[8:11], s55 offen offset:0 sc1
    v_mfma_f32_16x16x32_bf16 v[248:251], v[192:195], v[136:139], v[248:251]
    s_waitcnt lgkmcnt(8)
    buffer_store_dwordx4 v[140:143], v240, s[8:11], s55 offen offset:1024 sc1
    v_mfma_f32_16x16x32_bf16 v[248:251], v[196:199], v[140:143], v[248:251]
    s_waitcnt lgkmcnt(7)
    buffer_store_dwordx4 v[144:147], v240, s[8:11], s55 offen offset:2048 sc1
    v_mfma_f32_16x16x32_bf16 v[248:251], v[200:203], v[144:147], v[248:251]
    s_waitcnt lgkmcnt(6)
    buffer_store_dwordx4 v[148:151], v240, s[8:11], s55 offen offset:3072 sc1
    v_mfma_f32_16x16x32_bf16 v[248:251], v[204:207], v[148:151], v[248:251]
    s_add_u32 s55, s55, 4096
    s_waitcnt lgkmcnt(5)
    buffer_store_dwordx4 v[152:155], v240, s[8:11], s55 offen offset:0 sc1
    v_mfma_f32_16x16x32_bf16 v[248:251], v[208:211], v[152:155], v[248:251]
    s_waitcnt lgkmcnt(4)
    buffer_store_dwordx4 v[156:159], v240, s[8:11], s55 offen offset:1024 sc1
    v_mfma_f32_16x16x32_bf16 v[248:251], v[212:215], v[156:159], v[248:251]
    s_waitcnt lgkmcnt(3)
    buffer_store_dwordx4 v[160:163], v240, s[8:11], s55 offen offset:2048 sc1
    v_mfma_f32_16x16x32_bf16 v[248:251], v[216:219], v[160:163], v[248:251]
    s_waitcnt lgkmcnt(2)
    buffer_store_dwordx4 v[164:167], v240, s[8:11], s55 offen offset:3072 sc1
    v_mfma_f32_16x16x32_bf16 v[248:251], v[220:223], v[164:167], v[248:251]
    s_add_u32 s55, s55, 4096
    s_waitcnt lgkmcnt(1)
    buffer_store_dwordx4 v[168:171], v240, s[8:11], s55 offen offset:0 sc1
    v_mfma_f32_16x16x32_bf16 v[248:251], v[224:227], v[168:171], v[248:251]
    s_waitcnt lgkmcnt(0)
    buffer_store_dwordx4 v[172:175], v240, s[8:11], s55 offen offset:1024 sc1
    v_mfma_f32_16x16x32_bf16 v[248:251], v[228:231], v[172:175], v[248:251]
    s_nop 7
    v_mul_f32 v252, s56, v248
    v_exp_f32 v252, v252
    s_nop 0
    v_add_f32 v252, 1.0, v252
    v_rcp_f32 v252, v252
    s_lshl_b32 s55, s52, 6
    s_add_u32 s55, s55, 92274688
    s_mov_b64 exec, 0xffff
    buffer_store_dword v252, v246, s[8:11], s55 offen sc1
    s_mov_b64 exec, -1
    s_waitcnt vmcnt(15)
    ds_read_b128 a[0:3], v244 offset:14336
    ds_read_b128 a[4:7], v245 offset:14336
    ds_read_b128 a[8:11], v244 offset:15360
    ds_read_b128 a[12:15], v245 offset:15360
    ds_read_b128 a[16:19], v244 offset:16384
    ds_read_b128 a[20:23], v245 offset:16384
    ds_read_b128 a[24:27], v244 offset:17408
    ds_read_b128 a[28:31], v245 offset:17408
    ds_read_b128 a[32:35], v244 offset:18432
    ds_read_b128 a[36:39], v245 offset:18432
    ds_read_b128 a[40:43], v244 offset:19456
    ds_read_b128 a[44:47], v245 offset:19456
    ds_read_b128 a[48:51], v244 offset:20480
    ds_read_b128 a[52:55], v245 offset:20480
    s_add_u32 s55, s53, 84803584
    s_waitcnt lgkmcnt(13)
    buffer_store_dwordx4 a[0:3], v240, s[8:11], s55 offen offset:0 sc1
    v_mfma_f32_16x16x32_bf16 v[248:251], v[176:179], a[0:3], 0
    s_waitcnt lgkmcnt(12)
    buffer_store_dwordx4 a[4:7], v240, s[8:11], s55 offen offset:1024 sc1
    v_mfma_f32_16x16x32_bf16 v[248:251], v[180:183], a[4:7], v[248:251]
    s_waitcnt lgkmcnt(11)
    buffer_store_dwordx4 a[8:11], v240, s[8:11], s55 offen offset:2048 sc1
    v_mfma_f32_16x16x32_bf16 v[248:251], v[184:187], a[8:11], v[248:251]
    s_waitcnt lgkmcnt(10)
    buffer_store_dwordx4 a[12:15], v240, s[8:11], s55 offen offset:3072 sc1
    v_mfma_f32_16x16x32_bf16 v[248:251], v[188:191], a[12:15], v[248:251]
    s_add_u32 s55, s55, 4096
    s_waitcnt lgkmcnt(9)
    buffer_store_dwordx4 a[16:19], v240, s[8:11], s55 offen offset:0 sc1
    v_mfma_f32_16x16x32_bf16 v[248:251], v[192:195], a[16:19], v[248:251]
    s_waitcnt lgkmcnt(8)
    buffer_store_dwordx4 a[20:23], v240, s[8:11], s55 offen offset:1024 sc1
    v_mfma_f32_16x16x32_bf16 v[248:251], v[196:199], a[20:23], v[248:251]
    s_waitcnt lgkmcnt(7)
    buffer_store_dwordx4 a[24:27], v240, s[8:11], s55 offen offset:2048 sc1
    v_mfma_f32_16x16x32_bf16 v[248:251], v[200:203], a[24:27], v[248:251]
    s_waitcnt lgkmcnt(6)
    buffer_store_dwordx4 a[28:31], v240, s[8:11], s55 offen offset:3072 sc1
    v_mfma_f32_16x16x32_bf16 v[248:251], v[204:207], a[28:31], v[248:251]
    s_add_u32 s55, s55, 4096
    s_waitcnt lgkmcnt(5)
    buffer_store_dwordx4 a[32:35], v240, s[8:11], s55 offen offset:0 sc1
    v_mfma_f32_16x16x32_bf16 v[248:251], v[208:211], a[32:35], v[248:251]
    s_waitcnt lgkmcnt(4)
    buffer_store_dwordx4 a[36:39], v240, s[8:11], s55 offen offset:1024 sc1
    v_mfma_f32_16x16x32_bf16 v[248:251], v[212:215], a[36:39], v[248:251]
    s_waitcnt lgkmcnt(3)
    buffer_store_dwordx4 a[40:43], v240, s[8:11], s55 offen offset:2048 sc1
    v_mfma_f32_16x16x32_bf16 v[248:251], v[216:219], a[40:43], v[248:251]
    s_waitcnt lgkmcnt(2)
    buffer_store_dwordx4 a[44:47], v240, s[8:11], s55 offen offset:3072 sc1
    v_mfma_f32_16x16x32_bf16 v[248:251], v[220:223], a[44:47], v[248:251]
    s_add_u32 s55, s55, 4096
    s_waitcnt lgkmcnt(1)
    buffer_store_dwordx4 a[48:51], v240, s[8:11], s55 offen offset:0 sc1
    v_mfma_f32_16x16x32_bf16 v[248:251], v[224:227], a[48:51], v[248:251]
    s_waitcnt lgkmcnt(0)
    buffer_store_dwordx4 a[52:55], v240, s[8:11], s55 offen offset:1024 sc1
    v_mfma_f32_16x16x32_bf16 v[248:251], v[228:231], a[52:55], v[248:251]
    s_nop 7
    v_mul_f32 v253, s56, v248
    v_exp_f32 v253, v253
    s_nop 0
    v_add_f32 v253, 1.0, v253
    v_rcp_f32 v253, v253
    s_lshl_b32 s55, s52, 6
    s_add_u32 s55, s55, 92278784
    s_mov_b64 exec, 0xffff
    buffer_store_dword v253, v246, s[8:11], s55 offen sc1
    s_mov_b64 exec, -1
    v_mov_b64 v[232:233], -1
    v_mov_b64 v[234:235], -1
    s_mul_i32 s55, s52, 7168
    s_add_u32 s55, s55, 76546048
    buffer_store_dwordx4 v[232:235], v240, s[8:11], s55 offen offset:0 sc1
    buffer_store_dwordx4 v[232:235], v240, s[8:11], s55 offen offset:1024 sc1
    buffer_store_dwordx4 v[232:235], v240, s[8:11], s55 offen offset:2048 sc1
    buffer_store_dwordx4 v[232:235], v240, s[8:11], s55 offen offset:3072 sc1
    s_add_u32 s55, s55, 4096
    buffer_store_dwordx4 v[232:235], v240, s[8:11], s55 offen offset:0 sc1
    buffer_store_dwordx4 v[232:235], v240, s[8:11], s55 offen offset:1024 sc1
    buffer_store_dwordx4 v[232:235], v240, s[8:11], s55 offen offset:2048 sc1
    s_waitcnt vmcnt(0) lgkmcnt(0)
    s_barrier
    v_mov_b32 v12, 7200
    s_cmp_lg_u32 s13, 0
    s_cbranch_scc1 TBS_8
    v_mov_b32 v13, 1
    v_mov_b32 v15, 0
    s_mov_b64 exec, 1
    global_atomic_add v15, v13, s[4:5] offset:128 sc1
TBW_7:
    global_load_dword v14, v15, s[4:5] sc1
    s_add_u32 s22, s22, 1
    s_cmp_gt_u32 s22, 2000000
    s_cbranch_scc1 MEGA_EXIT
    s_sleep 2
    s_waitcnt vmcnt(0)
    v_and_b32 v13, 0x3f, v14
    v_cmp_gt_u32 vcc, 32, v13
    s_cbranch_vccnz TBW_7
    v_bfe_u32 v13, v14, 6, 10
    v_mul_u32_u24 v13, v13, v13
    v_lshrrev_b32 v14, 16, v14
    v_lshlrev_b32 v14, 5, v14
    v_sub_u32 v14, v14, v13
    ds_write_b32 v12, v14
    s_waitcnt lgkmcnt(0)
    s_mov_b64 exec, -1
TBS_8:
    s_barrier
    ds_read_b32 v13, v12
    s_waitcnt lgkmcnt(0)
    v_readfirstlane_b32 s40, v13
    v_and_b32 v20, 0x1f0, v2
    v_bfe_u32 v21, v2, 9, 1
    v_lshl_add_u32 v20, v21, 3, v20
    s_lshl_b32 s21, s12, 10
    s_and_b32 s18, s13, 1
    s_lshl_b32 s18, s18, 9
    s_add_u32 s21, s21, s18
    s_lshr_b32 s18, s13, 1
    s_lshl_b32 s18, s18, 14
    s_sub_u32 s21, s21, s18
    s_add_u32 s21, s21, 106414080
    v_mov_b64 v[22:23], -1
    buffer_store_dwordx2 v[22:23], v20, s[8:11], s21 offen sc1
    s_waitcnt vmcnt(0)
    s_barrier
    s_cmp_lg_u32 s13, 1
    s_cbranch_scc1 ARM_9
    s_lshl_b32 s18, s12, 2
    s_add_u32 s18, s18, 116436736
    v_mov_b32 v22, 1
    v_mov_b32 v23, 1
    v_mov_b32 v24, 1
    s_mov_b64 exec, 1
    buffer_store_dword v22, off, s[8:11], s18 sc1
    s_mov_b64 exec, -1
ARM_9:
    s_cmp_lg_u32 s13, 0
    s_cbranch_scc1 WFZ_11
    s_mov_b32 s35, 0
    s_lshl_b32 s30, s12, 8
    s_add_u32 s30, s30, 116449280
    v_lshrrev_b32 v16, 2, v2
    v_min_u32 v16, 220, v16
    s_branch WF0_12
WF_10:
    s_sleep 4
WF0_12:
    buffer_load_dword v18, v16, s[8:11], s30 offen sc1
    s_add_u32 s35, s35, 1
    s_cmp_gt_u32 s35, 4000000
    s_cbranch_scc1 MEGA_EXIT
    s_waitcnt vmcnt(0)
    v_cmp_eq_u32 vcc, 0, v18
    s_cbranch_vccnz WF_10
WFZ_11:
    s_barrier
    s_mul_i32 s18, s12, 401408
    s_mul_i32 s19, s13, 14336
    s_add_u32 s18, s18, s19
    s_add_u32 s18, s18, 0
    buffer_load_dwordx4 v[120:123], v2, s[8:11], s18 offen offset:0 sc1
    buffer_load_dwordx4 v[124:127], v2, s[8:11], s18 offen offset:1024 sc1
    buffer_load_dwordx4 v[128:131], v2, s[8:11], s18 offen offset:2048 sc1
    buffer_load_dwordx4 v[132:135], v2, s[8:11], s18 offen offset:3072 sc1
    s_add_u32 s18, s18, 4096
    buffer_load_dwordx4 v[136:139], v2, s[8:11], s18 offen offset:0 sc1
    buffer_load_dwordx4 v[140:143], v2, s[8:11], s18 offen offset:1024 sc1
    buffer_load_dwordx4 v[144:147], v2, s[8:11], s18 offen offset:2048 sc1
    buffer_load_dwordx4 v[148:151], v2, s[8:11], s18 offen offset:3072 sc1
    s_add_u32 s18, s18, 4096
    buffer_load_dwordx4 v[152:155], v2, s[8:11], s18 offen offset:0 sc1
    buffer_load_dwordx4 v[156:159], v2, s[8:11], s18 offen offset:1024 sc1
    buffer_load_dwordx4 v[160:163], v2, s[8:11], s18 offen offset:2048 sc1
    buffer_load_dwordx4 v[164:167], v2, s[8:11], s18 offen offset:3072 sc1
    s_add_u32 s18, s18, 4096
    buffer_load_dwordx4 v[168:171], v2, s[8:11], s18 offen offset:0 sc1
    buffer_load_dwordx4 v[172:175], v2, s[8:11], s18 offen offset:1024 sc1
    s_mul_i32 s18, s12, 401408
    s_mul_i32 s19, s13, 14336
    s_add_u32 s18, s18, s19
    s_add_u32 s18, s18, 57344
    buffer_load_dwordx4 v[176:179], v2, s[8:11], s18 offen offset:0 sc1
    buffer_load_dwordx4 v[180:183], v2, s[8:11], s18 offen offset:1024 sc1
    buffer_load_dwordx4 v[184:187], v2, s[8:11], s18 offen offset:2048 sc1
    buffer_load_dwordx4 v[188:191], v2, s[8:11], s18 offen offset:3072 sc1
    s_add_u32 s18, s18, 4096
    buffer_load_dwordx4 v[192:195], v2, s[8:11], s18 offen offset:0 sc1
    buffer_load_dwordx4 v[196:199], v2, s[8:11], s18 offen offset:1024 sc1
    buffer_load_dwordx4 v[200:203], v2, s[8:11], s18 offen offset:2048 sc1
    buffer_load_dwordx4 v[204:207], v2, s[8:11], s18 offen offset:3072 sc1
    s_add_u32 s18, s18, 4096
    buffer_load_dwordx4 v[208:211], v2, s[8:11], s18 offen offset:0 sc1
    buffer_load_dwordx4 v[212:215], v2, s[8:11], s18 offen offset:1024 sc1
    buffer_load_dwordx4 v[216:219], v2, s[8:11], s18 offen offset:2048 sc1
    buffer_load_dwordx4 v[220:223], v2, s[8:11], s18 offen offset:3072 sc1
    s_add_u32 s18, s18, 4096
    buffer_load_dwordx4 v[224:227], v2, s[8:11], s18 offen offset:0 sc1
    buffer_load_dwordx4 v[228:231], v2, s[8:11], s18 offen offset:1024 sc1
    s_mul_i32 s18, s12, 401408
    s_mul_i32 s19, s13, 14336
    s_add_u32 s18, s18, s19
    s_add_u32 s18, s18, 114688
    buffer_load_dwordx4 v[232:235], v2, s[8:11], s18 offen offset:0 sc1
    buffer_load_dwordx4 v[236:239], v2, s[8:11], s18 offen offset:1024 sc1
    buffer_load_dwordx4 v[240:243], v2, s[8:11], s18 offen offset:2048 sc1
    buffer_load_dwordx4 v[244:247], v2, s[8:11], s18 offen offset:3072 sc1
    s_add_u32 s18, s18, 4096
    buffer_load_dwordx4 v[248:251], v2, s[8:11], s18 offen offset:0 sc1
    buffer_load_dwordx4 v[252:255], v2, s[8:11], s18 offen offset:1024 sc1
    buffer_load_dwordx4 a[0:3], v2, s[8:11], s18 offen offset:2048 sc1
    buffer_load_dwordx4 a[4:7], v2, s[8:11], s18 offen offset:3072 sc1
    s_add_u32 s18, s18, 4096
    buffer_load_dwordx4 a[8:11], v2, s[8:11], s18 offen offset:0 sc1
    buffer_load_dwordx4 a[12:15], v2, s[8:11], s18 offen offset:1024 sc1
    buffer_load_dwordx4 a[16:19], v2, s[8:11], s18 offen offset:2048 sc1
    buffer_load_dwordx4 a[20:23], v2, s[8:11], s18 offen offset:3072 sc1
    s_add_u32 s18, s18, 4096
    buffer_load_dwordx4 a[24:27], v2, s[8:11], s18 offen offset:0 sc1
    buffer_load_dwordx4 a[28:31], v2, s[8:11], s18 offen offset:1024 sc1
    s_mul_i32 s18, s12, 401408
    s_mul_i32 s19, s13, 14336
    s_add_u32 s18, s18, s19
    s_add_u32 s18, s18, 172032
    buffer_load_dwordx4 a[32:35], v2, s[8:11], s18 offen offset:0 sc1
    buffer_load_dwordx4 a[36:39], v2, s[8:11], s18 offen offset:1024 sc1
    buffer_load_dwordx4 a[40:43], v2, s[8:11], s18 offen offset:2048 sc1
    buffer_load_dwordx4 a[44:47], v2, s[8:11], s18 offen offset:3072 sc1
    s_add_u32 s18, s18, 4096
    buffer_load_dwordx4 a[48:51], v2, s[8:11], s18 offen offset:0 sc1
    buffer_load_dwordx4 a[52:55], v2, s[8:11], s18 offen offset:1024 sc1
    buffer_load_dwordx4 a[56:59], v2, s[8:11], s18 offen offset:2048 sc1
    buffer_load_dwordx4 a[60:63], v2, s[8:11], s18 offen offset:3072 sc1
    s_add_u32 s18, s18, 4096
    buffer_load_dwordx4 a[64:67], v2, s[8:11], s18 offen offset:0 sc1
    buffer_load_dwordx4 a[68:71], v2, s[8:11], s18 offen offset:1024 sc1
    buffer_load_dwordx4 a[72:75], v2, s[8:11], s18 offen offset:2048 sc1
    buffer_load_dwordx4 a[76:79], v2, s[8:11], s18 offen offset:3072 sc1
    s_add_u32 s18, s18, 4096
    buffer_load_dwordx4 a[80:83], v2, s[8:11], s18 offen offset:0 sc1
    buffer_load_dwordx4 a[84:87], v2, s[8:11], s18 offen offset:1024 sc1
    s_mul_i32 s18, s12, 401408
    s_mul_i32 s19, s13, 14336
    s_add_u32 s18, s18, s19
    s_add_u32 s18, s18, 229376
    buffer_load_dwordx4 a[88:91], v2, s[8:11], s18 offen offset:0 sc1
    buffer_load_dwordx4 a[92:95], v2, s[8:11], s18 offen offset:1024 sc1
    buffer_load_dwordx4 a[96:99], v2, s[8:11], s18 offen offset:2048 sc1
    buffer_load_dwordx4 a[100:103], v2, s[8:11], s18 offen offset:3072 sc1
    s_add_u32 s18, s18, 4096
    buffer_load_dwordx4 a[104:107], v2, s[8:11], s18 offen offset:0 sc1
    buffer_load_dwordx4 a[108:111], v2, s[8:11], s18 offen offset:1024 sc1
    buffer_load_dwordx4 a[112:115], v2, s[8:11], s18 offen offset:2048 sc1
    buffer_load_dwordx4 a[116:119], v2, s[8:11], s18 offen offset:3072 sc1
    s_add_u32 s18, s18, 4096
    buffer_load_dwordx4 a[120:123], v2, s[8:11], s18 offen offset:0 sc1
    buffer_load_dwordx4 a[124:127], v2, s[8:11], s18 offen offset:1024 sc1
    buffer_load_dwordx4 a[128:131], v2, s[8:11], s18 offen offset:2048 sc1
    buffer_load_dwordx4 a[132:135], v2, s[8:11], s18 offen offset:3072 sc1
    s_add_u32 s18, s18, 4096
    buffer_load_dwordx4 a[136:139], v2, s[8:11], s18 offen offset:0 sc1
    buffer_load_dwordx4 a[140:143], v2, s[8:11], s18 offen offset:1024 sc1
    s_mov_b32 s18, 116394240
    buffer_load_dword v12, off, s[8:11], s18 sc1
    s_mul_i32 s18, s12, 401408
    s_mul_i32 s19, s13, 14336
    s_add_u32 s18, s18, s19
    s_add_u32 s18, s18, 286720
    buffer_load_dwordx4 a[144:147], v2, s[8:11], s18 offen offset:0 sc1
    buffer_load_dwordx4 a[148:151], v2, s[8:11], s18 offen offset:1024 sc1
    buffer_load_dwordx4 a[152:155], v2, s[8:11], s18 offen offset:2048 sc1
    buffer_load_dwordx4 a[156:159], v2, s[8:11], s18 offen offset:3072 sc1
    s_add_u32 s18, s18, 4096
    buffer_load_dwordx4 a[160:163], v2, s[8:11], s18 offen offset:0 sc1
    buffer_load_dwordx4 a[164:167], v2, s[8:11], s18 offen offset:1024 sc1
    buffer_load_dwordx4 a[168:171], v2, s[8:11], s18 offen offset:2048 sc1
    buffer_load_dwordx4 a[172:175], v2, s[8:11], s18 offen offset:3072 sc1
    s_add_u32 s18, s18, 4096
    buffer_load_dwordx4 a[176:179], v2, s[8:11], s18 offen offset:0 sc1
    buffer_load_dwordx4 a[180:183], v2, s[8:11], s18 offen offset:1024 sc1
    buffer_load_dwordx4 a[184:187], v2, s[8:11], s18 offen offset:2048 sc1
    buffer_load_dwordx4 a[188:191], v2, s[8:11], s18 offen offset:3072 sc1
    s_add_u32 s18, s18, 4096
    buffer_load_dwordx4 a[192:195], v2, s[8:11], s18 offen offset:0 sc1
    buffer_load_dwordx4 a[196:199], v2, s[8:11], s18 offen offset:1024 sc1
    s_mul_i32 s18, s12, 401408
    s_mul_i32 s19, s13, 14336
    s_add_u32 s18, s18, s19
    s_add_u32 s18, s18, 344064
    buffer_load_dwordx4 a[200:203], v2, s[8:11], s18 offen offset:0 sc1
    buffer_load_dwordx4 a[204:207], v2, s[8:11], s18 offen offset:1024 sc1
    buffer_load_dwordx4 a[208:211], v2, s[8:11], s18 offen offset:2048 sc1
    buffer_load_dwordx4 a[212:215], v2, s[8:11], s18 offen offset:3072 sc1
    s_add_u32 s18, s18, 4096
    buffer_load_dwordx4 a[216:219], v2, s[8:11], s18 offen offset:0 sc1
    buffer_load_dwordx4 a[220:223], v2, s[8:11], s18 offen offset:1024 sc1
    buffer_load_dwordx4 a[224:227], v2, s[8:11], s18 offen offset:2048 sc1
    buffer_load_dwordx4 a[228:231], v2, s[8:11], s18 offen offset:3072 sc1
    s_add_u32 s18, s18, 4096
    buffer_load_dwordx4 a[232:235], v2, s[8:11], s18 offen offset:0 sc1
    buffer_load_dwordx4 a[236:239], v2, s[8:11], s18 offen offset:1024 sc1
    buffer_load_dwordx4 a[240:243], v2, s[8:11], s18 offen offset:2048 sc1
    buffer_load_dwordx4 a[244:247], v2, s[8:11], s18 offen offset:3072 sc1
    s_add_u32 s18, s18, 4096
    buffer_load_dwordx4 a[248:251], v2, s[8:11], s18 offen offset:0 sc1
    buffer_load_dwordx4 a[252:255], v2, s[8:11], s18 offen offset:1024 sc1
    s_waitcnt vmcnt(28)
    v_readfirstlane_b32 s26, v12
    s_mul_i32 s18, s12, 28672
    s_add_u32 s23, s18, 16777216
    s_cmp_eq_u32 s13, 1
    s_cbranch_scc1 DSP_14
    s_cmp_eq_u32 s13, 2
    s_cbranch_scc1 DSP_15
    s_cmp_eq_u32 s13, 3
    s_cbranch_scc1 DSP_16
DSP_13:
    s_cmp_lg_u32 s40, 0
    s_cbranch_scc1 SLOW_17
    s_mov_b32 s93, 46137344
    s_mov_b32 s94, 116394240
    s_mov_b32 s14, 0
    s_barrier
ALOOP_18:
    s_and_b32 s18, s14, 3
    s_lshl_b32 s18, s18, 17
    s_add_u32 s15, s18, 75497472
    s_xor_b32 s17, s15, 262144
    s_mov_b32 s31, s15
    v_add_u32 v0, 1, v0
    s_mov_b32 s22, 0
    buffer_store_dword v54, v8, s[8:11], s17 offen
    v_mov_b64 v[64:65], 0
    v_mov_b64 v[66:67], 0
    v_mov_b64 v[68:69], 0
    v_mov_b64 v[70:71], 0
    v_mov_b64 v[72:73], 0
    v_mov_b64 v[74:75], 0
    v_mov_b64 v[76:77], 0
    v_mov_b64 v[78:79], 0
    v_mov_b64 v[108:109], 0
    v_mov_b64 v[110:111], 0
    v_mov_b64 v[112:113], 0
    v_mov_b64 v[114:115], 0
    v_mov_b64 v[116:117], 0
    v_mov_b64 v[118:119], 0
    v_mov_b64 v[44:45], 0
    v_mov_b64 v[46:47], 0
    s_cmp_eq_u32 s14, 0
    s_cbranch_scc1 NSL_20
    s_sleep 14
NSL_20:
    buffer_load_dwordx4 v[16:19], v2, s[8:11], s31 offen offset:0 sc1
    buffer_load_dwordx4 v[20:23], v2, s[8:11], s31 offen offset:1024 sc1
    s_sleep 2
    s_waitcnt lgkmcnt(0)
PM_19:
    buffer_load_dwordx4 v[16:19], v2, s[8:11], s31 offen offset:0 sc1
    buffer_load_dwordx4 v[20:23], v2, s[8:11], s31 offen offset:1024 sc1
    s_add_u32 s22, s22, 1
    s_cmp_gt_u32 s22, 2000000
    s_cbranch_scc1 MEGA_EXIT
    s_waitcnt vmcnt(3)
    v_max3_u32 v12, v16, v17, v18
    v_max_u32 v12, v12, v19
    s_waitcnt vmcnt(2)
    v_max3_u32 v12, v12, v20, v21
    v_max3_u32 v12, v12, v22, v23
    v_cmp_eq_u32 vcc, -1, v12
    s_cbranch_vccnz PM_19
    v_smfmac_f32_16x16x64_bf16 v[64:67], v[16:19], v[120:127], v3
    ds_write_b128 v2, v[16:19] offset:0
    v_smfmac_f32_16x16x64_bf16 v[68:71], v[16:19], v[176:183], v3
    ds_write_b128 v2, v[20:23] offset:1024
    v_smfmac_f32_16x16x64_bf16 v[72:75], v[16:19], v[232:239], v3
    v_smfmac_f32_16x16x64_bf16 v[76:79], v[16:19], a[32:39], v3
    v_smfmac_f32_16x16x64_bf16 v[108:111], v[16:19], a[88:95], v3
    s_waitcnt lgkmcnt(0)
    s_barrier
    ds_read_b128 v[24:27], v2 offset:2048
    ds_read_b128 v[28:31], v2 offset:3072
    v_smfmac_f32_16x16x64_bf16 v[112:115], v[16:19], a[144:151], v3
    ds_read_b128 v[32:35], v2 offset:4096
    ds_read_b128 v[36:39], v2 offset:5120
    v_smfmac_f32_16x16x64_bf16 v[116:119], v[16:19], a[200:207], v3
    ds_read_b128 v[40:43], v2 offset:6144
    v_smfmac_f32_16x16x64_bf16 v[64:67], v[20:23], v[128:135], v3
    v_smfmac_f32_16x16x64_bf16 v[68:71], v[20:23], v[184:191], v3
    v_smfmac_f32_16x16x64_bf16 v[72:75], v[20:23], v[240:247], v3
    v_smfmac_f32_16x16x64_bf16 v[76:79], v[20:23], a[40:47], v3
    s_waitcnt lgkmcnt(0)
    v_smfmac_f32_16x16x64_bf16 v[64:67], v[24:27], v[136:143], v3
    v_smfmac_f32_16x16x64_bf16 v[64:67], v[28:31], v[144:151], v3
    v_smfmac_f32_16x16x64_bf16 v[64:67], v[32:35], v[152:159], v3
    v_smfmac_f32_16x16x64_bf16 v[64:67], v[36:39], v[160:167], v3
    v_smfmac_f32_16x16x64_bf16 v[64:67], v[40:43], v[168:175], v3
    v_smfmac_f32_16x16x64_bf16 v[68:71], v[24:27], v[192:199], v3
    v_smfmac_f32_16x16x64_bf16 v[68:71], v[28:31], v[200:207], v3
    v_smfmac_f32_16x16x64_bf16 v[68:71], v[32:35], v[208:215], v3
    v_cvt_pk_bf16_f32 v12, v64, v65
    v_smfmac_f32_16x16x64_bf16 v[68:71], v[36:39], v[216:223], v3
    v_cvt_pk_bf16_f32 v13, v66, v67
    v_smfmac_f32_16x16x64_bf16 v[68:71], v[40:43], v[224:231], v3
    ds_write_b64 v4, v[12:13] offset:8192
    v_smfmac_f32_16x16x64_bf16 v[72:75], v[24:27], v[248:255], v3
    v_smfmac_f32_16x16x64_bf16 v[72:75], v[28:31], a[0:7], v3
    ds_read_b128 v[60:63], v10 offset:24688
    ds_read2st64_b32 v[80:81], v1 offset0:0 offset1:2
    ds_read2st64_b32 v[82:83], v55 offset0:0 offset1:2
    v_smfmac_f32_16x16x64_bf16 v[72:75], v[32:35], a[8:15], v3
    ds_read2st64_b32 v[96:97], v1 offset0:4 offset1:6
    ds_read2st64_b32 v[98:99], v55 offset0:4 offset1:6
    v_cvt_pk_bf16_f32 v12, v68, v69
    v_smfmac_f32_16x16x64_bf16 v[72:75], v[36:39], a[16:23], v3
    v_cvt_pk_bf16_f32 v13, v70, v71
    v_smfmac_f32_16x16x64_bf16 v[72:75], v[40:43], a[24:31], v3
    ds_write_b64 v4, v[12:13] offset:10240
    v_smfmac_f32_16x16x64_bf16 v[76:79], v[24:27], a[48:55], v3
    s_waitcnt lgkmcnt(1)
    v_min3_u32 v7, v63, v61, v62
    v_cmp_lt_u32 vcc, v7, v0
    v_smfmac_f32_16x16x64_bf16 v[76:79], v[28:31], a[56:63], v3
    s_cbranch_vccnz SXS_21
SXB_22:
    v_add_f32 v96, v96, v80
    v_add_f32 v97, v97, v81
    v_add_f32 v98, v98, v82
    v_smfmac_f32_16x16x64_bf16 v[76:79], v[32:35], a[64:71], v3
    v_add_f32 v99, v99, v83
    v_max3_f32 v48, v96, v97, v98
    v_max_f32 v48, v48, v99
    v_smfmac_f32_16x16x64_bf16 v[76:79], v[36:39], a[72:79], v3
    s_nop 0
    v_max_f32_dpp v48, v48, v48 quad_perm:[1,0,3,2] row_mask:0xf bank_mask:0xf
    v_cvt_pk_bf16_f32 v12, v72, v73
    v_smfmac_f32_16x16x64_bf16 v[76:79], v[40:43], a[80:87], v3
    ds_read_b128 v[56:59], v10 offset:24576
    v_max_f32_dpp v48, v48, v48 quad_perm:[2,3,0,1] row_mask:0xf bank_mask:0xf
    v_cvt_pk_bf16_f32 v13, v74, v75
    v_smfmac_f32_16x16x64_bf16 v[108:111], v[20:23], a[96:103], v3
    ds_write_b64 v4, v[12:13] offset:12288
    ds_read_b64_tr_b16 v[64:65], v5 offset:8192
    v_max_f32_dpp v48, v48, v48 row_half_mirror row_mask:0xf bank_mask:0xf
    v_sub_f32 v96, v96, v48
    v_sub_f32 v97, v97, v48
    v_smfmac_f32_16x16x64_bf16 v[108:111], v[24:27], a[104:111], v3
    ds_read_b64_tr_b16 v[66:67], v6 offset:8192
    v_sub_f32 v98, v98, v48
    v_sub_f32 v99, v99, v48
    v_exp_f32 v96, v96
    v_smfmac_f32_16x16x64_bf16 v[108:111], v[28:31], a[112:119], v3
    ds_read_b64_tr_b16 v[68:69], v5 offset:9216
    v_exp_f32 v97, v97
    v_exp_f32 v98, v98
    v_exp_f32 v99, v99
    v_smfmac_f32_16x16x64_bf16 v[108:111], v[32:35], a[120:127], v3
    ds_read_b64_tr_b16 v[70:71], v6 offset:9216
    v_cvt_pk_bf16_f32 v104, v96, v97
    v_cvt_pk_bf16_f32 v105, v98, v99
    v_min_u32 v104, -2, v104
    v_smfmac_f32_16x16x64_bf16 v[108:111], v[36:39], a[128:135], v3
    s_waitcnt lgkmcnt(5)
    ds_read_b128 v[60:63], v10 offset:24592
    v_min_u32 v105, -2, v105
    v_cvt_pk_bf16_f32 v12, v76, v77
    v_min3_u32 v50, v57, v58, v59
    v_smfmac_f32_16x16x64_bf16 v[108:111], v[40:43], a[136:143], v3
    buffer_store_dwordx2 v[104:105], v9, s[8:11], s15 offen
    ds_read_b64_tr_b16 v[80:81], v5 offset:10240
    v_cvt_pk_bf16_f32 v13, v78, v79
    v_smfmac_f32_16x16x64_bf16 v[112:115], v[20:23], a[152:159], v3
    ds_write_b64 v4, v[12:13] offset:14336
    ds_read_b64_tr_b16 v[82:83], v6 offset:10240
    v_smfmac_f32_16x16x64_bf16 v[112:115], v[24:27], a[160:167], v3
    ds_read_b64_tr_b16 v[84:85], v5 offset:11264
    v_add_f32 v96, v96, v98
    v_smfmac_f32_16x16x64_bf16 v[112:115], v[28:31], a[168:175], v3
    ds_read_b64_tr_b16 v[86:87], v6 offset:11264
    v_cvt_pk_bf16_f32 v12, v108, v109
    v_smfmac_f32_16x16x64_bf16 v[112:115], v[32:35], a[176:183], v3
    s_waitcnt lgkmcnt(5)
    ds_read_b128 v[56:59], v10 offset:24608
    v_cvt_pk_bf16_f32 v13, v110, v111
    v_min3_u32 v51, v61, v62, v63
    v_smfmac_f32_16x16x64_bf16 v[112:115], v[36:39], a[184:191], v3
    ds_write_b64 v4, v[12:13] offset:16384
    ds_read_b64_tr_b16 v[88:89], v5 offset:12288
    v_add_f32 v49, v97, v99
    v_smfmac_f32_16x16x64_bf16 v[112:115], v[40:43], a[192:199], v3
    ds_read_b64_tr_b16 v[90:91], v6 offset:12288
    v_add_f32 v49, v49, v96
    v_smfmac_f32_16x16x64_bf16 v[116:119], v[20:23], a[208:215], v3
    ds_read_b64_tr_b16 v[92:93], v5 offset:13312
    v_smfmac_f32_16x16x64_bf16 v[116:119], v[24:27], a[216:223], v3
    ds_read_b64_tr_b16 v[94:95], v6 offset:13312
    ds_read_b128 v[60:63], v10 offset:24624
    v_smfmac_f32_16x16x64_bf16 v[116:119], v[28:31], a[224:231], v3
    s_waitcnt lgkmcnt(5)
    ds_read_b64_tr_b16 v[72:73], v5 offset:14336
    v_cvt_pk_bf16_f32 v12, v112, v113
    v_min3_u32 v52, v57, v58, v59
    v_smfmac_f32_16x16x64_bf16 v[116:119], v[32:35], a[232:239], v3
    ds_read_b64_tr_b16 v[74:75], v6 offset:14336
    v_cvt_pk_bf16_f32 v13, v114, v115
    v_smfmac_f32_16x16x64_bf16 v[116:119], v[36:39], a[240:247], v3
    ds_write_b64 v4, v[12:13] offset:18432
    ds_read_b64_tr_b16 v[76:77], v5 offset:15360
    v_smfmac_f32_16x16x64_bf16 v[116:119], v[40:43], a[248:255], v3
    ds_read_b64_tr_b16 v[78:79], v6 offset:15360
    s_waitcnt lgkmcnt(5)
    v_min3_u32 v53, v61, v62, v63
    ds_read_b128 v[56:59], v10 offset:24640
    ds_read_b64_tr_b16 v[96:97], v5 offset:16384
    v_min3_u32 v7, v50, v51, v52
    v_min_u32 v7, v7, v53
    v_smfmac_f32_16x16x64_bf16 v[44:47], v[16:19], v[64:71], v3
    ds_read_b64_tr_b16 v[98:99], v6 offset:16384
    ds_read_b64_tr_b16 v[100:101], v5 offset:17408
    v_cvt_pk_bf16_f32 v12, v116, v117
    v_smfmac_f32_16x16x64_bf16 v[44:47], v[20:23], v[80:87], v3
    ds_read_b64_tr_b16 v[102:103], v6 offset:17408
    v_cvt_pk_bf16_f32 v13, v118, v119
    v_smfmac_f32_16x16x64_bf16 v[44:47], v[24:27], v[88:95], v3
    ds_write_b64 v4, v[12:13] offset:20480
    s_waitcnt lgkmcnt(5)
    v_min3_u32 v7, v7, v57, v58
    v_smfmac_f32_16x16x64_bf16 v[44:47], v[28:31], v[72:79], v3
    v_min_u32 v7, v7, v59
    v_cmp_lt_u32 vcc, v7, v0
    s_barrier
    ds_read_b64_tr_b16 v[104:105], v5 offset:18432
    ds_read_b64_tr_b16 v[106:107], v6 offset:18432
    ds_read_b64_tr_b16 v[108:109], v5 offset:19456
    ds_read_b64_tr_b16 v[110:111], v6 offset:19456
    ds_read_b64_tr_b16 v[112:113], v5 offset:20480
    ds_read_b64_tr_b16 v[114:115], v6 offset:20480
    ds_read_b64_tr_b16 v[116:117], v5 offset:21504
    ds_read_b64_tr_b16 v[118:119], v6 offset:21504
    s_cbranch_vccnz SSL_23
    s_waitcnt lgkmcnt(9)
SBK_24:
    v_smfmac_f32_16x16x64_bf16 v[44:47], v[32:35], v[96:103], v3
    s_nop 0
    s_nop 0
    s_nop 0
    s_waitcnt lgkmcnt(4)
    v_smfmac_f32_16x16x64_bf16 v[44:47], v[36:39], v[104:111], v3
    s_waitcnt lgkmcnt(0)
    v_smfmac_f32_16x16x64_bf16 v[44:47], v[40:43], v[112:119], v3
    v_add_f32_dpp v49, v49, v49 quad_perm:[1,0,3,2] row_mask:0xf bank_mask:0xf
    s_nop 1
    v_add_f32_dpp v49, v49, v49 quad_perm:[2,3,0,1] row_mask:0xf bank_mask:0xf
    s_nop 1
    v_add_f32_dpp v49, v49, v49 row_half_mirror row_mask:0xf bank_mask:0xf
    s_nop 0
    v_permlane32_swap_b32 v44, v46
    v_permlane32_swap_b32 v45, v47
    v_add_f32 v44, v44, v46
    v_add_f32 v45, v45, v47
    s_nop 0
    v_add_f32_dpp v12, v44, v44 row_ror:8 row_mask:0xf bank_mask:0x3
    s_nop 1
    v_add_f32_dpp v12, v45, v45 row_ror:8 row_mask:0xf bank_mask:0xc
    v_max_f32 v13, v12, v48
    s_nop 1
    v_max_f32_dpp v13, v12, v13 quad_perm:[1,0,3,2] row_mask:0xf bank_mask:0xf
    s_nop 1
    v_max_f32_dpp v13, v13, v13 quad_perm:[2,3,0,1] row_mask:0xf bank_mask:0xf
    s_nop 1
    v_max_f32_dpp v13, v13, v13 row_half_mirror row_mask:0xf bank_mask:0xf
    v_sub_f32 v15, v12, v13
    v_sub_f32 v14, v48, v13
    v_exp_f32 v15, v15
    v_exp_f32 v14, v14
    s_nop 0
    v_mov_b32_dpp v52, v15 quad_perm:[1,0,3,2] row_mask:0xf bank_mask:0xf
    v_cndmask_b32 v50, 0, v14, s[38:39]
    v_add_f32 v13, v15, v52
    v_cndmask_b32 v51, 0, v14, s[42:43]
    v_cndmask_b32 v50, v50, v15, s[36:37]
    v_add_f32_dpp v13, v13, v13 quad_perm:[2,3,0,1] row_mask:0xf bank_mask:0xf
    v_cndmask_b32 v51, v51, v52, s[36:37]
    s_nop 0
    v_add_f32_dpp v13, v13, v13 row_half_mirror row_mask:0xf bank_mask:0xf
    v_fma_f32 v13, v49, v14, v13
    v_rcp_f32 v13, v13
    s_nop 0
    v_mul_f32 v50, v50, v13
    v_mul_f32 v51, v51, v13
    v_cvt_pk_bf16_f32 v50, v50, v51
    v_min_u32 v50, -2, v50
    buffer_store_dword v50, v8, s[8:11], s15 offen
    s_barrier
    s_add_u32 s14, s14, 1
    s_cmp_lt_u32 s14, 63
    s_cbranch_scc1 ALOOP_18
    s_branch A_LAST0
SXS_21:
    ds_read_b128 v[60:63], v10 offset:24688
    ds_read2st64_b32 v[80:81], v1 offset0:0 offset1:2
    ds_read2st64_b32 v[82:83], v55 offset0:0 offset1:2
    ds_read2st64_b32 v[96:97], v1 offset0:4 offset1:6
    ds_read2st64_b32 v[98:99], v55 offset0:4 offset1:6
    s_add_u32 s22, s22, 1
    s_cmp_gt_u32 s22, 2000000
    s_cbranch_scc1 MEGA_EXIT
    s_waitcnt lgkmcnt(0)
    v_min3_u32 v7, v63, v61, v62
    v_cmp_lt_u32 vcc, v7, v0
    s_cbranch_vccnz SXS_21
    s_branch SXB_22
SSL_23:
    ds_read_b64_tr_b16 v[64:65], v5 offset:8192
    ds_read_b64_tr_b16 v[66:67], v6 offset:8192
    ds_read_b64_tr_b16 v[68:69], v5 offset:9216
    ds_read_b64_tr_b16 v[70:71], v6 offset:9216
    ds_read_b64_tr_b16 v[80:81], v5 offset:10240
    ds_read_b64_tr_b16 v[82:83], v6 offset:10240
    ds_read_b64_tr_b16 v[84:85], v5 offset:11264
    ds_read_b64_tr_b16 v[86:87], v6 offset:11264
    ds_read_b64_tr_b16 v[88:89], v5 offset:12288
    ds_read_b64_tr_b16 v[90:91], v6 offset:12288
    ds_read_b64_tr_b16 v[92:93], v5 offset:13312
    ds_read_b64_tr_b16 v[94:95], v6 offset:13312
    ds_read_b64_tr_b16 v[72:73], v5 offset:14336
    ds_read_b64_tr_b16 v[74:75], v6 offset:14336
    ds_read_b64_tr_b16 v[76:77], v5 offset:15360
    ds_read_b64_tr_b16 v[78:79], v6 offset:15360
    ds_read_b64_tr_b16 v[96:97], v5 offset:16384
    ds_read_b64_tr_b16 v[98:99], v6 offset:16384
    ds_read_b64_tr_b16 v[100:101], v5 offset:17408
    ds_read_b64_tr_b16 v[102:103], v6 offset:17408
    v_mov_b64 v[44:45], 0
    v_mov_b64 v[46:47], 0
    s_waitcnt lgkmcnt(0)
    s_nop 0
    v_smfmac_f32_16x16x64_bf16 v[44:47], v[16:19], v[64:71], v3
    v_smfmac_f32_16x16x64_bf16 v[44:47], v[20:23], v[80:87], v3
    v_smfmac_f32_16x16x64_bf16 v[44:47], v[24:27], v[88:95], v3
    v_smfmac_f32_16x16x64_bf16 v[44:47], v[28:31], v[72:79], v3
    s_branch SBK_24
SLOW_17:
    s_mov_b32 s93, 46137344
    s_mov_b32 s94, 116394240
    s_mov_b32 s14, 0
    s_barrier
ALOOP_25:
    s_and_b32 s18, s14, 3
    s_lshl_b32 s18, s18, 17
    s_add_u32 s15, s18, 75497472
    s_xor_b32 s17, s15, 262144
    s_mov_b32 s31, s15
    v_add_u32 v0, 1, v0
    s_mov_b32 s22, 0
    buffer_store_dword v54, v8, s[8:11], s17 offen sc1
    v_mov_b64 v[64:65], 0
    v_mov_b64 v[66:67], 0
    v_mov_b64 v[68:69], 0
    v_mov_b64 v[70:71], 0
    v_mov_b64 v[72:73], 0
    v_mov_b64 v[74:75], 0
    v_mov_b64 v[76:77], 0
    v_mov_b64 v[78:79], 0
    v_mov_b64 v[108:109], 0
    v_mov_b64 v[110:111], 0
    v_mov_b64 v[112:113], 0
    v_mov_b64 v[114:115], 0
    v_mov_b64 v[116:117], 0
    v_mov_b64 v[118:119], 0
    v_mov_b64 v[44:45], 0
    v_mov_b64 v[46:47], 0
    s_cmp_eq_u32 s14, 0
    s_cbranch_scc1 NSL_27
    s_sleep 14
NSL_27:
    buffer_load_dwordx4 v[16:19], v2, s[8:11], s31 offen offset:0 sc1
    buffer_load_dwordx4 v[20:23], v2, s[8:11], s31 offen offset:1024 sc1
    s_sleep 2
    s_waitcnt lgkmcnt(0)
PM_26:
    buffer_load_dwordx4 v[16:19], v2, s[8:11], s31 offen offset:0 sc1
    buffer_load_dwordx4 v[20:23], v2, s[8:11], s31 offen offset:1024 sc1
    s_add_u32 s22, s22, 1
    s_cmp_gt_u32 s22, 2000000
    s_cbranch_scc1 MEGA_EXIT
    s_waitcnt vmcnt(3)
    v_max3_u32 v12, v16, v17, v18
    v_max_u32 v12, v12, v19
    s_waitcnt vmcnt(2)
    v_max3_u32 v12, v12, v20, v21
    v_max3_u32 v12, v12, v22, v23
    v_cmp_eq_u32 vcc, -1, v12
    s_cbranch_vccnz PM_26
    v_smfmac_f32_16x16x64_bf16 v[64:67], v[16:19], v[120:127], v3
    ds_write_b128 v2, v[16:19] offset:0
    v_smfmac_f32_16x16x64_bf16 v[68:71], v[16:19], v[176:183], v3
    ds_write_b128 v2, v[20:23] offset:1024
    v_smfmac_f32_16x16x64_bf16 v[72:75], v[16:19], v[232:239], v3
    v_smfmac_f32_16x16x64_bf16 v[76:79], v[16:19], a[32:39], v3
    v_smfmac_f32_16x16x64_bf16 v[108:111], v[16:19], a[88:95], v3
    s_waitcnt lgkmcnt(0)
    s_barrier
    ds_read_b128 v[24:27], v2 offset:2048
    ds_read_b128 v[28:31], v2 offset:3072
    v_smfmac_f32_16x16x64_bf16 v[112:115], v[16:19], a[144:151], v3
    ds_read_b128 v[32:35], v2 offset:4096
    ds_read_b128 v[36:39], v2 offset:5120
    v_smfmac_f32_16x16x64_bf16 v[116:119], v[16:19], a[200:207], v3
    ds_read_b128 v[40:43], v2 offset:6144
    v_smfmac_f32_16x16x64_bf16 v[64:67], v[20:23], v[128:135], v3
    v_smfmac_f32_16x16x64_bf16 v[68:71], v[20:23], v[184:191], v3
    v_smfmac_f32_16x16x64_bf16 v[72:75], v[20:23], v[240:247], v3
    v_smfmac_f32_16x16x64_bf16 v[76:79], v[20:23], a[40:47], v3
    s_waitcnt lgkmcnt(0)
    v_smfmac_f32_16x16x64_bf16 v[64:67], v[24:27], v[136:143], v3
    v_smfmac_f32_16x16x64_bf16 v[64:67], v[28:31], v[144:151], v3
    v_smfmac_f32_16x16x64_bf16 v[64:67], v[32:35], v[152:159], v3
    v_smfmac_f32_16x16x64_bf16 v[64:67], v[36:39], v[160:167], v3
    v_smfmac_f32_16x16x64_bf16 v[64:67], v[40:43], v[168:175], v3
    v_smfmac_f32_16x16x64_bf16 v[68:71], v[24:27], v[192:199], v3
    v_smfmac_f32_16x16x64_bf16 v[68:71], v[28:31], v[200:207], v3
    v_smfmac_f32_16x16x64_bf16 v[68:71], v[32:35], v[208:215], v3
    v_cvt_pk_bf16_f32 v12, v64, v65
    v_smfmac_f32_16x16x64_bf16 v[68:71], v[36:39], v[216:223], v3
    v_cvt_pk_bf16_f32 v13, v66, v67
    v_smfmac_f32_16x16x64_bf16 v[68:71], v[40:43], v[224:231], v3
    ds_write_b64 v4, v[12:13] offset:8192
    v_smfmac_f32_16x16x64_bf16 v[72:75], v[24:27], v[248:255], v3
    v_smfmac_f32_16x16x64_bf16 v[72:75], v[28:31], a[0:7], v3
    ds_read_b128 v[60:63], v10 offset:24688
    ds_read2st64_b32 v[80:81], v1 offset0:0 offset1:2
    ds_read2st64_b32 v[82:83], v55 offset0:0 offset1:2
    v_smfmac_f32_16x16x64_bf16 v[72:75], v[32:35], a[8:15], v3
    ds_read2st64_b32 v[96:97], v1 offset0:4 offset1:6
    ds_read2st64_b32 v[98:99], v55 offset0:4 offset1:6
    v_cvt_pk_bf16_f32 v12, v68, v69
    v_smfmac_f32_16x16x64_bf16 v[72:75], v[36:39], a[16:23], v3
    v_cvt_pk_bf16_f32 v13, v70, v71
    v_smfmac_f32_16x16x64_bf16 v[72:75], v[40:43], a[24:31], v3
    ds_write_b64 v4, v[12:13] offset:10240
    v_smfmac_f32_16x16x64_bf16 v[76:79], v[24:27], a[48:55], v3
    s_waitcnt lgkmcnt(1)
    v_min3_u32 v7, v63, v61, v62
    v_cmp_lt_u32 vcc, v7, v0
    v_smfmac_f32_16x16x64_bf16 v[76:79], v[28:31], a[56:63], v3
    s_cbranch_vccnz SXS_28
SXB_29:
    v_add_f32 v96, v96, v80
    v_add_f32 v97, v97, v81
    v_add_f32 v98, v98, v82
    v_smfmac_f32_16x16x64_bf16 v[76:79], v[32:35], a[64:71], v3
    v_add_f32 v99, v99, v83
    v_max3_f32 v48, v96, v97, v98
    v_max_f32 v48, v48, v99
    v_smfmac_f32_16x16x64_bf16 v[76:79], v[36:39], a[72:79], v3
    s_nop 0
    v_max_f32_dpp v48, v48, v48 quad_perm:[1,0,3,2] row_mask:0xf bank_mask:0xf
    v_cvt_pk_bf16_f32 v12, v72, v73
    v_smfmac_f32_16x16x64_bf16 v[76:79], v[40:43], a[80:87], v3
    ds_read_b128 v[56:59], v10 offset:24576
    v_max_f32_dpp v48, v48, v48 quad_perm:[2,3,0,1] row_mask:0xf bank_mask:0xf
    v_cvt_pk_bf16_f32 v13, v74, v75
    v_smfmac_f32_16x16x64_bf16 v[108:111], v[20:23], a[96:103], v3
    ds_write_b64 v4, v[12:13] offset:12288
    ds_read_b64_tr_b16 v[64:65], v5 offset:8192
    v_max_f32_dpp v48, v48, v48 row_half_mirror row_mask:0xf bank_mask:0xf
    v_sub_f32 v96, v96, v48
    v_sub_f32 v97, v97, v48
    v_smfmac_f32_16x16x64_bf16 v[108:111], v[24:27], a[104:111], v3
    ds_read_b64_tr_b16 v[66:67], v6 offset:8192
    v_sub_f32 v98, v98, v48
    v_sub_f32 v99, v99, v48
    v_exp_f32 v96, v96
    v_smfmac_f32_16x16x64_bf16 v[108:111], v[28:31], a[112:119], v3
    ds_read_b64_tr_b16 v[68:69], v5 offset:9216
    v_exp_f32 v97, v97
    v_exp_f32 v98, v98
    v_exp_f32 v99, v99
    v_smfmac_f32_16x16x64_bf16 v[108:111], v[32:35], a[120:127], v3
    ds_read_b64_tr_b16 v[70:71], v6 offset:9216
    v_cvt_pk_bf16_f32 v104, v96, v97
    v_cvt_pk_bf16_f32 v105, v98, v99
    v_min_u32 v104, -2, v104
    v_smfmac_f32_16x16x64_bf16 v[108:111], v[36:39], a[128:135], v3
    s_waitcnt lgkmcnt(5)
    ds_read_b128 v[60:63], v10 offset:24592
    v_min_u32 v105, -2, v105
    v_cvt_pk_bf16_f32 v12, v76, v77
    v_min3_u32 v50, v57, v58, v59
    v_smfmac_f32_16x16x64_bf16 v[108:111], v[40:43], a[136:143], v3
    buffer_store_dwordx2 v[104:105], v9, s[8:11], s15 offen sc1
    ds_read_b64_tr_b16 v[80:81], v5 offset:10240
    v_cvt_pk_bf16_f32 v13, v78, v79
    v_smfmac_f32_16x16x64_bf16 v[112:115], v[20:23], a[152:159], v3
    ds_write_b64 v4, v[12:13] offset:14336
    ds_read_b64_tr_b16 v[82:83], v6 offset:10240
    v_smfmac_f32_16x16x64_bf16 v[112:115], v[24:27], a[160:167], v3
    ds_read_b64_tr_b16 v[84:85], v5 offset:11264
    v_add_f32 v96, v96, v98
    v_smfmac_f32_16x16x64_bf16 v[112:115], v[28:31], a[168:175], v3
    ds_read_b64_tr_b16 v[86:87], v6 offset:11264
    v_cvt_pk_bf16_f32 v12, v108, v109
    v_smfmac_f32_16x16x64_bf16 v[112:115], v[32:35], a[176:183], v3
    s_waitcnt lgkmcnt(5)
    ds_read_b128 v[56:59], v10 offset:24608
    v_cvt_pk_bf16_f32 v13, v110, v111
    v_min3_u32 v51, v61, v62, v63
    v_smfmac_f32_16x16x64_bf16 v[112:115], v[36:39], a[184:191], v3
    ds_write_b64 v4, v[12:13] offset:16384
    ds_read_b64_tr_b16 v[88:89], v5 offset:12288
    v_add_f32 v49, v97, v99
    v_smfmac_f32_16x16x64_bf16 v[112:115], v[40:43], a[192:199], v3
    ds_read_b64_tr_b16 v[90:91], v6 offset:12288
    v_add_f32 v49, v49, v96
    v_smfmac_f32_16x16x64_bf16 v[116:119], v[20:23], a[208:215], v3
    ds_read_b64_tr_b16 v[92:93], v5 offset:13312
    v_smfmac_f32_16x16x64_bf16 v[116:119], v[24:27], a[216:223], v3
    ds_read_b64_tr_b16 v[94:95], v6 offset:13312
    ds_read_b128 v[60:63], v10 offset:24624
    v_smfmac_f32_16x16x64_bf16 v[116:119], v[28:31], a[224:231], v3
    s_waitcnt lgkmcnt(5)
    ds_read_b64_tr_b16 v[72:73], v5 offset:14336
    v_cvt_pk_bf16_f32 v12, v112, v113
    v_min3_u32 v52, v57, v58, v59
    v_smfmac_f32_16x16x64_bf16 v[116:119], v[32:35], a[232:239], v3
    ds_read_b64_tr_b16 v[74:75], v6 offset:14336
    v_cvt_pk_bf16_f32 v13, v114, v115
    v_smfmac_f32_16x16x64_bf16 v[116:119], v[36:39], a[240:247], v3
    ds_write_b64 v4, v[12:13] offset:18432
    ds_read_b64_tr_b16 v[76:77], v5 offset:15360
    v_smfmac_f32_16x16x64_bf16 v[116:119], v[40:43], a[248:255], v3
    ds_read_b64_tr_b16 v[78:79], v6 offset:15360
    s_waitcnt lgkmcnt(5)
    v_min3_u32 v53, v61, v62, v63
    ds_read_b128 v[56:59], v10 offset:24640
    ds_read_b64_tr_b16 v[96:97], v5 offset:16384
    v_min3_u32 v7, v50, v51, v52
    v_min_u32 v7, v7, v53
    v_smfmac_f32_16x16x64_bf16 v[44:47], v[16:19], v[64:71], v3
    ds_read_b64_tr_b16 v[98:99], v6 offset:16384
    ds_read_b64_tr_b16 v[100:101], v5 offset:17408
    v_cvt_pk_bf16_f32 v12, v116, v117
    v_smfmac_f32_16x16x64_bf16 v[44:47], v[20:23], v[80:87], v3
    ds_read_b64_tr_b16 v[102:103], v6 offset:17408
    v_cvt_pk_bf16_f32 v13, v118, v119
    v_smfmac_f32_16x16x64_bf16 v[44:47], v[24:27], v[88:95], v3
    ds_write_b64 v4, v[12:13] offset:20480
    s_waitcnt lgkmcnt(5)
    v_min3_u32 v7, v7, v57, v58
    v_smfmac_f32_16x16x64_bf16 v[44:47], v[28:31], v[72:79], v3
    v_min_u32 v7, v7, v59
    v_cmp_lt_u32 vcc, v7, v0
    s_barrier
    ds_read_b64_tr_b16 v[104:105], v5 offset:18432
    ds_read_b64_tr_b16 v[106:107], v6 offset:18432
    ds_read_b64_tr_b16 v[108:109], v5 offset:19456
    ds_read_b64_tr_b16 v[110:111], v6 offset:19456
    ds_read_b64_tr_b16 v[112:113], v5 offset:20480
    ds_read_b64_tr_b16 v[114:115], v6 offset:20480
    ds_read_b64_tr_b16 v[116:117], v5 offset:21504
    ds_read_b64_tr_b16 v[118:119], v6 offset:21504
    s_cbranch_vccnz SSL_30
    s_waitcnt lgkmcnt(9)
SBK_31:
    v_smfmac_f32_16x16x64_bf16 v[44:47], v[32:35], v[96:103], v3
    s_nop 0
    s_nop 0
    s_nop 0
    s_waitcnt lgkmcnt(4)
    v_smfmac_f32_16x16x64_bf16 v[44:47], v[36:39], v[104:111], v3
    s_waitcnt lgkmcnt(0)
    v_smfmac_f32_16x16x64_bf16 v[44:47], v[40:43], v[112:119], v3
    v_add_f32_dpp v49, v49, v49 quad_perm:[1,0,3,2] row_mask:0xf bank_mask:0xf
    s_nop 1
    v_add_f32_dpp v49, v49, v49 quad_perm:[2,3,0,1] row_mask:0xf bank_mask:0xf
    s_nop 1
    v_add_f32_dpp v49, v49, v49 row_half_mirror row_mask:0xf bank_mask:0xf
    s_nop 0
    v_permlane32_swap_b32 v44, v46
    v_permlane32_swap_b32 v45, v47
    v_add_f32 v44, v44, v46
    v_add_f32 v45, v45, v47
    s_nop 0
    v_add_f32_dpp v12, v44, v44 row_ror:8 row_mask:0xf bank_mask:0x3
    s_nop 1
    v_add_f32_dpp v12, v45, v45 row_ror:8 row_mask:0xf bank_mask:0xc
    v_max_f32 v13, v12, v48
    s_nop 1
    v_max_f32_dpp v13, v12, v13 quad_perm:[1,0,3,2] row_mask:0xf bank_mask:0xf
    s_nop 1
    v_max_f32_dpp v13, v13, v13 quad_perm:[2,3,0,1] row_mask:0xf bank_mask:0xf
    s_nop 1
    v_max_f32_dpp v13, v13, v13 row_half_mirror row_mask:0xf bank_mask:0xf
    v_sub_f32 v15, v12, v13
    v_sub_f32 v14, v48, v13
    v_exp_f32 v15, v15
    v_exp_f32 v14, v14
    s_nop 0
    v_mov_b32_dpp v52, v15 quad_perm:[1,0,3,2] row_mask:0xf bank_mask:0xf
    v_cndmask_b32 v50, 0, v14, s[38:39]
    v_add_f32 v13, v15, v52
    v_cndmask_b32 v51, 0, v14, s[42:43]
    v_cndmask_b32 v50, v50, v15, s[36:37]
    v_add_f32_dpp v13, v13, v13 quad_perm:[2,3,0,1] row_mask:0xf bank_mask:0xf
    v_cndmask_b32 v51, v51, v52, s[36:37]
    s_nop 0
    v_add_f32_dpp v13, v13, v13 row_half_mirror row_mask:0xf bank_mask:0xf
    v_fma_f32 v13, v49, v14, v13
    v_rcp_f32 v13, v13
    s_nop 0
    v_mul_f32 v50, v50, v13
    v_mul_f32 v51, v51, v13
    v_cvt_pk_bf16_f32 v50, v50, v51
    v_min_u32 v50, -2, v50
    buffer_store_dword v50, v8, s[8:11], s15 offen sc1
    s_barrier
    s_add_u32 s14, s14, 1
    s_cmp_lt_u32 s14, 63
    s_cbranch_scc1 ALOOP_25
    s_branch A_LAST0
SXS_28:
    ds_read_b128 v[60:63], v10 offset:24688
    ds_read2st64_b32 v[80:81], v1 offset0:0 offset1:2
    ds_read2st64_b32 v[82:83], v55 offset0:0 offset1:2
    ds_read2st64_b32 v[96:97], v1 offset0:4 offset1:6
    ds_read2st64_b32 v[98:99], v55 offset0:4 offset1:6
    s_add_u32 s22, s22, 1
    s_cmp_gt_u32 s22, 2000000
    s_cbranch_scc1 MEGA_EXIT
    s_waitcnt lgkmcnt(0)
    v_min3_u32 v7, v63, v61, v62
    v_cmp_lt_u32 vcc, v7, v0
    s_cbranch_vccnz SXS_28
    s_branch SXB_29
SSL_30:
    ds_read_b64_tr_b16 v[64:65], v5 offset:8192
    ds_read_b64_tr_b16 v[66:67], v6 offset:8192
    ds_read_b64_tr_b16 v[68:69], v5 offset:9216
    ds_read_b64_tr_b16 v[70:71], v6 offset:9216
    ds_read_b64_tr_b16 v[80:81], v5 offset:10240
    ds_read_b64_tr_b16 v[82:83], v6 offset:10240
    ds_read_b64_tr_b16 v[84:85], v5 offset:11264
    ds_read_b64_tr_b16 v[86:87], v6 offset:11264
    ds_read_b64_tr_b16 v[88:89], v5 offset:12288
    ds_read_b64_tr_b16 v[90:91], v6 offset:12288
    ds_read_b64_tr_b16 v[92:93], v5 offset:13312
    ds_read_b64_tr_b16 v[94:95], v6 offset:13312
    ds_read_b64_tr_b16 v[72:73], v5 offset:14336
    ds_read_b64_tr_b16 v[74:75], v6 offset:14336
    ds_read_b64_tr_b16 v[76:77], v5 offset:15360
    ds_read_b64_tr_b16 v[78:79], v6 offset:15360
    ds_read_b64_tr_b16 v[96:97], v5 offset:16384
    ds_read_b64_tr_b16 v[98:99], v6 offset:16384
    ds_read_b64_tr_b16 v[100:101], v5 offset:17408
    ds_read_b64_tr_b16 v[102:103], v6 offset:17408
    v_mov_b64 v[44:45], 0
    v_mov_b64 v[46:47], 0
    s_waitcnt lgkmcnt(0)
    s_nop 0
    v_smfmac_f32_16x16x64_bf16 v[44:47], v[16:19], v[64:71], v3
    v_smfmac_f32_16x16x64_bf16 v[44:47], v[20:23], v[80:87], v3
    v_smfmac_f32_16x16x64_bf16 v[44:47], v[24:27], v[88:95], v3
    v_smfmac_f32_16x16x64_bf16 v[44:47], v[28:31], v[72:79], v3
    s_branch SBK_31
DSP_14:
    s_mov_b32 s27, 1
    s_cmp_ge_u32 s26, s27
    s_cbranch_scc1 RDO_32
    s_mov_b32 s18, 116394240
RDP_33:
    buffer_load_dword v12, off, s[8:11], s18 sc1
    s_add_u32 s22, s22, 1
    s_cmp_gt_u32 s22, 2000000
    s_cbranch_scc1 MEGA_EXIT
    s_waitcnt vmcnt(0)
    v_readfirstlane_b32 s26, v12
    s_nop 0
    s_cmp_lt_u32 s26, s27
    s_cbranch_scc1 RDP_33
RDO_32:
    s_add_u32 s18, s23, 4096
    buffer_load_dwordx4 v[80:83], v2, s[8:11], s18 offen offset:0 sc1
    buffer_load_dwordx4 v[84:87], v2, s[8:11], s18 offen offset:1024 sc1
    s_add_u32 s18, s23, 6144
    buffer_load_dwordx4 v[88:91], v2, s[8:11], s18 offen offset:0 sc1
    buffer_load_dwordx4 v[92:95], v2, s[8:11], s18 offen offset:1024 sc1
    s_add_u32 s18, s23, 2048
    buffer_load_dwordx4 v[96:99], v2, s[8:11], s18 offen offset:0 sc1
    buffer_load_dwordx4 v[100:103], v2, s[8:11], s18 offen offset:1024 sc1
    s_add_u32 s18, s23, 8192
    buffer_load_dwordx4 v[104:107], v2, s[8:11], s18 offen offset:0 sc1
    buffer_load_dwordx4 v[108:111], v2, s[8:11], s18 offen offset:1024 sc1
    s_add_u32 s18, s23, 10240
    buffer_load_dwordx4 v[112:115], v2, s[8:11], s18 offen offset:0 sc1
    buffer_load_dwordx4 v[116:119], v2, s[8:11], s18 offen offset:1024 sc1
    s_min_u32 s20, s12, 13
    s_mul_i32 s20, s20, 32768
    v_lshlrev_b32 v14, 7, v1
    s_add_u32 s19, s20, 46604288
    buffer_load_dword v15, v14, s[8:11], s19 offen sc1
    s_cmp_lg_u32 s40, 0
    s_cbranch_scc1 SLOW_34
    s_mov_b32 s93, 46137344
    s_mov_b32 s94, 116394240
    s_mov_b32 s14, 0
ALOOP_35:
    s_and_b32 s18, s14, 3
    s_lshl_b32 s18, s18, 17
    s_add_u32 s15, s18, 75497472
    s_xor_b32 s17, s15, 262144
    s_mov_b32 s31, s15
    v_add_u32 v0, 1, v0
    s_mov_b32 s22, 0
    s_add_u32 s23, s23, 458752
    s_add_u32 s27, s14, 2
    s_min_u32 s27, s27, 64
    s_cmp_ge_u32 s26, s27
    s_cbranch_scc1 RDO_36
    s_mov_b32 s18, 116394240
RDP_37:
    buffer_load_dword v12, off, s[8:11], s18 sc1
    s_add_u32 s22, s22, 1
    s_cmp_gt_u32 s22, 2000000
    s_cbranch_scc1 MEGA_EXIT
    s_waitcnt vmcnt(0)
    v_readfirstlane_b32 s26, v12
    s_nop 0
    s_cmp_lt_u32 s26, s27
    s_cbranch_scc1 RDP_37
RDO_36:
    s_min_u32 s20, s12, 13
    s_mul_i32 s20, s20, 32768
    s_add_u32 s19, s14, 2
    s_sub_u32 s21, s26, 1
    s_min_u32 s19, s19, s21
    s_mul_i32 s19, s19, 458752
    s_add_u32 s20, s20, s19
    s_add_u32 s20, s20, 46145536
    v_lshlrev_b32 v14, 7, v1
    v_mov_b64 v[44:45], 0
    v_mov_b64 v[46:47], 0
    v_mov_b64 v[48:49], 0
    v_mov_b64 v[50:51], 0
    v_mov_b64 v[52:53], 0
    v_mov_b64 v[54:55], 0
    v_mov_b64 v[56:57], 0
    v_mov_b64 v[58:59], 0
    v_mov_b64 v[60:61], 0
    v_mov_b64 v[62:63], 0
    v_mov_b64 v[64:65], 0
    v_mov_b64 v[66:67], 0
    v_mov_b64 v[68:69], 0
    v_mov_b64 v[70:71], 0
    v_mov_b64 v[72:73], 0
    v_mov_b64 v[74:75], 0
    s_barrier
    buffer_load_dword v15, v14, s[8:11], s20 offen sc1
    s_cmp_eq_u32 s14, 0
    s_cbranch_scc1 NSL_39
    s_sleep 14
NSL_39:
    buffer_load_dword v7, off, s[8:11], s94 sc1
    buffer_load_dwordx4 v[24:27], v2, s[8:11], s31 offen offset:2048 sc1
    buffer_load_dwordx4 v[28:31], v2, s[8:11], s31 offen offset:3072 sc1
    s_sleep 2
    s_waitcnt lgkmcnt(0)
PM_38:
    buffer_load_dwordx4 v[24:27], v2, s[8:11], s31 offen offset:2048 sc1
    buffer_load_dwordx4 v[28:31], v2, s[8:11], s31 offen offset:3072 sc1
    s_add_u32 s22, s22, 1
    s_cmp_gt_u32 s22, 2000000
    s_cbranch_scc1 MEGA_EXIT
    s_waitcnt vmcnt(3)
    v_max3_u32 v12, v24, v25, v26
    v_max_u32 v12, v12, v27
    s_waitcnt vmcnt(2)
    v_max3_u32 v12, v12, v28, v29
    v_max3_u32 v12, v12, v30, v31
    v_cmp_eq_u32 vcc, -1, v12
    s_cbranch_vccnz PM_38
    v_smfmac_f32_16x16x64_bf16 v[72:75], v[24:27], v[80:87], v3
    ds_write_b128 v2, v[24:27] offset:2048
    v_smfmac_f32_16x16x64_bf16 v[72:75], v[28:31], v[88:95], v3
    ds_write_b128 v2, v[28:31] offset:3072
    v_smfmac_f32_16x16x64_bf16 v[44:47], v[24:27], v[136:143], v3
    s_add_u32 s18, s23, 4096
    buffer_load_dwordx4 v[80:83], v2, s[8:11], s18 offen offset:0 sc1
    v_readfirstlane_b32 s26, v7
    v_smfmac_f32_16x16x64_bf16 v[48:51], v[24:27], v[192:199], v3
    v_smfmac_f32_16x16x64_bf16 v[52:55], v[24:27], v[248:255], v3
    s_waitcnt lgkmcnt(0)
    s_barrier
    ds_read_b128 v[16:19], v2 offset:0
    ds_read_b128 v[20:23], v2 offset:1024
    v_smfmac_f32_16x16x64_bf16 v[56:59], v[24:27], a[48:55], v3
    ds_read_b128 v[32:35], v2 offset:4096
    ds_read_b128 v[36:39], v2 offset:5120
    v_smfmac_f32_16x16x64_bf16 v[60:63], v[24:27], a[104:111], v3
    ds_read_b128 v[40:43], v2 offset:6144
    v_smfmac_f32_16x16x64_bf16 v[64:67], v[24:27], a[160:167], v3
    buffer_load_dwordx4 v[84:87], v2, s[8:11], s18 offen offset:1024 sc1
    v_smfmac_f32_16x16x64_bf16 v[68:71], v[24:27], a[216:223], v3
    v_smfmac_f32_16x16x64_bf16 v[44:47], v[28:31], v[144:151], v3
    v_smfmac_f32_16x16x64_bf16 v[48:51], v[28:31], v[200:207], v3
    s_waitcnt lgkmcnt(0)
    v_smfmac_f32_16x16x64_bf16 v[72:75], v[20:23], v[96:103], v3
    s_add_u32 s18, s23, 6144
    buffer_load_dwordx4 v[88:91], v2, s[8:11], s18 offen offset:0 sc1
    v_smfmac_f32_16x16x64_bf16 v[72:75], v[32:35], v[104:111], v3
    v_smfmac_f32_16x16x64_bf16 v[72:75], v[36:39], v[112:119], v3
    v_smfmac_f32_16x16x64_bf16 v[44:47], v[16:19], v[120:127], v3
    v_smfmac_f32_16x16x64_bf16 v[44:47], v[20:23], v[128:135], v3
    buffer_load_dwordx4 v[92:95], v2, s[8:11], s18 offen offset:1024 sc1
    v_smfmac_f32_16x16x64_bf16 v[44:47], v[32:35], v[152:159], v3
    v_permlane32_swap_b32 v72, v74
    v_permlane32_swap_b32 v73, v75
    v_add_f32 v72, v72, v74
    v_add_f32 v73, v73, v75
    v_smfmac_f32_16x16x64_bf16 v[44:47], v[36:39], v[160:167], v3
    ds_write_b64 v5, v[72:73] offset:28672
    ds_write_b32 v10, v0 offset:24688
    v_smfmac_f32_16x16x64_bf16 v[44:47], v[40:43], v[168:175], v3
    v_smfmac_f32_16x16x64_bf16 v[48:51], v[16:19], v[176:183], v3
    s_add_u32 s18, s23, 2048
    buffer_load_dwordx4 v[96:99], v2, s[8:11], s18 offen offset:0 sc1
    v_smfmac_f32_16x16x64_bf16 v[48:51], v[20:23], v[184:191], v3
    v_smfmac_f32_16x16x64_bf16 v[48:51], v[32:35], v[208:215], v3
    v_cvt_pk_bf16_f32 v12, v44, v45
    v_smfmac_f32_16x16x64_bf16 v[48:51], v[36:39], v[216:223], v3
    v_cvt_pk_bf16_f32 v13, v46, v47
    v_smfmac_f32_16x16x64_bf16 v[48:51], v[40:43], v[224:231], v3
    ds_write_b64 v4, v[12:13] offset:8192
    v_smfmac_f32_16x16x64_bf16 v[52:55], v[28:31], a[0:7], v3
    ds_write_b32 v10, v0 offset:24576
    v_smfmac_f32_16x16x64_bf16 v[52:55], v[16:19], v[232:239], v3
    buffer_load_dwordx4 v[100:103], v2, s[8:11], s18 offen offset:1024 sc1
    v_smfmac_f32_16x16x64_bf16 v[52:55], v[20:23], v[240:247], v3
    v_cvt_pk_bf16_f32 v12, v48, v49
    v_smfmac_f32_16x16x64_bf16 v[52:55], v[32:35], a[8:15], v3
    v_cvt_pk_bf16_f32 v13, v50, v51
    v_smfmac_f32_16x16x64_bf16 v[52:55], v[36:39], a[16:23], v3
    ds_write_b64 v4, v[12:13] offset:10240
    v_smfmac_f32_16x16x64_bf16 v[52:55], v[40:43], a[24:31], v3
    ds_write_b32 v10, v0 offset:24592
    v_smfmac_f32_16x16x64_bf16 v[56:59], v[28:31], a[56:63], v3
    s_add_u32 s18, s23, 8192
    buffer_load_dwordx4 v[104:107], v2, s[8:11], s18 offen offset:0 sc1
    v_smfmac_f32_16x16x64_bf16 v[56:59], v[16:19], a[32:39], v3
    v_smfmac_f32_16x16x64_bf16 v[56:59], v[20:23], a[40:47], v3
    v_cvt_pk_bf16_f32 v12, v52, v53
    v_smfmac_f32_16x16x64_bf16 v[56:59], v[32:35], a[64:71], v3
    v_cvt_pk_bf16_f32 v13, v54, v55
    v_smfmac_f32_16x16x64_bf16 v[56:59], v[36:39], a[72:79], v3
    ds_write_b64 v4, v[12:13] offset:12288
    v_smfmac_f32_16x16x64_bf16 v[56:59], v[40:43], a[80:87], v3
    ds_write_b32 v10, v0 offset:24608
    v_smfmac_f32_16x16x64_bf16 v[60:63], v[28:31], a[112:119], v3
    buffer_load_dwordx4 v[108:111], v2, s[8:11], s18 offen offset:1024 sc1
    v_smfmac_f32_16x16x64_bf16 v[60:63], v[16:19], a[88:95], v3
    v_smfmac_f32_16x16x64_bf16 v[60:63], v[20:23], a[96:103], v3
    v_cvt_pk_bf16_f32 v12, v56, v57
    v_smfmac_f32_16x16x64_bf16 v[60:63], v[32:35], a[120:127], v3
    v_cvt_pk_bf16_f32 v13, v58, v59
    v_smfmac_f32_16x16x64_bf16 v[60:63], v[36:39], a[128:135], v3
    ds_write_b64 v4, v[12:13] offset:14336
    v_smfmac_f32_16x16x64_bf16 v[60:63], v[40:43], a[136:143], v3
    ds_write_b32 v10, v0 offset:24624
    v_smfmac_f32_16x16x64_bf16 v[64:67], v[28:31], a[168:175], v3
    s_add_u32 s18, s23, 10240
    buffer_load_dwordx4 v[112:115], v2, s[8:11], s18 offen offset:0 sc1
    v_smfmac_f32_16x16x64_bf16 v[64:67], v[16:19], a[144:151], v3
    v_smfmac_f32_16x16x64_bf16 v[64:67], v[20:23], a[152:159], v3
    v_cvt_pk_bf16_f32 v12, v60, v61
    v_smfmac_f32_16x16x64_bf16 v[64:67], v[32:35], a[176:183], v3
    v_cvt_pk_bf16_f32 v13, v62, v63
    v_smfmac_f32_16x16x64_bf16 v[64:67], v[36:39], a[184:191], v3
    ds_write_b64 v4, v[12:13] offset:16384
    v_smfmac_f32_16x16x64_bf16 v[64:67], v[40:43], a[192:199], v3
    ds_write_b32 v10, v0 offset:24640
    v_smfmac_f32_16x16x64_bf16 v[68:71], v[28:31], a[224:231], v3
    buffer_load_dwordx4 v[116:119], v2, s[8:11], s18 offen offset:1024 sc1
    v_smfmac_f32_16x16x64_bf16 v[68:71], v[16:19], a[200:207], v3
    v_smfmac_f32_16x16x64_bf16 v[68:71], v[20:23], a[208:215], v3
    v_cvt_pk_bf16_f32 v12, v64, v65
    v_smfmac_f32_16x16x64_bf16 v[68:71], v[32:35], a[232:239], v3
    v_cvt_pk_bf16_f32 v13, v66, v67
    v_smfmac_f32_16x16x64_bf16 v[68:71], v[36:39], a[240:247], v3
    ds_write_b64 v4, v[12:13] offset:18432
    v_smfmac_f32_16x16x64_bf16 v[68:71], v[40:43], a[248:255], v3
    s_nop 7
    v_cvt_pk_bf16_f32 v12, v68, v69
    v_cvt_pk_bf16_f32 v13, v70, v71
    ds_write_b64 v4, v[12:13] offset:20480
    s_waitcnt lgkmcnt(0)
    s_barrier
    s_add_u32 s14, s14, 1
    s_cmp_lt_u32 s14, 63
    s_cbranch_scc1 ALOOP_35
    s_branch A_LAST
SLOW_34:
    s_mov_b32 s93, 46137344
    s_mov_b32 s94, 116394240
    s_mov_b32 s14, 0
ALOOP_40:
    s_and_b32 s18, s14, 3
    s_lshl_b32 s18, s18, 17
    s_add_u32 s15, s18, 75497472
    s_xor_b32 s17, s15, 262144
    s_mov_b32 s31, s15
    v_add_u32 v0, 1, v0
    s_mov_b32 s22, 0
    s_add_u32 s23, s23, 458752
    s_add_u32 s27, s14, 2
    s_min_u32 s27, s27, 64
    s_cmp_ge_u32 s26, s27
    s_cbranch_scc1 RDO_41
    s_mov_b32 s18, 116394240
RDP_42:
    buffer_load_dword v12, off, s[8:11], s18 sc1
    s_add_u32 s22, s22, 1
    s_cmp_gt_u32 s22, 2000000
    s_cbranch_scc1 MEGA_EXIT
    s_waitcnt vmcnt(0)
    v_readfirstlane_b32 s26, v12
    s_nop 0
    s_cmp_lt_u32 s26, s27
    s_cbranch_scc1 RDP_42
RDO_41:
    s_min_u32 s20, s12, 13
    s_mul_i32 s20, s20, 32768
    s_add_u32 s19, s14, 2
    s_sub_u32 s21, s26, 1
    s_min_u32 s19, s19, s21
    s_mul_i32 s19, s19, 458752
    s_add_u32 s20, s20, s19
    s_add_u32 s20, s20, 46145536
    v_lshlrev_b32 v14, 7, v1
    v_mov_b64 v[44:45], 0
    v_mov_b64 v[46:47], 0
    v_mov_b64 v[48:49], 0
    v_mov_b64 v[50:51], 0
    v_mov_b64 v[52:53], 0
    v_mov_b64 v[54:55], 0
    v_mov_b64 v[56:57], 0
    v_mov_b64 v[58:59], 0
    v_mov_b64 v[60:61], 0
    v_mov_b64 v[62:63], 0
    v_mov_b64 v[64:65], 0
    v_mov_b64 v[66:67], 0
    v_mov_b64 v[68:69], 0
    v_mov_b64 v[70:71], 0
    v_mov_b64 v[72:73], 0
    v_mov_b64 v[74:75], 0
    s_barrier
    buffer_load_dword v15, v14, s[8:11], s20 offen sc1
    s_cmp_eq_u32 s14, 0
    s_cbranch_scc1 NSL_44
    s_sleep 14
NSL_44:
    buffer_load_dword v7, off, s[8:11], s94 sc1
    buffer_load_dwordx4 v[24:27], v2, s[8:11], s31 offen offset:2048 sc1
    buffer_load_dwordx4 v[28:31], v2, s[8:11], s31 offen offset:3072 sc1
    s_sleep 2
    s_waitcnt lgkmcnt(0)
PM_43:
    buffer_load_dwordx4 v[24:27], v2, s[8:11], s31 offen offset:2048 sc1
    buffer_load_dwordx4 v[28:31], v2, s[8:11], s31 offen offset:3072 sc1
    s_add_u32 s22, s22, 1
    s_cmp_gt_u32 s22, 2000000
    s_cbranch_scc1 MEGA_EXIT
    s_waitcnt vmcnt(3)
    v_max3_u32 v12, v24, v25, v26
    v_max_u32 v12, v12, v27
    s_waitcnt vmcnt(2)
    v_max3_u32 v12, v12, v28, v29
    v_max3_u32 v12, v12, v30, v31
    v_cmp_eq_u32 vcc, -1, v12
    s_cbranch_vccnz PM_43
    v_smfmac_f32_16x16x64_bf16 v[72:75], v[24:27], v[80:87], v3
    ds_write_b128 v2, v[24:27] offset:2048
    v_smfmac_f32_16x16x64_bf16 v[72:75], v[28:31], v[88:95], v3
    ds_write_b128 v2, v[28:31] offset:3072
    v_smfmac_f32_16x16x64_bf16 v[44:47], v[24:27], v[136:143], v3
    s_add_u32 s18, s23, 4096
    buffer_load_dwordx4 v[80:83], v2, s[8:11], s18 offen offset:0 sc1
    v_readfirstlane_b32 s26, v7
    v_smfmac_f32_16x16x64_bf16 v[48:51], v[24:27], v[192:199], v3
    v_smfmac_f32_16x16x64_bf16 v[52:55], v[24:27], v[248:255], v3
    s_waitcnt lgkmcnt(0)
    s_barrier
    ds_read_b128 v[16:19], v2 offset:0
    ds_read_b128 v[20:23], v2 offset:1024
    v_smfmac_f32_16x16x64_bf16 v[56:59], v[24:27], a[48:55], v3
    ds_read_b128 v[32:35], v2 offset:4096
    ds_read_b128 v[36:39], v2 offset:5120
    v_smfmac_f32_16x16x64_bf16 v[60:63], v[24:27], a[104:111], v3
    ds_read_b128 v[40:43], v2 offset:6144
    v_smfmac_f32_16x16x64_bf16 v[64:67], v[24:27], a[160:167], v3
    buffer_load_dwordx4 v[84:87], v2, s[8:11], s18 offen offset:1024 sc1
    v_smfmac_f32_16x16x64_bf16 v[68:71], v[24:27], a[216:223], v3
    v_smfmac_f32_16x16x64_bf16 v[44:47], v[28:31], v[144:151], v3
    v_smfmac_f32_16x16x64_bf16 v[48:51], v[28:31], v[200:207], v3
    s_waitcnt lgkmcnt(0)
    v_smfmac_f32_16x16x64_bf16 v[72:75], v[20:23], v[96:103], v3
    s_add_u32 s18, s23, 6144
    buffer_load_dwordx4 v[88:91], v2, s[8:11], s18 offen offset:0 sc1
    v_smfmac_f32_16x16x64_bf16 v[72:75], v[32:35], v[104:111], v3
    v_smfmac_f32_16x16x64_bf16 v[72:75], v[36:39], v[112:119], v3
    v_smfmac_f32_16x16x64_bf16 v[44:47], v[16:19], v[120:127], v3
    v_smfmac_f32_16x16x64_bf16 v[44:47], v[20:23], v[128:135], v3
    buffer_load_dwordx4 v[92:95], v2, s[8:11], s18 offen offset:1024 sc1
    v_smfmac_f32_16x16x64_bf16 v[44:47], v[32:35], v[152:159], v3
    v_permlane32_swap_b32 v72, v74
    v_permlane32_swap_b32 v73, v75
    v_add_f32 v72, v72, v74
    v_add_f32 v73, v73, v75
    v_smfmac_f32_16x16x64_bf16 v[44:47], v[36:39], v[160:167], v3
    ds_write_b64 v5, v[72:73] offset:28672
    ds_write_b32 v10, v0 offset:24688
    v_smfmac_f32_16x16x64_bf16 v[44:47], v[40:43], v[168:175], v3
    v_smfmac_f32_16x16x64_bf16 v[48:51], v[16:19], v[176:183], v3
    s_add_u32 s18, s23, 2048
    buffer_load_dwordx4 v[96:99], v2, s[8:11], s18 offen offset:0 sc1
    v_smfmac_f32_16x16x64_bf16 v[48:51], v[20:23], v[184:191], v3
    v_smfmac_f32_16x16x64_bf16 v[48:51], v[32:35], v[208:215], v3
    v_cvt_pk_bf16_f32 v12, v44, v45
    v_smfmac_f32_16x16x64_bf16 v[48:51], v[36:39], v[216:223], v3
    v_cvt_pk_bf16_f32 v13, v46, v47
    v_smfmac_f32_16x16x64_bf16 v[48:51], v[40:43], v[224:231], v3
    ds_write_b64 v4, v[12:13] offset:8192
    v_smfmac_f32_16x16x64_bf16 v[52:55], v[28:31], a[0:7], v3
    ds_write_b32 v10, v0 offset:24576
    v_smfmac_f32_16x16x64_bf16 v[52:55], v[16:19], v[232:239], v3
    buffer_load_dwordx4 v[100:103], v2, s[8:11], s18 offen offset:1024 sc1
    v_smfmac_f32_16x16x64_bf16 v[52:55], v[20:23], v[240:247], v3
    v_cvt_pk_bf16_f32 v12, v48, v49
    v_smfmac_f32_16x16x64_bf16 v[52:55], v[32:35], a[8:15], v3
    v_cvt_pk_bf16_f32 v13, v50, v51
    v_smfmac_f32_16x16x64_bf16 v[52:55], v[36:39], a[16:23], v3
    ds_write_b64 v4, v[12:13] offset:10240
    v_smfmac_f32_16x16x64_bf16 v[52:55], v[40:43], a[24:31], v3
    ds_write_b32 v10, v0 offset:24592
    v_smfmac_f32_16x16x64_bf16 v[56:59], v[28:31], a[56:63], v3
    s_add_u32 s18, s23, 8192
    buffer_load_dwordx4 v[104:107], v2, s[8:11], s18 offen offset:0 sc1
    v_smfmac_f32_16x16x64_bf16 v[56:59], v[16:19], a[32:39], v3
    v_smfmac_f32_16x16x64_bf16 v[56:59], v[20:23], a[40:47], v3
    v_cvt_pk_bf16_f32 v12, v52, v53
    v_smfmac_f32_16x16x64_bf16 v[56:59], v[32:35], a[64:71], v3
    v_cvt_pk_bf16_f32 v13, v54, v55
    v_smfmac_f32_16x16x64_bf16 v[56:59], v[36:39], a[72:79], v3
    ds_write_b64 v4, v[12:13] offset:12288
    v_smfmac_f32_16x16x64_bf16 v[56:59], v[40:43], a[80:87], v3
    ds_write_b32 v10, v0 offset:24608
    v_smfmac_f32_16x16x64_bf16 v[60:63], v[28:31], a[112:119], v3
    buffer_load_dwordx4 v[108:111], v2, s[8:11], s18 offen offset:1024 sc1
    v_smfmac_f32_16x16x64_bf16 v[60:63], v[16:19], a[88:95], v3
    v_smfmac_f32_16x16x64_bf16 v[60:63], v[20:23], a[96:103], v3
    v_cvt_pk_bf16_f32 v12, v56, v57
    v_smfmac_f32_16x16x64_bf16 v[60:63], v[32:35], a[120:127], v3
    v_cvt_pk_bf16_f32 v13, v58, v59
    v_smfmac_f32_16x16x64_bf16 v[60:63], v[36:39], a[128:135], v3
    ds_write_b64 v4, v[12:13] offset:14336
    v_smfmac_f32_16x16x64_bf16 v[60:63], v[40:43], a[136:143], v3
    ds_write_b32 v10, v0 offset:24624
    v_smfmac_f32_16x16x64_bf16 v[64:67], v[28:31], a[168:175], v3
    s_add_u32 s18, s23, 10240
    buffer_load_dwordx4 v[112:115], v2, s[8:11], s18 offen offset:0 sc1
    v_smfmac_f32_16x16x64_bf16 v[64:67], v[16:19], a[144:151], v3
    v_smfmac_f32_16x16x64_bf16 v[64:67], v[20:23], a[152:159], v3
    v_cvt_pk_bf16_f32 v12, v60, v61
    v_smfmac_f32_16x16x64_bf16 v[64:67], v[32:35], a[176:183], v3
    v_cvt_pk_bf16_f32 v13, v62, v63
    v_smfmac_f32_16x16x64_bf16 v[64:67], v[36:39], a[184:191], v3
    ds_write_b64 v4, v[12:13] offset:16384
    v_smfmac_f32_16x16x64_bf16 v[64:67], v[40:43], a[192:199], v3
    ds_write_b32 v10, v0 offset:24640
    v_smfmac_f32_16x16x64_bf16 v[68:71], v[28:31], a[224:231], v3
    buffer_load_dwordx4 v[116:119], v2, s[8:11], s18 offen offset:1024 sc1
    v_smfmac_f32_16x16x64_bf16 v[68:71], v[16:19], a[200:207], v3
    v_smfmac_f32_16x16x64_bf16 v[68:71], v[20:23], a[208:215], v3
    v_cvt_pk_bf16_f32 v12, v64, v65
    v_smfmac_f32_16x16x64_bf16 v[68:71], v[32:35], a[232:239], v3
    v_cvt_pk_bf16_f32 v13, v66, v67
    v_smfmac_f32_16x16x64_bf16 v[68:71], v[36:39], a[240:247], v3
    ds_write_b64 v4, v[12:13] offset:18432
    v_smfmac_f32_16x16x64_bf16 v[68:71], v[40:43], a[248:255], v3
    s_nop 7
    v_cvt_pk_bf16_f32 v12, v68, v69
    v_cvt_pk_bf16_f32 v13, v70, v71
    ds_write_b64 v4, v[12:13] offset:20480
    s_waitcnt lgkmcnt(0)
    s_barrier
    s_add_u32 s14, s14, 1
    s_cmp_lt_u32 s14, 63
    s_cbranch_scc1 ALOOP_40
    s_branch A_LAST
DSP_15:
    s_mov_b32 s27, 1
    s_cmp_ge_u32 s26, s27
    s_cbranch_scc1 RDO_45
    s_mov_b32 s18, 116394240
RDP_46:
    buffer_load_dword v12, off, s[8:11], s18 sc1
    s_add_u32 s22, s22, 1
    s_cmp_gt_u32 s22, 2000000
    s_cbranch_scc1 MEGA_EXIT
    s_waitcnt vmcnt(0)
    v_readfirstlane_b32 s26, v12
    s_nop 0
    s_cmp_lt_u32 s26, s27
    s_cbranch_scc1 RDP_46
RDO_45:
    s_add_u32 s18, s23, 22528
    buffer_load_dwordx4 v[80:83], v2, s[8:11], s18 offen offset:0 sc1
    buffer_load_dwordx4 v[84:87], v2, s[8:11], s18 offen offset:1024 sc1
    s_add_u32 s18, s23, 24576
    buffer_load_dwordx4 v[88:91], v2, s[8:11], s18 offen offset:0 sc1
    buffer_load_dwordx4 v[92:95], v2, s[8:11], s18 offen offset:1024 sc1
    s_add_u32 s18, s23, 16384
    buffer_load_dwordx4 v[96:99], v2, s[8:11], s18 offen offset:0 sc1
    buffer_load_dwordx4 v[100:103], v2, s[8:11], s18 offen offset:1024 sc1
    s_add_u32 s18, s23, 18432
    buffer_load_dwordx4 v[104:107], v2, s[8:11], s18 offen offset:0 sc1
    buffer_load_dwordx4 v[108:111], v2, s[8:11], s18 offen offset:1024 sc1
    s_add_u32 s18, s23, 20480
    buffer_load_dwordx4 v[112:115], v2, s[8:11], s18 offen offset:0 sc1
    buffer_load_dwordx4 v[116:119], v2, s[8:11], s18 offen offset:1024 sc1
    s_min_u32 s20, s12, 13
    s_mul_i32 s20, s20, 32768
    v_lshlrev_b32 v14, 7, v1
    s_add_u32 s19, s20, 46620672
    buffer_load_dword v15, v14, s[8:11], s19 offen sc1
    s_cmp_lg_u32 s40, 0
    s_cbranch_scc1 SLOW_47
    s_mov_b32 s93, 46137344
    s_mov_b32 s94, 116394240
    s_mov_b32 s14, 0
ALOOP_48:
    s_and_b32 s18, s14, 3
    s_lshl_b32 s18, s18, 17
    s_add_u32 s15, s18, 75497472
    s_xor_b32 s17, s15, 262144
    s_mov_b32 s31, s15
    v_add_u32 v0, 1, v0
    s_mov_b32 s22, 0
    s_add_u32 s23, s23, 458752
    s_add_u32 s27, s14, 2
    s_min_u32 s27, s27, 64
    s_cmp_ge_u32 s26, s27
    s_cbranch_scc1 RDO_49
    s_mov_b32 s18, 116394240
RDP_50:
    buffer_load_dword v12, off, s[8:11], s18 sc1
    s_add_u32 s22, s22, 1
    s_cmp_gt_u32 s22, 2000000
    s_cbranch_scc1 MEGA_EXIT
    s_waitcnt vmcnt(0)
    v_readfirstlane_b32 s26, v12
    s_nop 0
    s_cmp_lt_u32 s26, s27
    s_cbranch_scc1 RDP_50
RDO_49:
    s_min_u32 s20, s12, 13
    s_mul_i32 s20, s20, 32768
    s_add_u32 s19, s14, 2
    s_sub_u32 s21, s26, 1
    s_min_u32 s19, s19, s21
    s_mul_i32 s19, s19, 458752
    s_add_u32 s20, s20, s19
    s_add_u32 s20, s20, 46161920
    v_lshlrev_b32 v14, 7, v1
    v_mov_b64 v[44:45], 0
    v_mov_b64 v[46:47], 0
    v_mov_b64 v[48:49], 0
    v_mov_b64 v[50:51], 0
    v_mov_b64 v[52:53], 0
    v_mov_b64 v[54:55], 0
    v_mov_b64 v[56:57], 0
    v_mov_b64 v[58:59], 0
    v_mov_b64 v[60:61], 0
    v_mov_b64 v[62:63], 0
    v_mov_b64 v[64:65], 0
    v_mov_b64 v[66:67], 0
    v_mov_b64 v[68:69], 0
    v_mov_b64 v[70:71], 0
    v_mov_b64 v[76:77], 0
    v_mov_b64 v[78:79], 0
    s_barrier
    buffer_load_dword v15, v14, s[8:11], s20 offen sc1
    s_cmp_eq_u32 s14, 0
    s_cbranch_scc1 NSL_52
    s_sleep 14
NSL_52:
    buffer_load_dword v7, off, s[8:11], s94 sc1
    buffer_load_dwordx4 v[32:35], v11, s[8:11], s31 offen offset:0 sc1
    buffer_load_dwordx4 v[36:39], v11, s[8:11], s31 offen offset:1024 sc1
    s_sleep 2
    s_waitcnt lgkmcnt(0)
PM_51:
    buffer_load_dwordx4 v[32:35], v11, s[8:11], s31 offen offset:0 sc1
    buffer_load_dwordx4 v[36:39], v11, s[8:11], s31 offen offset:1024 sc1
    s_add_u32 s22, s22, 1
    s_cmp_gt_u32 s22, 2000000
    s_cbranch_scc1 MEGA_EXIT
    s_waitcnt vmcnt(3)
    v_max3_u32 v12, v32, v33, v34
    v_max_u32 v12, v12, v35
    s_waitcnt vmcnt(2)
    v_max3_u32 v12, v12, v36, v37
    v_max3_u32 v12, v12, v38, v39
    v_cmp_eq_u32 vcc, -1, v12
    s_cbranch_vccnz PM_51
    v_smfmac_f32_16x16x64_bf16 v[76:79], v[32:35], v[80:87], v3
    ds_write_b128 v2, v[32:35] offset:4096
    v_smfmac_f32_16x16x64_bf16 v[76:79], v[36:39], v[88:95], v3
    ds_write_b128 v2, v[36:39] offset:5120
    v_smfmac_f32_16x16x64_bf16 v[44:47], v[32:35], v[152:159], v3
    v_readfirstlane_b32 s26, v7
    v_smfmac_f32_16x16x64_bf16 v[48:51], v[32:35], v[208:215], v3
    v_smfmac_f32_16x16x64_bf16 v[52:55], v[32:35], a[8:15], v3
    s_waitcnt lgkmcnt(0)
    s_barrier
    ds_read_b128 v[16:19], v2 offset:0
    ds_read_b128 v[20:23], v2 offset:1024
    v_smfmac_f32_16x16x64_bf16 v[56:59], v[32:35], a[64:71], v3
    ds_read_b128 v[24:27], v2 offset:2048
    ds_read_b128 v[28:31], v2 offset:3072
    v_smfmac_f32_16x16x64_bf16 v[60:63], v[32:35], a[120:127], v3
    ds_read_b128 v[40:43], v2 offset:6144
    v_smfmac_f32_16x16x64_bf16 v[64:67], v[32:35], a[176:183], v3
    s_add_u32 s18, s23, 22528
    buffer_load_dwordx4 v[80:83], v2, s[8:11], s18 offen offset:0 sc1
    v_smfmac_f32_16x16x64_bf16 v[68:71], v[32:35], a[232:239], v3
    v_smfmac_f32_16x16x64_bf16 v[44:47], v[36:39], v[160:167], v3
    v_smfmac_f32_16x16x64_bf16 v[48:51], v[36:39], v[216:223], v3
    s_waitcnt lgkmcnt(0)
    v_smfmac_f32_16x16x64_bf16 v[76:79], v[20:23], v[96:103], v3
    buffer_load_dwordx4 v[84:87], v2, s[8:11], s18 offen offset:1024 sc1
    v_smfmac_f32_16x16x64_bf16 v[76:79], v[24:27], v[104:111], v3
    v_smfmac_f32_16x16x64_bf16 v[76:79], v[28:31], v[112:119], v3
    v_smfmac_f32_16x16x64_bf16 v[44:47], v[16:19], v[120:127], v3
    v_smfmac_f32_16x16x64_bf16 v[44:47], v[20:23], v[128:135], v3
    s_add_u32 s18, s23, 24576
    buffer_load_dwordx4 v[88:91], v2, s[8:11], s18 offen offset:0 sc1
    v_smfmac_f32_16x16x64_bf16 v[44:47], v[24:27], v[136:143], v3
    v_permlane32_swap_b32 v76, v78
    v_permlane32_swap_b32 v77, v79
    v_add_f32 v76, v76, v78
    v_add_f32 v77, v77, v79
    v_smfmac_f32_16x16x64_bf16 v[44:47], v[28:31], v[144:151], v3
    ds_write_b64 v5, v[76:77] offset:29184
    ds_write_b32 v10, v0 offset:24688
    v_smfmac_f32_16x16x64_bf16 v[44:47], v[40:43], v[168:175], v3
    v_smfmac_f32_16x16x64_bf16 v[48:51], v[16:19], v[176:183], v3
    buffer_load_dwordx4 v[92:95], v2, s[8:11], s18 offen offset:1024 sc1
    v_smfmac_f32_16x16x64_bf16 v[48:51], v[20:23], v[184:191], v3
    v_smfmac_f32_16x16x64_bf16 v[48:51], v[24:27], v[192:199], v3
    v_cvt_pk_bf16_f32 v12, v44, v45
    v_smfmac_f32_16x16x64_bf16 v[48:51], v[28:31], v[200:207], v3
    v_cvt_pk_bf16_f32 v13, v46, v47
    v_smfmac_f32_16x16x64_bf16 v[48:51], v[40:43], v[224:231], v3
    ds_write_b64 v4, v[12:13] offset:8192
    v_smfmac_f32_16x16x64_bf16 v[52:55], v[36:39], a[16:23], v3
    ds_write_b32 v10, v0 offset:24576
    v_smfmac_f32_16x16x64_bf16 v[52:55], v[16:19], v[232:239], v3
    s_add_u32 s18, s23, 16384
    buffer_load_dwordx4 v[96:99], v2, s[8:11], s18 offen offset:0 sc1
    v_smfmac_f32_16x16x64_bf16 v[52:55], v[20:23], v[240:247], v3
    v_cvt_pk_bf16_f32 v12, v48, v49
    v_smfmac_f32_16x16x64_bf16 v[52:55], v[24:27], v[248:255], v3
    v_cvt_pk_bf16_f32 v13, v50, v51
    v_smfmac_f32_16x16x64_bf16 v[52:55], v[28:31], a[0:7], v3
    ds_write_b64 v4, v[12:13] offset:10240
    v_smfmac_f32_16x16x64_bf16 v[52:55], v[40:43], a[24:31], v3
    ds_write_b32 v10, v0 offset:24592
    v_smfmac_f32_16x16x64_bf16 v[56:59], v[36:39], a[72:79], v3
    buffer_load_dwordx4 v[100:103], v2, s[8:11], s18 offen offset:1024 sc1
    v_smfmac_f32_16x16x64_bf16 v[56:59], v[16:19], a[32:39], v3
    v_smfmac_f32_16x16x64_bf16 v[56:59], v[20:23], a[40:47], v3
    v_cvt_pk_bf16_f32 v12, v52, v53
    v_smfmac_f32_16x16x64_bf16 v[56:59], v[24:27], a[48:55], v3
    v_cvt_pk_bf16_f32 v13, v54, v55
    v_smfmac_f32_16x16x64_bf16 v[56:59], v[28:31], a[56:63], v3
    ds_write_b64 v4, v[12:13] offset:12288
    v_smfmac_f32_16x16x64_bf16 v[56:59], v[40:43], a[80:87], v3
    ds_write_b32 v10, v0 offset:24608
    v_smfmac_f32_16x16x64_bf16 v[60:63], v[36:39], a[128:135], v3
    s_add_u32 s18, s23, 18432
    buffer_load_dwordx4 v[104:107], v2, s[8:11], s18 offen offset:0 sc1
    v_smfmac_f32_16x16x64_bf16 v[60:63], v[16:19], a[88:95], v3
    v_smfmac_f32_16x16x64_bf16 v[60:63], v[20:23], a[96:103], v3
    v_cvt_pk_bf16_f32 v12, v56, v57
    v_smfmac_f32_16x16x64_bf16 v[60:63], v[24:27], a[104:111], v3
    v_cvt_pk_bf16_f32 v13, v58, v59
    v_smfmac_f32_16x16x64_bf16 v[60:63], v[28:31], a[112:119], v3
    ds_write_b64 v4, v[12:13] offset:14336
    v_smfmac_f32_16x16x64_bf16 v[60:63], v[40:43], a[136:143], v3
    ds_write_b32 v10, v0 offset:24624
    v_smfmac_f32_16x16x64_bf16 v[64:67], v[36:39], a[184:191], v3
    buffer_load_dwordx4 v[108:111], v2, s[8:11], s18 offen offset:1024 sc1
    v_smfmac_f32_16x16x64_bf16 v[64:67], v[16:19], a[144:151], v3
    v_smfmac_f32_16x16x64_bf16 v[64:67], v[20:23], a[152:159], v3
    v_cvt_pk_bf16_f32 v12, v60, v61
    v_smfmac_f32_16x16x64_bf16 v[64:67], v[24:27], a[160:167], v3
    v_cvt_pk_bf16_f32 v13, v62, v63
    v_smfmac_f32_16x16x64_bf16 v[64:67], v[28:31], a[168:175], v3
    ds_write_b64 v4, v[12:13] offset:16384
    v_smfmac_f32_16x16x64_bf16 v[64:67], v[40:43], a[192:199], v3
    ds_write_b32 v10, v0 offset:24640
    v_smfmac_f32_16x16x64_bf16 v[68:71], v[36:39], a[240:247], v3
    s_add_u32 s18, s23, 20480
    buffer_load_dwordx4 v[112:115], v2, s[8:11], s18 offen offset:0 sc1
    v_smfmac_f32_16x16x64_bf16 v[68:71], v[16:19], a[200:207], v3
    v_smfmac_f32_16x16x64_bf16 v[68:71], v[20:23], a[208:215], v3
    v_cvt_pk_bf16_f32 v12, v64, v65
    v_smfmac_f32_16x16x64_bf16 v[68:71], v[24:27], a[216:223], v3
    v_cvt_pk_bf16_f32 v13, v66, v67
    v_smfmac_f32_16x16x64_bf16 v[68:71], v[28:31], a[224:231], v3
    ds_write_b64 v4, v[12:13] offset:18432
    v_smfmac_f32_16x16x64_bf16 v[68:71], v[40:43], a[248:255], v3
    buffer_load_dwordx4 v[116:119], v2, s[8:11], s18 offen offset:1024 sc1
    s_nop 6
    v_cvt_pk_bf16_f32 v12, v68, v69
    v_cvt_pk_bf16_f32 v13, v70, v71
    ds_write_b64 v4, v[12:13] offset:20480
    s_waitcnt lgkmcnt(0)
    s_barrier
    s_add_u32 s14, s14, 1
    s_cmp_lt_u32 s14, 63
    s_cbranch_scc1 ALOOP_48
    s_branch A_LAST
SLOW_47:
    s_mov_b32 s93, 46137344
    s_mov_b32 s94, 116394240
    s_mov_b32 s14, 0
ALOOP_53:
    s_and_b32 s18, s14, 3
    s_lshl_b32 s18, s18, 17
    s_add_u32 s15, s18, 75497472
    s_xor_b32 s17, s15, 262144
    s_mov_b32 s31, s15
    v_add_u32 v0, 1, v0
    s_mov_b32 s22, 0
    s_add_u32 s23, s23, 458752
    s_add_u32 s27, s14, 2
    s_min_u32 s27, s27, 64
    s_cmp_ge_u32 s26, s27
    s_cbranch_scc1 RDO_54
    s_mov_b32 s18, 116394240
RDP_55:
    buffer_load_dword v12, off, s[8:11], s18 sc1
    s_add_u32 s22, s22, 1
    s_cmp_gt_u32 s22, 2000000
    s_cbranch_scc1 MEGA_EXIT
    s_waitcnt vmcnt(0)
    v_readfirstlane_b32 s26, v12
    s_nop 0
    s_cmp_lt_u32 s26, s27
    s_cbranch_scc1 RDP_55
RDO_54:
    s_min_u32 s20, s12, 13
    s_mul_i32 s20, s20, 32768
    s_add_u32 s19, s14, 2
    s_sub_u32 s21, s26, 1
    s_min_u32 s19, s19, s21
    s_mul_i32 s19, s19, 458752
    s_add_u32 s20, s20, s19
    s_add_u32 s20, s20, 46161920
    v_lshlrev_b32 v14, 7, v1
    v_mov_b64 v[44:45], 0
    v_mov_b64 v[46:47], 0
    v_mov_b64 v[48:49], 0
    v_mov_b64 v[50:51], 0
    v_mov_b64 v[52:53], 0
    v_mov_b64 v[54:55], 0
    v_mov_b64 v[56:57], 0
    v_mov_b64 v[58:59], 0
    v_mov_b64 v[60:61], 0
    v_mov_b64 v[62:63], 0
    v_mov_b64 v[64:65], 0
    v_mov_b64 v[66:67], 0
    v_mov_b64 v[68:69], 0
    v_mov_b64 v[70:71], 0
    v_mov_b64 v[76:77], 0
    v_mov_b64 v[78:79], 0
    s_barrier
    buffer_load_dword v15, v14, s[8:11], s20 offen sc1
    s_cmp_eq_u32 s14, 0
    s_cbranch_scc1 NSL_57
    s_sleep 14
NSL_57:
    buffer_load_dword v7, off, s[8:11], s94 sc1
    buffer_load_dwordx4 v[32:35], v11, s[8:11], s31 offen offset:0 sc1
    buffer_load_dwordx4 v[36:39], v11, s[8:11], s31 offen offset:1024 sc1
    s_sleep 2
    s_waitcnt lgkmcnt(0)
PM_56:
    buffer_load_dwordx4 v[32:35], v11, s[8:11], s31 offen offset:0 sc1
    buffer_load_dwordx4 v[36:39], v11, s[8:11], s31 offen offset:1024 sc1
    s_add_u32 s22, s22, 1
    s_cmp_gt_u32 s22, 2000000
    s_cbranch_scc1 MEGA_EXIT
    s_waitcnt vmcnt(3)
    v_max3_u32 v12, v32, v33, v34
    v_max_u32 v12, v12, v35
    s_waitcnt vmcnt(2)
    v_max3_u32 v12, v12, v36, v37
    v_max3_u32 v12, v12, v38, v39
    v_cmp_eq_u32 vcc, -1, v12
    s_cbranch_vccnz PM_56
    v_smfmac_f32_16x16x64_bf16 v[76:79], v[32:35], v[80:87], v3
    ds_write_b128 v2, v[32:35] offset:4096
    v_smfmac_f32_16x16x64_bf16 v[76:79], v[36:39], v[88:95], v3
    ds_write_b128 v2, v[36:39] offset:5120
    v_smfmac_f32_16x16x64_bf16 v[44:47], v[32:35], v[152:159], v3
    v_readfirstlane_b32 s26, v7
    v_smfmac_f32_16x16x64_bf16 v[48:51], v[32:35], v[208:215], v3
    v_smfmac_f32_16x16x64_bf16 v[52:55], v[32:35], a[8:15], v3
    s_waitcnt lgkmcnt(0)
    s_barrier
    ds_read_b128 v[16:19], v2 offset:0
    ds_read_b128 v[20:23], v2 offset:1024
    v_smfmac_f32_16x16x64_bf16 v[56:59], v[32:35], a[64:71], v3
    ds_read_b128 v[24:27], v2 offset:2048
    ds_read_b128 v[28:31], v2 offset:3072
    v_smfmac_f32_16x16x64_bf16 v[60:63], v[32:35], a[120:127], v3
    ds_read_b128 v[40:43], v2 offset:6144
    v_smfmac_f32_16x16x64_bf16 v[64:67], v[32:35], a[176:183], v3
    s_add_u32 s18, s23, 22528
    buffer_load_dwordx4 v[80:83], v2, s[8:11], s18 offen offset:0 sc1
    v_smfmac_f32_16x16x64_bf16 v[68:71], v[32:35], a[232:239], v3
    v_smfmac_f32_16x16x64_bf16 v[44:47], v[36:39], v[160:167], v3
    v_smfmac_f32_16x16x64_bf16 v[48:51], v[36:39], v[216:223], v3
    s_waitcnt lgkmcnt(0)
    v_smfmac_f32_16x16x64_bf16 v[76:79], v[20:23], v[96:103], v3
    buffer_load_dwordx4 v[84:87], v2, s[8:11], s18 offen offset:1024 sc1
    v_smfmac_f32_16x16x64_bf16 v[76:79], v[24:27], v[104:111], v3
    v_smfmac_f32_16x16x64_bf16 v[76:79], v[28:31], v[112:119], v3
    v_smfmac_f32_16x16x64_bf16 v[44:47], v[16:19], v[120:127], v3
    v_smfmac_f32_16x16x64_bf16 v[44:47], v[20:23], v[128:135], v3
    s_add_u32 s18, s23, 24576
    buffer_load_dwordx4 v[88:91], v2, s[8:11], s18 offen offset:0 sc1
    v_smfmac_f32_16x16x64_bf16 v[44:47], v[24:27], v[136:143], v3
    v_permlane32_swap_b32 v76, v78
    v_permlane32_swap_b32 v77, v79
    v_add_f32 v76, v76, v78
    v_add_f32 v77, v77, v79
    v_smfmac_f32_16x16x64_bf16 v[44:47], v[28:31], v[144:151], v3
    ds_write_b64 v5, v[76:77] offset:29184
    ds_write_b32 v10, v0 offset:24688
    v_smfmac_f32_16x16x64_bf16 v[44:47], v[40:43], v[168:175], v3
    v_smfmac_f32_16x16x64_bf16 v[48:51], v[16:19], v[176:183], v3
    buffer_load_dwordx4 v[92:95], v2, s[8:11], s18 offen offset:1024 sc1
    v_smfmac_f32_16x16x64_bf16 v[48:51], v[20:23], v[184:191], v3
    v_smfmac_f32_16x16x64_bf16 v[48:51], v[24:27], v[192:199], v3
    v_cvt_pk_bf16_f32 v12, v44, v45
    v_smfmac_f32_16x16x64_bf16 v[48:51], v[28:31], v[200:207], v3
    v_cvt_pk_bf16_f32 v13, v46, v47
    v_smfmac_f32_16x16x64_bf16 v[48:51], v[40:43], v[224:231], v3
    ds_write_b64 v4, v[12:13] offset:8192
    v_smfmac_f32_16x16x64_bf16 v[52:55], v[36:39], a[16:23], v3
    ds_write_b32 v10, v0 offset:24576
    v_smfmac_f32_16x16x64_bf16 v[52:55], v[16:19], v[232:239], v3
    s_add_u32 s18, s23, 16384
    buffer_load_dwordx4 v[96:99], v2, s[8:11], s18 offen offset:0 sc1
    v_smfmac_f32_16x16x64_bf16 v[52:55], v[20:23], v[240:247], v3
    v_cvt_pk_bf16_f32 v12, v48, v49
    v_smfmac_f32_16x16x64_bf16 v[52:55], v[24:27], v[248:255], v3
    v_cvt_pk_bf16_f32 v13, v50, v51
    v_smfmac_f32_16x16x64_bf16 v[52:55], v[28:31], a[0:7], v3
    ds_write_b64 v4, v[12:13] offset:10240
    v_smfmac_f32_16x16x64_bf16 v[52:55], v[40:43], a[24:31], v3
    ds_write_b32 v10, v0 offset:24592
    v_smfmac_f32_16x16x64_bf16 v[56:59], v[36:39], a[72:79], v3
    buffer_load_dwordx4 v[100:103], v2, s[8:11], s18 offen offset:1024 sc1
    v_smfmac_f32_16x16x64_bf16 v[56:59], v[16:19], a[32:39], v3
    v_smfmac_f32_16x16x64_bf16 v[56:59], v[20:23], a[40:47], v3
    v_cvt_pk_bf16_f32 v12, v52, v53
    v_smfmac_f32_16x16x64_bf16 v[56:59], v[24:27], a[48:55], v3
    v_cvt_pk_bf16_f32 v13, v54, v55
    v_smfmac_f32_16x16x64_bf16 v[56:59], v[28:31], a[56:63], v3
    ds_write_b64 v4, v[12:13] offset:12288
    v_smfmac_f32_16x16x64_bf16 v[56:59], v[40:43], a[80:87], v3
    ds_write_b32 v10, v0 offset:24608
    v_smfmac_f32_16x16x64_bf16 v[60:63], v[36:39], a[128:135], v3
    s_add_u32 s18, s23, 18432
    buffer_load_dwordx4 v[104:107], v2, s[8:11], s18 offen offset:0 sc1
    v_smfmac_f32_16x16x64_bf16 v[60:63], v[16:19], a[88:95], v3
    v_smfmac_f32_16x16x64_bf16 v[60:63], v[20:23], a[96:103], v3
    v_cvt_pk_bf16_f32 v12, v56, v57
    v_smfmac_f32_16x16x64_bf16 v[60:63], v[24:27], a[104:111], v3
    v_cvt_pk_bf16_f32 v13, v58, v59
    v_smfmac_f32_16x16x64_bf16 v[60:63], v[28:31], a[112:119], v3
    ds_write_b64 v4, v[12:13] offset:14336
    v_smfmac_f32_16x16x64_bf16 v[60:63], v[40:43], a[136:143], v3
    ds_write_b32 v10, v0 offset:24624
    v_smfmac_f32_16x16x64_bf16 v[64:67], v[36:39], a[184:191], v3
    buffer_load_dwordx4 v[108:111], v2, s[8:11], s18 offen offset:1024 sc1
    v_smfmac_f32_16x16x64_bf16 v[64:67], v[16:19], a[144:151], v3
    v_smfmac_f32_16x16x64_bf16 v[64:67], v[20:23], a[152:159], v3
    v_cvt_pk_bf16_f32 v12, v60, v61
    v_smfmac_f32_16x16x64_bf16 v[64:67], v[24:27], a[160:167], v3
    v_cvt_pk_bf16_f32 v13, v62, v63
    v_smfmac_f32_16x16x64_bf16 v[64:67], v[28:31], a[168:175], v3
    ds_write_b64 v4, v[12:13] offset:16384
    v_smfmac_f32_16x16x64_bf16 v[64:67], v[40:43], a[192:199], v3
    ds_write_b32 v10, v0 offset:24640
    v_smfmac_f32_16x16x64_bf16 v[68:71], v[36:39], a[240:247], v3
    s_add_u32 s18, s23, 20480
    buffer_load_dwordx4 v[112:115], v2, s[8:11], s18 offen offset:0 sc1
    v_smfmac_f32_16x16x64_bf16 v[68:71], v[16:19], a[200:207], v3
    v_smfmac_f32_16x16x64_bf16 v[68:71], v[20:23], a[208:215], v3
    v_cvt_pk_bf16_f32 v12, v64, v65
    v_smfmac_f32_16x16x64_bf16 v[68:71], v[24:27], a[216:223], v3
    v_cvt_pk_bf16_f32 v13, v66, v67
    v_smfmac_f32_16x16x64_bf16 v[68:71], v[28:31], a[224:231], v3
    ds_write_b64 v4, v[12:13] offset:18432
    v_smfmac_f32_16x16x64_bf16 v[68:71], v[40:43], a[248:255], v3
    buffer_load_dwordx4 v[116:119], v2, s[8:11], s18 offen offset:1024 sc1
    s_nop 6
    v_cvt_pk_bf16_f32 v12, v68, v69
    v_cvt_pk_bf16_f32 v13, v70, v71
    ds_write_b64 v4, v[12:13] offset:20480
    s_waitcnt lgkmcnt(0)
    s_barrier
    s_add_u32 s14, s14, 1
    s_cmp_lt_u32 s14, 63
    s_cbranch_scc1 ALOOP_53
    s_branch A_LAST
DSP_16:
    s_mov_b32 s27, 1
    s_cmp_ge_u32 s26, s27
    s_cbranch_scc1 RDO_58
    s_mov_b32 s18, 116394240
RDP_59:
    buffer_load_dword v12, off, s[8:11], s18 sc1
    s_add_u32 s22, s22, 1
    s_cmp_gt_u32 s22, 2000000
    s_cbranch_scc1 MEGA_EXIT
    s_waitcnt vmcnt(0)
    v_readfirstlane_b32 s26, v12
    s_nop 0
    s_cmp_lt_u32 s26, s27
    s_cbranch_scc1 RDP_59
RDO_58:
    s_add_u32 s18, s23, 12288
    buffer_load_dwordx4 v[80:83], v2, s[8:11], s18 offen offset:0 sc1
    buffer_load_dwordx4 v[84:87], v2, s[8:11], s18 offen offset:1024 sc1
    s_add_u32 s18, s23, 26624
    buffer_load_dwordx4 v[88:91], v2, s[8:11], s18 offen offset:0 sc1
    buffer_load_dwordx4 v[92:95], v2, s[8:11], s18 offen offset:1024 sc1
    s_add_u32 s18, s23, 0
    buffer_load_dwordx4 v[96:99], v2, s[8:11], s18 offen offset:0 sc1
    buffer_load_dwordx4 v[100:103], v2, s[8:11], s18 offen offset:1024 sc1
    s_add_u32 s18, s23, 14336
    buffer_load_dwordx4 v[104:107], v2, s[8:11], s18 offen offset:0 sc1
    buffer_load_dwordx4 v[108:111], v2, s[8:11], s18 offen offset:1024 sc1
    s_cmp_lg_u32 s40, 0
    s_cbranch_scc1 SLOW_60
    s_mov_b32 s93, 46137344
    s_mov_b32 s94, 116394240
    s_mov_b32 s14, 0
ALOOP_61:
    s_and_b32 s18, s14, 3
    s_lshl_b32 s18, s18, 17
    s_add_u32 s15, s18, 75497472
    s_xor_b32 s17, s15, 262144
    s_mov_b32 s31, s15
    v_add_u32 v0, 1, v0
    s_mov_b32 s22, 0
    v_mov_b64 v[14:15], -1
    buffer_store_dwordx2 v[14:15], v8, s[8:11], s17 offen
    s_add_u32 s23, s23, 458752
    s_add_u32 s27, s14, 2
    s_min_u32 s27, s27, 64
    s_cmp_ge_u32 s26, s27
    s_cbranch_scc1 RDO_62
    s_mov_b32 s18, 116394240
RDP_63:
    buffer_load_dword v12, off, s[8:11], s18 sc1
    s_add_u32 s22, s22, 1
    s_cmp_gt_u32 s22, 2000000
    s_cbranch_scc1 MEGA_EXIT
    s_waitcnt vmcnt(0)
    v_readfirstlane_b32 s26, v12
    s_nop 0
    s_cmp_lt_u32 s26, s27
    s_cbranch_scc1 RDP_63
RDO_62:
    v_mov_b64 v[44:45], 0
    v_mov_b64 v[46:47], 0
    v_mov_b64 v[48:49], 0
    v_mov_b64 v[50:51], 0
    v_mov_b64 v[52:53], 0
    v_mov_b64 v[54:55], 0
    v_mov_b64 v[56:57], 0
    v_mov_b64 v[58:59], 0
    v_mov_b64 v[60:61], 0
    v_mov_b64 v[62:63], 0
    v_mov_b64 v[64:65], 0
    v_mov_b64 v[66:67], 0
    v_mov_b64 v[68:69], 0
    v_mov_b64 v[70:71], 0
    v_mov_b64 v[72:73], 0
    v_mov_b64 v[74:75], 0
    v_mov_b64 v[76:77], 0
    v_mov_b64 v[78:79], 0
    s_barrier
    s_cmp_eq_u32 s14, 0
    s_cbranch_scc1 NSL_65
    s_sleep 14
NSL_65:
    buffer_load_dword v7, off, s[8:11], s94 sc1
    buffer_load_dwordx4 v[40:43], v11, s[8:11], s31 offen offset:2048 sc1
    buffer_load_dwordx4 v[16:19], v2, s[8:11], s31 offen offset:0 sc1
    s_sleep 2
    s_waitcnt lgkmcnt(0)
PM_64:
    buffer_load_dwordx4 v[40:43], v11, s[8:11], s31 offen offset:2048 sc1
    buffer_load_dwordx4 v[16:19], v2, s[8:11], s31 offen offset:0 sc1
    s_add_u32 s22, s22, 1
    s_cmp_gt_u32 s22, 2000000
    s_cbranch_scc1 MEGA_EXIT
    s_waitcnt vmcnt(3)
    v_max3_u32 v12, v40, v41, v42
    v_max_u32 v12, v12, v43
    s_waitcnt vmcnt(2)
    v_max3_u32 v12, v12, v16, v17
    v_max3_u32 v12, v12, v18, v19
    v_cmp_eq_u32 vcc, -1, v12
    s_cbranch_vccnz PM_64
    v_smfmac_f32_16x16x64_bf16 v[72:75], v[40:43], v[80:87], v3
    ds_write_b128 v2, v[40:43] offset:6144
    v_smfmac_f32_16x16x64_bf16 v[76:79], v[40:43], v[88:95], v3
    v_smfmac_f32_16x16x64_bf16 v[72:75], v[16:19], v[96:103], v3
    v_readfirstlane_b32 s26, v7
    v_smfmac_f32_16x16x64_bf16 v[76:79], v[16:19], v[104:111], v3
    v_smfmac_f32_16x16x64_bf16 v[44:47], v[40:43], v[168:175], v3
    s_waitcnt lgkmcnt(0)
    s_barrier
    ds_read_b128 v[20:23], v2 offset:1024
    ds_read_b128 v[24:27], v2 offset:2048
    v_smfmac_f32_16x16x64_bf16 v[48:51], v[40:43], v[224:231], v3
    ds_read_b128 v[28:31], v2 offset:3072
    ds_read_b128 v[32:35], v2 offset:4096
    v_smfmac_f32_16x16x64_bf16 v[52:55], v[40:43], a[24:31], v3
    ds_read_b128 v[36:39], v2 offset:5120
    v_permlane32_swap_b32 v72, v74
    v_smfmac_f32_16x16x64_bf16 v[56:59], v[40:43], a[80:87], v3
    s_add_u32 s18, s23, 12288
    buffer_load_dwordx4 v[80:83], v2, s[8:11], s18 offen offset:0 sc1
    v_permlane32_swap_b32 v73, v75
    v_smfmac_f32_16x16x64_bf16 v[60:63], v[40:43], a[136:143], v3
    v_add_f32 v72, v72, v74
    v_smfmac_f32_16x16x64_bf16 v[64:67], v[40:43], a[192:199], v3
    v_add_f32 v73, v73, v75
    v_smfmac_f32_16x16x64_bf16 v[68:71], v[40:43], a[248:255], v3
    ds_write_b64 v5, v[72:73] offset:29696
    s_waitcnt lgkmcnt(1)
    v_permlane32_swap_b32 v76, v78
    v_smfmac_f32_16x16x64_bf16 v[44:47], v[16:19], v[120:127], v3
    buffer_load_dwordx4 v[84:87], v2, s[8:11], s18 offen offset:1024 sc1
    v_permlane32_swap_b32 v77, v79
    v_smfmac_f32_16x16x64_bf16 v[44:47], v[20:23], v[128:135], v3
    v_add_f32 v76, v76, v78
    v_smfmac_f32_16x16x64_bf16 v[44:47], v[24:27], v[136:143], v3
    v_add_f32 v77, v77, v79
    v_smfmac_f32_16x16x64_bf16 v[44:47], v[28:31], v[144:151], v3
    ds_write_b64 v5, v[76:77] offset:30208
    v_smfmac_f32_16x16x64_bf16 v[44:47], v[32:35], v[152:159], v3
    ds_write_b32 v10, v0 offset:24688
    v_smfmac_f32_16x16x64_bf16 v[44:47], v[36:39], v[160:167], v3
    s_add_u32 s18, s23, 26624
    buffer_load_dwordx4 v[88:91], v2, s[8:11], s18 offen offset:0 sc1
    v_smfmac_f32_16x16x64_bf16 v[48:51], v[16:19], v[176:183], v3
    v_smfmac_f32_16x16x64_bf16 v[48:51], v[20:23], v[184:191], v3
    v_smfmac_f32_16x16x64_bf16 v[48:51], v[24:27], v[192:199], v3
    v_cvt_pk_bf16_f32 v12, v44, v45
    v_smfmac_f32_16x16x64_bf16 v[48:51], v[28:31], v[200:207], v3
    buffer_load_dwordx4 v[92:95], v2, s[8:11], s18 offen offset:1024 sc1
    v_cvt_pk_bf16_f32 v13, v46, v47
    v_smfmac_f32_16x16x64_bf16 v[48:51], v[32:35], v[208:215], v3
    ds_write_b64 v4, v[12:13] offset:8192
    v_smfmac_f32_16x16x64_bf16 v[48:51], v[36:39], v[216:223], v3
    ds_write_b32 v10, v0 offset:24576
    v_smfmac_f32_16x16x64_bf16 v[52:55], v[16:19], v[232:239], v3
    v_smfmac_f32_16x16x64_bf16 v[52:55], v[20:23], v[240:247], v3
    s_add_u32 s18, s23, 0
    buffer_load_dwordx4 v[96:99], v2, s[8:11], s18 offen offset:0 sc1
    v_smfmac_f32_16x16x64_bf16 v[52:55], v[24:27], v[248:255], v3
    v_cvt_pk_bf16_f32 v12, v48, v49
    v_smfmac_f32_16x16x64_bf16 v[52:55], v[28:31], a[0:7], v3
    v_cvt_pk_bf16_f32 v13, v50, v51
    v_smfmac_f32_16x16x64_bf16 v[52:55], v[32:35], a[8:15], v3
    ds_write_b64 v4, v[12:13] offset:10240
    v_smfmac_f32_16x16x64_bf16 v[52:55], v[36:39], a[16:23], v3
    ds_write_b32 v10, v0 offset:24592
    v_smfmac_f32_16x16x64_bf16 v[56:59], v[16:19], a[32:39], v3
    buffer_load_dwordx4 v[100:103], v2, s[8:11], s18 offen offset:1024 sc1
    v_smfmac_f32_16x16x64_bf16 v[56:59], v[20:23], a[40:47], v3
    v_smfmac_f32_16x16x64_bf16 v[56:59], v[24:27], a[48:55], v3
    v_cvt_pk_bf16_f32 v12, v52, v53
    v_smfmac_f32_16x16x64_bf16 v[56:59], v[28:31], a[56:63], v3
    v_cvt_pk_bf16_f32 v13, v54, v55
    v_smfmac_f32_16x16x64_bf16 v[56:59], v[32:35], a[64:71], v3
    ds_write_b64 v4, v[12:13] offset:12288
    v_smfmac_f32_16x16x64_bf16 v[56:59], v[36:39], a[72:79], v3
    ds_write_b32 v10, v0 offset:24608
    v_smfmac_f32_16x16x64_bf16 v[60:63], v[16:19], a[88:95], v3
    s_add_u32 s18, s23, 14336
    buffer_load_dwordx4 v[104:107], v2, s[8:11], s18 offen offset:0 sc1
    v_smfmac_f32_16x16x64_bf16 v[60:63], v[20:23], a[96:103], v3
    v_smfmac_f32_16x16x64_bf16 v[60:63], v[24:27], a[104:111], v3
    v_cvt_pk_bf16_f32 v12, v56, v57
    v_smfmac_f32_16x16x64_bf16 v[60:63], v[28:31], a[112:119], v3
    v_cvt_pk_bf16_f32 v13, v58, v59
    v_smfmac_f32_16x16x64_bf16 v[60:63], v[32:35], a[120:127], v3
    ds_write_b64 v4, v[12:13] offset:14336
    v_smfmac_f32_16x16x64_bf16 v[60:63], v[36:39], a[128:135], v3
    ds_write_b32 v10, v0 offset:24624
    v_smfmac_f32_16x16x64_bf16 v[64:67], v[16:19], a[144:151], v3
    buffer_load_dwordx4 v[108:111], v2, s[8:11], s18 offen offset:1024 sc1
    v_smfmac_f32_16x16x64_bf16 v[64:67], v[20:23], a[152:159], v3
    v_smfmac_f32_16x16x64_bf16 v[64:67], v[24:27], a[160:167], v3
    v_cvt_pk_bf16_f32 v12, v60, v61
    v_smfmac_f32_16x16x64_bf16 v[64:67], v[28:31], a[168:175], v3
    v_cvt_pk_bf16_f32 v13, v62, v63
    v_smfmac_f32_16x16x64_bf16 v[64:67], v[32:35], a[176:183], v3
    ds_write_b64 v4, v[12:13] offset:16384
    v_smfmac_f32_16x16x64_bf16 v[64:67], v[36:39], a[184:191], v3
    ds_write_b32 v10, v0 offset:24640
    v_smfmac_f32_16x16x64_bf16 v[68:71], v[16:19], a[200:207], v3
    v_smfmac_f32_16x16x64_bf16 v[68:71], v[20:23], a[208:215], v3
    v_smfmac_f32_16x16x64_bf16 v[68:71], v[24:27], a[216:223], v3
    v_cvt_pk_bf16_f32 v12, v64, v65
    v_smfmac_f32_16x16x64_bf16 v[68:71], v[28:31], a[224:231], v3
    v_cvt_pk_bf16_f32 v13, v66, v67
    v_smfmac_f32_16x16x64_bf16 v[68:71], v[32:35], a[232:239], v3
    ds_write_b64 v4, v[12:13] offset:18432
    v_smfmac_f32_16x16x64_bf16 v[68:71], v[36:39], a[240:247], v3
    s_nop 7
    v_cvt_pk_bf16_f32 v12, v68, v69
    v_cvt_pk_bf16_f32 v13, v70, v71
    ds_write_b64 v4, v[12:13] offset:20480
    s_waitcnt lgkmcnt(0)
    s_barrier
    s_cmp_lg_u32 s12, 0
    s_cbranch_scc1 NPG_66
    v_mov_b32 v12, s14
    s_mov_b32 s18, 76021504
    buffer_store_dword v12, off, s[8:11], s18
NPG_66:
    s_add_u32 s14, s14, 1
    s_cmp_lt_u32 s14, 63
    s_cbranch_scc1 ALOOP_61
    s_branch A_LAST
SLOW_60:
    s_mov_b32 s93, 46137344
    s_mov_b32 s94, 116394240
    s_mov_b32 s14, 0
ALOOP_67:
    s_and_b32 s18, s14, 3
    s_lshl_b32 s18, s18, 17
    s_add_u32 s15, s18, 75497472
    s_xor_b32 s17, s15, 262144
    s_mov_b32 s31, s15
    v_add_u32 v0, 1, v0
    s_mov_b32 s22, 0
    v_mov_b64 v[14:15], -1
    buffer_store_dwordx2 v[14:15], v8, s[8:11], s17 offen sc1
    s_add_u32 s23, s23, 458752
    s_add_u32 s27, s14, 2
    s_min_u32 s27, s27, 64
    s_cmp_ge_u32 s26, s27
    s_cbranch_scc1 RDO_68
    s_mov_b32 s18, 116394240
RDP_69:
    buffer_load_dword v12, off, s[8:11], s18 sc1
    s_add_u32 s22, s22, 1
    s_cmp_gt_u32 s22, 2000000
    s_cbranch_scc1 MEGA_EXIT
    s_waitcnt vmcnt(0)
    v_readfirstlane_b32 s26, v12
    s_nop 0
    s_cmp_lt_u32 s26, s27
    s_cbranch_scc1 RDP_69
RDO_68:
    v_mov_b64 v[44:45], 0
    v_mov_b64 v[46:47], 0
    v_mov_b64 v[48:49], 0
    v_mov_b64 v[50:51], 0
    v_mov_b64 v[52:53], 0
    v_mov_b64 v[54:55], 0
    v_mov_b64 v[56:57], 0
    v_mov_b64 v[58:59], 0
    v_mov_b64 v[60:61], 0
    v_mov_b64 v[62:63], 0
    v_mov_b64 v[64:65], 0
    v_mov_b64 v[66:67], 0
    v_mov_b64 v[68:69], 0
    v_mov_b64 v[70:71], 0
    v_mov_b64 v[72:73], 0
    v_mov_b64 v[74:75], 0
    v_mov_b64 v[76:77], 0
    v_mov_b64 v[78:79], 0
    s_barrier
    s_cmp_eq_u32 s14, 0
    s_cbranch_scc1 NSL_71
    s_sleep 14
NSL_71:
    buffer_load_dword v7, off, s[8:11], s94 sc1
    buffer_load_dwordx4 v[40:43], v11, s[8:11], s31 offen offset:2048 sc1
    buffer_load_dwordx4 v[16:19], v2, s[8:11], s31 offen offset:0 sc1
    s_sleep 2
    s_waitcnt lgkmcnt(0)
PM_70:
    buffer_load_dwordx4 v[40:43], v11, s[8:11], s31 offen offset:2048 sc1
    buffer_load_dwordx4 v[16:19], v2, s[8:11], s31 offen offset:0 sc1
    s_add_u32 s22, s22, 1
    s_cmp_gt_u32 s22, 2000000
    s_cbranch_scc1 MEGA_EXIT
    s_waitcnt vmcnt(3)
    v_max3_u32 v12, v40, v41, v42
    v_max_u32 v12, v12, v43
    s_waitcnt vmcnt(2)
    v_max3_u32 v12, v12, v16, v17
    v_max3_u32 v12, v12, v18, v19
    v_cmp_eq_u32 vcc, -1, v12
    s_cbranch_vccnz PM_70
    v_smfmac_f32_16x16x64_bf16 v[72:75], v[40:43], v[80:87], v3
    ds_write_b128 v2, v[40:43] offset:6144
    v_smfmac_f32_16x16x64_bf16 v[76:79], v[40:43], v[88:95], v3
    v_smfmac_f32_16x16x64_bf16 v[72:75], v[16:19], v[96:103], v3
    v_readfirstlane_b32 s26, v7
    v_smfmac_f32_16x16x64_bf16 v[76:79], v[16:19], v[104:111], v3
    v_smfmac_f32_16x16x64_bf16 v[44:47], v[40:43], v[168:175], v3
    s_waitcnt lgkmcnt(0)
    s_barrier
    ds_read_b128 v[20:23], v2 offset:1024
    ds_read_b128 v[24:27], v2 offset:2048
    v_smfmac_f32_16x16x64_bf16 v[48:51], v[40:43], v[224:231], v3
    ds_read_b128 v[28:31], v2 offset:3072
    ds_read_b128 v[32:35], v2 offset:4096
    v_smfmac_f32_16x16x64_bf16 v[52:55], v[40:43], a[24:31], v3
    ds_read_b128 v[36:39], v2 offset:5120
    v_permlane32_swap_b32 v72, v74
    v_smfmac_f32_16x16x64_bf16 v[56:59], v[40:43], a[80:87], v3
    s_add_u32 s18, s23, 12288
    buffer_load_dwordx4 v[80:83], v2, s[8:11], s18 offen offset:0 sc1
    v_permlane32_swap_b32 v73, v75
    v_smfmac_f32_16x16x64_bf16 v[60:63], v[40:43], a[136:143], v3
    v_add_f32 v72, v72, v74
    v_smfmac_f32_16x16x64_bf16 v[64:67], v[40:43], a[192:199], v3
    v_add_f32 v73, v73, v75
    v_smfmac_f32_16x16x64_bf16 v[68:71], v[40:43], a[248:255], v3
    ds_write_b64 v5, v[72:73] offset:29696
    s_waitcnt lgkmcnt(1)
    v_permlane32_swap_b32 v76, v78
    v_smfmac_f32_16x16x64_bf16 v[44:47], v[16:19], v[120:127], v3
    buffer_load_dwordx4 v[84:87], v2, s[8:11], s18 offen offset:1024 sc1
    v_permlane32_swap_b32 v77, v79
    v_smfmac_f32_16x16x64_bf16 v[44:47], v[20:23], v[128:135], v3
    v_add_f32 v76, v76, v78
    v_smfmac_f32_16x16x64_bf16 v[44:47], v[24:27], v[136:143], v3
    v_add_f32 v77, v77, v79
    v_smfmac_f32_16x16x64_bf16 v[44:47], v[28:31], v[144:151], v3
    ds_write_b64 v5, v[76:77] offset:30208
    v_smfmac_f32_16x16x64_bf16 v[44:47], v[32:35], v[152:159], v3
    ds_write_b32 v10, v0 offset:24688
    v_smfmac_f32_16x16x64_bf16 v[44:47], v[36:39], v[160:167], v3
    s_add_u32 s18, s23, 26624
    buffer_load_dwordx4 v[88:91], v2, s[8:11], s18 offen offset:0 sc1
    v_smfmac_f32_16x16x64_bf16 v[48:51], v[16:19], v[176:183], v3
    v_smfmac_f32_16x16x64_bf16 v[48:51], v[20:23], v[184:191], v3
    v_smfmac_f32_16x16x64_bf16 v[48:51], v[24:27], v[192:199], v3
    v_cvt_pk_bf16_f32 v12, v44, v45
    v_smfmac_f32_16x16x64_bf16 v[48:51], v[28:31], v[200:207], v3
    buffer_load_dwordx4 v[92:95], v2, s[8:11], s18 offen offset:1024 sc1
    v_cvt_pk_bf16_f32 v13, v46, v47
    v_smfmac_f32_16x16x64_bf16 v[48:51], v[32:35], v[208:215], v3
    ds_write_b64 v4, v[12:13] offset:8192
    v_smfmac_f32_16x16x64_bf16 v[48:51], v[36:39], v[216:223], v3
    ds_write_b32 v10, v0 offset:24576
    v_smfmac_f32_16x16x64_bf16 v[52:55], v[16:19], v[232:239], v3
    v_smfmac_f32_16x16x64_bf16 v[52:55], v[20:23], v[240:247], v3
    s_add_u32 s18, s23, 0
    buffer_load_dwordx4 v[96:99], v2, s[8:11], s18 offen offset:0 sc1
    v_smfmac_f32_16x16x64_bf16 v[52:55], v[24:27], v[248:255], v3
    v_cvt_pk_bf16_f32 v12, v48, v49
    v_smfmac_f32_16x16x64_bf16 v[52:55], v[28:31], a[0:7], v3
    v_cvt_pk_bf16_f32 v13, v50, v51
    v_smfmac_f32_16x16x64_bf16 v[52:55], v[32:35], a[8:15], v3
    ds_write_b64 v4, v[12:13] offset:10240
    v_smfmac_f32_16x16x64_bf16 v[52:55], v[36:39], a[16:23], v3
    ds_write_b32 v10, v0 offset:24592
    v_smfmac_f32_16x16x64_bf16 v[56:59], v[16:19], a[32:39], v3
    buffer_load_dwordx4 v[100:103], v2, s[8:11], s18 offen offset:1024 sc1
    v_smfmac_f32_16x16x64_bf16 v[56:59], v[20:23], a[40:47], v3
    v_smfmac_f32_16x16x64_bf16 v[56:59], v[24:27], a[48:55], v3
    v_cvt_pk_bf16_f32 v12, v52, v53
    v_smfmac_f32_16x16x64_bf16 v[56:59], v[28:31], a[56:63], v3
    v_cvt_pk_bf16_f32 v13, v54, v55
    v_smfmac_f32_16x16x64_bf16 v[56:59], v[32:35], a[64:71], v3
    ds_write_b64 v4, v[12:13] offset:12288
    v_smfmac_f32_16x16x64_bf16 v[56:59], v[36:39], a[72:79], v3
    ds_write_b32 v10, v0 offset:24608
    v_smfmac_f32_16x16x64_bf16 v[60:63], v[16:19], a[88:95], v3
    s_add_u32 s18, s23, 14336
    buffer_load_dwordx4 v[104:107], v2, s[8:11], s18 offen offset:0 sc1
    v_smfmac_f32_16x16x64_bf16 v[60:63], v[20:23], a[96:103], v3
    v_smfmac_f32_16x16x64_bf16 v[60:63], v[24:27], a[104:111], v3
    v_cvt_pk_bf16_f32 v12, v56, v57
    v_smfmac_f32_16x16x64_bf16 v[60:63], v[28:31], a[112:119], v3
    v_cvt_pk_bf16_f32 v13, v58, v59
    v_smfmac_f32_16x16x64_bf16 v[60:63], v[32:35], a[120:127], v3
    ds_write_b64 v4, v[12:13] offset:14336
    v_smfmac_f32_16x16x64_bf16 v[60:63], v[36:39], a[128:135], v3
    ds_write_b32 v10, v0 offset:24624
    v_smfmac_f32_16x16x64_bf16 v[64:67], v[16:19], a[144:151], v3
    buffer_load_dwordx4 v[108:111], v2, s[8:11], s18 offen offset:1024 sc1
    v_smfmac_f32_16x16x64_bf16 v[64:67], v[20:23], a[152:159], v3
    v_smfmac_f32_16x16x64_bf16 v[64:67], v[24:27], a[160:167], v3
    v_cvt_pk_bf16_f32 v12, v60, v61
    v_smfmac_f32_16x16x64_bf16 v[64:67], v[28:31], a[168:175], v3
    v_cvt_pk_bf16_f32 v13, v62, v63
    v_smfmac_f32_16x16x64_bf16 v[64:67], v[32:35], a[176:183], v3
    ds_write_b64 v4, v[12:13] offset:16384
    v_smfmac_f32_16x16x64_bf16 v[64:67], v[36:39], a[184:191], v3
    ds_write_b32 v10, v0 offset:24640
    v_smfmac_f32_16x16x64_bf16 v[68:71], v[16:19], a[200:207], v3
    v_smfmac_f32_16x16x64_bf16 v[68:71], v[20:23], a[208:215], v3
    v_smfmac_f32_16x16x64_bf16 v[68:71], v[24:27], a[216:223], v3
    v_cvt_pk_bf16_f32 v12, v64, v65
    v_smfmac_f32_16x16x64_bf16 v[68:71], v[28:31], a[224:231], v3
    v_cvt_pk_bf16_f32 v13, v66, v67
    v_smfmac_f32_16x16x64_bf16 v[68:71], v[32:35], a[232:239], v3
    ds_write_b64 v4, v[12:13] offset:18432
    v_smfmac_f32_16x16x64_bf16 v[68:71], v[36:39], a[240:247], v3
    s_nop 7
    v_cvt_pk_bf16_f32 v12, v68, v69
    v_cvt_pk_bf16_f32 v13, v70, v71
    ds_write_b64 v4, v[12:13] offset:20480
    s_waitcnt lgkmcnt(0)
    s_barrier
    s_cmp_lg_u32 s12, 0
    s_cbranch_scc1 NPG_72
    v_mov_b32 v12, s14
    s_mov_b32 s18, 76021504
    buffer_store_dword v12, off, s[8:11], s18 sc1
NPG_72:
    s_add_u32 s14, s14, 1
    s_cmp_lt_u32 s14, 63
    s_cbranch_scc1 ALOOP_67
    s_branch A_LAST
A_LAST:
    s_barrier
    s_cmp_lt_u32 s13, 2
    s_cbranch_scc1 AL1_73
    s_and_b32 s18, s13, 1
    s_mul_i32 s18, s18, 14336
    s_add_u32 s19, s18, 85663744
    buffer_load_dwordx4 v[64:67], v2, s[8:11], s19 offen offset:0 sc1
    buffer_load_dwordx4 v[68:71], v2, s[8:11], s19 offen offset:1024 sc1
    buffer_load_dwordx4 v[72:75], v2, s[8:11], s19 offen offset:2048 sc1
    buffer_load_dwordx4 v[76:79], v2, s[8:11], s19 offen offset:3072 sc1
    s_add_u32 s19, s18, 85667840
    buffer_load_dwordx4 v[80:83], v2, s[8:11], s19 offen offset:0 sc1
    buffer_load_dwordx4 v[84:87], v2, s[8:11], s19 offen offset:1024 sc1
    buffer_load_dwordx4 v[88:91], v2, s[8:11], s19 offen offset:2048 sc1
    buffer_load_dwordx4 v[92:95], v2, s[8:11], s19 offen offset:3072 sc1
    s_add_u32 s19, s18, 85671936
    buffer_load_dwordx4 v[96:99], v2, s[8:11], s19 offen offset:0 sc1
    buffer_load_dwordx4 v[100:103], v2, s[8:11], s19 offen offset:1024 sc1
    buffer_load_dwordx4 v[104:107], v2, s[8:11], s19 offen offset:2048 sc1
    buffer_load_dwordx4 v[108:111], v2, s[8:11], s19 offen offset:3072 sc1
    s_add_u32 s19, s18, 85676032
    buffer_load_dwordx4 v[112:115], v2, s[8:11], s19 offen offset:0 sc1
    buffer_load_dwordx4 v[116:119], v2, s[8:11], s19 offen offset:1024 sc1
    v_and_b32 v8, 0x1f0, v2
    v_bfe_u32 v12, v2, 9, 1
    v_lshl_add_u32 v8, v12, 3, v8
    s_lshl_b32 s21, s12, 10
    s_and_b32 s18, s13, 1
    s_lshl_b32 s18, s18, 9
    s_add_u32 s21, s21, s18
    s_lshr_b32 s18, s13, 1
    s_lshl_b32 s18, s18, 14
    s_sub_u32 s21, s21, s18
    s_add_u32 s21, s21, 106414080
    v_bfe_u32 v12, v2, 4, 4
    v_lshrrev_b32 v13, 8, v2
    v_and_b32 v14, 3, v12
    v_xor_b32 v14, v14, v13
    v_and_b32 v15, 12, v12
    v_add_u32 v14, v14, v15
    v_and_b32 v15, 1, v13
    v_lshl_add_u32 v14, v15, 4, v14
    v_lshlrev_b32 v14, 3, v14
    v_lshl_add_u32 v5, v13, 8, v14
    v_xor_b32 v6, 128, v5
    s_waitcnt vmcnt(0)
    ds_read_b64_tr_b16 v[16:17], v5 offset:8192
    ds_read_b64_tr_b16 v[18:19], v6 offset:8192
    ds_read_b64_tr_b16 v[20:21], v5 offset:9216
    ds_read_b64_tr_b16 v[22:23], v6 offset:9216
    ds_read_b64_tr_b16 v[24:25], v5 offset:10240
    ds_read_b64_tr_b16 v[26:27], v6 offset:10240
    ds_read_b64_tr_b16 v[28:29], v5 offset:11264
    ds_read_b64_tr_b16 v[30:31], v6 offset:11264
    ds_read_b64_tr_b16 v[32:33], v5 offset:12288
    ds_read_b64_tr_b16 v[34:35], v6 offset:12288
    ds_read_b64_tr_b16 v[36:37], v5 offset:13312
    ds_read_b64_tr_b16 v[38:39], v6 offset:13312
    s_waitcnt lgkmcnt(10)
    v_mfma_f32_16x16x32_bf16 v[56:59], v[16:19], v[64:67], 0
    ds_read_b64_tr_b16 v[16:17], v5 offset:14336
    ds_read_b64_tr_b16 v[18:19], v6 offset:14336
    s_waitcnt lgkmcnt(10)
    v_mfma_f32_16x16x32_bf16 v[56:59], v[20:23], v[68:71], v[56:59]
    ds_read_b64_tr_b16 v[20:21], v5 offset:15360
    ds_read_b64_tr_b16 v[22:23], v6 offset:15360
    s_waitcnt lgkmcnt(10)
    v_mfma_f32_16x16x32_bf16 v[56:59], v[24:27], v[72:75], v[56:59]
    ds_read_b64_tr_b16 v[24:25], v5 offset:16384
    ds_read_b64_tr_b16 v[26:27], v6 offset:16384
    s_waitcnt lgkmcnt(10)
    v_mfma_f32_16x16x32_bf16 v[56:59], v[28:31], v[76:79], v[56:59]
    ds_read_b64_tr_b16 v[28:29], v5 offset:17408
    ds_read_b64_tr_b16 v[30:31], v6 offset:17408
    s_waitcnt lgkmcnt(10)
    v_mfma_f32_16x16x32_bf16 v[56:59], v[32:35], v[80:83], v[56:59]
    ds_read_b64_tr_b16 v[32:33], v5 offset:18432
    ds_read_b64_tr_b16 v[34:35], v6 offset:18432
    s_waitcnt lgkmcnt(10)
    v_mfma_f32_16x16x32_bf16 v[56:59], v[36:39], v[84:87], v[56:59]
    ds_read_b64_tr_b16 v[36:37], v5 offset:19456
    ds_read_b64_tr_b16 v[38:39], v6 offset:19456
    s_waitcnt lgkmcnt(10)
    v_mfma_f32_16x16x32_bf16 v[56:59], v[16:19], v[88:91], v[56:59]
    ds_read_b64_tr_b16 v[16:17], v5 offset:20480
    ds_read_b64_tr_b16 v[18:19], v6 offset:20480
    s_waitcnt lgkmcnt(10)
    v_mfma_f32_16x16x32_bf16 v[56:59], v[20:23], v[92:95], v[56:59]
    ds_read_b64_tr_b16 v[20:21], v5 offset:21504
    ds_read_b64_tr_b16 v[22:23], v6 offset:21504
    s_waitcnt lgkmcnt(10)
    v_mfma_f32_16x16x32_bf16 v[56:59], v[24:27], v[96:99], v[56:59]
    s_waitcnt lgkmcnt(8)
    v_mfma_f32_16x16x32_bf16 v[56:59], v[28:31], v[100:103], v[56:59]
    s_waitcnt lgkmcnt(6)
    v_mfma_f32_16x16x32_bf16 v[56:59], v[32:35], v[104:107], v[56:59]
    s_waitcnt lgkmcnt(4)
    v_mfma_f32_16x16x32_bf16 v[56:59], v[36:39], v[108:111], v[56:59]
    s_waitcnt lgkmcnt(2)
    v_mfma_f32_16x16x32_bf16 v[56:59], v[16:19], v[112:115], v[56:59]
    s_waitcnt lgkmcnt(0)
    v_mfma_f32_16x16x32_bf16 v[56:59], v[20:23], v[116:119], v[56:59]
    s_nop 7
    v_permlane32_swap_b32 v56, v58
    v_permlane32_swap_b32 v57, v59
    v_add_f32 v56, v56, v58
    v_add_f32 v57, v57, v59
    v_min_u32 v56, -2, v56
    v_min_u32 v57, -2, v57
    s_and_b32 s18, s13, 1
    s_mul_i32 s18, s18, 14336
    s_add_u32 s19, s18, 85692416
    buffer_load_dwordx4 v[64:67], v2, s[8:11], s19 offen offset:0 sc1
    buffer_load_dwordx4 v[68:71], v2, s[8:11], s19 offen offset:1024 sc1
    buffer_load_dwordx4 v[72:75], v2, s[8:11], s19 offen offset:2048 sc1
    buffer_load_dwordx4 v[76:79], v2, s[8:11], s19 offen offset:3072 sc1
    s_add_u32 s19, s18, 85696512
    buffer_load_dwordx4 v[80:83], v2, s[8:11], s19 offen offset:0 sc1
    buffer_load_dwordx4 v[84:87], v2, s[8:11], s19 offen offset:1024 sc1
    buffer_load_dwordx4 v[88:91], v2, s[8:11], s19 offen offset:2048 sc1
    buffer_load_dwordx4 v[92:95], v2, s[8:11], s19 offen offset:3072 sc1
    s_add_u32 s19, s18, 85700608
    buffer_load_dwordx4 v[96:99], v2, s[8:11], s19 offen offset:0 sc1
    buffer_load_dwordx4 v[100:103], v2, s[8:11], s19 offen offset:1024 sc1
    buffer_load_dwordx4 v[104:107], v2, s[8:11], s19 offen offset:2048 sc1
    buffer_load_dwordx4 v[108:111], v2, s[8:11], s19 offen offset:3072 sc1
    s_add_u32 s19, s18, 85704704
    buffer_load_dwordx4 v[112:115], v2, s[8:11], s19 offen offset:0 sc1
    buffer_load_dwordx4 v[116:119], v2, s[8:11], s19 offen offset:1024 sc1
A_LAST0:
AL1_73:
    s_barrier
    v_mov_b64 v[44:45], 0
    v_mov_b64 v[46:47], 0
    v_mov_b64 v[48:49], 0
    v_mov_b64 v[50:51], 0
    v_mov_b64 v[52:53], 0
    v_mov_b64 v[54:55], 0
    s_mov_b32 s15, 75890688
    s_mov_b32 s22, 0
LP_75:
    buffer_load_dwordx4 v[16:19], v2, s[8:11], s15 offen offset:0 sc1
    buffer_load_dwordx4 v[20:23], v2, s[8:11], s15 offen offset:1024 sc1
    buffer_load_dwordx4 v[24:27], v2, s[8:11], s15 offen offset:2048 sc1
    buffer_load_dwordx4 v[28:31], v2, s[8:11], s15 offen offset:3072 sc1
    buffer_load_dwordx4 v[32:35], v11, s[8:11], s15 offen offset:0 sc1
    buffer_load_dwordx4 v[36:39], v11, s[8:11], s15 offen offset:1024 sc1
    buffer_load_dwordx4 v[40:43], v11, s[8:11], s15 offen offset:2048 sc1
    s_add_u32 s22, s22, 1
    s_cmp_gt_u32 s22, 2000000
    s_cbranch_scc1 MEGA_EXIT
    s_waitcnt vmcnt(6)
    v_max3_u32 v7, v16, v17, v18
    v_max_u32 v7, v7, v19
    s_waitcnt vmcnt(5)
    v_max3_u32 v7, v7, v20, v21
    v_max3_u32 v7, v7, v22, v23
    s_waitcnt vmcnt(4)
    v_max3_u32 v7, v7, v24, v25
    v_max3_u32 v7, v7, v26, v27
    s_waitcnt vmcnt(3)
    v_max3_u32 v7, v7, v28, v29
    v_max3_u32 v7, v7, v30, v31
    s_waitcnt vmcnt(2)
    v_max3_u32 v7, v7, v32, v33
    v_max3_u32 v7, v7, v34, v35
    s_waitcnt vmcnt(1)
    v_max3_u32 v7, v7, v36, v37
    v_max3_u32 v7, v7, v38, v39
    s_waitcnt vmcnt(0)
    v_max3_u32 v7, v7, v40, v41
    v_max3_u32 v7, v7, v42, v43
    v_cmp_eq_u32 vcc, -1, v7
    s_cbranch_vccnz LP_75
    s_cmp_lt_u32 s13, 2
    s_cbranch_scc1 AL2_74
    buffer_store_dwordx2 v[56:57], v8, s[8:11], s21 offen sc1
AL2_74:
    v_smfmac_f32_16x16x64_bf16 v[44:47], v[16:19], v[120:127], v3
    v_smfmac_f32_16x16x64_bf16 v[44:47], v[20:23], v[128:135], v3
    v_smfmac_f32_16x16x64_bf16 v[44:47], v[24:27], v[136:143], v3
    v_smfmac_f32_16x16x64_bf16 v[44:47], v[28:31], v[144:151], v3
    v_smfmac_f32_16x16x64_bf16 v[44:47], v[32:35], v[152:159], v3
    v_smfmac_f32_16x16x64_bf16 v[44:47], v[36:39], v[160:167], v3
    v_smfmac_f32_16x16x64_bf16 v[44:47], v[40:43], v[168:175], v3
    v_smfmac_f32_16x16x64_bf16 v[48:51], v[16:19], v[176:183], v3
    v_smfmac_f32_16x16x64_bf16 v[48:51], v[20:23], v[184:191], v3
    v_smfmac_f32_16x16x64_bf16 v[48:51], v[24:27], v[192:199], v3
    v_cvt_pk_bf16_f32 v12, v44, v45
    v_smfmac_f32_16x16x64_bf16 v[48:51], v[28:31], v[200:207], v3
    v_cvt_pk_bf16_f32 v13, v46, v47
    v_smfmac_f32_16x16x64_bf16 v[48:51], v[32:35], v[208:215], v3
    ds_write_b64 v4, v[12:13] offset:8192
    v_smfmac_f32_16x16x64_bf16 v[48:51], v[36:39], v[216:223], v3
    v_mov_b64 v[44:45], 0
    v_smfmac_f32_16x16x64_bf16 v[48:51], v[40:43], v[224:231], v3
    v_mov_b64 v[46:47], 0
    v_smfmac_f32_16x16x64_bf16 v[52:55], v[16:19], v[232:239], v3
    v_smfmac_f32_16x16x64_bf16 v[52:55], v[20:23], v[240:247], v3
    v_smfmac_f32_16x16x64_bf16 v[52:55], v[24:27], v[248:255], v3
    v_cvt_pk_bf16_f32 v12, v48, v49
    v_smfmac_f32_16x16x64_bf16 v[52:55], v[28:31], a[0:7], v3
    v_cvt_pk_bf16_f32 v13, v50, v51
    v_smfmac_f32_16x16x64_bf16 v[52:55], v[32:35], a[8:15], v3
    ds_write_b64 v4, v[12:13] offset:10240
    v_smfmac_f32_16x16x64_bf16 v[52:55], v[36:39], a[16:23], v3
    v_mov_b64 v[48:49], 0
    v_smfmac_f32_16x16x64_bf16 v[52:55], v[40:43], a[24:31], v3
    v_mov_b64 v[50:51], 0
    v_smfmac_f32_16x16x64_bf16 v[44:47], v[16:19], a[32:39], v3
    v_smfmac_f32_16x16x64_bf16 v[44:47], v[20:23], a[40:47], v3
    v_smfmac_f32_16x16x64_bf16 v[44:47], v[24:27], a[48:55], v3
    v_cvt_pk_bf16_f32 v12, v52, v53
    v_smfmac_f32_16x16x64_bf16 v[44:47], v[28:31], a[56:63], v3
    v_cvt_pk_bf16_f32 v13, v54, v55
    v_smfmac_f32_16x16x64_bf16 v[44:47], v[32:35], a[64:71], v3
    ds_write_b64 v4, v[12:13] offset:12288
    v_smfmac_f32_16x16x64_bf16 v[44:47], v[36:39], a[72:79], v3
    v_mov_b64 v[52:53], 0
    v_smfmac_f32_16x16x64_bf16 v[44:47], v[40:43], a[80:87], v3
    v_mov_b64 v[54:55], 0
    v_smfmac_f32_16x16x64_bf16 v[48:51], v[16:19], a[88:95], v3
    v_smfmac_f32_16x16x64_bf16 v[48:51], v[20:23], a[96:103], v3
    v_smfmac_f32_16x16x64_bf16 v[48:51], v[24:27], a[104:111], v3
    v_cvt_pk_bf16_f32 v12, v44, v45
    v_smfmac_f32_16x16x64_bf16 v[48:51], v[28:31], a[112:119], v3
    v_cvt_pk_bf16_f32 v13, v46, v47
    v_smfmac_f32_16x16x64_bf16 v[48:51], v[32:35], a[120:127], v3
    ds_write_b64 v4, v[12:13] offset:14336
    v_smfmac_f32_16x16x64_bf16 v[48:51], v[36:39], a[128:135], v3
    v_mov_b64 v[44:45], 0
    v_smfmac_f32_16x16x64_bf16 v[48:51], v[40:43], a[136:143], v3
    v_mov_b64 v[46:47], 0
    v_smfmac_f32_16x16x64_bf16 v[52:55], v[16:19], a[144:151], v3
    v_smfmac_f32_16x16x64_bf16 v[52:55], v[20:23], a[152:159], v3
    v_smfmac_f32_16x16x64_bf16 v[52:55], v[24:27], a[160:167], v3
    v_cvt_pk_bf16_f32 v12, v48, v49
    v_smfmac_f32_16x16x64_bf16 v[52:55], v[28:31], a[168:175], v3
    v_cvt_pk_bf16_f32 v13, v50, v51
    v_smfmac_f32_16x16x64_bf16 v[52:55], v[32:35], a[176:183], v3
    ds_write_b64 v4, v[12:13] offset:16384
    v_smfmac_f32_16x16x64_bf16 v[52:55], v[36:39], a[184:191], v3
    v_smfmac_f32_16x16x64_bf16 v[52:55], v[40:43], a[192:199], v3
    v_smfmac_f32_16x16x64_bf16 v[44:47], v[16:19], a[200:207], v3
    v_smfmac_f32_16x16x64_bf16 v[44:47], v[20:23], a[208:215], v3
    v_smfmac_f32_16x16x64_bf16 v[44:47], v[24:27], a[216:223], v3
    v_cvt_pk_bf16_f32 v12, v52, v53
    v_smfmac_f32_16x16x64_bf16 v[44:47], v[28:31], a[224:231], v3
    v_cvt_pk_bf16_f32 v13, v54, v55
    v_smfmac_f32_16x16x64_bf16 v[44:47], v[32:35], a[232:239], v3
    ds_write_b64 v4, v[12:13] offset:18432
    v_smfmac_f32_16x16x64_bf16 v[44:47], v[36:39], a[240:247], v3
    v_smfmac_f32_16x16x64_bf16 v[44:47], v[40:43], a[248:255], v3
    s_nop 7
    v_cvt_pk_bf16_f32 v12, v44, v45
    v_cvt_pk_bf16_f32 v13, v46, v47
    ds_write_b64 v4, v[12:13] offset:20480
    s_waitcnt lgkmcnt(0)
    s_barrier
    s_cmp_lt_u32 s13, 2
    s_cbranch_scc1 MEGA_EXIT
    ds_read_b64_tr_b16 v[16:17], v5 offset:8192
    ds_read_b64_tr_b16 v[18:19], v6 offset:8192
    ds_read_b64_tr_b16 v[20:21], v5 offset:9216
    ds_read_b64_tr_b16 v[22:23], v6 offset:9216
    ds_read_b64_tr_b16 v[24:25], v5 offset:10240
    ds_read_b64_tr_b16 v[26:27], v6 offset:10240
    ds_read_b64_tr_b16 v[28:29], v5 offset:11264
    ds_read_b64_tr_b16 v[30:31], v6 offset:11264
    ds_read_b64_tr_b16 v[32:33], v5 offset:12288
    ds_read_b64_tr_b16 v[34:35], v6 offset:12288
    ds_read_b64_tr_b16 v[36:37], v5 offset:13312
    ds_read_b64_tr_b16 v[38:39], v6 offset:13312
    s_waitcnt lgkmcnt(10)
    v_mfma_f32_16x16x32_bf16 v[56:59], v[16:19], v[64:67], 0
    ds_read_b64_tr_b16 v[16:17], v5 offset:14336
    ds_read_b64_tr_b16 v[18:19], v6 offset:14336
    s_waitcnt lgkmcnt(10)
    v_mfma_f32_16x16x32_bf16 v[56:59], v[20:23], v[68:71], v[56:59]
    ds_read_b64_tr_b16 v[20:21], v5 offset:15360
    ds_read_b64_tr_b16 v[22:23], v6 offset:15360
    s_waitcnt lgkmcnt(10)
    v_mfma_f32_16x16x32_bf16 v[56:59], v[24:27], v[72:75], v[56:59]
    ds_read_b64_tr_b16 v[24:25], v5 offset:16384
    ds_read_b64_tr_b16 v[26:27], v6 offset:16384
    s_waitcnt lgkmcnt(10)
    v_mfma_f32_16x16x32_bf16 v[56:59], v[28:31], v[76:79], v[56:59]
    ds_read_b64_tr_b16 v[28:29], v5 offset:17408
    ds_read_b64_tr_b16 v[30:31], v6 offset:17408
    s_waitcnt lgkmcnt(10)
    v_mfma_f32_16x16x32_bf16 v[56:59], v[32:35], v[80:83], v[56:59]
    ds_read_b64_tr_b16 v[32:33], v5 offset:18432
    ds_read_b64_tr_b16 v[34:35], v6 offset:18432
    s_waitcnt lgkmcnt(10)
    v_mfma_f32_16x16x32_bf16 v[56:59], v[36:39], v[84:87], v[56:59]
    ds_read_b64_tr_b16 v[36:37], v5 offset:19456
    ds_read_b64_tr_b16 v[38:39], v6 offset:19456
    s_waitcnt lgkmcnt(10)
    v_mfma_f32_16x16x32_bf16 v[56:59], v[16:19], v[88:91], v[56:59]
    ds_read_b64_tr_b16 v[16:17], v5 offset:20480
    ds_read_b64_tr_b16 v[18:19], v6 offset:20480
    s_waitcnt lgkmcnt(10)
    v_mfma_f32_16x16x32_bf16 v[56:59], v[20:23], v[92:95], v[56:59]
    ds_read_b64_tr_b16 v[20:21], v5 offset:21504
    ds_read_b64_tr_b16 v[22:23], v6 offset:21504
    s_waitcnt lgkmcnt(10)
    v_mfma_f32_16x16x32_bf16 v[56:59], v[24:27], v[96:99], v[56:59]
    s_waitcnt lgkmcnt(8)
    v_mfma_f32_16x16x32_bf16 v[56:59], v[28:31], v[100:103], v[56:59]
    s_waitcnt lgkmcnt(6)
    v_mfma_f32_16x16x32_bf16 v[56:59], v[32:35], v[104:107], v[56:59]
    s_waitcnt lgkmcnt(4)
    v_mfma_f32_16x16x32_bf16 v[56:59], v[36:39], v[108:111], v[56:59]
    s_waitcnt lgkmcnt(2)
    v_mfma_f32_16x16x32_bf16 v[56:59], v[16:19], v[112:115], v[56:59]
    s_waitcnt lgkmcnt(0)
    v_mfma_f32_16x16x32_bf16 v[56:59], v[20:23], v[116:119], v[56:59]
    s_nop 7
    v_permlane32_swap_b32 v56, v58
    v_permlane32_swap_b32 v57, v59
    v_add_f32 v56, v56, v58
    v_add_f32 v57, v57, v59
    v_min_u32 v56, -2, v56
    v_min_u32 v57, -2, v57
    s_add_u32 s21, s21, 16384
    buffer_store_dwordx2 v[56:57], v8, s[8:11], s21 offen sc1
    s_branch MEGA_EXIT
ROLE_C:
    s_sub_u32 s12, s12, 16
    v_and_b32 v1, 63, v0
    v_lshlrev_b32 v2, 4, v1
    v_and_b32 v12, 8, v1
    v_cmp_eq_u32 vcc, 0, v12
    v_mov_b32 v13, 0xeeee
    v_mov_b32 v14, 0x4444
    v_cndmask_b32 v3, v13, v14, vcc
    s_and_b32 s18, s13, 1
    s_lshl_b32 s25, s12, 1
    s_add_u32 s25, s25, s18
    v_and_b32 v12, 15, v1
    v_lshrrev_b32 v13, 4, v1
    v_and_b32 v14, 1, v13
    v_lshlrev_b32 v14, 2, v14
    v_and_b32 v15, 2, v13
    v_add_u32 v14, v14, v15
    v_and_b32 v15, 1, v12
    v_cmp_eq_u32 s[36:37], 0, v15
    v_add_u32 v14, v14, v15
    v_bfe_u32 v15, v12, 1, 1
    v_lshl_add_u32 v4, v15, 3, v14
    v_lshlrev_b32 v4, 4, v4
    v_and_b32 v15, 12, v12
    v_add_u32 v4, v4, v15
    s_lshl_b32 s18, s25, 8
    v_add_u32 v4, s18, v4
    v_mul_u32_u24 v5, 896, v14
    v_and_b32 v15, 14, v12
    v_lshl_add_u32 v5, v15, 1, v5
    s_lshl_b32 s18, s25, 5
    v_add_u32 v5, s18, v5
    s_lshl_b32 s18, s13, 11
    s_add_u32 s18, s18, 12288
    v_add_u32 v6, s18, v2
    v_add_u32 v7, 8192, v2
    s_mul_i32 s18, s13, 14336
    s_add_u32 s18, s18, 20480
    v_add_u32 v9, s18, v2
    s_mov_b32 m0, s18
    s_and_b32 s18, s13, 1
    s_mul_i32 s18, s18, 6144
    s_add_u32 s18, s18, 8192
    v_add_u32 v10, s18, v2
    s_mov_b32 s22, 0
    s_cmp_eq_u32 s13, 2
    s_cbranch_scc1 DSP_78
    s_cmp_eq_u32 s13, 3
    s_cbranch_scc1 DSP_79
DSP_77:
    buffer_load_dword v12, v5, s[32:35], 0 offen
    v_and_b32 v5, 0x70, v4
    v_bfe_u32 v13, v1, 3, 1
    v_lshl_add_u32 v5, v13, 8, v5
    v_bfe_u32 v13, v1, 1, 2
    v_lshl_add_u32 v5, v13, 2, v5
    s_lshl_b32 s18, s25, 9
    v_add_u32 v5, s18, v5
    s_waitcnt vmcnt(0)
    v_min_u32 v12, -2, v12
    s_mov_b32 s18, 75497472
    buffer_store_dword v12, v4, s[8:11], s18 offen sc1
    v_mov_b32 v56, v12
    v_bfe_u32 v12, v1, 1, 2
    v_cmp_eq_u32 s[84:85], 0, v12
    v_cmp_eq_u32 s[86:87], 1, v12
    v_cmp_eq_u32 s[88:89], 2, v12
    v_cmp_eq_u32 s[90:91], 3, v12
    v_lshlrev_b32 v0, 3, v1
    v_add_u32 v0, 10240, v0
    s_branch CJ_76
DSP_78:
    v_mov_b32 v5, -1
    s_mov_b32 s18, 75628544
    buffer_store_dword v5, v4, s[8:11], s18 offen sc1
    s_mov_b32 s18, 75759616
    buffer_store_dword v5, v4, s[8:11], s18 offen sc1
    s_mov_b32 s18, 75890688
    buffer_store_dword v5, v4, s[8:11], s18 offen sc1
    v_mov_b32 v12, 0
    s_mov_b32 s18, 76021504
    buffer_store_dword v12, off, s[8:11], s18 sc1
    s_branch CJ_76
DSP_79:
    v_mov_b32 v5, -1
    s_mov_b32 s18, 75628544
    buffer_store_dword v5, v4, s[8:11], s18 offen sc1
    s_mov_b32 s18, 75759616
    buffer_store_dword v5, v4, s[8:11], s18 offen sc1
    s_mov_b32 s18, 75890688
    buffer_store_dword v5, v4, s[8:11], s18 offen sc1
    v_mov_b32 v12, 0
    s_mov_b32 s18, 76021504
    buffer_store_dword v12, off, s[8:11], s18 sc1
    s_branch CJ_76
CJ_76:
    s_waitcnt vmcnt(0) lgkmcnt(0)
    s_barrier
    s_cmp_lg_u32 s13, 0
    s_cbranch_scc1 TB0_80
    v_mov_b32 v13, s41
    v_mov_b32 v14, 1
    v_mov_b32 v15, 0
    s_mov_b64 exec, 1
    global_atomic_add v15, v13, s[4:5] sc1
    global_atomic_add v15, v14, s[4:5] offset:128 sc1
TB1_81:
    global_load_dword v12, v15, s[4:5] offset:192 sc1
    s_add_u32 s22, s22, 1
    s_cmp_gt_u32 s22, 2000000
    s_cbranch_scc1 MEGA_EXIT
    s_sleep 4
    s_waitcnt vmcnt(0)
    v_cmp_eq_u32 vcc, 0, v12
    s_cbranch_vccnz TB1_81
    s_mov_b64 exec, -1
TB0_80:
    s_cmp_lg_u32 s13, 0
    s_cbranch_scc1 WFZ_83
    s_mov_b32 s35, 0
    s_lshr_b32 s30, s12, 1
    s_lshl_b32 s30, s30, 5
    s_add_u32 s30, s30, 116453376
    v_lshrrev_b32 v16, 6, v2
    v_lshlrev_b32 v16, 8, v16
    v_bfe_u32 v17, v2, 4, 2
    v_lshl_add_u32 v16, v17, 3, v16
    s_branch WF0_84
WF_82:
    s_sleep 4
WF0_84:
    buffer_load_dwordx2 v[18:19], v16, s[8:11], s30 offen sc1
    s_add_u32 s35, s35, 1
    s_cmp_gt_u32 s35, 4000000
    s_cbranch_scc1 MEGA_EXIT
    s_waitcnt vmcnt(0)
    v_min_u32 v18, v18, v19
    v_cmp_eq_u32 vcc, 0, v18
    s_cbranch_vccnz WF_82
WFZ_83:
    s_barrier
    s_mul_i32 s18, s13, 14336
    s_add_u32 m0, s18, 20480
    s_lshr_b32 s18, s13, 1
    s_lshl_b32 s18, s18, 3
    s_add_u32 s18, s18, 16
    s_mul_i32 s18, s18, 401408
    s_mul_i32 s19, s25, 14336
    s_add_u32 s18, s18, s19
    buffer_load_dwordx4 v2, s[8:11], s18 offen offset:0 sc1 lds
    buffer_load_dwordx4 v2, s[8:11], s18 offen offset:1024 sc1 lds
    buffer_load_dwordx4 v2, s[8:11], s18 offen offset:2048 sc1 lds
    buffer_load_dwordx4 v2, s[8:11], s18 offen offset:3072 sc1 lds
    s_add_u32 s18, s18, 4096
    s_add_u32 m0, m0, 4096
    s_nop 0
    buffer_load_dwordx4 v2, s[8:11], s18 offen offset:0 sc1 lds
    buffer_load_dwordx4 v2, s[8:11], s18 offen offset:1024 sc1 lds
    buffer_load_dwordx4 v2, s[8:11], s18 offen offset:2048 sc1 lds
    buffer_load_dwordx4 v2, s[8:11], s18 offen offset:3072 sc1 lds
    s_add_u32 s18, s18, 4096
    s_add_u32 m0, m0, 4096
    s_nop 0
    buffer_load_dwordx4 v2, s[8:11], s18 offen offset:0 sc1 lds
    buffer_load_dwordx4 v2, s[8:11], s18 offen offset:1024 sc1 lds
    buffer_load_dwordx4 v2, s[8:11], s18 offen offset:2048 sc1 lds
    buffer_load_dwordx4 v2, s[8:11], s18 offen offset:3072 sc1 lds
    s_add_u32 s18, s18, 4096
    s_add_u32 m0, m0, 4096
    s_nop 0
    buffer_load_dwordx4 v2, s[8:11], s18 offen offset:0 sc1 lds
    buffer_load_dwordx4 v2, s[8:11], s18 offen offset:1024 sc1 lds
    s_add_u32 s18, s18, 4096
    s_add_u32 m0, m0, 4096
    s_lshr_b32 s18, s13, 1
    s_lshl_b32 s18, s18, 3
    s_add_u32 s18, s18, 18
    s_mul_i32 s18, s18, 401408
    s_mul_i32 s19, s25, 14336
    s_add_u32 s18, s18, s19
    buffer_load_dwordx4 v[120:123], v2, s[8:11], s18 offen offset:0 sc1
    buffer_load_dwordx4 v[124:127], v2, s[8:11], s18 offen offset:1024 sc1
    buffer_load_dwordx4 v[128:131], v2, s[8:11], s18 offen offset:2048 sc1
    buffer_load_dwordx4 v[132:135], v2, s[8:11], s18 offen offset:3072 sc1
    s_add_u32 s18, s18, 4096
    buffer_load_dwordx4 v[136:139], v2, s[8:11], s18 offen offset:0 sc1
    buffer_load_dwordx4 v[140:143], v2, s[8:11], s18 offen offset:1024 sc1
    buffer_load_dwordx4 v[144:147], v2, s[8:11], s18 offen offset:2048 sc1
    buffer_load_dwordx4 v[148:151], v2, s[8:11], s18 offen offset:3072 sc1
    s_add_u32 s18, s18, 4096
    buffer_load_dwordx4 v[152:155], v2, s[8:11], s18 offen offset:0 sc1
    buffer_load_dwordx4 v[156:159], v2, s[8:11], s18 offen offset:1024 sc1
    buffer_load_dwordx4 v[160:163], v2, s[8:11], s18 offen offset:2048 sc1
    buffer_load_dwordx4 v[164:167], v2, s[8:11], s18 offen offset:3072 sc1
    s_add_u32 s18, s18, 4096
    buffer_load_dwordx4 v[168:171], v2, s[8:11], s18 offen offset:0 sc1
    buffer_load_dwordx4 v[172:175], v2, s[8:11], s18 offen offset:1024 sc1
    s_lshr_b32 s18, s13, 1
    s_lshl_b32 s18, s18, 3
    s_add_u32 s18, s18, 17
    s_mul_i32 s18, s18, 401408
    s_mul_i32 s19, s25, 14336
    s_add_u32 s18, s18, s19
    buffer_load_dwordx4 v[176:179], v2, s[8:11], s18 offen offset:0 sc1
    buffer_load_dwordx4 v[180:183], v2, s[8:11], s18 offen offset:1024 sc1
    buffer_load_dwordx4 v[184:187], v2, s[8:11], s18 offen offset:2048 sc1
    buffer_load_dwordx4 v[188:191], v2, s[8:11], s18 offen offset:3072 sc1
    s_add_u32 s18, s18, 4096
    buffer_load_dwordx4 v[192:195], v2, s[8:11], s18 offen offset:0 sc1
    buffer_load_dwordx4 v[196:199], v2, s[8:11], s18 offen offset:1024 sc1
    buffer_load_dwordx4 v[200:203], v2, s[8:11], s18 offen offset:2048 sc1
    buffer_load_dwordx4 v[204:207], v2, s[8:11], s18 offen offset:3072 sc1
    s_add_u32 s18, s18, 4096
    buffer_load_dwordx4 v[208:211], v2, s[8:11], s18 offen offset:0 sc1
    buffer_load_dwordx4 v[212:215], v2, s[8:11], s18 offen offset:1024 sc1
    buffer_load_dwordx4 v[216:219], v2, s[8:11], s18 offen offset:2048 sc1
    buffer_load_dwordx4 v[220:223], v2, s[8:11], s18 offen offset:3072 sc1
    s_add_u32 s18, s18, 4096
    buffer_load_dwordx4 v[224:227], v2, s[8:11], s18 offen offset:0 sc1
    buffer_load_dwordx4 v[228:231], v2, s[8:11], s18 offen offset:1024 sc1
    s_lshr_b32 s18, s13, 1
    s_lshl_b32 s18, s18, 3
    s_add_u32 s18, s18, 19
    s_mul_i32 s18, s18, 401408
    s_mul_i32 s19, s25, 14336
    s_add_u32 s18, s18, s19
    buffer_load_dwordx4 v[232:235], v2, s[8:11], s18 offen offset:0 sc1
    buffer_load_dwordx4 v[236:239], v2, s[8:11], s18 offen offset:1024 sc1
    buffer_load_dwordx4 v[240:243], v2, s[8:11], s18 offen offset:2048 sc1
    buffer_load_dwordx4 v[244:247], v2, s[8:11], s18 offen offset:3072 sc1
    s_add_u32 s18, s18, 4096
    buffer_load_dwordx4 v[248:251], v2, s[8:11], s18 offen offset:0 sc1
    buffer_load_dwordx4 v[252:255], v2, s[8:11], s18 offen offset:1024 sc1
    buffer_load_dwordx4 a[0:3], v2, s[8:11], s18 offen offset:2048 sc1
    buffer_load_dwordx4 a[4:7], v2, s[8:11], s18 offen offset:3072 sc1
    s_add_u32 s18, s18, 4096
    buffer_load_dwordx4 a[8:11], v2, s[8:11], s18 offen offset:0 sc1
    buffer_load_dwordx4 a[12:15], v2, s[8:11], s18 offen offset:1024 sc1
    buffer_load_dwordx4 a[16:19], v2, s[8:11], s18 offen offset:2048 sc1
    buffer_load_dwordx4 a[20:23], v2, s[8:11], s18 offen offset:3072 sc1
    s_add_u32 s18, s18, 4096
    buffer_load_dwordx4 a[24:27], v2, s[8:11], s18 offen offset:0 sc1
    buffer_load_dwordx4 a[28:31], v2, s[8:11], s18 offen offset:1024 sc1
    s_lshr_b32 s18, s13, 1
    s_lshl_b32 s18, s18, 3
    s_add_u32 s18, s18, 20
    s_mul_i32 s18, s18, 401408
    s_mul_i32 s19, s25, 14336
    s_add_u32 s18, s18, s19
    buffer_load_dwordx4 a[32:35], v2, s[8:11], s18 offen offset:0 sc1
    buffer_load_dwordx4 a[36:39], v2, s[8:11], s18 offen offset:1024 sc1
    buffer_load_dwordx4 a[40:43], v2, s[8:11], s18 offen offset:2048 sc1
    buffer_load_dwordx4 a[44:47], v2, s[8:11], s18 offen offset:3072 sc1
    s_add_u32 s18, s18, 4096
    buffer_load_dwordx4 a[48:51], v2, s[8:11], s18 offen offset:0 sc1
    buffer_load_dwordx4 a[52:55], v2, s[8:11], s18 offen offset:1024 sc1
    buffer_load_dwordx4 a[56:59], v2, s[8:11], s18 offen offset:2048 sc1
    buffer_load_dwordx4 a[60:63], v2, s[8:11], s18 offen offset:3072 sc1
    s_add_u32 s18, s18, 4096
    buffer_load_dwordx4 a[64:67], v2, s[8:11], s18 offen offset:0 sc1
    buffer_load_dwordx4 a[68:71], v2, s[8:11], s18 offen offset:1024 sc1
    buffer_load_dwordx4 a[72:75], v2, s[8:11], s18 offen offset:2048 sc1
    buffer_load_dwordx4 a[76:79], v2, s[8:11], s18 offen offset:3072 sc1
    s_add_u32 s18, s18, 4096
    buffer_load_dwordx4 a[80:83], v2, s[8:11], s18 offen offset:0 sc1
    buffer_load_dwordx4 a[84:87], v2, s[8:11], s18 offen offset:1024 sc1
    s_lshr_b32 s18, s13, 1
    s_lshl_b32 s18, s18, 3
    s_add_u32 s18, s18, 22
    s_mul_i32 s18, s18, 401408
    s_mul_i32 s19, s25, 14336
    s_add_u32 s18, s18, s19
    buffer_load_dwordx4 a[88:91], v2, s[8:11], s18 offen offset:0 sc1
    buffer_load_dwordx4 a[92:95], v2, s[8:11], s18 offen offset:1024 sc1
    buffer_load_dwordx4 a[96:99], v2, s[8:11], s18 offen offset:2048 sc1
    buffer_load_dwordx4 a[100:103], v2, s[8:11], s18 offen offset:3072 sc1
    s_add_u32 s18, s18, 4096
    buffer_load_dwordx4 a[104:107], v2, s[8:11], s18 offen offset:0 sc1
    buffer_load_dwordx4 a[108:111], v2, s[8:11], s18 offen offset:1024 sc1
    buffer_load_dwordx4 a[112:115], v2, s[8:11], s18 offen offset:2048 sc1
    buffer_load_dwordx4 a[116:119], v2, s[8:11], s18 offen offset:3072 sc1
    s_add_u32 s18, s18, 4096
    buffer_load_dwordx4 a[120:123], v2, s[8:11], s18 offen offset:0 sc1
    buffer_load_dwordx4 a[124:127], v2, s[8:11], s18 offen offset:1024 sc1
    buffer_load_dwordx4 a[128:131], v2, s[8:11], s18 offen offset:2048 sc1
    buffer_load_dwordx4 a[132:135], v2, s[8:11], s18 offen offset:3072 sc1
    s_add_u32 s18, s18, 4096
    buffer_load_dwordx4 a[136:139], v2, s[8:11], s18 offen offset:0 sc1
    buffer_load_dwordx4 a[140:143], v2, s[8:11], s18 offen offset:1024 sc1
    s_lshr_b32 s18, s13, 1
    s_lshl_b32 s18, s18, 3
    s_add_u32 s18, s18, 21
    s_mul_i32 s18, s18, 401408
    s_mul_i32 s19, s25, 14336
    s_add_u32 s18, s18, s19
    buffer_load_dwordx4 a[144:147], v2, s[8:11], s18 offen offset:0 sc1
    buffer_load_dwordx4 a[148:151], v2, s[8:11], s18 offen offset:1024 sc1
    buffer_load_dwordx4 a[152:155], v2, s[8:11], s18 offen offset:2048 sc1
    buffer_load_dwordx4 a[156:159], v2, s[8:11], s18 offen offset:3072 sc1
    s_add_u32 s18, s18, 4096
    buffer_load_dwordx4 a[160:163], v2, s[8:11], s18 offen offset:0 sc1
    buffer_load_dwordx4 a[164:167], v2, s[8:11], s18 offen offset:1024 sc1
    buffer_load_dwordx4 a[168:171], v2, s[8:11], s18 offen offset:2048 sc1
    buffer_load_dwordx4 a[172:175], v2, s[8:11], s18 offen offset:3072 sc1
    s_add_u32 s18, s18, 4096
    buffer_load_dwordx4 a[176:179], v2, s[8:11], s18 offen offset:0 sc1
    buffer_load_dwordx4 a[180:183], v2, s[8:11], s18 offen offset:1024 sc1
    buffer_load_dwordx4 a[184:187], v2, s[8:11], s18 offen offset:2048 sc1
    buffer_load_dwordx4 a[188:191], v2, s[8:11], s18 offen offset:3072 sc1
    s_add_u32 s18, s18, 4096
    buffer_load_dwordx4 a[192:195], v2, s[8:11], s18 offen offset:0 sc1
    buffer_load_dwordx4 a[196:199], v2, s[8:11], s18 offen offset:1024 sc1
    s_lshr_b32 s18, s13, 1
    s_lshl_b32 s18, s18, 3
    s_add_u32 s18, s18, 23
    s_mul_i32 s18, s18, 401408
    s_mul_i32 s19, s25, 14336
    s_add_u32 s18, s18, s19
    buffer_load_dwordx4 a[200:203], v2, s[8:11], s18 offen offset:0 sc1
    buffer_load_dwordx4 a[204:207], v2, s[8:11], s18 offen offset:1024 sc1
    buffer_load_dwordx4 a[208:211], v2, s[8:11], s18 offen offset:2048 sc1
    buffer_load_dwordx4 a[212:215], v2, s[8:11], s18 offen offset:3072 sc1
    s_add_u32 s18, s18, 4096
    buffer_load_dwordx4 a[216:219], v2, s[8:11], s18 offen offset:0 sc1
    buffer_load_dwordx4 a[220:223], v2, s[8:11], s18 offen offset:1024 sc1
    buffer_load_dwordx4 a[224:227], v2, s[8:11], s18 offen offset:2048 sc1
    buffer_load_dwordx4 a[228:231], v2, s[8:11], s18 offen offset:3072 sc1
    s_add_u32 s18, s18, 4096
    buffer_load_dwordx4 a[232:235], v2, s[8:11], s18 offen offset:0 sc1
    buffer_load_dwordx4 a[236:239], v2, s[8:11], s18 offen offset:1024 sc1
    buffer_load_dwordx4 a[240:243], v2, s[8:11], s18 offen offset:2048 sc1
    buffer_load_dwordx4 a[244:247], v2, s[8:11], s18 offen offset:3072 sc1
    s_add_u32 s18, s18, 4096
    buffer_load_dwordx4 a[248:251], v2, s[8:11], s18 offen offset:0 sc1
    buffer_load_dwordx4 a[252:255], v2, s[8:11], s18 offen offset:1024 sc1
    v_mov_b32 v12, 7200
    s_cmp_lg_u32 s13, 0
    s_cbranch_scc1 TBS_86
    v_mov_b32 v15, 0
    s_mov_b64 exec, 1
TBW_85:
    global_load_dword v14, v15, s[4:5] sc1
    s_add_u32 s22, s22, 1
    s_cmp_gt_u32 s22, 2000000
    s_cbranch_scc1 MEGA_EXIT
    s_sleep 2
    s_waitcnt vmcnt(0)
    v_and_b32 v13, 0x3f, v14
    v_cmp_gt_u32 vcc, 32, v13
    s_cbranch_vccnz TBW_85
    v_bfe_u32 v13, v14, 6, 10
    v_mul_u32_u24 v13, v13, v13
    v_lshrrev_b32 v14, 16, v14
    v_lshlrev_b32 v14, 5, v14
    v_sub_u32 v14, v14, v13
    ds_write_b32 v12, v14
    s_waitcnt lgkmcnt(0)
    s_mov_b64 exec, -1
TBS_86:
    s_barrier
    ds_read_b32 v13, v12
    s_waitcnt lgkmcnt(0)
    v_readfirstlane_b32 s40, v13
    v_and_b32 v20, 0xf0, v2
    v_bfe_u32 v21, v2, 8, 1
    v_lshl_add_u32 v20, v21, 3, v20
    v_bfe_u32 v21, v2, 9, 1
    v_mul_u32_u24 v21, 14336, v21
    v_add_u32 v20, v20, v21
    s_lshr_b32 s21, s13, 1
    s_mul_i32 s21, s21, 57344
    s_lshl_b32 s18, s25, 8
    s_add_u32 s21, s21, s18
    s_add_u32 s21, s21, 114065408
    v_mov_b64 v[22:23], -1
    s_add_u32 s18, s21, 0
    buffer_store_dwordx2 v[22:23], v20, s[8:11], s18 offen sc1
    s_add_u32 s18, s21, 7168
    buffer_store_dwordx2 v[22:23], v20, s[8:11], s18 offen sc1
    s_add_u32 s18, s21, 28672
    buffer_store_dwordx2 v[22:23], v20, s[8:11], s18 offen sc1
    s_add_u32 s18, s21, 35840
    buffer_store_dwordx2 v[22:23], v20, s[8:11], s18 offen sc1
    s_add_u32 s18, s21, 114688
    buffer_store_dwordx2 v[22:23], v20, s[8:11], s18 offen sc1
    s_add_u32 s18, s21, 121856
    buffer_store_dwordx2 v[22:23], v20, s[8:11], s18 offen sc1
    s_add_u32 s18, s21, 143360
    buffer_store_dwordx2 v[22:23], v20, s[8:11], s18 offen sc1
    s_add_u32 s18, s21, 150528
    buffer_store_dwordx2 v[22:23], v20, s[8:11], s18 offen sc1
    s_waitcnt vmcnt(0)
    s_barrier
    s_cmp_lg_u32 s13, 1
    s_cbranch_scc1 ARM_87
    s_lshl_b32 s18, s12, 2
    s_add_u32 s18, s18, 116436800
    v_mov_b32 v22, 1
    v_mov_b32 v23, 1
    v_mov_b32 v24, 1
    s_mov_b64 exec, 1
    buffer_store_dword v22, off, s[8:11], s18 sc1
    s_cmp_lg_u32 s12, 13
    s_cbranch_scc1 AR2_88
    buffer_store_dwordx2 v[22:23], off, s[8:11], s18 offset:4 sc1
AR2_88:
    s_mov_b64 exec, -1
ARM_87:
    s_mul_i32 s23, s12, 32768
    s_lshl_b32 s18, s13, 12
    s_add_u32 s23, s23, s18
    s_add_u32 s23, s23, 46137344
    s_lshl_b32 s24, s13, 13
    s_add_u32 s24, s24, 77824
    s_mov_b32 s22, 0
    s_mov_b32 s27, 1
    s_cmp_ge_u32 s26, s27
    s_cbranch_scc1 RDO_89
    s_mov_b32 s18, 116394240
RDP_90:
    buffer_load_dword v12, off, s[8:11], s18 sc1
    s_add_u32 s22, s22, 1
    s_cmp_gt_u32 s22, 2000000
    s_cbranch_scc1 MEGA_EXIT
    s_waitcnt vmcnt(0)
    v_readfirstlane_b32 s26, v12
    s_nop 0
    s_cmp_lt_u32 s26, s27
    s_cbranch_scc1 RDP_90
RDO_89:
    s_add_u32 s18, s23, 0
    s_add_u32 m0, s24, 0
    s_nop 0
    buffer_load_dwordx4 v2, s[8:11], s18 offen offset:0 sc1 lds
    buffer_load_dwordx4 v2, s[8:11], s18 offen offset:1024 sc1 lds
    buffer_load_dwordx4 v2, s[8:11], s18 offen offset:2048 sc1 lds
    buffer_load_dwordx4 v2, s[8:11], s18 offen offset:3072 sc1 lds
    s_add_u32 s18, s23, 16384
    s_add_u32 m0, s24, 4096
    s_nop 0
    buffer_load_dwordx4 v2, s[8:11], s18 offen offset:0 sc1 lds
    buffer_load_dwordx4 v2, s[8:11], s18 offen offset:1024 sc1 lds
    buffer_load_dwordx4 v2, s[8:11], s18 offen offset:2048 sc1 lds
    buffer_load_dwordx4 v2, s[8:11], s18 offen offset:3072 sc1 lds
    s_mul_i32 s18, s12, 21846
    s_lshr_b32 s18, s18, 16
    s_mul_i32 s18, s18, 3
    s_sub_u32 s18, s12, s18
    s_lshl_b32 s18, s18, 13
    s_lshl_b32 s19, s13, 17
    s_add_u32 s18, s18, s19
    s_add_u32 s18, s18, 75497472
    v_lshlrev_b32 v13, 3, v2
    buffer_load_dword v14, v13, s[8:11], s18 offen sc1
    s_waitcnt vmcnt(0)
    s_cmp_ge_u32 s13, 2
    s_cbranch_scc1 CM0_91
    s_mov_b32 s18, 76546048
    buffer_store_dword v56, v5, s[8:11], s18 offen sc1
CM0_91:
    s_cmp_eq_u32 s13, 2
    s_cbranch_scc1 DSP_93
    s_cmp_eq_u32 s13, 3
    s_cbranch_scc1 DSP_94
DSP_92:
    s_cmp_lg_u32 s40, 0
    s_cbranch_scc1 SLOW_95
    s_mov_b32 s94, 116394240
    s_mov_b32 s14, 0
CLOOP_96:
    s_barrier
    s_and_b32 s18, s14, 3
    s_lshl_b32 s18, s18, 17
    s_add_u32 s15, s18, 75497472
    s_xor_b32 s17, s15, 262144
    s_add_u32 s18, s14, 1
    s_add_u32 s19, s18, 0
    s_lshr_b32 s31, s19, 1
    s_mul_i32 s31, s31, 14336
    s_and_b32 s19, s19, 1
    s_lshl_b32 s19, s19, 7
    s_add_u32 s31, s31, s19
    s_add_u32 s31, s31, 76546048
    s_and_b32 s18, s18, 3
    s_lshl_b32 s18, s18, 17
    s_add_u32 s16, s18, 75497472
    s_mov_b32 s22, 0
    v_add_u32 v11, s24, v2
    s_sub_u32 s18, s24, 77824
    s_xor_b32 s18, s18, 32768
    s_add_u32 s24, s18, 77824
    s_add_u32 s23, s23, 458752
    s_add_u32 s27, s14, 2
    s_min_u32 s27, s27, 64
    s_cmp_ge_u32 s26, s27
    s_cbranch_scc1 RDO_97
    s_mov_b32 s18, 116394240
RDP_98:
    buffer_load_dword v12, off, s[8:11], s18 sc1
    s_add_u32 s22, s22, 1
    s_cmp_gt_u32 s22, 2000000
    s_cbranch_scc1 MEGA_EXIT
    s_waitcnt vmcnt(0)
    v_readfirstlane_b32 s26, v12
    s_nop 0
    s_cmp_lt_u32 s26, s27
    s_cbranch_scc1 RDP_98
RDO_97:
    s_waitcnt vmcnt(2)
    ds_read_b128 v[64:67], v9 offset:0
    ds_read_b128 v[68:71], v9 offset:1024
    ds_read_b128 v[72:75], v9 offset:2048
    ds_read_b128 v[76:79], v9 offset:3072
    ds_read_b128 v[80:83], v9 offset:4096
    ds_read_b128 v[84:87], v9 offset:5120
    ds_read_b128 v[88:91], v9 offset:6144
    ds_read_b128 v[92:95], v9 offset:7168
    ds_read_b128 v[96:99], v9 offset:8192
    ds_read_b128 v[100:103], v9 offset:9216
    ds_read_b128 v[104:107], v9 offset:10240
    ds_read_b128 v[108:111], v9 offset:11264
    ds_read_b128 v[112:115], v9 offset:12288
    ds_read_b128 v[116:119], v9 offset:13312
    v_mov_b64 v[44:45], 0
    v_mov_b64 v[46:47], 0
    v_mov_b64 v[48:49], 0
    v_mov_b64 v[50:51], 0
    v_mov_b64 v[52:53], 0
    v_mov_b64 v[54:55], 0
    v_mov_b64 v[12:13], 0
    v_mov_b64 v[14:15], 0
    s_waitcnt lgkmcnt(0)
    s_barrier
    ds_read_b128 v[16:19], v2 offset:0
    ds_read_b128 v[20:23], v2 offset:1024
    ds_read_b128 v[24:27], v2 offset:2048
    ds_read_b128 v[28:31], v2 offset:3072
    ds_read_b128 v[32:35], v2 offset:4096
    ds_read_b128 v[36:39], v2 offset:5120
    ds_read_b128 v[40:43], v2 offset:6144
    s_waitcnt lgkmcnt(6)
    v_smfmac_f32_16x16x64_bf16 v[44:47], v[16:19], v[64:71], v3
    s_add_u32 s18, s23, 0
    s_add_u32 m0, s24, 0
    s_nop 0
    buffer_load_dwordx4 v2, s[8:11], s18 offen offset:0 sc1 lds
    s_waitcnt lgkmcnt(5)
    v_smfmac_f32_16x16x64_bf16 v[44:47], v[20:23], v[72:79], v3
    s_waitcnt lgkmcnt(4)
    v_smfmac_f32_16x16x64_bf16 v[44:47], v[24:27], v[80:87], v3
    s_waitcnt lgkmcnt(3)
    v_smfmac_f32_16x16x64_bf16 v[44:47], v[28:31], v[88:95], v3
    s_waitcnt lgkmcnt(2)
    v_smfmac_f32_16x16x64_bf16 v[44:47], v[32:35], v[96:103], v3
    buffer_load_dwordx4 v2, s[8:11], s18 offen offset:1024 sc1 lds
    s_waitcnt lgkmcnt(1)
    v_smfmac_f32_16x16x64_bf16 v[44:47], v[36:39], v[104:111], v3
    s_waitcnt lgkmcnt(0)
    v_smfmac_f32_16x16x64_bf16 v[44:47], v[40:43], v[112:119], v3
    v_smfmac_f32_16x16x64_bf16 v[48:51], v[16:19], v[120:127], v3
    ds_read_b128 v[80:83], v11 offset:0
    v_smfmac_f32_16x16x64_bf16 v[48:51], v[20:23], v[128:135], v3
    buffer_load_dwordx4 v2, s[8:11], s18 offen offset:2048 sc1 lds
    v_mov_b64 v[112:113], 0
    v_smfmac_f32_16x16x64_bf16 v[48:51], v[24:27], v[136:143], v3
    ds_read_b128 v[84:87], v11 offset:2048
    v_mov_b64 v[114:115], 0
    v_smfmac_f32_16x16x64_bf16 v[48:51], v[28:31], v[144:151], v3
    ds_read_b128 v[88:91], v11 offset:1024
    v_mov_b64 v[116:117], 0
    v_smfmac_f32_16x16x64_bf16 v[48:51], v[32:35], v[152:159], v3
    ds_read_b128 v[92:95], v11 offset:3072
    v_mov_b64 v[118:119], 0
    v_smfmac_f32_16x16x64_bf16 v[48:51], v[36:39], v[160:167], v3
    buffer_load_dwordx4 v2, s[8:11], s18 offen offset:3072 sc1 lds
    v_mov_b64 v[72:73], 0
    v_smfmac_f32_16x16x64_bf16 v[48:51], v[40:43], v[168:175], v3
    ds_read_b128 v[96:99], v11 offset:4096
    v_mov_b64 v[74:75], 0
    v_smfmac_f32_16x16x64_bf16 v[52:55], v[16:19], v[176:183], v3
    ds_read_b128 v[100:103], v11 offset:6144
    v_mov_b64 v[76:77], 0
    v_smfmac_f32_16x16x64_bf16 v[52:55], v[20:23], v[184:191], v3
    ds_read_b128 v[104:107], v11 offset:5120
    v_mov_b64 v[78:79], 0
    v_smfmac_f32_16x16x64_bf16 v[52:55], v[24:27], v[192:199], v3
    s_add_u32 s18, s23, 16384
    s_add_u32 m0, s24, 4096
    s_nop 0
    buffer_load_dwordx4 v2, s[8:11], s18 offen offset:0 sc1 lds
    v_permlane32_swap_b32 v44, v48
    v_smfmac_f32_16x16x64_bf16 v[52:55], v[28:31], v[200:207], v3
    ds_read_b128 v[108:111], v11 offset:7168
    v_permlane32_swap_b32 v45, v49
    v_smfmac_f32_16x16x64_bf16 v[52:55], v[32:35], v[208:215], v3
    v_permlane32_swap_b32 v46, v50
    v_smfmac_f32_16x16x64_bf16 v[52:55], v[36:39], v[216:223], v3
    v_permlane32_swap_b32 v47, v51
    v_smfmac_f32_16x16x64_bf16 v[52:55], v[40:43], v[224:231], v3
    buffer_load_dwordx4 v2, s[8:11], s18 offen offset:1024 sc1 lds
    v_add_f32 v44, v44, v48
    v_smfmac_f32_16x16x64_bf16 v[12:15], v[16:19], v[232:239], v3
    v_add_f32 v45, v45, v49
    v_smfmac_f32_16x16x64_bf16 v[12:15], v[20:23], v[240:247], v3
    s_waitcnt lgkmcnt(0)
    v_add_f32 v46, v46, v50
    v_swap_b32 v81, v84
    v_smfmac_f32_16x16x64_bf16 v[12:15], v[24:27], v[248:255], v3
    v_add_f32 v47, v47, v51
    v_smfmac_f32_16x16x64_bf16 v[12:15], v[28:31], a[0:7], v3
    buffer_load_dwordx4 v2, s[8:11], s18 offen offset:2048 sc1 lds
    v_cvt_pk_bf16_f32 v56, v44, v45
    v_smfmac_f32_16x16x64_bf16 v[12:15], v[32:35], a[8:15], v3
    v_cvt_pk_bf16_f32 v58, v46, v47
    v_smfmac_f32_16x16x64_bf16 v[12:15], v[36:39], a[16:23], v3
    v_mov_b64 v[44:45], 0
    v_mov_b64 v[46:47], 0
    v_smfmac_f32_16x16x64_bf16 v[12:15], v[40:43], a[24:31], v3
    v_mov_b64 v[48:49], 0
    v_swap_b32 v83, v86
    v_smfmac_f32_16x16x64_bf16 v[44:47], v[16:19], a[32:39], v3
    buffer_load_dwordx4 v2, s[8:11], s18 offen offset:3072 sc1 lds
    v_mov_b64 v[50:51], 0
    v_smfmac_f32_16x16x64_bf16 v[44:47], v[20:23], a[40:47], v3
    v_smfmac_f32_16x16x64_bf16 v[44:47], v[24:27], a[48:55], v3
    v_permlane32_swap_b32 v52, v12
    v_smfmac_f32_16x16x64_bf16 v[44:47], v[28:31], a[56:63], v3
    v_permlane32_swap_b32 v53, v13
    v_swap_b32 v89, v92
    v_smfmac_f32_16x16x64_bf16 v[44:47], v[32:35], a[64:71], v3
    v_permlane32_swap_b32 v54, v14
    v_smfmac_f32_16x16x64_bf16 v[44:47], v[36:39], a[72:79], v3
    v_permlane32_swap_b32 v55, v15
    v_smfmac_f32_16x16x64_bf16 v[44:47], v[40:43], a[80:87], v3
    v_add_f32 v52, v52, v12
    v_smfmac_f32_16x16x64_bf16 v[48:51], v[16:19], a[88:95], v3
    v_add_f32 v53, v53, v13
    v_swap_b32 v91, v94
    v_smfmac_f32_16x16x64_bf16 v[48:51], v[20:23], a[96:103], v3
    v_add_f32 v54, v54, v14
    v_smfmac_f32_16x16x64_bf16 v[48:51], v[24:27], a[104:111], v3
    v_add_f32 v55, v55, v15
    v_smfmac_f32_16x16x64_bf16 v[48:51], v[28:31], a[112:119], v3
    v_cvt_pk_bf16_f32 v57, v52, v53
    v_smfmac_f32_16x16x64_bf16 v[48:51], v[32:35], a[120:127], v3
    v_cvt_pk_bf16_f32 v59, v54, v55
    v_swap_b32 v97, v100
    v_smfmac_f32_16x16x64_bf16 v[48:51], v[36:39], a[128:135], v3
    buffer_load_dword v1, off, s[8:11], s94 sc1
    v_mov_b64 v[52:53], 0
    v_mov_b64 v[54:55], 0
    v_smfmac_f32_16x16x64_bf16 v[48:51], v[40:43], a[136:143], v3
    v_mov_b64 v[12:13], 0
    v_smfmac_f32_16x16x64_bf16 v[52:55], v[16:19], a[144:151], v3
    v_mov_b64 v[14:15], 0
    v_smfmac_f32_16x16x64_bf16 v[52:55], v[20:23], a[152:159], v3
    v_swap_b32 v99, v102
    v_smfmac_f32_16x16x64_bf16 v[52:55], v[24:27], a[160:167], v3
    buffer_load_dwordx4 v[64:67], v6, s[8:11], s15 offen offset:0 sc1
    v_permlane32_swap_b32 v44, v48
    v_smfmac_f32_16x16x64_bf16 v[52:55], v[28:31], a[168:175], v3
    buffer_load_dwordx4 v[68:71], v6, s[8:11], s15 offen offset:1024 sc1
    v_permlane32_swap_b32 v45, v49
    v_smfmac_f32_16x16x64_bf16 v[52:55], v[32:35], a[176:183], v3
    v_permlane32_swap_b32 v46, v50
    v_smfmac_f32_16x16x64_bf16 v[52:55], v[36:39], a[184:191], v3
    v_permlane32_swap_b32 v47, v51
    v_swap_b32 v105, v108
    v_smfmac_f32_16x16x64_bf16 v[52:55], v[40:43], a[192:199], v3
    v_add_f32 v44, v44, v48
    v_smfmac_f32_16x16x64_bf16 v[12:15], v[16:19], a[200:207], v3
    v_add_f32 v45, v45, v49
    v_smfmac_f32_16x16x64_bf16 v[12:15], v[20:23], a[208:215], v3
    buffer_load_dwordx4 v[64:67], v6, s[8:11], s15 offen offset:0 sc1
    v_add_f32 v46, v46, v50
    v_smfmac_f32_16x16x64_bf16 v[12:15], v[24:27], a[216:223], v3
    buffer_load_dwordx4 v[68:71], v6, s[8:11], s15 offen offset:1024 sc1
    v_add_f32 v47, v47, v51
    v_swap_b32 v107, v110
    v_smfmac_f32_16x16x64_bf16 v[12:15], v[28:31], a[224:231], v3
    v_cvt_pk_bf16_f32 v60, v44, v45
    v_smfmac_f32_16x16x64_bf16 v[12:15], v[32:35], a[232:239], v3
    v_cvt_pk_bf16_f32 v62, v46, v47
    v_smfmac_f32_16x16x64_bf16 v[12:15], v[36:39], a[240:247], v3
    buffer_load_dwordx4 v[64:67], v6, s[8:11], s15 offen offset:0 sc1
    v_smfmac_f32_16x16x64_bf16 v[12:15], v[40:43], a[248:255], v3
    buffer_load_dwordx4 v[68:71], v6, s[8:11], s15 offen offset:1024 sc1
    s_lshl_b32 s18, s13, 10
    s_add_u32 s18, s18, 10240
    v_add_u32 v16, s18, v2
    s_nop 3
    v_permlane32_swap_b32 v52, v12
    v_permlane32_swap_b32 v53, v13
    v_permlane32_swap_b32 v54, v14
    v_permlane32_swap_b32 v55, v15
    v_add_f32 v52, v52, v12
    v_add_f32 v53, v53, v13
    v_add_f32 v54, v54, v14
    v_add_f32 v55, v55, v15
    v_cvt_pk_bf16_f32 v61, v52, v53
    v_cvt_pk_bf16_f32 v63, v54, v55
    s_branch CPE1_100
CPE_99:
    buffer_load_dwordx4 v[64:67], v6, s[8:11], s15 offen offset:0 sc1
    buffer_load_dwordx4 v[68:71], v6, s[8:11], s15 offen offset:1024 sc1
    s_add_u32 s22, s22, 1
    s_cmp_gt_u32 s22, 2000000
    s_cbranch_scc1 MEGA_EXIT
CPE1_100:
    s_waitcnt vmcnt(4)
    v_max3_u32 v8, v64, v65, v66
    v_max3_u32 v8, v8, v67, v68
    v_max3_u32 v8, v8, v69, v70
    v_max_u32 v8, v8, v71
    v_cmp_eq_u32 vcc, -1, v8
    s_cbranch_vccnz CPE_99
    v_smfmac_f32_16x16x64_bf16 v[112:115], v[64:67], v[80:87], v3
    v_smfmac_f32_16x16x64_bf16 v[116:119], v[68:71], v[88:95], v3
    v_smfmac_f32_16x16x64_bf16 v[72:75], v[64:67], v[96:103], v3
    v_smfmac_f32_16x16x64_bf16 v[76:79], v[68:71], v[104:111], v3
    buffer_load_dwordx4 v[24:27], v7, s[8:11], s15 offen sc1
    buffer_load_dwordx2 v[32:33], v0, s[8:11], s15 offen sc1
    buffer_load_dwordx4 v[28:31], v7, s[8:11], s15 offen offset:1024 sc1
    v_readfirstlane_b32 s26, v1
    v_cvt_pk_bf16_f32 v44, v112, v113
    v_cvt_pk_bf16_f32 v46, v114, v115
    v_cvt_pk_bf16_f32 v45, v116, v117
    v_cvt_pk_bf16_f32 v47, v118, v119
    ds_write_b128 v16, v[44:47]
    v_cvt_pk_bf16_f32 v48, v72, v73
    v_cvt_pk_bf16_f32 v50, v74, v75
    v_cvt_pk_bf16_f32 v49, v76, v77
    v_cvt_pk_bf16_f32 v51, v78, v79
    ds_write_b128 v16, v[48:51] offset:6144
    buffer_load_dwordx4 v[24:27], v7, s[8:11], s15 offen sc1
    buffer_load_dwordx2 v[32:33], v0, s[8:11], s15 offen sc1
    buffer_load_dwordx4 v[28:31], v7, s[8:11], s15 offen offset:1024 sc1
    v_mov_b64 v[52:53], 0
    v_mov_b64 v[54:55], 0
    s_waitcnt lgkmcnt(0)
    s_barrier
    ds_read_b128 v[36:39], v10 offset:0
    ds_read_b128 v[40:43], v10 offset:1024
    ds_read_b128 v[88:91], v10 offset:2048
    ds_read_b128 v[92:95], v10 offset:3072
    ds_read_b128 v[96:99], v10 offset:4096
    ds_read_b128 v[100:103], v10 offset:5120
CPP_101:
    buffer_load_dwordx4 v[24:27], v7, s[8:11], s15 offen sc1
    buffer_load_dwordx2 v[32:33], v0, s[8:11], s15 offen sc1
    buffer_load_dwordx4 v[28:31], v7, s[8:11], s15 offen offset:1024 sc1
    s_add_u32 s22, s22, 1
    s_cmp_gt_u32 s22, 2000000
    s_cbranch_scc1 MEGA_EXIT
CPP1_102:
    s_waitcnt vmcnt(8)
    v_max3_u32 v12, v24, v25, v26
    v_max_u32 v12, v12, v27
    s_waitcnt vmcnt(6)
    v_max3_u32 v12, v12, v28, v29
    v_max3_u32 v12, v12, v30, v31
    v_max3_u32 v12, v12, v32, v33
    v_cmp_eq_u32 vcc, -1, v12
    s_cbranch_vccnz CPP_101
    v_smfmac_f32_16x16x64_bf16 v[52:55], v[24:27], v[56:63], v3
    v_cndmask_b32 v80, 0, v32, s[84:85]
    v_cndmask_b32 v81, 0, v32, s[86:87]
    v_cndmask_b32 v82, 0, v32, s[88:89]
    v_cndmask_b32 v83, 0, v32, s[90:91]
    v_cndmask_b32 v84, 0, v33, s[84:85]
    v_cndmask_b32 v85, 0, v33, s[86:87]
    v_cndmask_b32 v86, 0, v33, s[88:89]
    s_waitcnt lgkmcnt(4)
    v_smfmac_f32_16x16x64_bf16 v[52:55], v[28:31], v[36:43], v3
    s_waitcnt lgkmcnt(2)
    v_cndmask_b32 v87, 0, v33, s[90:91]
    v_smfmac_f32_16x16x64_bf16 v[52:55], v[80:83], v[88:95], v3
    s_waitcnt lgkmcnt(0)
    v_smfmac_f32_16x16x64_bf16 v[52:55], v[84:87], v[96:103], v3
    s_nop 7
    v_permlane32_swap_b32 v52, v54
    v_permlane32_swap_b32 v53, v55
    v_add_f32 v52, v52, v54
    v_add_f32 v53, v53, v55
    s_nop 0
    v_mov_b32_dpp v54, v52 quad_perm:[1,0,3,2] row_mask:0xf bank_mask:0xf
    v_mov_b32_dpp v55, v53 quad_perm:[1,0,3,2] row_mask:0xf bank_mask:0xf
    v_cvt_pk_bf16_f32 v52, v52, v54
    v_cvt_pk_bf16_f32 v53, v55, v53
    v_cndmask_b32 v52, v53, v52, s[36:37]
    v_min_u32 v52, -2, v52
    buffer_store_dword v52, v4, s[8:11], s16 offen
    buffer_store_dword v52, v5, s[8:11], s31 offen
    s_add_u32 s14, s14, 1
    s_cmp_lt_u32 s14, 63
    s_cbranch_scc1 CLOOP_96
    s_branch C_LAST
SLOW_95:
    s_mov_b32 s94, 116394240
    s_mov_b32 s14, 0
CLOOP_103:
    s_barrier
    s_and_b32 s18, s14, 3
    s_lshl_b32 s18, s18, 17
    s_add_u32 s15, s18, 75497472
    s_xor_b32 s17, s15, 262144
    s_add_u32 s18, s14, 1
    s_add_u32 s19, s18, 0
    s_lshr_b32 s31, s19, 1
    s_mul_i32 s31, s31, 14336
    s_and_b32 s19, s19, 1
    s_lshl_b32 s19, s19, 7
    s_add_u32 s31, s31, s19
    s_add_u32 s31, s31, 76546048
    s_and_b32 s18, s18, 3
    s_lshl_b32 s18, s18, 17
    s_add_u32 s16, s18, 75497472
    s_mov_b32 s22, 0
    v_add_u32 v11, s24, v2
    s_sub_u32 s18, s24, 77824
    s_xor_b32 s18, s18, 32768
    s_add_u32 s24, s18, 77824
    s_add_u32 s23, s23, 458752
    s_add_u32 s27, s14, 2
    s_min_u32 s27, s27, 64
    s_cmp_ge_u32 s26, s27
    s_cbranch_scc1 RDO_104
    s_mov_b32 s18, 116394240
RDP_105:
    buffer_load_dword v12, off, s[8:11], s18 sc1
    s_add_u32 s22, s22, 1
    s_cmp_gt_u32 s22, 2000000
    s_cbranch_scc1 MEGA_EXIT
    s_waitcnt vmcnt(0)
    v_readfirstlane_b32 s26, v12
    s_nop 0
    s_cmp_lt_u32 s26, s27
    s_cbranch_scc1 RDP_105
RDO_104:
    s_waitcnt vmcnt(2)
    ds_read_b128 v[64:67], v9 offset:0
    ds_read_b128 v[68:71], v9 offset:1024
    ds_read_b128 v[72:75], v9 offset:2048
    ds_read_b128 v[76:79], v9 offset:3072
    ds_read_b128 v[80:83], v9 offset:4096
    ds_read_b128 v[84:87], v9 offset:5120
    ds_read_b128 v[88:91], v9 offset:6144
    ds_read_b128 v[92:95], v9 offset:7168
    ds_read_b128 v[96:99], v9 offset:8192
    ds_read_b128 v[100:103], v9 offset:9216
    ds_read_b128 v[104:107], v9 offset:10240
    ds_read_b128 v[108:111], v9 offset:11264
    ds_read_b128 v[112:115], v9 offset:12288
    ds_read_b128 v[116:119], v9 offset:13312
    v_mov_b64 v[44:45], 0
    v_mov_b64 v[46:47], 0
    v_mov_b64 v[48:49], 0
    v_mov_b64 v[50:51], 0
    v_mov_b64 v[52:53], 0
    v_mov_b64 v[54:55], 0
    v_mov_b64 v[12:13], 0
    v_mov_b64 v[14:15], 0
    s_waitcnt lgkmcnt(0)
    s_barrier
    ds_read_b128 v[16:19], v2 offset:0
    ds_read_b128 v[20:23], v2 offset:1024
    ds_read_b128 v[24:27], v2 offset:2048
    ds_read_b128 v[28:31], v2 offset:3072
    ds_read_b128 v[32:35], v2 offset:4096
    ds_read_b128 v[36:39], v2 offset:5120
    ds_read_b128 v[40:43], v2 offset:6144
    s_waitcnt lgkmcnt(6)
    v_smfmac_f32_16x16x64_bf16 v[44:47], v[16:19], v[64:71], v3
    s_add_u32 s18, s23, 0
    s_add_u32 m0, s24, 0
    s_nop 0
    buffer_load_dwordx4 v2, s[8:11], s18 offen offset:0 sc1 lds
    s_waitcnt lgkmcnt(5)
    v_smfmac_f32_16x16x64_bf16 v[44:47], v[20:23], v[72:79], v3
    s_waitcnt lgkmcnt(4)
    v_smfmac_f32_16x16x64_bf16 v[44:47], v[24:27], v[80:87], v3
    s_waitcnt lgkmcnt(3)
    v_smfmac_f32_16x16x64_bf16 v[44:47], v[28:31], v[88:95], v3
    s_waitcnt lgkmcnt(2)
    v_smfmac_f32_16x16x64_bf16 v[44:47], v[32:35], v[96:103], v3
    buffer_load_dwordx4 v2, s[8:11], s18 offen offset:1024 sc1 lds
    s_waitcnt lgkmcnt(1)
    v_smfmac_f32_16x16x64_bf16 v[44:47], v[36:39], v[104:111], v3
    s_waitcnt lgkmcnt(0)
    v_smfmac_f32_16x16x64_bf16 v[44:47], v[40:43], v[112:119], v3
    v_smfmac_f32_16x16x64_bf16 v[48:51], v[16:19], v[120:127], v3
    ds_read_b128 v[80:83], v11 offset:0
    v_smfmac_f32_16x16x64_bf16 v[48:51], v[20:23], v[128:135], v3
    buffer_load_dwordx4 v2, s[8:11], s18 offen offset:2048 sc1 lds
    v_mov_b64 v[112:113], 0
    v_smfmac_f32_16x16x64_bf16 v[48:51], v[24:27], v[136:143], v3
    ds_read_b128 v[84:87], v11 offset:2048
    v_mov_b64 v[114:115], 0
    v_smfmac_f32_16x16x64_bf16 v[48:51], v[28:31], v[144:151], v3
    ds_read_b128 v[88:91], v11 offset:1024
    v_mov_b64 v[116:117], 0
    v_smfmac_f32_16x16x64_bf16 v[48:51], v[32:35], v[152:159], v3
    ds_read_b128 v[92:95], v11 offset:3072
    v_mov_b64 v[118:119], 0
    v_smfmac_f32_16x16x64_bf16 v[48:51], v[36:39], v[160:167], v3
    buffer_load_dwordx4 v2, s[8:11], s18 offen offset:3072 sc1 lds
    v_mov_b64 v[72:73], 0
    v_smfmac_f32_16x16x64_bf16 v[48:51], v[40:43], v[168:175], v3
    ds_read_b128 v[96:99], v11 offset:4096
    v_mov_b64 v[74:75], 0
    v_smfmac_f32_16x16x64_bf16 v[52:55], v[16:19], v[176:183], v3
    ds_read_b128 v[100:103], v11 offset:6144
    v_mov_b64 v[76:77], 0
    v_smfmac_f32_16x16x64_bf16 v[52:55], v[20:23], v[184:191], v3
    ds_read_b128 v[104:107], v11 offset:5120
    v_mov_b64 v[78:79], 0
    v_smfmac_f32_16x16x64_bf16 v[52:55], v[24:27], v[192:199], v3
    s_add_u32 s18, s23, 16384
    s_add_u32 m0, s24, 4096
    s_nop 0
    buffer_load_dwordx4 v2, s[8:11], s18 offen offset:0 sc1 lds
    v_permlane32_swap_b32 v44, v48
    v_smfmac_f32_16x16x64_bf16 v[52:55], v[28:31], v[200:207], v3
    ds_read_b128 v[108:111], v11 offset:7168
    v_permlane32_swap_b32 v45, v49
    v_smfmac_f32_16x16x64_bf16 v[52:55], v[32:35], v[208:215], v3
    v_permlane32_swap_b32 v46, v50
    v_smfmac_f32_16x16x64_bf16 v[52:55], v[36:39], v[216:223], v3
    v_permlane32_swap_b32 v47, v51
    v_smfmac_f32_16x16x64_bf16 v[52:55], v[40:43], v[224:231], v3
    buffer_load_dwordx4 v2, s[8:11], s18 offen offset:1024 sc1 lds
    v_add_f32 v44, v44, v48
    v_smfmac_f32_16x16x64_bf16 v[12:15], v[16:19], v[232:239], v3
    v_add_f32 v45, v45, v49
    v_smfmac_f32_16x16x64_bf16 v[12:15], v[20:23], v[240:247], v3
    s_waitcnt lgkmcnt(0)
    v_add_f32 v46, v46, v50
    v_swap_b32 v81, v84
    v_smfmac_f32_16x16x64_bf16 v[12:15], v[24:27], v[248:255], v3
    v_add_f32 v47, v47, v51
    v_smfmac_f32_16x16x64_bf16 v[12:15], v[28:31], a[0:7], v3
    buffer_load_dwordx4 v2, s[8:11], s18 offen offset:2048 sc1 lds
    v_cvt_pk_bf16_f32 v56, v44, v45
    v_smfmac_f32_16x16x64_bf16 v[12:15], v[32:35], a[8:15], v3
    v_cvt_pk_bf16_f32 v58, v46, v47
    v_smfmac_f32_16x16x64_bf16 v[12:15], v[36:39], a[16:23], v3
    v_mov_b64 v[44:45], 0
    v_mov_b64 v[46:47], 0
    v_smfmac_f32_16x16x64_bf16 v[12:15], v[40:43], a[24:31], v3
    v_mov_b64 v[48:49], 0
    v_swap_b32 v83, v86
    v_smfmac_f32_16x16x64_bf16 v[44:47], v[16:19], a[32:39], v3
    buffer_load_dwordx4 v2, s[8:11], s18 offen offset:3072 sc1 lds
    v_mov_b64 v[50:51], 0
    v_smfmac_f32_16x16x64_bf16 v[44:47], v[20:23], a[40:47], v3
    v_smfmac_f32_16x16x64_bf16 v[44:47], v[24:27], a[48:55], v3
    v_permlane32_swap_b32 v52, v12
    v_smfmac_f32_16x16x64_bf16 v[44:47], v[28:31], a[56:63], v3
    v_permlane32_swap_b32 v53, v13
    v_swap_b32 v89, v92
    v_smfmac_f32_16x16x64_bf16 v[44:47], v[32:35], a[64:71], v3
    v_permlane32_swap_b32 v54, v14
    v_smfmac_f32_16x16x64_bf16 v[44:47], v[36:39], a[72:79], v3
    v_permlane32_swap_b32 v55, v15
    v_smfmac_f32_16x16x64_bf16 v[44:47], v[40:43], a[80:87], v3
    v_add_f32 v52, v52, v12
    v_smfmac_f32_16x16x64_bf16 v[48:51], v[16:19], a[88:95], v3
    v_add_f32 v53, v53, v13
    v_swap_b32 v91, v94
    v_smfmac_f32_16x16x64_bf16 v[48:51], v[20:23], a[96:103], v3
    v_add_f32 v54, v54, v14
    v_smfmac_f32_16x16x64_bf16 v[48:51], v[24:27], a[104:111], v3
    v_add_f32 v55, v55, v15
    v_smfmac_f32_16x16x64_bf16 v[48:51], v[28:31], a[112:119], v3
    v_cvt_pk_bf16_f32 v57, v52, v53
    v_smfmac_f32_16x16x64_bf16 v[48:51], v[32:35], a[120:127], v3
    v_cvt_pk_bf16_f32 v59, v54, v55
    v_swap_b32 v97, v100
    v_smfmac_f32_16x16x64_bf16 v[48:51], v[36:39], a[128:135], v3
    buffer_load_dword v1, off, s[8:11], s94 sc1
    v_mov_b64 v[52:53], 0
    v_mov_b64 v[54:55], 0
    v_smfmac_f32_16x16x64_bf16 v[48:51], v[40:43], a[136:143], v3
    v_mov_b64 v[12:13], 0
    v_smfmac_f32_16x16x64_bf16 v[52:55], v[16:19], a[144:151], v3
    v_mov_b64 v[14:15], 0
    v_smfmac_f32_16x16x64_bf16 v[52:55], v[20:23], a[152:159], v3
    v_swap_b32 v99, v102
    v_smfmac_f32_16x16x64_bf16 v[52:55], v[24:27], a[160:167], v3
    buffer_load_dwordx4 v[64:67], v6, s[8:11], s15 offen offset:0 sc1
    v_permlane32_swap_b32 v44, v48
    v_smfmac_f32_16x16x64_bf16 v[52:55], v[28:31], a[168:175], v3
    buffer_load_dwordx4 v[68:71], v6, s[8:11], s15 offen offset:1024 sc1
    v_permlane32_swap_b32 v45, v49
    v_smfmac_f32_16x16x64_bf16 v[52:55], v[32:35], a[176:183], v3
    v_permlane32_swap_b32 v46, v50
    v_smfmac_f32_16x16x64_bf16 v[52:55], v[36:39], a[184:191], v3
    v_permlane32_swap_b32 v47, v51
    v_swap_b32 v105, v108
    v_smfmac_f32_16x16x64_bf16 v[52:55], v[40:43], a[192:199], v3
    v_add_f32 v44, v44, v48
    v_smfmac_f32_16x16x64_bf16 v[12:15], v[16:19], a[200:207], v3
    v_add_f32 v45, v45, v49
    v_smfmac_f32_16x16x64_bf16 v[12:15], v[20:23], a[208:215], v3
    buffer_load_dwordx4 v[64:67], v6, s[8:11], s15 offen offset:0 sc1
    v_add_f32 v46, v46, v50
    v_smfmac_f32_16x16x64_bf16 v[12:15], v[24:27], a[216:223], v3
    buffer_load_dwordx4 v[68:71], v6, s[8:11], s15 offen offset:1024 sc1
    v_add_f32 v47, v47, v51
    v_swap_b32 v107, v110
    v_smfmac_f32_16x16x64_bf16 v[12:15], v[28:31], a[224:231], v3
    v_cvt_pk_bf16_f32 v60, v44, v45
    v_smfmac_f32_16x16x64_bf16 v[12:15], v[32:35], a[232:239], v3
    v_cvt_pk_bf16_f32 v62, v46, v47
    v_smfmac_f32_16x16x64_bf16 v[12:15], v[36:39], a[240:247], v3
    buffer_load_dwordx4 v[64:67], v6, s[8:11], s15 offen offset:0 sc1
    v_smfmac_f32_16x16x64_bf16 v[12:15], v[40:43], a[248:255], v3
    buffer_load_dwordx4 v[68:71], v6, s[8:11], s15 offen offset:1024 sc1
    s_lshl_b32 s18, s13, 10
    s_add_u32 s18, s18, 10240
    v_add_u32 v16, s18, v2
    s_nop 3
    v_permlane32_swap_b32 v52, v12
    v_permlane32_swap_b32 v53, v13
    v_permlane32_swap_b32 v54, v14
    v_permlane32_swap_b32 v55, v15
    v_add_f32 v52, v52, v12
    v_add_f32 v53, v53, v13
    v_add_f32 v54, v54, v14
    v_add_f32 v55, v55, v15
    v_cvt_pk_bf16_f32 v61, v52, v53
    v_cvt_pk_bf16_f32 v63, v54, v55
    s_branch CPE1_107
CPE_106:
    buffer_load_dwordx4 v[64:67], v6, s[8:11], s15 offen offset:0 sc1
    buffer_load_dwordx4 v[68:71], v6, s[8:11], s15 offen offset:1024 sc1
    s_add_u32 s22, s22, 1
    s_cmp_gt_u32 s22, 2000000
    s_cbranch_scc1 MEGA_EXIT
CPE1_107:
    s_waitcnt vmcnt(4)
    v_max3_u32 v8, v64, v65, v66
    v_max3_u32 v8, v8, v67, v68
    v_max3_u32 v8, v8, v69, v70
    v_max_u32 v8, v8, v71
    v_cmp_eq_u32 vcc, -1, v8
    s_cbranch_vccnz CPE_106
    v_smfmac_f32_16x16x64_bf16 v[112:115], v[64:67], v[80:87], v3
    v_smfmac_f32_16x16x64_bf16 v[116:119], v[68:71], v[88:95], v3
    v_smfmac_f32_16x16x64_bf16 v[72:75], v[64:67], v[96:103], v3
    v_smfmac_f32_16x16x64_bf16 v[76:79], v[68:71], v[104:111], v3
    buffer_load_dwordx4 v[24:27], v7, s[8:11], s15 offen sc1
    buffer_load_dwordx2 v[32:33], v0, s[8:11], s15 offen sc1
    buffer_load_dwordx4 v[28:31], v7, s[8:11], s15 offen offset:1024 sc1
    v_readfirstlane_b32 s26, v1
    v_cvt_pk_bf16_f32 v44, v112, v113
    v_cvt_pk_bf16_f32 v46, v114, v115
    v_cvt_pk_bf16_f32 v45, v116, v117
    v_cvt_pk_bf16_f32 v47, v118, v119
    ds_write_b128 v16, v[44:47]
    v_cvt_pk_bf16_f32 v48, v72, v73
    v_cvt_pk_bf16_f32 v50, v74, v75
    v_cvt_pk_bf16_f32 v49, v76, v77
    v_cvt_pk_bf16_f32 v51, v78, v79
    ds_write_b128 v16, v[48:51] offset:6144
    buffer_load_dwordx4 v[24:27], v7, s[8:11], s15 offen sc1
    buffer_load_dwordx2 v[32:33], v0, s[8:11], s15 offen sc1
    buffer_load_dwordx4 v[28:31], v7, s[8:11], s15 offen offset:1024 sc1
    v_mov_b64 v[52:53], 0
    v_mov_b64 v[54:55], 0
    s_waitcnt lgkmcnt(0)
    s_barrier
    ds_read_b128 v[36:39], v10 offset:0
    ds_read_b128 v[40:43], v10 offset:1024
    ds_read_b128 v[88:91], v10 offset:2048
    ds_read_b128 v[92:95], v10 offset:3072
    ds_read_b128 v[96:99], v10 offset:4096
    ds_read_b128 v[100:103], v10 offset:5120
CPP_108:
    buffer_load_dwordx4 v[24:27], v7, s[8:11], s15 offen sc1
    buffer_load_dwordx2 v[32:33], v0, s[8:11], s15 offen sc1
    buffer_load_dwordx4 v[28:31], v7, s[8:11], s15 offen offset:1024 sc1
    s_add_u32 s22, s22, 1
    s_cmp_gt_u32 s22, 2000000
    s_cbranch_scc1 MEGA_EXIT
CPP1_109:
    s_waitcnt vmcnt(8)
    v_max3_u32 v12, v24, v25, v26
    v_max_u32 v12, v12, v27
    s_waitcnt vmcnt(6)
    v_max3_u32 v12, v12, v28, v29
    v_max3_u32 v12, v12, v30, v31
    v_max3_u32 v12, v12, v32, v33
    v_cmp_eq_u32 vcc, -1, v12
    s_cbranch_vccnz CPP_108
    v_smfmac_f32_16x16x64_bf16 v[52:55], v[24:27], v[56:63], v3
    v_cndmask_b32 v80, 0, v32, s[84:85]
    v_cndmask_b32 v81, 0, v32, s[86:87]
    v_cndmask_b32 v82, 0, v32, s[88:89]
    v_cndmask_b32 v83, 0, v32, s[90:91]
    v_cndmask_b32 v84, 0, v33, s[84:85]
    v_cndmask_b32 v85, 0, v33, s[86:87]
    v_cndmask_b32 v86, 0, v33, s[88:89]
    s_waitcnt lgkmcnt(4)
    v_smfmac_f32_16x16x64_bf16 v[52:55], v[28:31], v[36:43], v3
    s_waitcnt lgkmcnt(2)
    v_cndmask_b32 v87, 0, v33, s[90:91]
    v_smfmac_f32_16x16x64_bf16 v[52:55], v[80:83], v[88:95], v3
    s_waitcnt lgkmcnt(0)
    v_smfmac_f32_16x16x64_bf16 v[52:55], v[84:87], v[96:103], v3
    s_nop 7
    v_permlane32_swap_b32 v52, v54
    v_permlane32_swap_b32 v53, v55
    v_add_f32 v52, v52, v54
    v_add_f32 v53, v53, v55
    s_nop 0
    v_mov_b32_dpp v54, v52 quad_perm:[1,0,3,2] row_mask:0xf bank_mask:0xf
    v_mov_b32_dpp v55, v53 quad_perm:[1,0,3,2] row_mask:0xf bank_mask:0xf
    v_cvt_pk_bf16_f32 v52, v52, v54
    v_cvt_pk_bf16_f32 v53, v55, v53
    v_cndmask_b32 v52, v53, v52, s[36:37]
    v_min_u32 v52, -2, v52
    buffer_store_dword v52, v4, s[8:11], s16 offen sc1
    buffer_store_dword v52, v5, s[8:11], s31 offen sc1
    s_add_u32 s14, s14, 1
    s_cmp_lt_u32 s14, 63
    s_cbranch_scc1 CLOOP_103
    s_branch C_LAST
DSP_93:
    s_cmp_lg_u32 s40, 0
    s_cbranch_scc1 SLOW_110
    s_mov_b32 s94, 116394240
    s_mov_b32 s14, 0
CLOOP_111:
    s_and_b32 s18, s14, 3
    s_lshl_b32 s18, s18, 17
    s_add_u32 s15, s18, 75497472
    s_xor_b32 s17, s15, 262144
    s_add_u32 s18, s14, 1
    s_add_u32 s19, s18, 0
    s_lshr_b32 s31, s19, 1
    s_mul_i32 s31, s31, 14336
    s_and_b32 s19, s19, 1
    s_lshl_b32 s19, s19, 7
    s_add_u32 s31, s31, s19
    s_add_u32 s31, s31, 76546048
    s_and_b32 s18, s18, 3
    s_lshl_b32 s18, s18, 17
    s_add_u32 s16, s18, 75497472
    s_mov_b32 s22, 0
    v_add_u32 v11, s24, v2
    s_sub_u32 s18, s24, 77824
    s_xor_b32 s18, s18, 32768
    s_add_u32 s24, s18, 77824
    s_add_u32 s23, s23, 458752
    s_add_u32 s27, s14, 2
    s_min_u32 s27, s27, 64
    s_cmp_ge_u32 s26, s27
    s_cbranch_scc1 RDO_112
    s_mov_b32 s18, 116394240
RDP_113:
    buffer_load_dword v12, off, s[8:11], s18 sc1
    s_add_u32 s22, s22, 1
    s_cmp_gt_u32 s22, 2000000
    s_cbranch_scc1 MEGA_EXIT
    s_waitcnt vmcnt(0)
    v_readfirstlane_b32 s26, v12
    s_nop 0
    s_cmp_lt_u32 s26, s27
    s_cbranch_scc1 RDP_113
RDO_112:
    s_add_u32 s21, s15, 0
    s_waitcnt vmcnt(0)
    ds_read_b128 v[64:67], v9 offset:0
    ds_read_b128 v[68:71], v9 offset:1024
    ds_read_b128 v[72:75], v9 offset:2048
    ds_read_b128 v[76:79], v9 offset:3072
    ds_read_b128 v[80:83], v9 offset:4096
    ds_read_b128 v[84:87], v9 offset:5120
    ds_read_b128 v[88:91], v9 offset:6144
    ds_read_b128 v[92:95], v9 offset:7168
    ds_read_b128 v[96:99], v9 offset:8192
    ds_read_b128 v[100:103], v9 offset:9216
    ds_read_b128 v[104:107], v9 offset:10240
    ds_read_b128 v[108:111], v9 offset:11264
    ds_read_b128 v[112:115], v9 offset:12288
    ds_read_b128 v[116:119], v9 offset:13312
    v_mov_b64 v[44:45], 0
    v_mov_b64 v[46:47], 0
    v_mov_b64 v[48:49], 0
    v_mov_b64 v[50:51], 0
    v_mov_b64 v[52:53], 0
    v_mov_b64 v[54:55], 0
    v_lshlrev_b32 v13, 7, v1
    s_add_u32 s19, s23, 917504
    s_barrier
    s_sleep 5
CPM_114:
    buffer_load_dwordx4 v[16:19], v2, s[8:11], s21 offen offset:0 sc1
    buffer_load_dwordx4 v[20:23], v2, s[8:11], s21 offen offset:1024 sc1
    buffer_load_dwordx4 v[24:27], v2, s[8:11], s21 offen offset:2048 sc1
    buffer_load_dwordx4 v[28:31], v2, s[8:11], s21 offen offset:3072 sc1
    s_add_u32 s22, s22, 1
    s_cmp_gt_u32 s22, 2000000
    s_cbranch_scc1 MEGA_EXIT
    s_waitcnt vmcnt(3)
    v_max3_u32 v8, v16, v17, v18
    v_max_u32 v8, v8, v19
    s_waitcnt vmcnt(2)
    v_max3_u32 v8, v8, v20, v21
    v_max3_u32 v8, v8, v22, v23
    s_waitcnt vmcnt(1)
    v_max3_u32 v8, v8, v24, v25
    v_max3_u32 v8, v8, v26, v27
    s_waitcnt vmcnt(0)
    v_max3_u32 v8, v8, v28, v29
    v_max3_u32 v8, v8, v30, v31
    v_cmp_eq_u32 vcc, -1, v8
    s_cbranch_vccnz CPM_114
    ds_write_b128 v2, v[16:19] offset:0
    ds_write_b128 v2, v[20:23] offset:1024
    ds_write_b128 v2, v[24:27] offset:2048
    ds_write_b128 v2, v[28:31] offset:3072
    v_mov_b64 v[12:13], 0
    v_mov_b64 v[14:15], 0
    s_waitcnt lgkmcnt(0)
    s_barrier
    ds_read_b128 v[32:35], v2 offset:4096
    ds_read_b128 v[36:39], v2 offset:5120
    ds_read_b128 v[40:43], v2 offset:6144
    s_waitcnt lgkmcnt(6)
    v_smfmac_f32_16x16x64_bf16 v[44:47], v[16:19], v[64:71], v3
    s_add_u32 s18, s23, 0
    s_add_u32 m0, s24, 0
    s_nop 0
    buffer_load_dwordx4 v2, s[8:11], s18 offen offset:0 sc1 lds
    s_waitcnt lgkmcnt(5)
    v_smfmac_f32_16x16x64_bf16 v[44:47], v[20:23], v[72:79], v3
    buffer_store_dword v5, v4, s[8:11], s17 offen
    s_waitcnt lgkmcnt(4)
    v_smfmac_f32_16x16x64_bf16 v[44:47], v[24:27], v[80:87], v3
    s_waitcnt lgkmcnt(3)
    v_smfmac_f32_16x16x64_bf16 v[44:47], v[28:31], v[88:95], v3
    s_waitcnt lgkmcnt(2)
    v_smfmac_f32_16x16x64_bf16 v[44:47], v[32:35], v[96:103], v3
    buffer_load_dwordx4 v2, s[8:11], s18 offen offset:1024 sc1 lds
    s_waitcnt lgkmcnt(1)
    v_smfmac_f32_16x16x64_bf16 v[44:47], v[36:39], v[104:111], v3
    s_waitcnt lgkmcnt(0)
    v_smfmac_f32_16x16x64_bf16 v[44:47], v[40:43], v[112:119], v3
    v_smfmac_f32_16x16x64_bf16 v[48:51], v[16:19], v[120:127], v3
    ds_read_b128 v[80:83], v11 offset:0
    v_smfmac_f32_16x16x64_bf16 v[48:51], v[20:23], v[128:135], v3
    buffer_load_dwordx4 v2, s[8:11], s18 offen offset:2048 sc1 lds
    v_mov_b64 v[112:113], 0
    v_smfmac_f32_16x16x64_bf16 v[48:51], v[24:27], v[136:143], v3
    ds_read_b128 v[84:87], v11 offset:2048
    v_mov_b64 v[114:115], 0
    v_smfmac_f32_16x16x64_bf16 v[48:51], v[28:31], v[144:151], v3
    ds_read_b128 v[88:91], v11 offset:1024
    v_mov_b64 v[116:117], 0
    v_smfmac_f32_16x16x64_bf16 v[48:51], v[32:35], v[152:159], v3
    ds_read_b128 v[92:95], v11 offset:3072
    v_mov_b64 v[118:119], 0
    v_smfmac_f32_16x16x64_bf16 v[48:51], v[36:39], v[160:167], v3
    buffer_load_dwordx4 v2, s[8:11], s18 offen offset:3072 sc1 lds
    v_mov_b64 v[72:73], 0
    v_smfmac_f32_16x16x64_bf16 v[48:51], v[40:43], v[168:175], v3
    ds_read_b128 v[96:99], v11 offset:4096
    v_mov_b64 v[74:75], 0
    v_smfmac_f32_16x16x64_bf16 v[52:55], v[16:19], v[176:183], v3
    ds_read_b128 v[100:103], v11 offset:6144
    v_mov_b64 v[76:77], 0
    v_smfmac_f32_16x16x64_bf16 v[52:55], v[20:23], v[184:191], v3
    ds_read_b128 v[104:107], v11 offset:5120
    v_mov_b64 v[78:79], 0
    v_smfmac_f32_16x16x64_bf16 v[52:55], v[24:27], v[192:199], v3
    s_add_u32 s18, s23, 16384
    s_add_u32 m0, s24, 4096
    s_nop 0
    buffer_load_dwordx4 v2, s[8:11], s18 offen offset:0 sc1 lds
    v_permlane32_swap_b32 v44, v48
    v_smfmac_f32_16x16x64_bf16 v[52:55], v[28:31], v[200:207], v3
    ds_read_b128 v[108:111], v11 offset:7168
    v_permlane32_swap_b32 v45, v49
    v_smfmac_f32_16x16x64_bf16 v[52:55], v[32:35], v[208:215], v3
    v_permlane32_swap_b32 v46, v50
    v_smfmac_f32_16x16x64_bf16 v[52:55], v[36:39], v[216:223], v3
    v_permlane32_swap_b32 v47, v51
    v_smfmac_f32_16x16x64_bf16 v[52:55], v[40:43], v[224:231], v3
    buffer_load_dwordx4 v2, s[8:11], s18 offen offset:1024 sc1 lds
    v_add_f32 v44, v44, v48
    v_smfmac_f32_16x16x64_bf16 v[12:15], v[16:19], v[232:239], v3
    v_add_f32 v45, v45, v49
    v_smfmac_f32_16x16x64_bf16 v[12:15], v[20:23], v[240:247], v3
    s_waitcnt lgkmcnt(0)
    v_add_f32 v46, v46, v50
    v_swap_b32 v81, v84
    v_smfmac_f32_16x16x64_bf16 v[12:15], v[24:27], v[248:255], v3
    v_add_f32 v47, v47, v51
    v_smfmac_f32_16x16x64_bf16 v[12:15], v[28:31], a[0:7], v3
    buffer_load_dwordx4 v2, s[8:11], s18 offen offset:2048 sc1 lds
    v_cvt_pk_bf16_f32 v56, v44, v45
    v_smfmac_f32_16x16x64_bf16 v[12:15], v[32:35], a[8:15], v3
    v_cvt_pk_bf16_f32 v58, v46, v47
    v_smfmac_f32_16x16x64_bf16 v[12:15], v[36:39], a[16:23], v3
    v_mov_b64 v[44:45], 0
    v_mov_b64 v[46:47], 0
    v_smfmac_f32_16x16x64_bf16 v[12:15], v[40:43], a[24:31], v3
    v_mov_b64 v[48:49], 0
    v_swap_b32 v83, v86
    v_smfmac_f32_16x16x64_bf16 v[44:47], v[16:19], a[32:39], v3
    buffer_load_dwordx4 v2, s[8:11], s18 offen offset:3072 sc1 lds
    v_mov_b64 v[50:51], 0
    v_smfmac_f32_16x16x64_bf16 v[44:47], v[20:23], a[40:47], v3
    v_smfmac_f32_16x16x64_bf16 v[44:47], v[24:27], a[48:55], v3
    v_permlane32_swap_b32 v52, v12
    v_smfmac_f32_16x16x64_bf16 v[44:47], v[28:31], a[56:63], v3
    v_permlane32_swap_b32 v53, v13
    v_swap_b32 v89, v92
    v_smfmac_f32_16x16x64_bf16 v[44:47], v[32:35], a[64:71], v3
    v_permlane32_swap_b32 v54, v14
    v_smfmac_f32_16x16x64_bf16 v[44:47], v[36:39], a[72:79], v3
    v_permlane32_swap_b32 v55, v15
    v_smfmac_f32_16x16x64_bf16 v[44:47], v[40:43], a[80:87], v3
    v_add_f32 v52, v52, v12
    v_smfmac_f32_16x16x64_bf16 v[48:51], v[16:19], a[88:95], v3
    v_add_f32 v53, v53, v13
    v_swap_b32 v91, v94
    v_smfmac_f32_16x16x64_bf16 v[48:51], v[20:23], a[96:103], v3
    v_add_f32 v54, v54, v14
    v_smfmac_f32_16x16x64_bf16 v[48:51], v[24:27], a[104:111], v3
    v_add_f32 v55, v55, v15
    v_smfmac_f32_16x16x64_bf16 v[48:51], v[28:31], a[112:119], v3
    v_cvt_pk_bf16_f32 v57, v52, v53
    v_smfmac_f32_16x16x64_bf16 v[48:51], v[32:35], a[120:127], v3
    v_cvt_pk_bf16_f32 v59, v54, v55
    v_swap_b32 v97, v100
    v_smfmac_f32_16x16x64_bf16 v[48:51], v[36:39], a[128:135], v3
    buffer_load_dword v1, off, s[8:11], s94 sc1
    v_mov_b64 v[52:53], 0
    v_mov_b64 v[54:55], 0
    v_smfmac_f32_16x16x64_bf16 v[48:51], v[40:43], a[136:143], v3
    v_mov_b64 v[12:13], 0
    v_smfmac_f32_16x16x64_bf16 v[52:55], v[16:19], a[144:151], v3
    v_mov_b64 v[14:15], 0
    v_smfmac_f32_16x16x64_bf16 v[52:55], v[20:23], a[152:159], v3
    v_swap_b32 v99, v102
    v_smfmac_f32_16x16x64_bf16 v[52:55], v[24:27], a[160:167], v3
    buffer_load_dwordx4 v[64:67], v6, s[8:11], s15 offen offset:0 sc1
    v_permlane32_swap_b32 v44, v48
    v_smfmac_f32_16x16x64_bf16 v[52:55], v[28:31], a[168:175], v3
    buffer_load_dwordx4 v[68:71], v6, s[8:11], s15 offen offset:1024 sc1
    v_permlane32_swap_b32 v45, v49
    v_smfmac_f32_16x16x64_bf16 v[52:55], v[32:35], a[176:183], v3
    v_permlane32_swap_b32 v46, v50
    v_smfmac_f32_16x16x64_bf16 v[52:55], v[36:39], a[184:191], v3
    v_permlane32_swap_b32 v47, v51
    v_swap_b32 v105, v108
    v_smfmac_f32_16x16x64_bf16 v[52:55], v[40:43], a[192:199], v3
    v_add_f32 v44, v44, v48
    v_smfmac_f32_16x16x64_bf16 v[12:15], v[16:19], a[200:207], v3
    v_add_f32 v45, v45, v49
    v_smfmac_f32_16x16x64_bf16 v[12:15], v[20:23], a[208:215], v3
    buffer_load_dwordx4 v[64:67], v6, s[8:11], s15 offen offset:0 sc1
    v_add_f32 v46, v46, v50
    v_smfmac_f32_16x16x64_bf16 v[12:15], v[24:27], a[216:223], v3
    buffer_load_dwordx4 v[68:71], v6, s[8:11], s15 offen offset:1024 sc1
    v_add_f32 v47, v47, v51
    v_swap_b32 v107, v110
    v_smfmac_f32_16x16x64_bf16 v[12:15], v[28:31], a[224:231], v3
    v_cvt_pk_bf16_f32 v60, v44, v45
    v_smfmac_f32_16x16x64_bf16 v[12:15], v[32:35], a[232:239], v3
    v_cvt_pk_bf16_f32 v62, v46, v47
    v_smfmac_f32_16x16x64_bf16 v[12:15], v[36:39], a[240:247], v3
    buffer_load_dwordx4 v[64:67], v6, s[8:11], s15 offen offset:0 sc1
    v_smfmac_f32_16x16x64_bf16 v[12:15], v[40:43], a[248:255], v3
    buffer_load_dwordx4 v[68:71], v6, s[8:11], s15 offen offset:1024 sc1
    s_lshl_b32 s18, s13, 10
    s_add_u32 s18, s18, 10240
    v_add_u32 v16, s18, v2
    s_nop 3
    v_permlane32_swap_b32 v52, v12
    v_permlane32_swap_b32 v53, v13
    v_permlane32_swap_b32 v54, v14
    v_permlane32_swap_b32 v55, v15
    v_add_f32 v52, v52, v12
    v_add_f32 v53, v53, v13
    v_add_f32 v54, v54, v14
    v_add_f32 v55, v55, v15
    v_cvt_pk_bf16_f32 v61, v52, v53
    v_cvt_pk_bf16_f32 v63, v54, v55
    ds_write_b128 v10, v[56:59]
    ds_write_b128 v10, v[60:63] offset:1024
    s_branch CPE1_116
CPE_115:
    buffer_load_dwordx4 v[64:67], v6, s[8:11], s15 offen offset:0 sc1
    buffer_load_dwordx4 v[68:71], v6, s[8:11], s15 offen offset:1024 sc1
    s_add_u32 s22, s22, 1
    s_cmp_gt_u32 s22, 2000000
    s_cbranch_scc1 MEGA_EXIT
CPE1_116:
    s_waitcnt vmcnt(4)
    v_max3_u32 v8, v64, v65, v66
    v_max3_u32 v8, v8, v67, v68
    v_max3_u32 v8, v8, v69, v70
    v_max_u32 v8, v8, v71
    v_cmp_eq_u32 vcc, -1, v8
    s_cbranch_vccnz CPE_115
    v_smfmac_f32_16x16x64_bf16 v[112:115], v[64:67], v[80:87], v3
    v_smfmac_f32_16x16x64_bf16 v[116:119], v[68:71], v[88:95], v3
    v_smfmac_f32_16x16x64_bf16 v[72:75], v[64:67], v[96:103], v3
    v_smfmac_f32_16x16x64_bf16 v[76:79], v[68:71], v[104:111], v3
    v_readfirstlane_b32 s26, v1
    v_cvt_pk_bf16_f32 v44, v112, v113
    v_cvt_pk_bf16_f32 v46, v114, v115
    v_cvt_pk_bf16_f32 v45, v116, v117
    v_cvt_pk_bf16_f32 v47, v118, v119
    ds_write_b128 v16, v[44:47]
    v_cvt_pk_bf16_f32 v48, v72, v73
    v_cvt_pk_bf16_f32 v50, v74, v75
    v_cvt_pk_bf16_f32 v49, v76, v77
    v_cvt_pk_bf16_f32 v51, v78, v79
    ds_write_b128 v16, v[48:51] offset:6144
    s_waitcnt lgkmcnt(0)
    s_barrier
    s_add_u32 s14, s14, 1
    s_cmp_lt_u32 s14, 63
    s_cbranch_scc1 CLOOP_111
    s_branch C_LAST
SLOW_110:
    s_mov_b32 s94, 116394240
    s_mov_b32 s14, 0
CLOOP_117:
    s_and_b32 s18, s14, 3
    s_lshl_b32 s18, s18, 17
    s_add_u32 s15, s18, 75497472
    s_xor_b32 s17, s15, 262144
    s_add_u32 s18, s14, 1
    s_add_u32 s19, s18, 0
    s_lshr_b32 s31, s19, 1
    s_mul_i32 s31, s31, 14336
    s_and_b32 s19, s19, 1
    s_lshl_b32 s19, s19, 7
    s_add_u32 s31, s31, s19
    s_add_u32 s31, s31, 76546048
    s_and_b32 s18, s18, 3
    s_lshl_b32 s18, s18, 17
    s_add_u32 s16, s18, 75497472
    s_mov_b32 s22, 0
    v_add_u32 v11, s24, v2
    s_sub_u32 s18, s24, 77824
    s_xor_b32 s18, s18, 32768
    s_add_u32 s24, s18, 77824
    s_add_u32 s23, s23, 458752
    s_add_u32 s27, s14, 2
    s_min_u32 s27, s27, 64
    s_cmp_ge_u32 s26, s27
    s_cbranch_scc1 RDO_118
    s_mov_b32 s18, 116394240
RDP_119:
    buffer_load_dword v12, off, s[8:11], s18 sc1
    s_add_u32 s22, s22, 1
    s_cmp_gt_u32 s22, 2000000
    s_cbranch_scc1 MEGA_EXIT
    s_waitcnt vmcnt(0)
    v_readfirstlane_b32 s26, v12
    s_nop 0
    s_cmp_lt_u32 s26, s27
    s_cbranch_scc1 RDP_119
RDO_118:
    s_add_u32 s21, s15, 0
    s_waitcnt vmcnt(0)
    ds_read_b128 v[64:67], v9 offset:0
    ds_read_b128 v[68:71], v9 offset:1024
    ds_read_b128 v[72:75], v9 offset:2048
    ds_read_b128 v[76:79], v9 offset:3072
    ds_read_b128 v[80:83], v9 offset:4096
    ds_read_b128 v[84:87], v9 offset:5120
    ds_read_b128 v[88:91], v9 offset:6144
    ds_read_b128 v[92:95], v9 offset:7168
    ds_read_b128 v[96:99], v9 offset:8192
    ds_read_b128 v[100:103], v9 offset:9216
    ds_read_b128 v[104:107], v9 offset:10240
    ds_read_b128 v[108:111], v9 offset:11264
    ds_read_b128 v[112:115], v9 offset:12288
    ds_read_b128 v[116:119], v9 offset:13312
    v_mov_b64 v[44:45], 0
    v_mov_b64 v[46:47], 0
    v_mov_b64 v[48:49], 0
    v_mov_b64 v[50:51], 0
    v_mov_b64 v[52:53], 0
    v_mov_b64 v[54:55], 0
    v_lshlrev_b32 v13, 7, v1
    s_add_u32 s19, s23, 917504
    s_barrier
    s_sleep 5
CPM_120:
    buffer_load_dwordx4 v[16:19], v2, s[8:11], s21 offen offset:0 sc1
    buffer_load_dwordx4 v[20:23], v2, s[8:11], s21 offen offset:1024 sc1
    buffer_load_dwordx4 v[24:27], v2, s[8:11], s21 offen offset:2048 sc1
    buffer_load_dwordx4 v[28:31], v2, s[8:11], s21 offen offset:3072 sc1
    s_add_u32 s22, s22, 1
    s_cmp_gt_u32 s22, 2000000
    s_cbranch_scc1 MEGA_EXIT
    s_waitcnt vmcnt(3)
    v_max3_u32 v8, v16, v17, v18
    v_max_u32 v8, v8, v19
    s_waitcnt vmcnt(2)
    v_max3_u32 v8, v8, v20, v21
    v_max3_u32 v8, v8, v22, v23
    s_waitcnt vmcnt(1)
    v_max3_u32 v8, v8, v24, v25
    v_max3_u32 v8, v8, v26, v27
    s_waitcnt vmcnt(0)
    v_max3_u32 v8, v8, v28, v29
    v_max3_u32 v8, v8, v30, v31
    v_cmp_eq_u32 vcc, -1, v8
    s_cbranch_vccnz CPM_120
    ds_write_b128 v2, v[16:19] offset:0
    ds_write_b128 v2, v[20:23] offset:1024
    ds_write_b128 v2, v[24:27] offset:2048
    ds_write_b128 v2, v[28:31] offset:3072
    v_mov_b64 v[12:13], 0
    v_mov_b64 v[14:15], 0
    s_waitcnt lgkmcnt(0)
    s_barrier
    ds_read_b128 v[32:35], v2 offset:4096
    ds_read_b128 v[36:39], v2 offset:5120
    ds_read_b128 v[40:43], v2 offset:6144
    s_waitcnt lgkmcnt(6)
    v_smfmac_f32_16x16x64_bf16 v[44:47], v[16:19], v[64:71], v3
    s_add_u32 s18, s23, 0
    s_add_u32 m0, s24, 0
    s_nop 0
    buffer_load_dwordx4 v2, s[8:11], s18 offen offset:0 sc1 lds
    s_waitcnt lgkmcnt(5)
    v_smfmac_f32_16x16x64_bf16 v[44:47], v[20:23], v[72:79], v3
    buffer_store_dword v5, v4, s[8:11], s17 offen sc1
    s_waitcnt lgkmcnt(4)
    v_smfmac_f32_16x16x64_bf16 v[44:47], v[24:27], v[80:87], v3
    s_waitcnt lgkmcnt(3)
    v_smfmac_f32_16x16x64_bf16 v[44:47], v[28:31], v[88:95], v3
    s_waitcnt lgkmcnt(2)
    v_smfmac_f32_16x16x64_bf16 v[44:47], v[32:35], v[96:103], v3
    buffer_load_dwordx4 v2, s[8:11], s18 offen offset:1024 sc1 lds
    s_waitcnt lgkmcnt(1)
    v_smfmac_f32_16x16x64_bf16 v[44:47], v[36:39], v[104:111], v3
    s_waitcnt lgkmcnt(0)
    v_smfmac_f32_16x16x64_bf16 v[44:47], v[40:43], v[112:119], v3
    v_smfmac_f32_16x16x64_bf16 v[48:51], v[16:19], v[120:127], v3
    ds_read_b128 v[80:83], v11 offset:0
    v_smfmac_f32_16x16x64_bf16 v[48:51], v[20:23], v[128:135], v3
    buffer_load_dwordx4 v2, s[8:11], s18 offen offset:2048 sc1 lds
    v_mov_b64 v[112:113], 0
    v_smfmac_f32_16x16x64_bf16 v[48:51], v[24:27], v[136:143], v3
    ds_read_b128 v[84:87], v11 offset:2048
    v_mov_b64 v[114:115], 0
    v_smfmac_f32_16x16x64_bf16 v[48:51], v[28:31], v[144:151], v3
    ds_read_b128 v[88:91], v11 offset:1024
    v_mov_b64 v[116:117], 0
    v_smfmac_f32_16x16x64_bf16 v[48:51], v[32:35], v[152:159], v3
    ds_read_b128 v[92:95], v11 offset:3072
    v_mov_b64 v[118:119], 0
    v_smfmac_f32_16x16x64_bf16 v[48:51], v[36:39], v[160:167], v3
    buffer_load_dwordx4 v2, s[8:11], s18 offen offset:3072 sc1 lds
    v_mov_b64 v[72:73], 0
    v_smfmac_f32_16x16x64_bf16 v[48:51], v[40:43], v[168:175], v3
    ds_read_b128 v[96:99], v11 offset:4096
    v_mov_b64 v[74:75], 0
    v_smfmac_f32_16x16x64_bf16 v[52:55], v[16:19], v[176:183], v3
    ds_read_b128 v[100:103], v11 offset:6144
    v_mov_b64 v[76:77], 0
    v_smfmac_f32_16x16x64_bf16 v[52:55], v[20:23], v[184:191], v3
    ds_read_b128 v[104:107], v11 offset:5120
    v_mov_b64 v[78:79], 0
    v_smfmac_f32_16x16x64_bf16 v[52:55], v[24:27], v[192:199], v3
    s_add_u32 s18, s23, 16384
    s_add_u32 m0, s24, 4096
    s_nop 0
    buffer_load_dwordx4 v2, s[8:11], s18 offen offset:0 sc1 lds
    v_permlane32_swap_b32 v44, v48
    v_smfmac_f32_16x16x64_bf16 v[52:55], v[28:31], v[200:207], v3
    ds_read_b128 v[108:111], v11 offset:7168
    v_permlane32_swap_b32 v45, v49
    v_smfmac_f32_16x16x64_bf16 v[52:55], v[32:35], v[208:215], v3
    v_permlane32_swap_b32 v46, v50
    v_smfmac_f32_16x16x64_bf16 v[52:55], v[36:39], v[216:223], v3
    v_permlane32_swap_b32 v47, v51
    v_smfmac_f32_16x16x64_bf16 v[52:55], v[40:43], v[224:231], v3
    buffer_load_dwordx4 v2, s[8:11], s18 offen offset:1024 sc1 lds
    v_add_f32 v44, v44, v48
    v_smfmac_f32_16x16x64_bf16 v[12:15], v[16:19], v[232:239], v3
    v_add_f32 v45, v45, v49
    v_smfmac_f32_16x16x64_bf16 v[12:15], v[20:23], v[240:247], v3
    s_waitcnt lgkmcnt(0)
    v_add_f32 v46, v46, v50
    v_swap_b32 v81, v84
    v_smfmac_f32_16x16x64_bf16 v[12:15], v[24:27], v[248:255], v3
    v_add_f32 v47, v47, v51
    v_smfmac_f32_16x16x64_bf16 v[12:15], v[28:31], a[0:7], v3
    buffer_load_dwordx4 v2, s[8:11], s18 offen offset:2048 sc1 lds
    v_cvt_pk_bf16_f32 v56, v44, v45
    v_smfmac_f32_16x16x64_bf16 v[12:15], v[32:35], a[8:15], v3
    v_cvt_pk_bf16_f32 v58, v46, v47
    v_smfmac_f32_16x16x64_bf16 v[12:15], v[36:39], a[16:23], v3
    v_mov_b64 v[44:45], 0
    v_mov_b64 v[46:47], 0
    v_smfmac_f32_16x16x64_bf16 v[12:15], v[40:43], a[24:31], v3
    v_mov_b64 v[48:49], 0
    v_swap_b32 v83, v86
    v_smfmac_f32_16x16x64_bf16 v[44:47], v[16:19], a[32:39], v3
    buffer_load_dwordx4 v2, s[8:11], s18 offen offset:3072 sc1 lds
    v_mov_b64 v[50:51], 0
    v_smfmac_f32_16x16x64_bf16 v[44:47], v[20:23], a[40:47], v3
    v_smfmac_f32_16x16x64_bf16 v[44:47], v[24:27], a[48:55], v3
    v_permlane32_swap_b32 v52, v12
    v_smfmac_f32_16x16x64_bf16 v[44:47], v[28:31], a[56:63], v3
    v_permlane32_swap_b32 v53, v13
    v_swap_b32 v89, v92
    v_smfmac_f32_16x16x64_bf16 v[44:47], v[32:35], a[64:71], v3
    v_permlane32_swap_b32 v54, v14
    v_smfmac_f32_16x16x64_bf16 v[44:47], v[36:39], a[72:79], v3
    v_permlane32_swap_b32 v55, v15
    v_smfmac_f32_16x16x64_bf16 v[44:47], v[40:43], a[80:87], v3
    v_add_f32 v52, v52, v12
    v_smfmac_f32_16x16x64_bf16 v[48:51], v[16:19], a[88:95], v3
    v_add_f32 v53, v53, v13
    v_swap_b32 v91, v94
    v_smfmac_f32_16x16x64_bf16 v[48:51], v[20:23], a[96:103], v3
    v_add_f32 v54, v54, v14
    v_smfmac_f32_16x16x64_bf16 v[48:51], v[24:27], a[104:111], v3
    v_add_f32 v55, v55, v15
    v_smfmac_f32_16x16x64_bf16 v[48:51], v[28:31], a[112:119], v3
    v_cvt_pk_bf16_f32 v57, v52, v53
    v_smfmac_f32_16x16x64_bf16 v[48:51], v[32:35], a[120:127], v3
    v_cvt_pk_bf16_f32 v59, v54, v55
    v_swap_b32 v97, v100
    v_smfmac_f32_16x16x64_bf16 v[48:51], v[36:39], a[128:135], v3
    buffer_load_dword v1, off, s[8:11], s94 sc1
    v_mov_b64 v[52:53], 0
    v_mov_b64 v[54:55], 0
    v_smfmac_f32_16x16x64_bf16 v[48:51], v[40:43], a[136:143], v3
    v_mov_b64 v[12:13], 0
    v_smfmac_f32_16x16x64_bf16 v[52:55], v[16:19], a[144:151], v3
    v_mov_b64 v[14:15], 0
    v_smfmac_f32_16x16x64_bf16 v[52:55], v[20:23], a[152:159], v3
    v_swap_b32 v99, v102
    v_smfmac_f32_16x16x64_bf16 v[52:55], v[24:27], a[160:167], v3
    buffer_load_dwordx4 v[64:67], v6, s[8:11], s15 offen offset:0 sc1
    v_permlane32_swap_b32 v44, v48
    v_smfmac_f32_16x16x64_bf16 v[52:55], v[28:31], a[168:175], v3
    buffer_load_dwordx4 v[68:71], v6, s[8:11], s15 offen offset:1024 sc1
    v_permlane32_swap_b32 v45, v49
    v_smfmac_f32_16x16x64_bf16 v[52:55], v[32:35], a[176:183], v3
    v_permlane32_swap_b32 v46, v50
    v_smfmac_f32_16x16x64_bf16 v[52:55], v[36:39], a[184:191], v3
    v_permlane32_swap_b32 v47, v51
    v_swap_b32 v105, v108
    v_smfmac_f32_16x16x64_bf16 v[52:55], v[40:43], a[192:199], v3
    v_add_f32 v44, v44, v48
    v_smfmac_f32_16x16x64_bf16 v[12:15], v[16:19], a[200:207], v3
    v_add_f32 v45, v45, v49
    v_smfmac_f32_16x16x64_bf16 v[12:15], v[20:23], a[208:215], v3
    buffer_load_dwordx4 v[64:67], v6, s[8:11], s15 offen offset:0 sc1
    v_add_f32 v46, v46, v50
    v_smfmac_f32_16x16x64_bf16 v[12:15], v[24:27], a[216:223], v3
    buffer_load_dwordx4 v[68:71], v6, s[8:11], s15 offen offset:1024 sc1
    v_add_f32 v47, v47, v51
    v_swap_b32 v107, v110
    v_smfmac_f32_16x16x64_bf16 v[12:15], v[28:31], a[224:231], v3
    v_cvt_pk_bf16_f32 v60, v44, v45
    v_smfmac_f32_16x16x64_bf16 v[12:15], v[32:35], a[232:239], v3
    v_cvt_pk_bf16_f32 v62, v46, v47
    v_smfmac_f32_16x16x64_bf16 v[12:15], v[36:39], a[240:247], v3
    buffer_load_dwordx4 v[64:67], v6, s[8:11], s15 offen offset:0 sc1
    v_smfmac_f32_16x16x64_bf16 v[12:15], v[40:43], a[248:255], v3
    buffer_load_dwordx4 v[68:71], v6, s[8:11], s15 offen offset:1024 sc1
    s_lshl_b32 s18, s13, 10
    s_add_u32 s18, s18, 10240
    v_add_u32 v16, s18, v2
    s_nop 3
    v_permlane32_swap_b32 v52, v12
    v_permlane32_swap_b32 v53, v13
    v_permlane32_swap_b32 v54, v14
    v_permlane32_swap_b32 v55, v15
    v_add_f32 v52, v52, v12
    v_add_f32 v53, v53, v13
    v_add_f32 v54, v54, v14
    v_add_f32 v55, v55, v15
    v_cvt_pk_bf16_f32 v61, v52, v53
    v_cvt_pk_bf16_f32 v63, v54, v55
    ds_write_b128 v10, v[56:59]
    ds_write_b128 v10, v[60:63] offset:1024
    s_branch CPE1_122
CPE_121:
    buffer_load_dwordx4 v[64:67], v6, s[8:11], s15 offen offset:0 sc1
    buffer_load_dwordx4 v[68:71], v6, s[8:11], s15 offen offset:1024 sc1
    s_add_u32 s22, s22, 1
    s_cmp_gt_u32 s22, 2000000
    s_cbranch_scc1 MEGA_EXIT
CPE1_122:
    s_waitcnt vmcnt(4)
    v_max3_u32 v8, v64, v65, v66
    v_max3_u32 v8, v8, v67, v68
    v_max3_u32 v8, v8, v69, v70
    v_max_u32 v8, v8, v71
    v_cmp_eq_u32 vcc, -1, v8
    s_cbranch_vccnz CPE_121
    v_smfmac_f32_16x16x64_bf16 v[112:115], v[64:67], v[80:87], v3
    v_smfmac_f32_16x16x64_bf16 v[116:119], v[68:71], v[88:95], v3
    v_smfmac_f32_16x16x64_bf16 v[72:75], v[64:67], v[96:103], v3
    v_smfmac_f32_16x16x64_bf16 v[76:79], v[68:71], v[104:111], v3
    v_readfirstlane_b32 s26, v1
    v_cvt_pk_bf16_f32 v44, v112, v113
    v_cvt_pk_bf16_f32 v46, v114, v115
    v_cvt_pk_bf16_f32 v45, v116, v117
    v_cvt_pk_bf16_f32 v47, v118, v119
    ds_write_b128 v16, v[44:47]
    v_cvt_pk_bf16_f32 v48, v72, v73
    v_cvt_pk_bf16_f32 v50, v74, v75
    v_cvt_pk_bf16_f32 v49, v76, v77
    v_cvt_pk_bf16_f32 v51, v78, v79
    ds_write_b128 v16, v[48:51] offset:6144
    s_waitcnt lgkmcnt(0)
    s_barrier
    s_add_u32 s14, s14, 1
    s_cmp_lt_u32 s14, 63
    s_cbranch_scc1 CLOOP_117
    s_branch C_LAST
DSP_94:
    s_cmp_lg_u32 s40, 0
    s_cbranch_scc1 SLOW_123
    s_mov_b32 s94, 116394240
    s_mov_b32 s14, 0
CLOOP_124:
    s_and_b32 s18, s14, 3
    s_lshl_b32 s18, s18, 17
    s_add_u32 s15, s18, 75497472
    s_xor_b32 s17, s15, 262144
    s_add_u32 s18, s14, 1
    s_add_u32 s19, s18, 0
    s_lshr_b32 s31, s19, 1
    s_mul_i32 s31, s31, 14336
    s_and_b32 s19, s19, 1
    s_lshl_b32 s19, s19, 7
    s_add_u32 s31, s31, s19
    s_add_u32 s31, s31, 76546048
    s_and_b32 s18, s18, 3
    s_lshl_b32 s18, s18, 17
    s_add_u32 s16, s18, 75497472
    s_mov_b32 s22, 0
    v_add_u32 v11, s24, v2
    s_sub_u32 s18, s24, 77824
    s_xor_b32 s18, s18, 32768
    s_add_u32 s24, s18, 77824
    s_add_u32 s23, s23, 458752
    s_add_u32 s27, s14, 2
    s_min_u32 s27, s27, 64
    s_cmp_ge_u32 s26, s27
    s_cbranch_scc1 RDO_125
    s_mov_b32 s18, 116394240
RDP_126:
    buffer_load_dword v12, off, s[8:11], s18 sc1
    s_add_u32 s22, s22, 1
    s_cmp_gt_u32 s22, 2000000
    s_cbranch_scc1 MEGA_EXIT
    s_waitcnt vmcnt(0)
    v_readfirstlane_b32 s26, v12
    s_nop 0
    s_cmp_lt_u32 s26, s27
    s_cbranch_scc1 RDP_126
RDO_125:
    s_add_u32 s21, s15, 4096
    s_waitcnt vmcnt(0)
    ds_read_b128 v[64:67], v9 offset:0
    ds_read_b128 v[68:71], v9 offset:1024
    ds_read_b128 v[72:75], v9 offset:2048
    ds_read_b128 v[76:79], v9 offset:3072
    ds_read_b128 v[80:83], v9 offset:4096
    ds_read_b128 v[84:87], v9 offset:5120
    ds_read_b128 v[88:91], v9 offset:6144
    ds_read_b128 v[92:95], v9 offset:7168
    ds_read_b128 v[96:99], v9 offset:8192
    ds_read_b128 v[100:103], v9 offset:9216
    ds_read_b128 v[104:107], v9 offset:10240
    ds_read_b128 v[108:111], v9 offset:11264
    ds_read_b128 v[112:115], v9 offset:12288
    ds_read_b128 v[116:119], v9 offset:13312
    v_mov_b64 v[44:45], 0
    v_mov_b64 v[46:47], 0
    v_mov_b64 v[48:49], 0
    v_mov_b64 v[50:51], 0
    v_mov_b64 v[52:53], 0
    v_mov_b64 v[54:55], 0
    v_lshlrev_b32 v13, 7, v1
    s_add_u32 s19, s23, 917504
    s_barrier
    s_sleep 5
CPM_127:
    buffer_load_dwordx4 v[32:35], v2, s[8:11], s21 offen offset:0 sc1
    buffer_load_dwordx4 v[36:39], v2, s[8:11], s21 offen offset:1024 sc1
    buffer_load_dwordx4 v[40:43], v2, s[8:11], s21 offen offset:2048 sc1
    s_add_u32 s22, s22, 1
    s_cmp_gt_u32 s22, 2000000
    s_cbranch_scc1 MEGA_EXIT
    s_waitcnt vmcnt(2)
    v_max3_u32 v8, v32, v33, v34
    v_max_u32 v8, v8, v35
    s_waitcnt vmcnt(1)
    v_max3_u32 v8, v8, v36, v37
    v_max3_u32 v8, v8, v38, v39
    s_waitcnt vmcnt(0)
    v_max3_u32 v8, v8, v40, v41
    v_max3_u32 v8, v8, v42, v43
    v_cmp_eq_u32 vcc, -1, v8
    s_cbranch_vccnz CPM_127
    ds_write_b128 v2, v[32:35] offset:4096
    ds_write_b128 v2, v[36:39] offset:5120
    ds_write_b128 v2, v[40:43] offset:6144
    v_mov_b64 v[12:13], 0
    v_mov_b64 v[14:15], 0
    s_waitcnt lgkmcnt(0)
    s_barrier
    ds_read_b128 v[16:19], v2 offset:0
    ds_read_b128 v[20:23], v2 offset:1024
    ds_read_b128 v[24:27], v2 offset:2048
    ds_read_b128 v[28:31], v2 offset:3072
    s_waitcnt lgkmcnt(6)
    v_smfmac_f32_16x16x64_bf16 v[44:47], v[32:35], v[96:103], v3
    s_add_u32 s18, s23, 0
    s_add_u32 m0, s24, 0
    s_nop 0
    buffer_load_dwordx4 v2, s[8:11], s18 offen offset:0 sc1 lds
    s_waitcnt lgkmcnt(5)
    v_smfmac_f32_16x16x64_bf16 v[44:47], v[36:39], v[104:111], v3
    buffer_store_dword v5, v4, s[8:11], s17 offen
    s_waitcnt lgkmcnt(4)
    v_smfmac_f32_16x16x64_bf16 v[44:47], v[40:43], v[112:119], v3
    s_waitcnt lgkmcnt(3)
    v_smfmac_f32_16x16x64_bf16 v[44:47], v[16:19], v[64:71], v3
    s_waitcnt lgkmcnt(2)
    v_smfmac_f32_16x16x64_bf16 v[44:47], v[20:23], v[72:79], v3
    buffer_load_dwordx4 v2, s[8:11], s18 offen offset:1024 sc1 lds
    s_waitcnt lgkmcnt(1)
    v_smfmac_f32_16x16x64_bf16 v[44:47], v[24:27], v[80:87], v3
    s_waitcnt lgkmcnt(0)
    v_smfmac_f32_16x16x64_bf16 v[44:47], v[28:31], v[88:95], v3
    v_smfmac_f32_16x16x64_bf16 v[48:51], v[32:35], v[152:159], v3
    ds_read_b128 v[80:83], v11 offset:0
    v_smfmac_f32_16x16x64_bf16 v[48:51], v[36:39], v[160:167], v3
    buffer_load_dwordx4 v2, s[8:11], s18 offen offset:2048 sc1 lds
    v_mov_b64 v[112:113], 0
    v_smfmac_f32_16x16x64_bf16 v[48:51], v[40:43], v[168:175], v3
    ds_read_b128 v[84:87], v11 offset:2048
    v_mov_b64 v[114:115], 0
    v_smfmac_f32_16x16x64_bf16 v[48:51], v[16:19], v[120:127], v3
    ds_read_b128 v[88:91], v11 offset:1024
    v_mov_b64 v[116:117], 0
    v_smfmac_f32_16x16x64_bf16 v[48:51], v[20:23], v[128:135], v3
    ds_read_b128 v[92:95], v11 offset:3072
    v_mov_b64 v[118:119], 0
    v_smfmac_f32_16x16x64_bf16 v[48:51], v[24:27], v[136:143], v3
    buffer_load_dwordx4 v2, s[8:11], s18 offen offset:3072 sc1 lds
    v_mov_b64 v[72:73], 0
    v_smfmac_f32_16x16x64_bf16 v[48:51], v[28:31], v[144:151], v3
    ds_read_b128 v[96:99], v11 offset:4096
    v_mov_b64 v[74:75], 0
    v_smfmac_f32_16x16x64_bf16 v[52:55], v[32:35], v[208:215], v3
    ds_read_b128 v[100:103], v11 offset:6144
    v_mov_b64 v[76:77], 0
    v_smfmac_f32_16x16x64_bf16 v[52:55], v[36:39], v[216:223], v3
    ds_read_b128 v[104:107], v11 offset:5120
    v_mov_b64 v[78:79], 0
    v_smfmac_f32_16x16x64_bf16 v[52:55], v[40:43], v[224:231], v3
    s_add_u32 s18, s23, 16384
    s_add_u32 m0, s24, 4096
    s_nop 0
    buffer_load_dwordx4 v2, s[8:11], s18 offen offset:0 sc1 lds
    v_permlane32_swap_b32 v44, v48
    v_smfmac_f32_16x16x64_bf16 v[52:55], v[16:19], v[176:183], v3
    ds_read_b128 v[108:111], v11 offset:7168
    v_permlane32_swap_b32 v45, v49
    v_smfmac_f32_16x16x64_bf16 v[52:55], v[20:23], v[184:191], v3
    v_permlane32_swap_b32 v46, v50
    v_smfmac_f32_16x16x64_bf16 v[52:55], v[24:27], v[192:199], v3
    v_permlane32_swap_b32 v47, v51
    v_smfmac_f32_16x16x64_bf16 v[52:55], v[28:31], v[200:207], v3
    buffer_load_dwordx4 v2, s[8:11], s18 offen offset:1024 sc1 lds
    v_add_f32 v44, v44, v48
    v_smfmac_f32_16x16x64_bf16 v[12:15], v[32:35], a[8:15], v3
    v_add_f32 v45, v45, v49
    v_smfmac_f32_16x16x64_bf16 v[12:15], v[36:39], a[16:23], v3
    s_waitcnt lgkmcnt(0)
    v_add_f32 v46, v46, v50
    v_swap_b32 v81, v84
    v_smfmac_f32_16x16x64_bf16 v[12:15], v[40:43], a[24:31], v3
    v_add_f32 v47, v47, v51
    v_smfmac_f32_16x16x64_bf16 v[12:15], v[16:19], v[232:239], v3
    buffer_load_dwordx4 v2, s[8:11], s18 offen offset:2048 sc1 lds
    v_cvt_pk_bf16_f32 v56, v44, v45
    v_smfmac_f32_16x16x64_bf16 v[12:15], v[20:23], v[240:247], v3
    v_cvt_pk_bf16_f32 v58, v46, v47
    v_smfmac_f32_16x16x64_bf16 v[12:15], v[24:27], v[248:255], v3
    v_mov_b64 v[44:45], 0
    v_mov_b64 v[46:47], 0
    v_smfmac_f32_16x16x64_bf16 v[12:15], v[28:31], a[0:7], v3
    v_mov_b64 v[48:49], 0
    v_swap_b32 v83, v86
    v_smfmac_f32_16x16x64_bf16 v[44:47], v[32:35], a[64:71], v3
    buffer_load_dwordx4 v2, s[8:11], s18 offen offset:3072 sc1 lds
    v_mov_b64 v[50:51], 0
    v_smfmac_f32_16x16x64_bf16 v[44:47], v[36:39], a[72:79], v3
    v_smfmac_f32_16x16x64_bf16 v[44:47], v[40:43], a[80:87], v3
    v_permlane32_swap_b32 v52, v12
    v_smfmac_f32_16x16x64_bf16 v[44:47], v[16:19], a[32:39], v3
    v_permlane32_swap_b32 v53, v13
    v_swap_b32 v89, v92
    v_smfmac_f32_16x16x64_bf16 v[44:47], v[20:23], a[40:47], v3
    v_permlane32_swap_b32 v54, v14
    v_smfmac_f32_16x16x64_bf16 v[44:47], v[24:27], a[48:55], v3
    v_permlane32_swap_b32 v55, v15
    v_smfmac_f32_16x16x64_bf16 v[44:47], v[28:31], a[56:63], v3
    v_add_f32 v52, v52, v12
    v_smfmac_f32_16x16x64_bf16 v[48:51], v[32:35], a[120:127], v3
    v_add_f32 v53, v53, v13
    v_swap_b32 v91, v94
    v_smfmac_f32_16x16x64_bf16 v[48:51], v[36:39], a[128:135], v3
    v_add_f32 v54, v54, v14
    v_smfmac_f32_16x16x64_bf16 v[48:51], v[40:43], a[136:143], v3
    v_add_f32 v55, v55, v15
    v_smfmac_f32_16x16x64_bf16 v[48:51], v[16:19], a[88:95], v3
    v_cvt_pk_bf16_f32 v57, v52, v53
    v_smfmac_f32_16x16x64_bf16 v[48:51], v[20:23], a[96:103], v3
    v_cvt_pk_bf16_f32 v59, v54, v55
    v_swap_b32 v97, v100
    v_smfmac_f32_16x16x64_bf16 v[48:51], v[24:27], a[104:111], v3
    buffer_load_dword v1, off, s[8:11], s94 sc1
    v_mov_b64 v[52:53], 0
    v_mov_b64 v[54:55], 0
    v_smfmac_f32_16x16x64_bf16 v[48:51], v[28:31], a[112:119], v3
    v_mov_b64 v[12:13], 0
    v_smfmac_f32_16x16x64_bf16 v[52:55], v[32:35], a[176:183], v3
    v_mov_b64 v[14:15], 0
    v_smfmac_f32_16x16x64_bf16 v[52:55], v[36:39], a[184:191], v3
    v_swap_b32 v99, v102
    v_smfmac_f32_16x16x64_bf16 v[52:55], v[40:43], a[192:199], v3
    buffer_load_dwordx4 v[64:67], v6, s[8:11], s15 offen offset:0 sc1
    v_permlane32_swap_b32 v44, v48
    v_smfmac_f32_16x16x64_bf16 v[52:55], v[16:19], a[144:151], v3
    buffer_load_dwordx4 v[68:71], v6, s[8:11], s15 offen offset:1024 sc1
    v_permlane32_swap_b32 v45, v49
    v_smfmac_f32_16x16x64_bf16 v[52:55], v[20:23], a[152:159], v3
    v_permlane32_swap_b32 v46, v50
    v_smfmac_f32_16x16x64_bf16 v[52:55], v[24:27], a[160:167], v3
    v_permlane32_swap_b32 v47, v51
    v_swap_b32 v105, v108
    v_smfmac_f32_16x16x64_bf16 v[52:55], v[28:31], a[168:175], v3
    v_add_f32 v44, v44, v48
    v_smfmac_f32_16x16x64_bf16 v[12:15], v[32:35], a[232:239], v3
    v_add_f32 v45, v45, v49
    v_smfmac_f32_16x16x64_bf16 v[12:15], v[36:39], a[240:247], v3
    buffer_load_dwordx4 v[64:67], v6, s[8:11], s15 offen offset:0 sc1
    v_add_f32 v46, v46, v50
    v_smfmac_f32_16x16x64_bf16 v[12:15], v[40:43], a[248:255], v3
    buffer_load_dwordx4 v[68:71], v6, s[8:11], s15 offen offset:1024 sc1
    v_add_f32 v47, v47, v51
    v_swap_b32 v107, v110
    v_smfmac_f32_16x16x64_bf16 v[12:15], v[16:19], a[200:207], v3
    v_cvt_pk_bf16_f32 v60, v44, v45
    v_smfmac_f32_16x16x64_bf16 v[12:15], v[20:23], a[208:215], v3
    v_cvt_pk_bf16_f32 v62, v46, v47
    v_smfmac_f32_16x16x64_bf16 v[12:15], v[24:27], a[216:223], v3
    buffer_load_dwordx4 v[64:67], v6, s[8:11], s15 offen offset:0 sc1
    v_smfmac_f32_16x16x64_bf16 v[12:15], v[28:31], a[224:231], v3
    buffer_load_dwordx4 v[68:71], v6, s[8:11], s15 offen offset:1024 sc1
    s_lshl_b32 s18, s13, 10
    s_add_u32 s18, s18, 10240
    v_add_u32 v16, s18, v2
    s_nop 3
    v_permlane32_swap_b32 v52, v12
    v_permlane32_swap_b32 v53, v13
    v_permlane32_swap_b32 v54, v14
    v_permlane32_swap_b32 v55, v15
    v_add_f32 v52, v52, v12
    v_add_f32 v53, v53, v13
    v_add_f32 v54, v54, v14
    v_add_f32 v55, v55, v15
    v_cvt_pk_bf16_f32 v61, v52, v53
    v_cvt_pk_bf16_f32 v63, v54, v55
    ds_write_b128 v10, v[56:59]
    ds_write_b128 v10, v[60:63] offset:1024
    s_branch CPE1_129
CPE_128:
    buffer_load_dwordx4 v[64:67], v6, s[8:11], s15 offen offset:0 sc1
    buffer_load_dwordx4 v[68:71], v6, s[8:11], s15 offen offset:1024 sc1
    s_add_u32 s22, s22, 1
    s_cmp_gt_u32 s22, 2000000
    s_cbranch_scc1 MEGA_EXIT
CPE1_129:
    s_waitcnt vmcnt(4)
    v_max3_u32 v8, v64, v65, v66
    v_max3_u32 v8, v8, v67, v68
    v_max3_u32 v8, v8, v69, v70
    v_max_u32 v8, v8, v71
    v_cmp_eq_u32 vcc, -1, v8
    s_cbranch_vccnz CPE_128
    v_smfmac_f32_16x16x64_bf16 v[112:115], v[64:67], v[80:87], v3
    v_smfmac_f32_16x16x64_bf16 v[116:119], v[68:71], v[88:95], v3
    v_smfmac_f32_16x16x64_bf16 v[72:75], v[64:67], v[96:103], v3
    v_smfmac_f32_16x16x64_bf16 v[76:79], v[68:71], v[104:111], v3
    v_readfirstlane_b32 s26, v1
    v_cvt_pk_bf16_f32 v44, v112, v113
    v_cvt_pk_bf16_f32 v46, v114, v115
    v_cvt_pk_bf16_f32 v45, v116, v117
    v_cvt_pk_bf16_f32 v47, v118, v119
    ds_write_b128 v16, v[44:47]
    v_cvt_pk_bf16_f32 v48, v72, v73
    v_cvt_pk_bf16_f32 v50, v74, v75
    v_cvt_pk_bf16_f32 v49, v76, v77
    v_cvt_pk_bf16_f32 v51, v78, v79
    ds_write_b128 v16, v[48:51] offset:6144
    s_waitcnt lgkmcnt(0)
    s_barrier
    s_add_u32 s14, s14, 1
    s_cmp_lt_u32 s14, 63
    s_cbranch_scc1 CLOOP_124
    s_branch C_LAST
SLOW_123:
    s_mov_b32 s94, 116394240
    s_mov_b32 s14, 0
CLOOP_130:
    s_and_b32 s18, s14, 3
    s_lshl_b32 s18, s18, 17
    s_add_u32 s15, s18, 75497472
    s_xor_b32 s17, s15, 262144
    s_add_u32 s18, s14, 1
    s_add_u32 s19, s18, 0
    s_lshr_b32 s31, s19, 1
    s_mul_i32 s31, s31, 14336
    s_and_b32 s19, s19, 1
    s_lshl_b32 s19, s19, 7
    s_add_u32 s31, s31, s19
    s_add_u32 s31, s31, 76546048
    s_and_b32 s18, s18, 3
    s_lshl_b32 s18, s18, 17
    s_add_u32 s16, s18, 75497472
    s_mov_b32 s22, 0
    v_add_u32 v11, s24, v2
    s_sub_u32 s18, s24, 77824
    s_xor_b32 s18, s18, 32768
    s_add_u32 s24, s18, 77824
    s_add_u32 s23, s23, 458752
    s_add_u32 s27, s14, 2
    s_min_u32 s27, s27, 64
    s_cmp_ge_u32 s26, s27
    s_cbranch_scc1 RDO_131
    s_mov_b32 s18, 116394240
RDP_132:
    buffer_load_dword v12, off, s[8:11], s18 sc1
    s_add_u32 s22, s22, 1
    s_cmp_gt_u32 s22, 2000000
    s_cbranch_scc1 MEGA_EXIT
    s_waitcnt vmcnt(0)
    v_readfirstlane_b32 s26, v12
    s_nop 0
    s_cmp_lt_u32 s26, s27
    s_cbranch_scc1 RDP_132
RDO_131:
    s_add_u32 s21, s15, 4096
    s_waitcnt vmcnt(0)
    ds_read_b128 v[64:67], v9 offset:0
    ds_read_b128 v[68:71], v9 offset:1024
    ds_read_b128 v[72:75], v9 offset:2048
    ds_read_b128 v[76:79], v9 offset:3072
    ds_read_b128 v[80:83], v9 offset:4096
    ds_read_b128 v[84:87], v9 offset:5120
    ds_read_b128 v[88:91], v9 offset:6144
    ds_read_b128 v[92:95], v9 offset:7168
    ds_read_b128 v[96:99], v9 offset:8192
    ds_read_b128 v[100:103], v9 offset:9216
    ds_read_b128 v[104:107], v9 offset:10240
    ds_read_b128 v[108:111], v9 offset:11264
    ds_read_b128 v[112:115], v9 offset:12288
    ds_read_b128 v[116:119], v9 offset:13312
    v_mov_b64 v[44:45], 0
    v_mov_b64 v[46:47], 0
    v_mov_b64 v[48:49], 0
    v_mov_b64 v[50:51], 0
    v_mov_b64 v[52:53], 0
    v_mov_b64 v[54:55], 0
    v_lshlrev_b32 v13, 7, v1
    s_add_u32 s19, s23, 917504
    s_barrier
    s_sleep 5
CPM_133:
    buffer_load_dwordx4 v[32:35], v2, s[8:11], s21 offen offset:0 sc1
    buffer_load_dwordx4 v[36:39], v2, s[8:11], s21 offen offset:1024 sc1
    buffer_load_dwordx4 v[40:43], v2, s[8:11], s21 offen offset:2048 sc1
    s_add_u32 s22, s22, 1
    s_cmp_gt_u32 s22, 2000000
    s_cbranch_scc1 MEGA_EXIT
    s_waitcnt vmcnt(2)
    v_max3_u32 v8, v32, v33, v34
    v_max_u32 v8, v8, v35
    s_waitcnt vmcnt(1)
    v_max3_u32 v8, v8, v36, v37
    v_max3_u32 v8, v8, v38, v39
    s_waitcnt vmcnt(0)
    v_max3_u32 v8, v8, v40, v41
    v_max3_u32 v8, v8, v42, v43
    v_cmp_eq_u32 vcc, -1, v8
    s_cbranch_vccnz CPM_133
    ds_write_b128 v2, v[32:35] offset:4096
    ds_write_b128 v2, v[36:39] offset:5120
    ds_write_b128 v2, v[40:43] offset:6144
    v_mov_b64 v[12:13], 0
    v_mov_b64 v[14:15], 0
    s_waitcnt lgkmcnt(0)
    s_barrier
    ds_read_b128 v[16:19], v2 offset:0
    ds_read_b128 v[20:23], v2 offset:1024
    ds_read_b128 v[24:27], v2 offset:2048
    ds_read_b128 v[28:31], v2 offset:3072
    s_waitcnt lgkmcnt(6)
    v_smfmac_f32_16x16x64_bf16 v[44:47], v[32:35], v[96:103], v3
    s_add_u32 s18, s23, 0
    s_add_u32 m0, s24, 0
    s_nop 0
    buffer_load_dwordx4 v2, s[8:11], s18 offen offset:0 sc1 lds
    s_waitcnt lgkmcnt(5)
    v_smfmac_f32_16x16x64_bf16 v[44:47], v[36:39], v[104:111], v3
    buffer_store_dword v5, v4, s[8:11], s17 offen sc1
    s_waitcnt lgkmcnt(4)
    v_smfmac_f32_16x16x64_bf16 v[44:47], v[40:43], v[112:119], v3
    s_waitcnt lgkmcnt(3)
    v_smfmac_f32_16x16x64_bf16 v[44:47], v[16:19], v[64:71], v3
    s_waitcnt lgkmcnt(2)
    v_smfmac_f32_16x16x64_bf16 v[44:47], v[20:23], v[72:79], v3
    buffer_load_dwordx4 v2, s[8:11], s18 offen offset:1024 sc1 lds
    s_waitcnt lgkmcnt(1)
    v_smfmac_f32_16x16x64_bf16 v[44:47], v[24:27], v[80:87], v3
    s_waitcnt lgkmcnt(0)
    v_smfmac_f32_16x16x64_bf16 v[44:47], v[28:31], v[88:95], v3
    v_smfmac_f32_16x16x64_bf16 v[48:51], v[32:35], v[152:159], v3
    ds_read_b128 v[80:83], v11 offset:0
    v_smfmac_f32_16x16x64_bf16 v[48:51], v[36:39], v[160:167], v3
    buffer_load_dwordx4 v2, s[8:11], s18 offen offset:2048 sc1 lds
    v_mov_b64 v[112:113], 0
    v_smfmac_f32_16x16x64_bf16 v[48:51], v[40:43], v[168:175], v3
    ds_read_b128 v[84:87], v11 offset:2048
    v_mov_b64 v[114:115], 0
    v_smfmac_f32_16x16x64_bf16 v[48:51], v[16:19], v[120:127], v3
    ds_read_b128 v[88:91], v11 offset:1024
    v_mov_b64 v[116:117], 0
    v_smfmac_f32_16x16x64_bf16 v[48:51], v[20:23], v[128:135], v3
    ds_read_b128 v[92:95], v11 offset:3072
    v_mov_b64 v[118:119], 0
    v_smfmac_f32_16x16x64_bf16 v[48:51], v[24:27], v[136:143], v3
    buffer_load_dwordx4 v2, s[8:11], s18 offen offset:3072 sc1 lds
    v_mov_b64 v[72:73], 0
    v_smfmac_f32_16x16x64_bf16 v[48:51], v[28:31], v[144:151], v3
    ds_read_b128 v[96:99], v11 offset:4096
    v_mov_b64 v[74:75], 0
    v_smfmac_f32_16x16x64_bf16 v[52:55], v[32:35], v[208:215], v3
    ds_read_b128 v[100:103], v11 offset:6144
    v_mov_b64 v[76:77], 0
    v_smfmac_f32_16x16x64_bf16 v[52:55], v[36:39], v[216:223], v3
    ds_read_b128 v[104:107], v11 offset:5120
    v_mov_b64 v[78:79], 0
    v_smfmac_f32_16x16x64_bf16 v[52:55], v[40:43], v[224:231], v3
    s_add_u32 s18, s23, 16384
    s_add_u32 m0, s24, 4096
    s_nop 0
    buffer_load_dwordx4 v2, s[8:11], s18 offen offset:0 sc1 lds
    v_permlane32_swap_b32 v44, v48
    v_smfmac_f32_16x16x64_bf16 v[52:55], v[16:19], v[176:183], v3
    ds_read_b128 v[108:111], v11 offset:7168
    v_permlane32_swap_b32 v45, v49
    v_smfmac_f32_16x16x64_bf16 v[52:55], v[20:23], v[184:191], v3
    v_permlane32_swap_b32 v46, v50
    v_smfmac_f32_16x16x64_bf16 v[52:55], v[24:27], v[192:199], v3
    v_permlane32_swap_b32 v47, v51
    v_smfmac_f32_16x16x64_bf16 v[52:55], v[28:31], v[200:207], v3
    buffer_load_dwordx4 v2, s[8:11], s18 offen offset:1024 sc1 lds
    v_add_f32 v44, v44, v48
    v_smfmac_f32_16x16x64_bf16 v[12:15], v[32:35], a[8:15], v3
    v_add_f32 v45, v45, v49
    v_smfmac_f32_16x16x64_bf16 v[12:15], v[36:39], a[16:23], v3
    s_waitcnt lgkmcnt(0)
    v_add_f32 v46, v46, v50
    v_swap_b32 v81, v84
    v_smfmac_f32_16x16x64_bf16 v[12:15], v[40:43], a[24:31], v3
    v_add_f32 v47, v47, v51
    v_smfmac_f32_16x16x64_bf16 v[12:15], v[16:19], v[232:239], v3
    buffer_load_dwordx4 v2, s[8:11], s18 offen offset:2048 sc1 lds
    v_cvt_pk_bf16_f32 v56, v44, v45
    v_smfmac_f32_16x16x64_bf16 v[12:15], v[20:23], v[240:247], v3
    v_cvt_pk_bf16_f32 v58, v46, v47
    v_smfmac_f32_16x16x64_bf16 v[12:15], v[24:27], v[248:255], v3
    v_mov_b64 v[44:45], 0
    v_mov_b64 v[46:47], 0
    v_smfmac_f32_16x16x64_bf16 v[12:15], v[28:31], a[0:7], v3
    v_mov_b64 v[48:49], 0
    v_swap_b32 v83, v86
    v_smfmac_f32_16x16x64_bf16 v[44:47], v[32:35], a[64:71], v3
    buffer_load_dwordx4 v2, s[8:11], s18 offen offset:3072 sc1 lds
    v_mov_b64 v[50:51], 0
    v_smfmac_f32_16x16x64_bf16 v[44:47], v[36:39], a[72:79], v3
    v_smfmac_f32_16x16x64_bf16 v[44:47], v[40:43], a[80:87], v3
    v_permlane32_swap_b32 v52, v12
    v_smfmac_f32_16x16x64_bf16 v[44:47], v[16:19], a[32:39], v3
    v_permlane32_swap_b32 v53, v13
    v_swap_b32 v89, v92
    v_smfmac_f32_16x16x64_bf16 v[44:47], v[20:23], a[40:47], v3
    v_permlane32_swap_b32 v54, v14
    v_smfmac_f32_16x16x64_bf16 v[44:47], v[24:27], a[48:55], v3
    v_permlane32_swap_b32 v55, v15
    v_smfmac_f32_16x16x64_bf16 v[44:47], v[28:31], a[56:63], v3
    v_add_f32 v52, v52, v12
    v_smfmac_f32_16x16x64_bf16 v[48:51], v[32:35], a[120:127], v3
    v_add_f32 v53, v53, v13
    v_swap_b32 v91, v94
    v_smfmac_f32_16x16x64_bf16 v[48:51], v[36:39], a[128:135], v3
    v_add_f32 v54, v54, v14
    v_smfmac_f32_16x16x64_bf16 v[48:51], v[40:43], a[136:143], v3
    v_add_f32 v55, v55, v15
    v_smfmac_f32_16x16x64_bf16 v[48:51], v[16:19], a[88:95], v3
    v_cvt_pk_bf16_f32 v57, v52, v53
    v_smfmac_f32_16x16x64_bf16 v[48:51], v[20:23], a[96:103], v3
    v_cvt_pk_bf16_f32 v59, v54, v55
    v_swap_b32 v97, v100
    v_smfmac_f32_16x16x64_bf16 v[48:51], v[24:27], a[104:111], v3
    buffer_load_dword v1, off, s[8:11], s94 sc1
    v_mov_b64 v[52:53], 0
    v_mov_b64 v[54:55], 0
    v_smfmac_f32_16x16x64_bf16 v[48:51], v[28:31], a[112:119], v3
    v_mov_b64 v[12:13], 0
    v_smfmac_f32_16x16x64_bf16 v[52:55], v[32:35], a[176:183], v3
    v_mov_b64 v[14:15], 0
    v_smfmac_f32_16x16x64_bf16 v[52:55], v[36:39], a[184:191], v3
    v_swap_b32 v99, v102
    v_smfmac_f32_16x16x64_bf16 v[52:55], v[40:43], a[192:199], v3
    buffer_load_dwordx4 v[64:67], v6, s[8:11], s15 offen offset:0 sc1
    v_permlane32_swap_b32 v44, v48
    v_smfmac_f32_16x16x64_bf16 v[52:55], v[16:19], a[144:151], v3
    buffer_load_dwordx4 v[68:71], v6, s[8:11], s15 offen offset:1024 sc1
    v_permlane32_swap_b32 v45, v49
    v_smfmac_f32_16x16x64_bf16 v[52:55], v[20:23], a[152:159], v3
    v_permlane32_swap_b32 v46, v50
    v_smfmac_f32_16x16x64_bf16 v[52:55], v[24:27], a[160:167], v3
    v_permlane32_swap_b32 v47, v51
    v_swap_b32 v105, v108
    v_smfmac_f32_16x16x64_bf16 v[52:55], v[28:31], a[168:175], v3
    v_add_f32 v44, v44, v48
    v_smfmac_f32_16x16x64_bf16 v[12:15], v[32:35], a[232:239], v3
    v_add_f32 v45, v45, v49
    v_smfmac_f32_16x16x64_bf16 v[12:15], v[36:39], a[240:247], v3
    buffer_load_dwordx4 v[64:67], v6, s[8:11], s15 offen offset:0 sc1
    v_add_f32 v46, v46, v50
    v_smfmac_f32_16x16x64_bf16 v[12:15], v[40:43], a[248:255], v3
    buffer_load_dwordx4 v[68:71], v6, s[8:11], s15 offen offset:1024 sc1
    v_add_f32 v47, v47, v51
    v_swap_b32 v107, v110
    v_smfmac_f32_16x16x64_bf16 v[12:15], v[16:19], a[200:207], v3
    v_cvt_pk_bf16_f32 v60, v44, v45
    v_smfmac_f32_16x16x64_bf16 v[12:15], v[20:23], a[208:215], v3
    v_cvt_pk_bf16_f32 v62, v46, v47
    v_smfmac_f32_16x16x64_bf16 v[12:15], v[24:27], a[216:223], v3
    buffer_load_dwordx4 v[64:67], v6, s[8:11], s15 offen offset:0 sc1
    v_smfmac_f32_16x16x64_bf16 v[12:15], v[28:31], a[224:231], v3
    buffer_load_dwordx4 v[68:71], v6, s[8:11], s15 offen offset:1024 sc1
    s_lshl_b32 s18, s13, 10
    s_add_u32 s18, s18, 10240
    v_add_u32 v16, s18, v2
    s_nop 3
    v_permlane32_swap_b32 v52, v12
    v_permlane32_swap_b32 v53, v13
    v_permlane32_swap_b32 v54, v14
    v_permlane32_swap_b32 v55, v15
    v_add_f32 v52, v52, v12
    v_add_f32 v53, v53, v13
    v_add_f32 v54, v54, v14
    v_add_f32 v55, v55, v15
    v_cvt_pk_bf16_f32 v61, v52, v53
    v_cvt_pk_bf16_f32 v63, v54, v55
    ds_write_b128 v10, v[56:59]
    ds_write_b128 v10, v[60:63] offset:1024
    s_branch CPE1_135
CPE_134:
    buffer_load_dwordx4 v[64:67], v6, s[8:11], s15 offen offset:0 sc1
    buffer_load_dwordx4 v[68:71], v6, s[8:11], s15 offen offset:1024 sc1
    s_add_u32 s22, s22, 1
    s_cmp_gt_u32 s22, 2000000
    s_cbranch_scc1 MEGA_EXIT
CPE1_135:
    s_waitcnt vmcnt(4)
    v_max3_u32 v8, v64, v65, v66
    v_max3_u32 v8, v8, v67, v68
    v_max3_u32 v8, v8, v69, v70
    v_max_u32 v8, v8, v71
    v_cmp_eq_u32 vcc, -1, v8
    s_cbranch_vccnz CPE_134
    v_smfmac_f32_16x16x64_bf16 v[112:115], v[64:67], v[80:87], v3
    v_smfmac_f32_16x16x64_bf16 v[116:119], v[68:71], v[88:95], v3
    v_smfmac_f32_16x16x64_bf16 v[72:75], v[64:67], v[96:103], v3
    v_smfmac_f32_16x16x64_bf16 v[76:79], v[68:71], v[104:111], v3
    v_readfirstlane_b32 s26, v1
    v_cvt_pk_bf16_f32 v44, v112, v113
    v_cvt_pk_bf16_f32 v46, v114, v115
    v_cvt_pk_bf16_f32 v45, v116, v117
    v_cvt_pk_bf16_f32 v47, v118, v119
    ds_write_b128 v16, v[44:47]
    v_cvt_pk_bf16_f32 v48, v72, v73
    v_cvt_pk_bf16_f32 v50, v74, v75
    v_cvt_pk_bf16_f32 v49, v76, v77
    v_cvt_pk_bf16_f32 v51, v78, v79
    ds_write_b128 v16, v[48:51] offset:6144
    s_waitcnt lgkmcnt(0)
    s_barrier
    s_add_u32 s14, s14, 1
    s_cmp_lt_u32 s14, 63
    s_cbranch_scc1 CLOOP_130
    s_branch C_LAST
C_LAST:
    s_waitcnt vmcnt(0)
    ds_read_b128 v[64:67], v9 offset:0
    ds_read_b128 v[68:71], v9 offset:1024
    ds_read_b128 v[72:75], v9 offset:2048
    ds_read_b128 v[76:79], v9 offset:3072
    ds_read_b128 v[80:83], v9 offset:4096
    ds_read_b128 v[84:87], v9 offset:5120
    ds_read_b128 v[88:91], v9 offset:6144
    ds_read_b128 v[92:95], v9 offset:7168
    ds_read_b128 v[96:99], v9 offset:8192
    ds_read_b128 v[100:103], v9 offset:9216
    ds_read_b128 v[104:107], v9 offset:10240
    ds_read_b128 v[108:111], v9 offset:11264
    ds_read_b128 v[112:115], v9 offset:12288
    ds_read_b128 v[116:119], v9 offset:13312
    v_add_u32 v11, 4096, v2
    v_and_b32 v8, 0xf0, v2
    v_bfe_u32 v12, v2, 8, 1
    v_lshl_add_u32 v8, v12, 3, v8
    v_bfe_u32 v12, v2, 9, 1
    v_mul_u32_u24 v12, 14336, v12
    v_add_u32 v8, v8, v12
    s_lshr_b32 s21, s13, 1
    s_mul_i32 s21, s21, 57344
    s_lshl_b32 s18, s25, 8
    s_add_u32 s21, s21, s18
    s_add_u32 s21, s21, 114065408
    v_mov_b64 v[44:45], 0
    v_mov_b64 v[46:47], 0
    v_mov_b64 v[48:49], 0
    v_mov_b64 v[50:51], 0
    v_mov_b64 v[52:53], 0
    v_mov_b64 v[54:55], 0
    v_mov_b64 v[12:13], 0
    v_mov_b64 v[14:15], 0
    v_swap_b32 v57, v58
    v_swap_b32 v61, v62
    v_min_u32 v56, -2, v56
    v_min_u32 v57, -2, v57
    v_min_u32 v58, -2, v58
    v_min_u32 v59, -2, v59
    v_min_u32 v60, -2, v60
    v_min_u32 v61, -2, v61
    v_min_u32 v62, -2, v62
    v_min_u32 v63, -2, v63
    s_barrier
    s_sleep 4
    s_mov_b32 s15, 75890688
    s_mov_b32 s22, 0
LP_136:
    buffer_load_dwordx4 v[16:19], v2, s[8:11], s15 offen offset:0 sc1
    buffer_load_dwordx4 v[20:23], v2, s[8:11], s15 offen offset:1024 sc1
    buffer_load_dwordx4 v[24:27], v2, s[8:11], s15 offen offset:2048 sc1
    buffer_load_dwordx4 v[28:31], v2, s[8:11], s15 offen offset:3072 sc1
    buffer_load_dwordx4 v[32:35], v11, s[8:11], s15 offen offset:0 sc1
    buffer_load_dwordx4 v[36:39], v11, s[8:11], s15 offen offset:1024 sc1
    buffer_load_dwordx4 v[40:43], v11, s[8:11], s15 offen offset:2048 sc1
    s_add_u32 s22, s22, 1
    s_cmp_gt_u32 s22, 2000000
    s_cbranch_scc1 MEGA_EXIT
    s_waitcnt vmcnt(6)
    v_max3_u32 v7, v16, v17, v18
    v_max_u32 v7, v7, v19
    s_waitcnt vmcnt(5)
    v_max3_u32 v7, v7, v20, v21
    v_max3_u32 v7, v7, v22, v23
    s_waitcnt vmcnt(4)
    v_max3_u32 v7, v7, v24, v25
    v_max3_u32 v7, v7, v26, v27
    s_waitcnt vmcnt(3)
    v_max3_u32 v7, v7, v28, v29
    v_max3_u32 v7, v7, v30, v31
    s_waitcnt vmcnt(2)
    v_max3_u32 v7, v7, v32, v33
    v_max3_u32 v7, v7, v34, v35
    s_waitcnt vmcnt(1)
    v_max3_u32 v7, v7, v36, v37
    v_max3_u32 v7, v7, v38, v39
    s_waitcnt vmcnt(0)
    v_max3_u32 v7, v7, v40, v41
    v_max3_u32 v7, v7, v42, v43
    v_cmp_eq_u32 vcc, -1, v7
    s_cbranch_vccnz LP_136
    s_add_u32 s18, s21, 0
    buffer_store_dwordx2 v[56:57], v8, s[8:11], s18 offen sc1
    s_add_u32 s18, s21, 7168
    buffer_store_dwordx2 v[58:59], v8, s[8:11], s18 offen sc1
    s_add_u32 s18, s21, 28672
    buffer_store_dwordx2 v[60:61], v8, s[8:11], s18 offen sc1
    s_add_u32 s18, s21, 35840
    buffer_store_dwordx2 v[62:63], v8, s[8:11], s18 offen sc1
    s_waitcnt lgkmcnt(0)
    v_smfmac_f32_16x16x64_bf16 v[44:47], v[16:19], v[64:71], v3
    v_smfmac_f32_16x16x64_bf16 v[44:47], v[20:23], v[72:79], v3
    v_smfmac_f32_16x16x64_bf16 v[44:47], v[24:27], v[80:87], v3
    v_smfmac_f32_16x16x64_bf16 v[44:47], v[28:31], v[88:95], v3
    v_smfmac_f32_16x16x64_bf16 v[44:47], v[32:35], v[96:103], v3
    v_smfmac_f32_16x16x64_bf16 v[44:47], v[36:39], v[104:111], v3
    v_smfmac_f32_16x16x64_bf16 v[44:47], v[40:43], v[112:119], v3
    v_smfmac_f32_16x16x64_bf16 v[48:51], v[16:19], v[120:127], v3
    v_smfmac_f32_16x16x64_bf16 v[48:51], v[20:23], v[128:135], v3
    v_smfmac_f32_16x16x64_bf16 v[48:51], v[24:27], v[136:143], v3
    v_smfmac_f32_16x16x64_bf16 v[48:51], v[28:31], v[144:151], v3
    v_smfmac_f32_16x16x64_bf16 v[48:51], v[32:35], v[152:159], v3
    v_smfmac_f32_16x16x64_bf16 v[48:51], v[36:39], v[160:167], v3
    v_smfmac_f32_16x16x64_bf16 v[48:51], v[40:43], v[168:175], v3
    v_smfmac_f32_16x16x64_bf16 v[52:55], v[16:19], v[176:183], v3
    v_smfmac_f32_16x16x64_bf16 v[52:55], v[20:23], v[184:191], v3
    v_smfmac_f32_16x16x64_bf16 v[52:55], v[24:27], v[192:199], v3
    v_permlane32_swap_b32 v44, v48
    v_permlane32_swap_b32 v45, v49
    v_smfmac_f32_16x16x64_bf16 v[52:55], v[28:31], v[200:207], v3
    v_permlane32_swap_b32 v46, v50
    v_permlane32_swap_b32 v47, v51
    v_smfmac_f32_16x16x64_bf16 v[52:55], v[32:35], v[208:215], v3
    v_add_f32 v44, v44, v48
    v_add_f32 v45, v45, v49
    v_smfmac_f32_16x16x64_bf16 v[52:55], v[36:39], v[216:223], v3
    v_add_f32 v46, v46, v50
    v_add_f32 v47, v47, v51
    v_smfmac_f32_16x16x64_bf16 v[52:55], v[40:43], v[224:231], v3
    v_cvt_pk_bf16_f32 v56, v44, v45
    v_cvt_pk_bf16_f32 v57, v46, v47
    v_smfmac_f32_16x16x64_bf16 v[12:15], v[16:19], v[232:239], v3
    v_mov_b64 v[44:45], 0
    v_mov_b64 v[46:47], 0
    v_smfmac_f32_16x16x64_bf16 v[12:15], v[20:23], v[240:247], v3
    v_mov_b64 v[48:49], 0
    v_mov_b64 v[50:51], 0
    v_smfmac_f32_16x16x64_bf16 v[12:15], v[24:27], v[248:255], v3
    v_min_u32 v56, -2, v56
    v_min_u32 v57, -2, v57
    v_smfmac_f32_16x16x64_bf16 v[12:15], v[28:31], a[0:7], v3
    s_add_u32 s18, s21, 114688
    buffer_store_dwordx2 v[56:57], v8, s[8:11], s18 offen sc1
    v_smfmac_f32_16x16x64_bf16 v[12:15], v[32:35], a[8:15], v3
    v_smfmac_f32_16x16x64_bf16 v[12:15], v[36:39], a[16:23], v3
    v_smfmac_f32_16x16x64_bf16 v[12:15], v[40:43], a[24:31], v3
    v_smfmac_f32_16x16x64_bf16 v[44:47], v[16:19], a[32:39], v3
    v_smfmac_f32_16x16x64_bf16 v[44:47], v[20:23], a[40:47], v3
    v_smfmac_f32_16x16x64_bf16 v[44:47], v[24:27], a[48:55], v3
    v_permlane32_swap_b32 v52, v12
    v_permlane32_swap_b32 v53, v13
    v_smfmac_f32_16x16x64_bf16 v[44:47], v[28:31], a[56:63], v3
    v_permlane32_swap_b32 v54, v14
    v_permlane32_swap_b32 v55, v15
    v_smfmac_f32_16x16x64_bf16 v[44:47], v[32:35], a[64:71], v3
    v_add_f32 v52, v52, v12
    v_add_f32 v53, v53, v13
    v_smfmac_f32_16x16x64_bf16 v[44:47], v[36:39], a[72:79], v3
    v_add_f32 v54, v54, v14
    v_add_f32 v55, v55, v15
    v_smfmac_f32_16x16x64_bf16 v[44:47], v[40:43], a[80:87], v3
    v_cvt_pk_bf16_f32 v58, v52, v53
    v_cvt_pk_bf16_f32 v59, v54, v55
    v_smfmac_f32_16x16x64_bf16 v[48:51], v[16:19], a[88:95], v3
    v_mov_b64 v[52:53], 0
    v_mov_b64 v[54:55], 0
    v_smfmac_f32_16x16x64_bf16 v[48:51], v[20:23], a[96:103], v3
    v_mov_b64 v[12:13], 0
    v_mov_b64 v[14:15], 0
    v_smfmac_f32_16x16x64_bf16 v[48:51], v[24:27], a[104:111], v3
    v_min_u32 v58, -2, v58
    v_min_u32 v59, -2, v59
    v_smfmac_f32_16x16x64_bf16 v[48:51], v[28:31], a[112:119], v3
    s_add_u32 s18, s21, 121856
    buffer_store_dwordx2 v[58:59], v8, s[8:11], s18 offen sc1
    v_smfmac_f32_16x16x64_bf16 v[48:51], v[32:35], a[120:127], v3
    v_smfmac_f32_16x16x64_bf16 v[48:51], v[36:39], a[128:135], v3
    v_smfmac_f32_16x16x64_bf16 v[48:51], v[40:43], a[136:143], v3
    v_smfmac_f32_16x16x64_bf16 v[52:55], v[16:19], a[144:151], v3
    v_smfmac_f32_16x16x64_bf16 v[52:55], v[20:23], a[152:159], v3
    v_smfmac_f32_16x16x64_bf16 v[52:55], v[24:27], a[160:167], v3
    v_permlane32_swap_b32 v44, v48
    v_permlane32_swap_b32 v45, v49
    v_smfmac_f32_16x16x64_bf16 v[52:55], v[28:31], a[168:175], v3
    v_permlane32_swap_b32 v46, v50
    v_permlane32_swap_b32 v47, v51
    v_smfmac_f32_16x16x64_bf16 v[52:55], v[32:35], a[176:183], v3
    v_add_f32 v44, v44, v48
    v_add_f32 v45, v45, v49
    v_smfmac_f32_16x16x64_bf16 v[52:55], v[36:39], a[184:191], v3
    v_add_f32 v46, v46, v50
    v_add_f32 v47, v47, v51
    v_smfmac_f32_16x16x64_bf16 v[52:55], v[40:43], a[192:199], v3
    v_cvt_pk_bf16_f32 v60, v44, v45
    v_cvt_pk_bf16_f32 v61, v46, v47
    v_smfmac_f32_16x16x64_bf16 v[12:15], v[16:19], a[200:207], v3
    v_min_u32 v60, -2, v60
    v_min_u32 v61, -2, v61
    v_smfmac_f32_16x16x64_bf16 v[12:15], v[20:23], a[208:215], v3
    s_add_u32 s18, s21, 143360
    buffer_store_dwordx2 v[60:61], v8, s[8:11], s18 offen sc1
    v_smfmac_f32_16x16x64_bf16 v[12:15], v[24:27], a[216:223], v3
    v_smfmac_f32_16x16x64_bf16 v[12:15], v[28:31], a[224:231], v3
    v_smfmac_f32_16x16x64_bf16 v[12:15], v[32:35], a[232:239], v3
    v_smfmac_f32_16x16x64_bf16 v[12:15], v[36:39], a[240:247], v3
    v_smfmac_f32_16x16x64_bf16 v[12:15], v[40:43], a[248:255], v3
    s_nop 7
    v_permlane32_swap_b32 v52, v12
    v_permlane32_swap_b32 v53, v13
    v_permlane32_swap_b32 v54, v14
    v_permlane32_swap_b32 v55, v15
    v_add_f32 v52, v52, v12
    v_add_f32 v53, v53, v13
    v_add_f32 v54, v54, v14
    v_add_f32 v55, v55, v15
    v_cvt_pk_bf16_f32 v62, v52, v53
    v_cvt_pk_bf16_f32 v63, v54, v55
    v_min_u32 v62, -2, v62
    v_min_u32 v63, -2, v63
    s_add_u32 s18, s21, 150528
    buffer_store_dwordx2 v[62:63], v8, s[8:11], s18 offen sc1
    s_branch MEGA_EXIT
ROLE_P:
    s_sub_u32 s12, s12, 30
    v_and_b32 v1, 63, v0
    s_mov_b32 s22, 0
    v_mov_b32 v8, 0
    v_mov_b32 v9, 0
    ds_write_b32 v8, v9
    s_waitcnt vmcnt(0) lgkmcnt(0)
    s_barrier
    v_mov_b32 v13, s41
    v_mov_b32 v15, 0
    s_cmp_lg_u32 s13, 0
    s_cbranch_scc1 TB0_141
    s_mov_b64 exec, 1
    global_atomic_add v15, v13, s[4:5] sc1
    s_mov_b64 exec, -1
TB0_141:
    s_waitcnt vmcnt(0) lgkmcnt(0)
    s_barrier
    v_mov_b32 v12, 7200
    s_cmp_lg_u32 s13, 0
    s_cbranch_scc1 TBS_143
    v_mov_b32 v13, 1
    v_mov_b32 v15, 0
    s_mov_b64 exec, 1
    global_atomic_add v15, v13, s[4:5] offset:128 sc1
TBW_142:
    global_load_dword v14, v15, s[4:5] sc1
    s_add_u32 s22, s22, 1
    s_cmp_gt_u32 s22, 2000000
    s_cbranch_scc1 MEGA_EXIT
    s_sleep 2
    s_waitcnt vmcnt(0)
    v_and_b32 v13, 0x3f, v14
    v_cmp_gt_u32 vcc, 32, v13
    s_cbranch_vccnz TBW_142
    v_bfe_u32 v13, v14, 6, 10
    v_mul_u32_u24 v13, v13, v13
    v_lshrrev_b32 v14, 16, v14
    v_lshlrev_b32 v14, 5, v14
    v_sub_u32 v14, v14, v13
    ds_write_b32 v12, v14
    s_waitcnt lgkmcnt(0)
    s_mov_b64 exec, -1
TBS_143:
    s_barrier
    ds_read_b32 v13, v12
    s_waitcnt lgkmcnt(0)
    v_readfirstlane_b32 s40, v13
    s_lshl_b32 s25, s12, 2
    s_add_u32 s25, s25, s13
    s_cmp_eq_u32 s25, 1
    s_cbranch_scc1 SGK_139
    s_cmp_eq_u32 s25, 5
    s_cbranch_scc1 SEX_138
    s_cmp_eq_u32 s25, 6
    s_cbranch_scc1 SEX_138
    s_sub_u32 s31, 3, s12
    s_add_u32 s19, s12, 1
    s_max_u32 s25, s13, s19
    s_sub_u32 s25, s25, s19
    v_lshlrev_b32 v2, 7, v1
    s_mov_b32 s14, 1
    s_mov_b32 s21, 76021504
PFL_144:
    s_mov_b32 s22, 0
    s_add_u32 s27, s14, 1
    s_min_u32 s27, s27, 64
    s_cmp_ge_u32 s26, s27
    s_cbranch_scc1 RDO_148
    s_mov_b32 s18, 116394240
RDP_149:
    buffer_load_dword v12, off, s[8:11], s18 sc1
    s_add_u32 s22, s22, 1
    s_cmp_gt_u32 s22, 2000000
    s_cbranch_scc1 MEGA_EXIT
    s_waitcnt vmcnt(0)
    v_readfirstlane_b32 s26, v12
    s_nop 0
    s_cmp_lt_u32 s26, s27
    s_cbranch_scc1 RDP_149
RDO_148:
    buffer_load_dword v13, off, s[8:11], s21 sc1
    s_mul_i32 s18, s14, 458752
    s_mul_i32 s19, s12, 229376
    s_add_u32 s18, s18, s19
    s_add_u32 s18, s18, 46137344
    s_mov_b32 s20, s25
PFS_150:
    s_mul_i32 s19, s20, 16384
    s_add_u32 s19, s19, s18
    buffer_load_dword v14, v2, s[8:11], s19 offen sc1
    s_add_u32 s20, s20, s31
    s_cmp_lt_u32 s20, 14
    s_cbranch_scc1 PFS_150
    s_add_u32 s14, s14, 1
    s_cmp_ge_u32 s14, 63
    s_cbranch_scc1 PFE_151
    s_waitcnt vmcnt(4)
    s_branch PFC_147
PFW_145:
    s_sleep 2
    buffer_load_dword v13, off, s[8:11], s21 sc1
    s_add_u32 s22, s22, 1
    s_cmp_gt_u32 s22, 2000000
    s_cbranch_scc1 MEGA_EXIT
    s_waitcnt vmcnt(0)
PFC_147:
    v_readfirstlane_b32 s18, v13
    s_nop 0
    s_add_u32 s18, s18, 4
    s_cmp_le_u32 s14, s18
    s_cbranch_scc1 PFL_144
    s_branch PFW_145
PFE_151:
    s_cmp_lg_u32 s12, 0
    s_cbranch_scc1 PFY_153
PFX_152:
    s_lshl_b32 s19, s25, 13
    s_add_u32 s19, s19, 85663744
    buffer_load_dword v14, v2, s[8:11], s19 offen sc1
    s_add_u32 s25, s25, 3
    s_cmp_lt_u32 s25, 7
    s_cbranch_scc1 PFX_152
    s_branch MEGA_EXIT
PFY_153:
    s_mov_b32 s18, A_LAST - CODE_BEGIN
    s_mov_b32 s19, C_LAST - CODE_BEGIN
    s_cmp_eq_u32 s25, 0
    s_cselect_b32 s18, s18, s19
    v_lshrrev_b32 v13, 1, v2
    v_add_u32 v13, s18, v13
    global_load_dword v14, v13, s[6:7]
    s_branch MEGA_EXIT
SGK_139:
    v_lshlrev_b32 v2, 3, v1
    s_mov_b32 s14, 0
    s_mov_b32 s20, 116394240
    v_min_u32 v4, 55, v1
    v_lshlrev_b32 v4, 4, v4
    s_mov_b32 s21, 116395008
GKF_154:
    buffer_load_dwordx4 v[16:19], v4, s[8:11], s21 offen sc1
    s_add_u32 s22, s22, 1
    s_cmp_gt_u32 s22, 2000000
    s_cbranch_scc1 MEGA_EXIT
    s_sleep 2
    s_waitcnt vmcnt(0)
    v_min3_u32 v12, v16, v17, v18
    v_min_u32 v12, v12, v19
    v_lshlrev_b32 v12, 2, v12
    v_cmp_ge_u32 vcc, s14, v12
    s_cbranch_vccnz GKF_154
    s_add_u32 s14, s14, 4
    v_mov_b32 v14, s14
    s_mov_b64 exec, 1
    s_cmp_lg_u32 s40, 0
    s_cbranch_scc1 RP1_155
    buffer_store_dword v14, off, s[8:11], s20
    s_branch RP2_156
RP1_155:
    buffer_store_dword v14, off, s[8:11], s20 sc1
RP2_156:
    s_mov_b64 exec, -1
    s_cmp_lt_u32 s14, 8
    s_cbranch_scc1 GKF_154
    s_mov_b32 s21, 116400128
GKL_157:
    buffer_load_dwordx2 v[16:17], v2, s[8:11], s21 offen offset:0 sc1
    buffer_load_dwordx2 v[18:19], v2, s[8:11], s21 offen offset:512 sc1
    s_add_u32 s22, s22, 1
    s_cmp_gt_u32 s22, 2000000
    s_cbranch_scc1 MEGA_EXIT
    s_sleep 2
    s_waitcnt vmcnt(0)
    v_min_u32 v12, v16, v17
    v_min3_u32 v12, v12, v18, v19
    v_cmp_eq_u32 vcc, 0, v12
    s_cbranch_vccnz GKL_157
    s_add_u32 s14, s14, 2
    v_mov_b32 v14, s14
    s_mov_b64 exec, 1
    s_cmp_lg_u32 s40, 0
    s_cbranch_scc1 RP1_158
    buffer_store_dword v14, off, s[8:11], s20
    s_branch RP2_159
RP1_158:
    buffer_store_dword v14, off, s[8:11], s20 sc1
RP2_159:
    s_mov_b64 exec, -1
    s_add_u32 s21, s21, 1024
    s_cmp_lt_u32 s14, 64
    s_cbranch_scc1 GKL_157
    s_branch MEGA_EXIT
SEX_138:
    v_lshrrev_b32 v12, 3, v1
    v_lshlrev_b32 v12, 8, v12
    v_and_b32 v13, 7, v1
    v_lshl_add_u32 v4, v13, 4, v12
    v_add_u32 v5, 4096, v4
    v_add_u32 v6, 8192, v4
    v_add_u32 v7, 12288, v4
    s_and_b32 s14, s25, 1
    s_mov_b32 s27, 1
    s_cmp_ge_u32 s26, s27
    s_cbranch_scc1 RDO_160
    s_mov_b32 s18, 116394240
RDP_161:
    buffer_load_dword v12, off, s[8:11], s18 sc1
    s_add_u32 s22, s22, 1
    s_cmp_gt_u32 s22, 2000000
    s_cbranch_scc1 MEGA_EXIT
    s_waitcnt vmcnt(0)
    v_readfirstlane_b32 s26, v12
    s_nop 0
    s_cmp_lt_u32 s26, s27
    s_cbranch_scc1 RDP_161
RDO_160:
    s_lshl_b32 s21, s14, 7
    s_add_u32 s21, s21, 76546048
    s_branch EXL0_163
EXL_162:
    s_sleep 4
EXL0_163:
    buffer_load_dwordx4 v[16:19], v4, s[8:11], s21 offen offset:0 sc1
    buffer_load_dwordx4 v[20:23], v4, s[8:11], s21 offen offset:2048 sc1
    buffer_load_dwordx4 v[24:27], v5, s[8:11], s21 offen offset:0 sc1
    buffer_load_dwordx4 v[28:31], v5, s[8:11], s21 offen offset:2048 sc1
    buffer_load_dwordx4 v[32:35], v6, s[8:11], s21 offen offset:0 sc1
    buffer_load_dwordx4 v[36:39], v6, s[8:11], s21 offen offset:2048 sc1
    buffer_load_dwordx4 v[40:43], v7, s[8:11], s21 offen offset:0 sc1
    s_add_u32 s22, s22, 1
    s_cmp_gt_u32 s22, 2000000
    s_cbranch_scc1 MEGA_EXIT
    s_waitcnt vmcnt(0)
    v_max3_u32 v12, v16, v17, v18
    v_max3_u32 v12, v12, v19, v20
    v_max3_u32 v12, v12, v21, v22
    v_max3_u32 v12, v12, v23, v24
    v_max3_u32 v12, v12, v25, v26
    v_max3_u32 v12, v12, v27, v28
    v_max3_u32 v12, v12, v29, v30
    v_max3_u32 v12, v12, v31, v32
    v_max3_u32 v12, v12, v33, v34
    v_max3_u32 v12, v12, v35, v36
    v_max3_u32 v12, v12, v37, v38
    v_max3_u32 v12, v12, v39, v40
    v_max3_u32 v12, v12, v41, v42
    v_max_u32 v12, v12, v43
    v_cmp_eq_u32 vcc, -1, v12
    s_cbranch_vccnz EXL_162
    s_add_u32 s20, s21, 38797312
    buffer_store_dwordx4 v[16:19], v4, s[8:11], s20 offen offset:0 sc1
    buffer_store_dwordx4 v[20:23], v4, s[8:11], s20 offen offset:2048 sc1
    buffer_store_dwordx4 v[24:27], v5, s[8:11], s20 offen offset:0 sc1
    buffer_store_dwordx4 v[28:31], v5, s[8:11], s20 offen offset:2048 sc1
    buffer_store_dwordx4 v[32:35], v6, s[8:11], s20 offen offset:0 sc1
    buffer_store_dwordx4 v[36:39], v6, s[8:11], s20 offen offset:2048 sc1
    buffer_store_dwordx4 v[40:43], v7, s[8:11], s20 offen offset:0 sc1
    s_add_u32 s18, s14, 1
    v_mov_b32 v13, s18
    s_bitcmp1_b32 s14, 0
    s_cbranch_scc1 EXO_164
    s_waitcnt vmcnt(0)
    ds_write_b32 v8, v13
    s_branch EXN_165
EXO_164:
    ds_read_b32 v14, v8
    s_add_u32 s22, s22, 1
    s_cmp_gt_u32 s22, 2000000
    s_cbranch_scc1 MEGA_EXIT
    s_waitcnt lgkmcnt(0)
    v_cmp_gt_u32 vcc, s14, v14
    s_cbranch_vccnz EXO_164
    s_and_b32 s18, s14, 2
    s_lshl_b32 s18, s18, 6
    s_add_u32 s18, s18, 116391936
    v_lshlrev_b32 v14, 8, v1
    s_waitcnt vmcnt(0)
    s_mov_b64 exec, 0xff
    buffer_store_dword v13, v14, s[8:11], s18 offen sc1
    s_mov_b64 exec, -1
EXN_165:
    s_mov_b32 s22, 0
    s_add_u32 s21, s21, 14336
    s_add_u32 s14, s14, 2
    s_cmp_lt_u32 s14, 62
    s_cbranch_scc1 EXL_162
    s_branch MEGA_EXIT
WORKER:
    s_sub_u32 s12, s12, 32
    v_and_b32 v1, 63, v0
    v_lshlrev_b32 v2, 4, v1
    v_and_b32 v3, 15, v1
    v_lshrrev_b32 v4, 4, v1
    s_load_dwordx2 s[44:45], s[0:1], 24
    s_mov_b32 s46, 3670016
    s_mov_b32 s47, 0x20000
    s_load_dwordx2 s[48:49], s[0:1], 16
    s_mov_b32 s50, 3670016
    s_mov_b32 s51, 0x20000
    s_load_dwordx2 s[52:53], s[0:1], 32
    s_mov_b32 s54, 3670016
    s_mov_b32 s55, 0x20000
    s_load_dwordx2 s[56:57], s[0:1], 40
    s_mov_b32 s58, 3670016
    s_mov_b32 s59, 0x20000
    s_mul_i32 s16, s12, 4682
    s_lshr_b32 s16, s16, 16
    s_mul_i32 s14, s16, 14
    s_sub_u32 s14, s12, s14
    s_lshr_b32 s15, s14, 1
    s_and_b32 s31, s14, 1
    s_lshl_b32 s23, s13, 1
    s_min_u32 s23, s23, 5
    s_mul_i32 s24, s31, 7
    s_add_u32 s23, s23, s24
    v_lshrrev_b32 v5, 5, v1
    v_and_b32 v6, 31, v1
    v_lshlrev_b32 v6, 4, v6
    v_lshlrev_b32 v7, 6, v5
    v_xor_b32 v6, v6, v7
    v_lshl_add_u32 v6, v5, 13, v6
    v_xor_b32 v7, 128, v6
    v_lshrrev_b32 v9, 3, v1
    v_mul_u32_u24 v8, 896, v9
    v_bfe_u32 v9, v1, 4, 1
    v_lshlrev_b32 v9, 2, v9
    v_xor_b32 v9, v9, v1
    v_and_b32 v9, 7, v9
    v_lshl_add_u32 v8, v9, 4, v8
    s_lshl_b32 s17, s16, 9
    s_lshl_b32 s18, s23, 18
    s_add_u32 s18, s18, s17
    s_lshl_b32 s19, s15, 19
    s_lshl_b32 s20, s13, 17
    s_add_u32 s19, s19, s20
    s_add_u32 s19, s19, s17
    s_mul_i32 s20, s16, 229376
    s_lshl_b32 s24, s15, 7
    s_add_u32 s33, s20, s24
    s_mul_i32 s24, s13, 57344
    s_add_u32 s20, s33, s24
    s_lshl_b32 s21, s13, 15
    s_lshl_b32 s22, s13, 13
    s_add_u32 s22, s22, 131072
    v_lshrrev_b32 v9, 2, v1
    v_lshlrev_b32 v9, 13, v9
    v_and_b32 v10, 3, v1
    v_lshl_add_u32 v9, v10, 7, v9
    v_mul_u32_u24 v10, 896, v1
    s_mul_i32 s30, s31, 14
    s_lshl_b32 s24, s15, 1
    s_add_u32 s30, s30, s24
    s_add_u32 s30, s30, s13
    s_lshl_b32 s30, s30, 17
    s_add_u32 s30, s30, s17
    s_lshl_b32 s24, s31, 1
    s_add_u32 s24, s24, s13
    s_sub_u32 s24, s24, 2
    s_lshl_b32 s32, s15, 2
    s_add_u32 s32, s32, s24
    s_lshl_b32 s32, s32, 17
    s_add_u32 s32, s32, s17
    s_mul_i32 s24, s24, 57344
    s_add_u32 s33, s33, s24
    s_waitcnt lgkmcnt(0)
    s_cmp_ge_u32 s13, 2
    s_cbranch_scc1 P0T_166
    buffer_load_dword v11, v9, s[52:55], s30 offen
    s_branch P0U_167
P0T_166:
    buffer_load_dword v11, v10, s[56:59], s33 offen
P0U_167:
    s_add_u32 m0, s22, 0
    s_add_u32 s24, s20, 0
    buffer_load_dwordx4 v8, s[56:59], s24 offen lds
    s_add_u32 m0, s22, 1024
    s_add_u32 s24, s20, 7168
    buffer_load_dwordx4 v8, s[56:59], s24 offen lds
    s_add_u32 m0, s22, 2048
    s_add_u32 s24, s20, 14336
    buffer_load_dwordx4 v8, s[56:59], s24 offen lds
    s_add_u32 m0, s22, 3072
    s_add_u32 s24, s20, 21504
    buffer_load_dwordx4 v8, s[56:59], s24 offen lds
    s_add_u32 m0, s22, 4096
    s_add_u32 s24, s20, 28672
    buffer_load_dwordx4 v8, s[56:59], s24 offen lds
    s_add_u32 m0, s22, 5120
    s_add_u32 s24, s20, 35840
    buffer_load_dwordx4 v8, s[56:59], s24 offen lds
    s_add_u32 m0, s22, 6144
    s_add_u32 s24, s20, 43008
    buffer_load_dwordx4 v8, s[56:59], s24 offen lds
    s_add_u32 m0, s22, 7168
    s_add_u32 s24, s20, 50176
    buffer_load_dwordx4 v8, s[56:59], s24 offen lds
    s_add_u32 m0, s21, 0
    s_add_u32 s24, s18, 0
    buffer_load_dwordx4 v6, s[52:55], s24 offen lds
    s_add_u32 m0, s21, 1024
    s_add_u32 s24, s18, 16384
    buffer_load_dwordx4 v7, s[52:55], s24 offen lds
    s_add_u32 m0, s21, 2048
    s_add_u32 s24, s18, 32768
    buffer_load_dwordx4 v6, s[52:55], s24 offen lds
    s_add_u32 m0, s21, 3072
    s_add_u32 s24, s18, 49152
    buffer_load_dwordx4 v7, s[52:55], s24 offen lds
    s_add_u32 m0, s21, 4096
    s_add_u32 s24, s18, 65536
    buffer_load_dwordx4 v6, s[52:55], s24 offen lds
    s_add_u32 m0, s21, 5120
    s_add_u32 s24, s18, 81920
    buffer_load_dwordx4 v7, s[52:55], s24 offen lds
    s_add_u32 m0, s21, 6144
    s_add_u32 s24, s18, 98304
    buffer_load_dwordx4 v6, s[52:55], s24 offen lds
    s_add_u32 m0, s21, 7168
    s_add_u32 s24, s18, 114688
    buffer_load_dwordx4 v7, s[52:55], s24 offen lds
    s_add_u32 m0, s21, 8192
    s_add_u32 s24, s18, 131072
    buffer_load_dwordx4 v6, s[52:55], s24 offen lds
    s_add_u32 m0, s21, 9216
    s_add_u32 s24, s18, 147456
    buffer_load_dwordx4 v7, s[52:55], s24 offen lds
    s_add_u32 m0, s21, 10240
    s_add_u32 s24, s18, 163840
    buffer_load_dwordx4 v6, s[52:55], s24 offen lds
    s_add_u32 m0, s21, 11264
    s_add_u32 s24, s18, 180224
    buffer_load_dwordx4 v7, s[52:55], s24 offen lds
    s_add_u32 m0, s21, 12288
    s_add_u32 s24, s18, 196608
    buffer_load_dwordx4 v6, s[52:55], s24 offen lds
    s_add_u32 m0, s21, 13312
    s_add_u32 s24, s18, 212992
    buffer_load_dwordx4 v7, s[52:55], s24 offen lds
    s_add_u32 m0, s21, 14336
    s_add_u32 s24, s18, 229376
    buffer_load_dwordx4 v6, s[52:55], s24 offen lds
    s_add_u32 m0, s21, 15360
    s_add_u32 s24, s18, 245760
    buffer_load_dwordx4 v7, s[52:55], s24 offen lds
    v_lshrrev_b32 v5, 2, v3
    v_lshlrev_b32 v5, 12, v5
    v_and_b32 v12, 3, v3
    v_lshl_add_u32 v5, v12, 9, v5
    v_lshl_add_u32 v5, v12, 6, v5
    v_lshl_add_u32 v5, v4, 4, v5
    v_lshrrev_b32 v161, 2, v3
    v_lshlrev_b32 v160, 7, v161
    v_lshl_add_u32 v160, v4, 10, v160
    v_bfe_u32 v161, v3, 3, 1
    v_lshl_add_u32 v160, v161, 6, v160
    v_and_b32 v161, 3, v3
    v_lshl_add_u32 v160, v161, 3, v160
    v_add_u32 v160, 131072, v160
    v_xor_b32 v161, 64, v160
    v_xor_b32 v12, 0, v5
    v_add_u32 v164, 131072, v12
    v_add_u32 v12, s21, v12
    v_xor_b32 v13, 64, v5
    v_add_u32 v165, 131072, v13
    v_add_u32 v13, s21, v13
    v_xor_b32 v14, 128, v5
    v_add_u32 v166, 131072, v14
    v_add_u32 v14, s21, v14
    v_xor_b32 v15, 192, v5
    v_add_u32 v167, 131072, v15
    v_add_u32 v15, s21, v15
    s_waitcnt vmcnt(16)
    s_barrier
    ds_read_b64_tr_b16 a[0:1], v160 offset:0
    ds_read_b64_tr_b16 a[2:3], v160 offset:512
    ds_read_b64_tr_b16 a[4:5], v160 offset:32
    ds_read_b64_tr_b16 a[6:7], v160 offset:544
    s_add_u32 m0, s21, 16384
    s_add_u32 s24, s18, 262144
    buffer_load_dwordx4 v6, s[52:55], s24 offen lds
    ds_read_b64_tr_b16 a[8:9], v161 offset:0
    ds_read_b64_tr_b16 a[10:11], v161 offset:512
    ds_read_b64_tr_b16 a[12:13], v161 offset:32
    ds_read_b64_tr_b16 a[14:15], v161 offset:544
    s_add_u32 m0, s21, 17408
    s_add_u32 s24, s18, 278528
    buffer_load_dwordx4 v7, s[52:55], s24 offen lds
    ds_read_b64_tr_b16 a[16:17], v160 offset:4096
    ds_read_b64_tr_b16 a[18:19], v160 offset:4608
    ds_read_b64_tr_b16 a[20:21], v160 offset:4128
    ds_read_b64_tr_b16 a[22:23], v160 offset:4640
    s_add_u32 m0, s21, 18432
    s_add_u32 s24, s18, 294912
    buffer_load_dwordx4 v6, s[52:55], s24 offen lds
    ds_read_b64_tr_b16 a[24:25], v161 offset:4096
    ds_read_b64_tr_b16 a[26:27], v161 offset:4608
    ds_read_b64_tr_b16 a[28:29], v161 offset:4128
    ds_read_b64_tr_b16 a[30:31], v161 offset:4640
    s_add_u32 m0, s21, 19456
    s_add_u32 s24, s18, 311296
    buffer_load_dwordx4 v7, s[52:55], s24 offen lds
    ds_read_b64_tr_b16 a[32:33], v160 offset:8192
    ds_read_b64_tr_b16 a[34:35], v160 offset:8704
    ds_read_b64_tr_b16 a[36:37], v160 offset:8224
    ds_read_b64_tr_b16 a[38:39], v160 offset:8736
    s_add_u32 m0, s21, 20480
    s_add_u32 s24, s18, 327680
    buffer_load_dwordx4 v6, s[52:55], s24 offen lds
    ds_read_b64_tr_b16 a[40:41], v161 offset:8192
    ds_read_b64_tr_b16 a[42:43], v161 offset:8704
    ds_read_b64_tr_b16 a[44:45], v161 offset:8224
    ds_read_b64_tr_b16 a[46:47], v161 offset:8736
    s_add_u32 m0, s21, 21504
    s_add_u32 s24, s18, 344064
    buffer_load_dwordx4 v7, s[52:55], s24 offen lds
    ds_read_b64_tr_b16 a[48:49], v160 offset:12288
    ds_read_b64_tr_b16 a[50:51], v160 offset:12800
    ds_read_b64_tr_b16 a[52:53], v160 offset:12320
    ds_read_b64_tr_b16 a[54:55], v160 offset:12832
    s_add_u32 m0, s21, 22528
    s_add_u32 s24, s18, 360448
    buffer_load_dwordx4 v6, s[52:55], s24 offen lds
    ds_read_b64_tr_b16 a[56:57], v161 offset:12288
    ds_read_b64_tr_b16 a[58:59], v161 offset:12800
    ds_read_b64_tr_b16 a[60:61], v161 offset:12320
    ds_read_b64_tr_b16 a[62:63], v161 offset:12832
    s_add_u32 m0, s21, 23552
    s_add_u32 s24, s18, 376832
    buffer_load_dwordx4 v7, s[52:55], s24 offen lds
    ds_read_b64_tr_b16 a[64:65], v160 offset:16384
    ds_read_b64_tr_b16 a[66:67], v160 offset:16896
    ds_read_b64_tr_b16 a[68:69], v160 offset:16416
    ds_read_b64_tr_b16 a[70:71], v160 offset:16928
    s_add_u32 m0, s21, 24576
    s_add_u32 s24, s18, 393216
    buffer_load_dwordx4 v6, s[52:55], s24 offen lds
    ds_read_b64_tr_b16 a[72:73], v161 offset:16384
    ds_read_b64_tr_b16 a[74:75], v161 offset:16896
    ds_read_b64_tr_b16 a[76:77], v161 offset:16416
    ds_read_b64_tr_b16 a[78:79], v161 offset:16928
    s_add_u32 m0, s21, 25600
    s_add_u32 s24, s18, 409600
    buffer_load_dwordx4 v7, s[52:55], s24 offen lds
    ds_read_b64_tr_b16 a[80:81], v160 offset:20480
    ds_read_b64_tr_b16 a[82:83], v160 offset:20992
    ds_read_b64_tr_b16 a[84:85], v160 offset:20512
    ds_read_b64_tr_b16 a[86:87], v160 offset:21024
    s_add_u32 m0, s21, 26624
    s_add_u32 s24, s18, 425984
    buffer_load_dwordx4 v6, s[52:55], s24 offen lds
    ds_read_b64_tr_b16 a[88:89], v161 offset:20480
    ds_read_b64_tr_b16 a[90:91], v161 offset:20992
    ds_read_b64_tr_b16 a[92:93], v161 offset:20512
    ds_read_b64_tr_b16 a[94:95], v161 offset:21024
    s_add_u32 m0, s21, 27648
    s_add_u32 s24, s18, 442368
    buffer_load_dwordx4 v7, s[52:55], s24 offen lds
    ds_read_b64_tr_b16 a[96:97], v160 offset:24576
    ds_read_b64_tr_b16 a[98:99], v160 offset:25088
    ds_read_b64_tr_b16 a[100:101], v160 offset:24608
    ds_read_b64_tr_b16 a[102:103], v160 offset:25120
    s_add_u32 m0, s21, 28672
    s_add_u32 s24, s18, 458752
    buffer_load_dwordx4 v6, s[52:55], s24 offen lds
    ds_read_b64_tr_b16 a[104:105], v161 offset:24576
    ds_read_b64_tr_b16 a[106:107], v161 offset:25088
    ds_read_b64_tr_b16 a[108:109], v161 offset:24608
    ds_read_b64_tr_b16 a[110:111], v161 offset:25120
    s_add_u32 m0, s21, 29696
    s_add_u32 s24, s18, 475136
    buffer_load_dwordx4 v7, s[52:55], s24 offen lds
    ds_read_b64_tr_b16 a[112:113], v160 offset:28672
    ds_read_b64_tr_b16 a[114:115], v160 offset:29184
    ds_read_b64_tr_b16 a[116:117], v160 offset:28704
    ds_read_b64_tr_b16 a[118:119], v160 offset:29216
    s_add_u32 m0, s21, 30720
    s_add_u32 s24, s18, 491520
    buffer_load_dwordx4 v6, s[52:55], s24 offen lds
    ds_read_b64_tr_b16 a[120:121], v161 offset:28672
    ds_read_b64_tr_b16 a[122:123], v161 offset:29184
    ds_read_b64_tr_b16 a[124:125], v161 offset:28704
    ds_read_b64_tr_b16 a[126:127], v161 offset:29216
    s_add_u32 m0, s21, 31744
    s_add_u32 s24, s18, 507904
    buffer_load_dwordx4 v7, s[52:55], s24 offen lds
    s_cmp_ge_u32 s13, 2
    s_cbranch_scc1 P0T_168
    buffer_load_dword v11, v9, s[44:47], s30 offen
    s_branch P0U_169
P0T_168:
    buffer_load_dword v11, v9, s[48:51], s32 offen
P0U_169:
    s_mul_i32 s29, s16, 401408
    s_mul_i32 s25, s15, 57344
    s_add_u32 s29, s29, s25
    s_lshl_b32 s25, s23, 10
    s_add_u32 s29, s29, s25
    s_mov_b32 s26, 1035512379
    s_waitcnt vmcnt(17)
    ds_read_b128 v[16:19], v12 offset:0
    ds_read_b128 v[20:23], v12 offset:2048
    ds_read_b128 v[24:27], v13 offset:0
    ds_read_b128 v[28:31], v13 offset:2048
    ds_read_b128 v[32:35], v14 offset:0
    ds_read_b128 v[36:39], v14 offset:2048
    ds_read_b128 v[40:43], v15 offset:0
    ds_read_b128 v[44:47], v15 offset:2048
    ds_read_b128 v[48:51], v12 offset:256
    ds_read_b128 v[52:55], v12 offset:2304
    ds_read_b128 v[56:59], v13 offset:256
    ds_read_b128 v[60:63], v13 offset:2304
    ds_read_b128 v[64:67], v14 offset:256
    ds_read_b128 v[68:71], v14 offset:2304
    ds_read_b128 v[72:75], v15 offset:256
    ds_read_b128 v[76:79], v15 offset:2304
    s_waitcnt lgkmcnt(12)
    v_mfma_f32_16x16x32_bf16 v[80:83], v[16:19], a[0:3], 0
    v_mfma_f32_16x16x32_bf16 v[84:87], v[16:19], a[4:7], 0
    v_mfma_f32_16x16x32_bf16 v[88:91], v[16:19], a[8:11], 0
    v_mfma_f32_16x16x32_bf16 v[92:95], v[16:19], a[12:15], 0
    v_mfma_f32_16x16x32_bf16 v[96:99], v[20:23], a[0:3], 0
    v_mfma_f32_16x16x32_bf16 v[100:103], v[20:23], a[4:7], 0
    v_mfma_f32_16x16x32_bf16 v[104:107], v[20:23], a[8:11], 0
    v_mfma_f32_16x16x32_bf16 v[108:111], v[20:23], a[12:15], 0
    s_waitcnt lgkmcnt(8)
    v_mfma_f32_16x16x32_bf16 v[80:83], v[24:27], a[16:19], v[80:83]
    v_mfma_f32_16x16x32_bf16 v[84:87], v[24:27], a[20:23], v[84:87]
    v_mfma_f32_16x16x32_bf16 v[88:91], v[24:27], a[24:27], v[88:91]
    v_mfma_f32_16x16x32_bf16 v[92:95], v[24:27], a[28:31], v[92:95]
    v_mfma_f32_16x16x32_bf16 v[96:99], v[28:31], a[16:19], v[96:99]
    v_mfma_f32_16x16x32_bf16 v[100:103], v[28:31], a[20:23], v[100:103]
    v_mfma_f32_16x16x32_bf16 v[104:107], v[28:31], a[24:27], v[104:107]
    v_mfma_f32_16x16x32_bf16 v[108:111], v[28:31], a[28:31], v[108:111]
    s_waitcnt lgkmcnt(4)
    v_mfma_f32_16x16x32_bf16 v[80:83], v[32:35], a[32:35], v[80:83]
    v_mfma_f32_16x16x32_bf16 v[84:87], v[32:35], a[36:39], v[84:87]
    v_mfma_f32_16x16x32_bf16 v[88:91], v[32:35], a[40:43], v[88:91]
    v_mfma_f32_16x16x32_bf16 v[92:95], v[32:35], a[44:47], v[92:95]
    v_mfma_f32_16x16x32_bf16 v[96:99], v[36:39], a[32:35], v[96:99]
    v_mfma_f32_16x16x32_bf16 v[100:103], v[36:39], a[36:39], v[100:103]
    v_mfma_f32_16x16x32_bf16 v[104:107], v[36:39], a[40:43], v[104:107]
    v_mfma_f32_16x16x32_bf16 v[108:111], v[36:39], a[44:47], v[108:111]
    s_waitcnt lgkmcnt(0)
    v_mfma_f32_16x16x32_bf16 v[80:83], v[40:43], a[48:51], v[80:83]
    v_mfma_f32_16x16x32_bf16 v[84:87], v[40:43], a[52:55], v[84:87]
    v_mfma_f32_16x16x32_bf16 v[88:91], v[40:43], a[56:59], v[88:91]
    v_mfma_f32_16x16x32_bf16 v[92:95], v[40:43], a[60:63], v[92:95]
    v_mfma_f32_16x16x32_bf16 v[96:99], v[44:47], a[48:51], v[96:99]
    v_mfma_f32_16x16x32_bf16 v[100:103], v[44:47], a[52:55], v[100:103]
    v_mfma_f32_16x16x32_bf16 v[104:107], v[44:47], a[56:59], v[104:107]
    v_mfma_f32_16x16x32_bf16 v[108:111], v[44:47], a[60:63], v[108:111]
    v_mfma_f32_16x16x32_bf16 v[80:83], v[48:51], a[64:67], v[80:83]
    v_mfma_f32_16x16x32_bf16 v[84:87], v[48:51], a[68:71], v[84:87]
    v_mfma_f32_16x16x32_bf16 v[88:91], v[48:51], a[72:75], v[88:91]
    v_mfma_f32_16x16x32_bf16 v[92:95], v[48:51], a[76:79], v[92:95]
    v_mfma_f32_16x16x32_bf16 v[96:99], v[52:55], a[64:67], v[96:99]
    v_mfma_f32_16x16x32_bf16 v[100:103], v[52:55], a[68:71], v[100:103]
    v_mfma_f32_16x16x32_bf16 v[104:107], v[52:55], a[72:75], v[104:107]
    v_mfma_f32_16x16x32_bf16 v[108:111], v[52:55], a[76:79], v[108:111]
    v_mfma_f32_16x16x32_bf16 v[80:83], v[56:59], a[80:83], v[80:83]
    v_mfma_f32_16x16x32_bf16 v[84:87], v[56:59], a[84:87], v[84:87]
    v_mfma_f32_16x16x32_bf16 v[88:91], v[56:59], a[88:91], v[88:91]
    v_mfma_f32_16x16x32_bf16 v[92:95], v[56:59], a[92:95], v[92:95]
    v_mfma_f32_16x16x32_bf16 v[96:99], v[60:63], a[80:83], v[96:99]
    v_mfma_f32_16x16x32_bf16 v[100:103], v[60:63], a[84:87], v[100:103]
    v_mfma_f32_16x16x32_bf16 v[104:107], v[60:63], a[88:91], v[104:107]
    v_mfma_f32_16x16x32_bf16 v[108:111], v[60:63], a[92:95], v[108:111]
    v_mfma_f32_16x16x32_bf16 v[80:83], v[64:67], a[96:99], v[80:83]
    v_mfma_f32_16x16x32_bf16 v[84:87], v[64:67], a[100:103], v[84:87]
    v_mfma_f32_16x16x32_bf16 v[88:91], v[64:67], a[104:107], v[88:91]
    v_mfma_f32_16x16x32_bf16 v[92:95], v[64:67], a[108:111], v[92:95]
    v_mfma_f32_16x16x32_bf16 v[96:99], v[68:71], a[96:99], v[96:99]
    v_mfma_f32_16x16x32_bf16 v[100:103], v[68:71], a[100:103], v[100:103]
    v_mfma_f32_16x16x32_bf16 v[104:107], v[68:71], a[104:107], v[104:107]
    v_mfma_f32_16x16x32_bf16 v[108:111], v[68:71], a[108:111], v[108:111]
    v_mfma_f32_16x16x32_bf16 v[80:83], v[72:75], a[112:115], v[80:83]
    v_mfma_f32_16x16x32_bf16 v[84:87], v[72:75], a[116:119], v[84:87]
    v_mfma_f32_16x16x32_bf16 v[88:91], v[72:75], a[120:123], v[88:91]
    v_mfma_f32_16x16x32_bf16 v[92:95], v[72:75], a[124:127], v[92:95]
    v_mfma_f32_16x16x32_bf16 v[96:99], v[76:79], a[112:115], v[96:99]
    v_mfma_f32_16x16x32_bf16 v[100:103], v[76:79], a[116:119], v[100:103]
    v_mfma_f32_16x16x32_bf16 v[104:107], v[76:79], a[120:123], v[104:107]
    v_mfma_f32_16x16x32_bf16 v[108:111], v[76:79], a[124:127], v[108:111]
    s_waitcnt vmcnt(1)
    ds_read_b128 v[16:19], v12 offset:16384
    ds_read_b128 v[20:23], v12 offset:18432
    ds_read_b128 v[24:27], v13 offset:16384
    ds_read_b128 v[28:31], v13 offset:18432
    ds_read_b128 v[32:35], v14 offset:16384
    ds_read_b128 v[36:39], v14 offset:18432
    ds_read_b128 v[40:43], v15 offset:16384
    ds_read_b128 v[44:47], v15 offset:18432
    ds_read_b128 v[48:51], v12 offset:16640
    ds_read_b128 v[52:55], v12 offset:18688
    ds_read_b128 v[56:59], v13 offset:16640
    ds_read_b128 v[60:63], v13 offset:18688
    ds_read_b128 v[64:67], v14 offset:16640
    ds_read_b128 v[68:71], v14 offset:18688
    ds_read_b128 v[72:75], v15 offset:16640
    ds_read_b128 v[76:79], v15 offset:18688
    s_waitcnt lgkmcnt(12)
    v_mfma_f32_16x16x32_bf16 v[112:115], v[16:19], a[0:3], 0
    v_cvt_pk_bf16_f32 v144, v80, v81
    v_cvt_pk_bf16_f32 v145, v82, v83
    v_mfma_f32_16x16x32_bf16 v[116:119], v[16:19], a[4:7], 0
    v_cvt_pk_bf16_f32 v146, v96, v97
    v_cvt_pk_bf16_f32 v147, v98, v99
    v_mfma_f32_16x16x32_bf16 v[120:123], v[16:19], a[8:11], 0
    s_add_u32 s27, s29, 6422528
    buffer_store_dwordx4 v[144:147], v2, s[8:11], s27 offen offset:0 sc1
    v_cvt_pk_bf16_f32 v148, v84, v85
    v_mfma_f32_16x16x32_bf16 v[124:127], v[16:19], a[12:15], 0
    v_cvt_pk_bf16_f32 v149, v86, v87
    v_cvt_pk_bf16_f32 v150, v100, v101
    v_mfma_f32_16x16x32_bf16 v[128:131], v[20:23], a[0:3], 0
    v_cvt_pk_bf16_f32 v151, v102, v103
    s_add_u32 s27, s29, 6436864
    buffer_store_dwordx4 v[148:151], v2, s[8:11], s27 offen offset:0 sc1
    v_mfma_f32_16x16x32_bf16 v[132:135], v[20:23], a[4:7], 0
    v_cvt_pk_bf16_f32 v152, v88, v89
    v_cvt_pk_bf16_f32 v153, v90, v91
    v_mfma_f32_16x16x32_bf16 v[136:139], v[20:23], a[8:11], 0
    v_cvt_pk_bf16_f32 v154, v104, v105
    v_cvt_pk_bf16_f32 v155, v106, v107
    v_mfma_f32_16x16x32_bf16 v[140:143], v[20:23], a[12:15], 0
    s_add_u32 s27, s29, 6451200
    buffer_store_dwordx4 v[152:155], v2, s[8:11], s27 offen offset:0 sc1
    v_cvt_pk_bf16_f32 v156, v92, v93
    s_waitcnt lgkmcnt(8)
    v_mfma_f32_16x16x32_bf16 v[112:115], v[24:27], a[16:19], v[112:115]
    v_cvt_pk_bf16_f32 v157, v94, v95
    v_cvt_pk_bf16_f32 v158, v108, v109
    v_mfma_f32_16x16x32_bf16 v[116:119], v[24:27], a[20:23], v[116:119]
    v_cvt_pk_bf16_f32 v159, v110, v111
    s_add_u32 s27, s29, 6465536
    buffer_store_dwordx4 v[156:159], v2, s[8:11], s27 offen offset:0 sc1
    v_mfma_f32_16x16x32_bf16 v[120:123], v[24:27], a[24:27], v[120:123]
    v_mfma_f32_16x16x32_bf16 v[124:127], v[24:27], a[28:31], v[124:127]
    v_mfma_f32_16x16x32_bf16 v[128:131], v[28:31], a[16:19], v[128:131]
    v_mfma_f32_16x16x32_bf16 v[132:135], v[28:31], a[20:23], v[132:135]
    v_mfma_f32_16x16x32_bf16 v[136:139], v[28:31], a[24:27], v[136:139]
    v_mfma_f32_16x16x32_bf16 v[140:143], v[28:31], a[28:31], v[140:143]
    s_waitcnt lgkmcnt(4)
    v_mfma_f32_16x16x32_bf16 v[112:115], v[32:35], a[32:35], v[112:115]
    v_mfma_f32_16x16x32_bf16 v[116:119], v[32:35], a[36:39], v[116:119]
    v_mfma_f32_16x16x32_bf16 v[120:123], v[32:35], a[40:43], v[120:123]
    v_mfma_f32_16x16x32_bf16 v[124:127], v[32:35], a[44:47], v[124:127]
    v_mfma_f32_16x16x32_bf16 v[128:131], v[36:39], a[32:35], v[128:131]
    v_mfma_f32_16x16x32_bf16 v[132:135], v[36:39], a[36:39], v[132:135]
    v_mfma_f32_16x16x32_bf16 v[136:139], v[36:39], a[40:43], v[136:139]
    v_mfma_f32_16x16x32_bf16 v[140:143], v[36:39], a[44:47], v[140:143]
    s_waitcnt lgkmcnt(0)
    v_mfma_f32_16x16x32_bf16 v[112:115], v[40:43], a[48:51], v[112:115]
    v_mfma_f32_16x16x32_bf16 v[116:119], v[40:43], a[52:55], v[116:119]
    v_mfma_f32_16x16x32_bf16 v[120:123], v[40:43], a[56:59], v[120:123]
    v_mfma_f32_16x16x32_bf16 v[124:127], v[40:43], a[60:63], v[124:127]
    v_mfma_f32_16x16x32_bf16 v[128:131], v[44:47], a[48:51], v[128:131]
    v_mfma_f32_16x16x32_bf16 v[132:135], v[44:47], a[52:55], v[132:135]
    v_mfma_f32_16x16x32_bf16 v[136:139], v[44:47], a[56:59], v[136:139]
    v_mfma_f32_16x16x32_bf16 v[140:143], v[44:47], a[60:63], v[140:143]
    v_mfma_f32_16x16x32_bf16 v[112:115], v[48:51], a[64:67], v[112:115]
    v_mfma_f32_16x16x32_bf16 v[116:119], v[48:51], a[68:71], v[116:119]
    v_mfma_f32_16x16x32_bf16 v[120:123], v[48:51], a[72:75], v[120:123]
    v_mfma_f32_16x16x32_bf16 v[124:127], v[48:51], a[76:79], v[124:127]
    v_mfma_f32_16x16x32_bf16 v[128:131], v[52:55], a[64:67], v[128:131]
    v_mfma_f32_16x16x32_bf16 v[132:135], v[52:55], a[68:71], v[132:135]
    v_mfma_f32_16x16x32_bf16 v[136:139], v[52:55], a[72:75], v[136:139]
    v_mfma_f32_16x16x32_bf16 v[140:143], v[52:55], a[76:79], v[140:143]
    v_mfma_f32_16x16x32_bf16 v[112:115], v[56:59], a[80:83], v[112:115]
    v_mfma_f32_16x16x32_bf16 v[116:119], v[56:59], a[84:87], v[116:119]
    v_mfma_f32_16x16x32_bf16 v[120:123], v[56:59], a[88:91], v[120:123]
    v_mfma_f32_16x16x32_bf16 v[124:127], v[56:59], a[92:95], v[124:127]
    v_mfma_f32_16x16x32_bf16 v[128:131], v[60:63], a[80:83], v[128:131]
    v_mfma_f32_16x16x32_bf16 v[132:135], v[60:63], a[84:87], v[132:135]
    v_mfma_f32_16x16x32_bf16 v[136:139], v[60:63], a[88:91], v[136:139]
    v_mfma_f32_16x16x32_bf16 v[140:143], v[60:63], a[92:95], v[140:143]
    v_mfma_f32_16x16x32_bf16 v[112:115], v[64:67], a[96:99], v[112:115]
    v_mfma_f32_16x16x32_bf16 v[116:119], v[64:67], a[100:103], v[116:119]
    v_mfma_f32_16x16x32_bf16 v[120:123], v[64:67], a[104:107], v[120:123]
    v_mfma_f32_16x16x32_bf16 v[124:127], v[64:67], a[108:111], v[124:127]
    v_mfma_f32_16x16x32_bf16 v[128:131], v[68:71], a[96:99], v[128:131]
    v_mfma_f32_16x16x32_bf16 v[132:135], v[68:71], a[100:103], v[132:135]
    v_mfma_f32_16x16x32_bf16 v[136:139], v[68:71], a[104:107], v[136:139]
    v_mfma_f32_16x16x32_bf16 v[140:143], v[68:71], a[108:111], v[140:143]
    v_mfma_f32_16x16x32_bf16 v[112:115], v[72:75], a[112:115], v[112:115]
    v_mfma_f32_16x16x32_bf16 v[116:119], v[72:75], a[116:119], v[116:119]
    v_mfma_f32_16x16x32_bf16 v[120:123], v[72:75], a[120:123], v[120:123]
    v_mfma_f32_16x16x32_bf16 v[124:127], v[72:75], a[124:127], v[124:127]
    v_mfma_f32_16x16x32_bf16 v[128:131], v[76:79], a[112:115], v[128:131]
    v_mfma_f32_16x16x32_bf16 v[132:135], v[76:79], a[116:119], v[132:135]
    v_mfma_f32_16x16x32_bf16 v[136:139], v[76:79], a[120:123], v[136:139]
    v_mfma_f32_16x16x32_bf16 v[140:143], v[76:79], a[124:127], v[140:143]
    v_cvt_pk_bf16_f32 v144, v112, v113
    v_cvt_pk_bf16_f32 v145, v114, v115
    v_cvt_pk_bf16_f32 v146, v128, v129
    v_cvt_pk_bf16_f32 v147, v130, v131
    s_add_u32 s27, s29, 6422528
    buffer_store_dwordx4 v[144:147], v2, s[8:11], s27 offen offset:1024 sc1
    v_cvt_pk_bf16_f32 v148, v116, v117
    v_cvt_pk_bf16_f32 v149, v118, v119
    v_cvt_pk_bf16_f32 v150, v132, v133
    v_cvt_pk_bf16_f32 v151, v134, v135
    s_add_u32 s27, s29, 6436864
    buffer_store_dwordx4 v[148:151], v2, s[8:11], s27 offen offset:1024 sc1
    v_cvt_pk_bf16_f32 v152, v120, v121
    v_cvt_pk_bf16_f32 v153, v122, v123
    v_cvt_pk_bf16_f32 v154, v136, v137
    v_cvt_pk_bf16_f32 v155, v138, v139
    s_add_u32 s27, s29, 6451200
    buffer_store_dwordx4 v[152:155], v2, s[8:11], s27 offen offset:1024 sc1
    v_cvt_pk_bf16_f32 v156, v124, v125
    v_cvt_pk_bf16_f32 v157, v126, v127
    v_cvt_pk_bf16_f32 v158, v140, v141
    v_cvt_pk_bf16_f32 v159, v142, v143
    s_add_u32 s27, s29, 6465536
    buffer_store_dwordx4 v[156:159], v2, s[8:11], s27 offen offset:1024 sc1
    s_cmp_lg_u32 s13, 0
    s_cbranch_scc1 WIZ_171
    s_mov_b32 s35, 0
WI_170:
    v_mov_b32 v162, 0
    global_load_dword v163, v162, s[4:5] offset:192 sc1
    s_add_u32 s35, s35, 1
    s_cmp_gt_u32 s35, 4000000
    s_cbranch_scc1 MEGA_EXIT
    s_waitcnt vmcnt(0)
    v_readfirstlane_b32 s34, v163
    s_nop 0
    s_cmp_lg_u32 s34, 0
    s_cbranch_scc1 WIZ_171
    s_sleep 8
    s_branch WI_170
WIZ_171:
    s_waitcnt vmcnt(0)
    s_barrier
    s_cmp_lg_u32 s13, 1
    s_cbranch_scc1 PFL_172
    s_lshl_b32 s34, s16, 8
    s_lshl_b32 s24, s14, 4
    s_add_u32 s34, s34, s24
    s_add_u32 s34, s34, 116453376
    v_mov_b64 v[168:169], 1
    v_mov_b32 v169, 1
    v_mov_b64 v[170:171], v[168:169]
    s_mov_b64 exec, 1
    buffer_store_dwordx4 v[168:171], off, s[8:11], s34 sc1
    s_mov_b64 exec, -1
PFL_172:
    s_add_u32 m0, s22, 0
    s_add_u32 s24, s19, 0
    buffer_load_dwordx4 v6, s[48:51], s24 offen lds
    s_add_u32 m0, s22, 1024
    s_add_u32 s24, s19, 16384
    buffer_load_dwordx4 v7, s[48:51], s24 offen lds
    s_add_u32 m0, s22, 2048
    s_add_u32 s24, s19, 32768
    buffer_load_dwordx4 v6, s[48:51], s24 offen lds
    s_add_u32 m0, s22, 3072
    s_add_u32 s24, s19, 49152
    buffer_load_dwordx4 v7, s[48:51], s24 offen lds
    s_add_u32 m0, s22, 4096
    s_add_u32 s24, s19, 65536
    buffer_load_dwordx4 v6, s[48:51], s24 offen lds
    s_add_u32 m0, s22, 5120
    s_add_u32 s24, s19, 81920
    buffer_load_dwordx4 v7, s[48:51], s24 offen lds
    s_add_u32 m0, s22, 6144
    s_add_u32 s24, s19, 98304
    buffer_load_dwordx4 v6, s[48:51], s24 offen lds
    s_add_u32 m0, s22, 7168
    s_add_u32 s24, s19, 114688
    buffer_load_dwordx4 v7, s[48:51], s24 offen lds
    s_add_u32 m0, s21, 0
    s_add_u32 s24, s18, 0
    buffer_load_dwordx4 v6, s[44:47], s24 offen lds
    s_add_u32 m0, s21, 1024
    s_add_u32 s24, s18, 16384
    buffer_load_dwordx4 v7, s[44:47], s24 offen lds
    s_add_u32 m0, s21, 2048
    s_add_u32 s24, s18, 32768
    buffer_load_dwordx4 v6, s[44:47], s24 offen lds
    s_add_u32 m0, s21, 3072
    s_add_u32 s24, s18, 49152
    buffer_load_dwordx4 v7, s[44:47], s24 offen lds
    s_add_u32 m0, s21, 4096
    s_add_u32 s24, s18, 65536
    buffer_load_dwordx4 v6, s[44:47], s24 offen lds
    s_add_u32 m0, s21, 5120
    s_add_u32 s24, s18, 81920
    buffer_load_dwordx4 v7, s[44:47], s24 offen lds
    s_add_u32 m0, s21, 6144
    s_add_u32 s24, s18, 98304
    buffer_load_dwordx4 v6, s[44:47], s24 offen lds
    s_add_u32 m0, s21, 7168
    s_add_u32 s24, s18, 114688
    buffer_load_dwordx4 v7, s[44:47], s24 offen lds
    s_add_u32 m0, s21, 8192
    s_add_u32 s24, s18, 131072
    buffer_load_dwordx4 v6, s[44:47], s24 offen lds
    s_add_u32 m0, s21, 9216
    s_add_u32 s24, s18, 147456
    buffer_load_dwordx4 v7, s[44:47], s24 offen lds
    s_add_u32 m0, s21, 10240
    s_add_u32 s24, s18, 163840
    buffer_load_dwordx4 v6, s[44:47], s24 offen lds
    s_add_u32 m0, s21, 11264
    s_add_u32 s24, s18, 180224
    buffer_load_dwordx4 v7, s[44:47], s24 offen lds
    s_add_u32 m0, s21, 12288
    s_add_u32 s24, s18, 196608
    buffer_load_dwordx4 v6, s[44:47], s24 offen lds
    s_add_u32 m0, s21, 13312
    s_add_u32 s24, s18, 212992
    buffer_load_dwordx4 v7, s[44:47], s24 offen lds
    s_add_u32 m0, s21, 14336
    s_add_u32 s24, s18, 229376
    buffer_load_dwordx4 v6, s[44:47], s24 offen lds
    s_add_u32 m0, s21, 15360
    s_add_u32 s24, s18, 245760
    buffer_load_dwordx4 v7, s[44:47], s24 offen lds
    s_waitcnt vmcnt(16)
    s_barrier
    ds_read_b128 a[128:131], v164 offset:0
    ds_read_b128 a[132:135], v164 offset:2048
    s_add_u32 m0, s21, 16384
    s_add_u32 s24, s18, 262144
    buffer_load_dwordx4 v6, s[44:47], s24 offen lds
    ds_read_b128 a[136:139], v164 offset:16384
    ds_read_b128 a[140:143], v164 offset:18432
    s_add_u32 m0, s21, 17408
    s_add_u32 s24, s18, 278528
    buffer_load_dwordx4 v7, s[44:47], s24 offen lds
    ds_read_b128 a[144:147], v165 offset:0
    ds_read_b128 a[148:151], v165 offset:2048
    s_add_u32 m0, s21, 18432
    s_add_u32 s24, s18, 294912
    buffer_load_dwordx4 v6, s[44:47], s24 offen lds
    ds_read_b128 a[152:155], v165 offset:16384
    ds_read_b128 a[156:159], v165 offset:18432
    s_add_u32 m0, s21, 19456
    s_add_u32 s24, s18, 311296
    buffer_load_dwordx4 v7, s[44:47], s24 offen lds
    ds_read_b128 a[160:163], v166 offset:0
    ds_read_b128 a[164:167], v166 offset:2048
    s_add_u32 m0, s21, 20480
    s_add_u32 s24, s18, 327680
    buffer_load_dwordx4 v6, s[44:47], s24 offen lds
    ds_read_b128 a[168:171], v166 offset:16384
    ds_read_b128 a[172:175], v166 offset:18432
    s_add_u32 m0, s21, 21504
    s_add_u32 s24, s18, 344064
    buffer_load_dwordx4 v7, s[44:47], s24 offen lds
    ds_read_b128 a[176:179], v167 offset:0
    ds_read_b128 a[180:183], v167 offset:2048
    s_add_u32 m0, s21, 22528
    s_add_u32 s24, s18, 360448
    buffer_load_dwordx4 v6, s[44:47], s24 offen lds
    ds_read_b128 a[184:187], v167 offset:16384
    ds_read_b128 a[188:191], v167 offset:18432
    s_add_u32 m0, s21, 23552
    s_add_u32 s24, s18, 376832
    buffer_load_dwordx4 v7, s[44:47], s24 offen lds
    ds_read_b128 a[192:195], v164 offset:256
    ds_read_b128 a[196:199], v164 offset:2304
    s_add_u32 m0, s21, 24576
    s_add_u32 s24, s18, 393216
    buffer_load_dwordx4 v6, s[44:47], s24 offen lds
    ds_read_b128 a[200:203], v164 offset:16640
    ds_read_b128 a[204:207], v164 offset:18688
    s_add_u32 m0, s21, 25600
    s_add_u32 s24, s18, 409600
    buffer_load_dwordx4 v7, s[44:47], s24 offen lds
    ds_read_b128 a[208:211], v165 offset:256
    ds_read_b128 a[212:215], v165 offset:2304
    s_add_u32 m0, s21, 26624
    s_add_u32 s24, s18, 425984
    buffer_load_dwordx4 v6, s[44:47], s24 offen lds
    ds_read_b128 a[216:219], v165 offset:16640
    ds_read_b128 a[220:223], v165 offset:18688
    s_add_u32 m0, s21, 27648
    s_add_u32 s24, s18, 442368
    buffer_load_dwordx4 v7, s[44:47], s24 offen lds
    ds_read_b128 a[224:227], v166 offset:256
    ds_read_b128 a[228:231], v166 offset:2304
    s_add_u32 m0, s21, 28672
    s_add_u32 s24, s18, 458752
    buffer_load_dwordx4 v6, s[44:47], s24 offen lds
    ds_read_b128 a[232:235], v166 offset:16640
    ds_read_b128 a[236:239], v166 offset:18688
    s_add_u32 m0, s21, 29696
    s_add_u32 s24, s18, 475136
    buffer_load_dwordx4 v7, s[44:47], s24 offen lds
    ds_read_b128 a[240:243], v167 offset:256
    ds_read_b128 a[244:247], v167 offset:2304
    s_add_u32 m0, s21, 30720
    s_add_u32 s24, s18, 491520
    buffer_load_dwordx4 v6, s[44:47], s24 offen lds
    ds_read_b128 a[248:251], v167 offset:16640
    ds_read_b128 a[252:255], v167 offset:18688
    s_add_u32 m0, s21, 31744
    s_add_u32 s24, s18, 507904
    buffer_load_dwordx4 v7, s[44:47], s24 offen lds
    s_waitcnt vmcnt(16)
    ds_read_b128 v[16:19], v12 offset:0
    ds_read_b128 v[20:23], v12 offset:2048
    ds_read_b128 v[24:27], v13 offset:0
    ds_read_b128 v[28:31], v13 offset:2048
    ds_read_b128 v[32:35], v14 offset:0
    ds_read_b128 v[36:39], v14 offset:2048
    ds_read_b128 v[40:43], v15 offset:0
    ds_read_b128 v[44:47], v15 offset:2048
    ds_read_b128 v[48:51], v12 offset:256
    ds_read_b128 v[52:55], v12 offset:2304
    ds_read_b128 v[56:59], v13 offset:256
    ds_read_b128 v[60:63], v13 offset:2304
    ds_read_b128 v[64:67], v14 offset:256
    ds_read_b128 v[68:71], v14 offset:2304
    ds_read_b128 v[72:75], v15 offset:256
    ds_read_b128 v[76:79], v15 offset:2304
    s_waitcnt lgkmcnt(12)
    v_mfma_f32_16x16x32_bf16 v[80:83], v[16:19], a[128:131], 0
    v_mfma_f32_16x16x32_bf16 v[84:87], v[16:19], a[132:135], 0
    v_mfma_f32_16x16x32_bf16 v[88:91], v[16:19], a[136:139], 0
    v_mfma_f32_16x16x32_bf16 v[92:95], v[16:19], a[140:143], 0
    v_mfma_f32_16x16x32_bf16 v[96:99], v[20:23], a[128:131], 0
    v_mfma_f32_16x16x32_bf16 v[100:103], v[20:23], a[132:135], 0
    v_mfma_f32_16x16x32_bf16 v[104:107], v[20:23], a[136:139], 0
    v_mfma_f32_16x16x32_bf16 v[108:111], v[20:23], a[140:143], 0
    s_waitcnt lgkmcnt(8)
    v_mfma_f32_16x16x32_bf16 v[80:83], v[24:27], a[144:147], v[80:83]
    v_mfma_f32_16x16x32_bf16 v[84:87], v[24:27], a[148:151], v[84:87]
    v_mfma_f32_16x16x32_bf16 v[88:91], v[24:27], a[152:155], v[88:91]
    v_mfma_f32_16x16x32_bf16 v[92:95], v[24:27], a[156:159], v[92:95]
    v_mfma_f32_16x16x32_bf16 v[96:99], v[28:31], a[144:147], v[96:99]
    v_mfma_f32_16x16x32_bf16 v[100:103], v[28:31], a[148:151], v[100:103]
    v_mfma_f32_16x16x32_bf16 v[104:107], v[28:31], a[152:155], v[104:107]
    v_mfma_f32_16x16x32_bf16 v[108:111], v[28:31], a[156:159], v[108:111]
    s_waitcnt lgkmcnt(4)
    v_mfma_f32_16x16x32_bf16 v[80:83], v[32:35], a[160:163], v[80:83]
    v_mfma_f32_16x16x32_bf16 v[84:87], v[32:35], a[164:167], v[84:87]
    v_mfma_f32_16x16x32_bf16 v[88:91], v[32:35], a[168:171], v[88:91]
    v_mfma_f32_16x16x32_bf16 v[92:95], v[32:35], a[172:175], v[92:95]
    v_mfma_f32_16x16x32_bf16 v[96:99], v[36:39], a[160:163], v[96:99]
    v_mfma_f32_16x16x32_bf16 v[100:103], v[36:39], a[164:167], v[100:103]
    v_mfma_f32_16x16x32_bf16 v[104:107], v[36:39], a[168:171], v[104:107]
    v_mfma_f32_16x16x32_bf16 v[108:111], v[36:39], a[172:175], v[108:111]
    s_waitcnt lgkmcnt(0)
    v_mfma_f32_16x16x32_bf16 v[80:83], v[40:43], a[176:179], v[80:83]
    v_mfma_f32_16x16x32_bf16 v[84:87], v[40:43], a[180:183], v[84:87]
    v_mfma_f32_16x16x32_bf16 v[88:91], v[40:43], a[184:187], v[88:91]
    v_mfma_f32_16x16x32_bf16 v[92:95], v[40:43], a[188:191], v[92:95]
    v_mfma_f32_16x16x32_bf16 v[96:99], v[44:47], a[176:179], v[96:99]
    v_mfma_f32_16x16x32_bf16 v[100:103], v[44:47], a[180:183], v[100:103]
    v_mfma_f32_16x16x32_bf16 v[104:107], v[44:47], a[184:187], v[104:107]
    v_mfma_f32_16x16x32_bf16 v[108:111], v[44:47], a[188:191], v[108:111]
    v_mfma_f32_16x16x32_bf16 v[80:83], v[48:51], a[192:195], v[80:83]
    v_mfma_f32_16x16x32_bf16 v[84:87], v[48:51], a[196:199], v[84:87]
    v_mfma_f32_16x16x32_bf16 v[88:91], v[48:51], a[200:203], v[88:91]
    v_mfma_f32_16x16x32_bf16 v[92:95], v[48:51], a[204:207], v[92:95]
    v_mfma_f32_16x16x32_bf16 v[96:99], v[52:55], a[192:195], v[96:99]
    v_mfma_f32_16x16x32_bf16 v[100:103], v[52:55], a[196:199], v[100:103]
    v_mfma_f32_16x16x32_bf16 v[104:107], v[52:55], a[200:203], v[104:107]
    v_mfma_f32_16x16x32_bf16 v[108:111], v[52:55], a[204:207], v[108:111]
    v_mfma_f32_16x16x32_bf16 v[80:83], v[56:59], a[208:211], v[80:83]
    v_mfma_f32_16x16x32_bf16 v[84:87], v[56:59], a[212:215], v[84:87]
    v_mfma_f32_16x16x32_bf16 v[88:91], v[56:59], a[216:219], v[88:91]
    v_mfma_f32_16x16x32_bf16 v[92:95], v[56:59], a[220:223], v[92:95]
    v_mfma_f32_16x16x32_bf16 v[96:99], v[60:63], a[208:211], v[96:99]
    v_mfma_f32_16x16x32_bf16 v[100:103], v[60:63], a[212:215], v[100:103]
    v_mfma_f32_16x16x32_bf16 v[104:107], v[60:63], a[216:219], v[104:107]
    v_mfma_f32_16x16x32_bf16 v[108:111], v[60:63], a[220:223], v[108:111]
    v_mfma_f32_16x16x32_bf16 v[80:83], v[64:67], a[224:227], v[80:83]
    v_mfma_f32_16x16x32_bf16 v[84:87], v[64:67], a[228:231], v[84:87]
    v_mfma_f32_16x16x32_bf16 v[88:91], v[64:67], a[232:235], v[88:91]
    v_mfma_f32_16x16x32_bf16 v[92:95], v[64:67], a[236:239], v[92:95]
    v_mfma_f32_16x16x32_bf16 v[96:99], v[68:71], a[224:227], v[96:99]
    v_mfma_f32_16x16x32_bf16 v[100:103], v[68:71], a[228:231], v[100:103]
    v_mfma_f32_16x16x32_bf16 v[104:107], v[68:71], a[232:235], v[104:107]
    v_mfma_f32_16x16x32_bf16 v[108:111], v[68:71], a[236:239], v[108:111]
    v_mfma_f32_16x16x32_bf16 v[80:83], v[72:75], a[240:243], v[80:83]
    v_mfma_f32_16x16x32_bf16 v[84:87], v[72:75], a[244:247], v[84:87]
    v_mfma_f32_16x16x32_bf16 v[88:91], v[72:75], a[248:251], v[88:91]
    v_mfma_f32_16x16x32_bf16 v[92:95], v[72:75], a[252:255], v[92:95]
    v_mfma_f32_16x16x32_bf16 v[96:99], v[76:79], a[240:243], v[96:99]
    v_mfma_f32_16x16x32_bf16 v[100:103], v[76:79], a[244:247], v[100:103]
    v_mfma_f32_16x16x32_bf16 v[104:107], v[76:79], a[248:251], v[104:107]
    v_mfma_f32_16x16x32_bf16 v[108:111], v[76:79], a[252:255], v[108:111]
    s_waitcnt vmcnt(0)
    ds_read_b128 v[16:19], v12 offset:16384
    ds_read_b128 v[20:23], v12 offset:18432
    ds_read_b128 v[24:27], v13 offset:16384
    ds_read_b128 v[28:31], v13 offset:18432
    ds_read_b128 v[32:35], v14 offset:16384
    ds_read_b128 v[36:39], v14 offset:18432
    ds_read_b128 v[40:43], v15 offset:16384
    ds_read_b128 v[44:47], v15 offset:18432
    ds_read_b128 v[48:51], v12 offset:16640
    ds_read_b128 v[52:55], v12 offset:18688
    ds_read_b128 v[56:59], v13 offset:16640
    ds_read_b128 v[60:63], v13 offset:18688
    ds_read_b128 v[64:67], v14 offset:16640
    ds_read_b128 v[68:71], v14 offset:18688
    ds_read_b128 v[72:75], v15 offset:16640
    ds_read_b128 v[76:79], v15 offset:18688
    s_waitcnt lgkmcnt(12)
    v_mfma_f32_16x16x32_bf16 v[112:115], v[16:19], a[128:131], 0
    v_mul_f32 v80, s26, v80
    v_mul_f32 v81, s26, v81
    v_mfma_f32_16x16x32_bf16 v[116:119], v[16:19], a[132:135], 0
    v_mul_f32 v82, s26, v82
    v_mul_f32 v83, s26, v83
    v_mfma_f32_16x16x32_bf16 v[120:123], v[16:19], a[136:139], 0
    v_cvt_pk_bf16_f32 v144, v80, v81
    v_cvt_pk_bf16_f32 v145, v82, v83
    v_mfma_f32_16x16x32_bf16 v[124:127], v[16:19], a[140:143], 0
    v_mul_f32 v96, s26, v96
    v_mul_f32 v97, s26, v97
    v_mfma_f32_16x16x32_bf16 v[128:131], v[20:23], a[128:131], 0
    v_mul_f32 v98, s26, v98
    v_mul_f32 v99, s26, v99
    v_mfma_f32_16x16x32_bf16 v[132:135], v[20:23], a[132:135], 0
    v_cvt_pk_bf16_f32 v146, v96, v97
    v_cvt_pk_bf16_f32 v147, v98, v99
    v_mfma_f32_16x16x32_bf16 v[136:139], v[20:23], a[136:139], 0
    s_add_u32 s27, s29, 0
    buffer_store_dwordx4 v[144:147], v2, s[8:11], s27 offen offset:0 sc1
    v_mul_f32 v84, s26, v84
    v_mfma_f32_16x16x32_bf16 v[140:143], v[20:23], a[140:143], 0
    v_mul_f32 v85, s26, v85
    v_mul_f32 v86, s26, v86
    s_waitcnt lgkmcnt(8)
    v_mfma_f32_16x16x32_bf16 v[112:115], v[24:27], a[144:147], v[112:115]
    v_mul_f32 v87, s26, v87
    v_cvt_pk_bf16_f32 v148, v84, v85
    v_mfma_f32_16x16x32_bf16 v[116:119], v[24:27], a[148:151], v[116:119]
    v_cvt_pk_bf16_f32 v149, v86, v87
    v_mul_f32 v100, s26, v100
    v_mfma_f32_16x16x32_bf16 v[120:123], v[24:27], a[152:155], v[120:123]
    v_mul_f32 v101, s26, v101
    v_mul_f32 v102, s26, v102
    v_mfma_f32_16x16x32_bf16 v[124:127], v[24:27], a[156:159], v[124:127]
    v_mul_f32 v103, s26, v103
    v_cvt_pk_bf16_f32 v150, v100, v101
    v_mfma_f32_16x16x32_bf16 v[128:131], v[28:31], a[144:147], v[128:131]
    v_cvt_pk_bf16_f32 v151, v102, v103
    s_add_u32 s27, s29, 14336
    buffer_store_dwordx4 v[148:151], v2, s[8:11], s27 offen offset:0 sc1
    v_mfma_f32_16x16x32_bf16 v[132:135], v[28:31], a[148:151], v[132:135]
    v_mul_f32 v88, s26, v88
    v_mul_f32 v89, s26, v89
    v_mfma_f32_16x16x32_bf16 v[136:139], v[28:31], a[152:155], v[136:139]
    v_mul_f32 v90, s26, v90
    v_mul_f32 v91, s26, v91
    v_mfma_f32_16x16x32_bf16 v[140:143], v[28:31], a[156:159], v[140:143]
    v_cvt_pk_bf16_f32 v152, v88, v89
    v_cvt_pk_bf16_f32 v153, v90, v91
    s_waitcnt lgkmcnt(4)
    v_mfma_f32_16x16x32_bf16 v[112:115], v[32:35], a[160:163], v[112:115]
    v_mul_f32 v104, s26, v104
    v_mul_f32 v105, s26, v105
    v_mfma_f32_16x16x32_bf16 v[116:119], v[32:35], a[164:167], v[116:119]
    v_mul_f32 v106, s26, v106
    v_mul_f32 v107, s26, v107
    v_mfma_f32_16x16x32_bf16 v[120:123], v[32:35], a[168:171], v[120:123]
    v_cvt_pk_bf16_f32 v154, v104, v105
    v_cvt_pk_bf16_f32 v155, v106, v107
    v_mfma_f32_16x16x32_bf16 v[124:127], v[32:35], a[172:175], v[124:127]
    s_add_u32 s27, s29, 28672
    buffer_store_dwordx4 v[152:155], v2, s[8:11], s27 offen offset:0 sc1
    v_mul_f32 v92, s26, v92
    v_mfma_f32_16x16x32_bf16 v[128:131], v[36:39], a[160:163], v[128:131]
    v_mul_f32 v93, s26, v93
    v_mul_f32 v94, s26, v94
    v_mfma_f32_16x16x32_bf16 v[132:135], v[36:39], a[164:167], v[132:135]
    v_mul_f32 v95, s26, v95
    v_cvt_pk_bf16_f32 v156, v92, v93
    v_mfma_f32_16x16x32_bf16 v[136:139], v[36:39], a[168:171], v[136:139]
    v_cvt_pk_bf16_f32 v157, v94, v95
    v_mul_f32 v108, s26, v108
    v_mfma_f32_16x16x32_bf16 v[140:143], v[36:39], a[172:175], v[140:143]
    v_mul_f32 v109, s26, v109
    v_mul_f32 v110, s26, v110
    s_waitcnt lgkmcnt(0)
    v_mfma_f32_16x16x32_bf16 v[112:115], v[40:43], a[176:179], v[112:115]
    v_mul_f32 v111, s26, v111
    v_cvt_pk_bf16_f32 v158, v108, v109
    v_mfma_f32_16x16x32_bf16 v[116:119], v[40:43], a[180:183], v[116:119]
    v_cvt_pk_bf16_f32 v159, v110, v111
    s_add_u32 s27, s29, 43008
    buffer_store_dwordx4 v[156:159], v2, s[8:11], s27 offen offset:0 sc1
    v_mfma_f32_16x16x32_bf16 v[120:123], v[40:43], a[184:187], v[120:123]
    v_mfma_f32_16x16x32_bf16 v[124:127], v[40:43], a[188:191], v[124:127]
    v_mfma_f32_16x16x32_bf16 v[128:131], v[44:47], a[176:179], v[128:131]
    v_mfma_f32_16x16x32_bf16 v[132:135], v[44:47], a[180:183], v[132:135]
    v_mfma_f32_16x16x32_bf16 v[136:139], v[44:47], a[184:187], v[136:139]
    v_mfma_f32_16x16x32_bf16 v[140:143], v[44:47], a[188:191], v[140:143]
    v_mfma_f32_16x16x32_bf16 v[112:115], v[48:51], a[192:195], v[112:115]
    v_mfma_f32_16x16x32_bf16 v[116:119], v[48:51], a[196:199], v[116:119]
    v_mfma_f32_16x16x32_bf16 v[120:123], v[48:51], a[200:203], v[120:123]
    v_mfma_f32_16x16x32_bf16 v[124:127], v[48:51], a[204:207], v[124:127]
    v_mfma_f32_16x16x32_bf16 v[128:131], v[52:55], a[192:195], v[128:131]
    v_mfma_f32_16x16x32_bf16 v[132:135], v[52:55], a[196:199], v[132:135]
    v_mfma_f32_16x16x32_bf16 v[136:139], v[52:55], a[200:203], v[136:139]
    v_mfma_f32_16x16x32_bf16 v[140:143], v[52:55], a[204:207], v[140:143]
    v_mfma_f32_16x16x32_bf16 v[112:115], v[56:59], a[208:211], v[112:115]
    v_mfma_f32_16x16x32_bf16 v[116:119], v[56:59], a[212:215], v[116:119]
    v_mfma_f32_16x16x32_bf16 v[120:123], v[56:59], a[216:219], v[120:123]
    v_mfma_f32_16x16x32_bf16 v[124:127], v[56:59], a[220:223], v[124:127]
    v_mfma_f32_16x16x32_bf16 v[128:131], v[60:63], a[208:211], v[128:131]
    v_mfma_f32_16x16x32_bf16 v[132:135], v[60:63], a[212:215], v[132:135]
    v_mfma_f32_16x16x32_bf16 v[136:139], v[60:63], a[216:219], v[136:139]
    v_mfma_f32_16x16x32_bf16 v[140:143], v[60:63], a[220:223], v[140:143]
    v_mfma_f32_16x16x32_bf16 v[112:115], v[64:67], a[224:227], v[112:115]
    v_mfma_f32_16x16x32_bf16 v[116:119], v[64:67], a[228:231], v[116:119]
    v_mfma_f32_16x16x32_bf16 v[120:123], v[64:67], a[232:235], v[120:123]
    v_mfma_f32_16x16x32_bf16 v[124:127], v[64:67], a[236:239], v[124:127]
    v_mfma_f32_16x16x32_bf16 v[128:131], v[68:71], a[224:227], v[128:131]
    v_mfma_f32_16x16x32_bf16 v[132:135], v[68:71], a[228:231], v[132:135]
    v_mfma_f32_16x16x32_bf16 v[136:139], v[68:71], a[232:235], v[136:139]
    v_mfma_f32_16x16x32_bf16 v[140:143], v[68:71], a[236:239], v[140:143]
    v_mfma_f32_16x16x32_bf16 v[112:115], v[72:75], a[240:243], v[112:115]
    v_mfma_f32_16x16x32_bf16 v[116:119], v[72:75], a[244:247], v[116:119]
    v_mfma_f32_16x16x32_bf16 v[120:123], v[72:75], a[248:251], v[120:123]
    v_mfma_f32_16x16x32_bf16 v[124:127], v[72:75], a[252:255], v[124:127]
    v_mfma_f32_16x16x32_bf16 v[128:131], v[76:79], a[240:243], v[128:131]
    v_mfma_f32_16x16x32_bf16 v[132:135], v[76:79], a[244:247], v[132:135]
    v_mfma_f32_16x16x32_bf16 v[136:139], v[76:79], a[248:251], v[136:139]
    v_mfma_f32_16x16x32_bf16 v[140:143], v[76:79], a[252:255], v[140:143]
    v_mul_f32 v112, s26, v112
    v_mul_f32 v113, s26, v113
    v_mul_f32 v114, s26, v114
    v_mul_f32 v115, s26, v115
    v_cvt_pk_bf16_f32 v144, v112, v113
    v_cvt_pk_bf16_f32 v145, v114, v115
    v_mul_f32 v128, s26, v128
    v_mul_f32 v129, s26, v129
    v_mul_f32 v130, s26, v130
    v_mul_f32 v131, s26, v131
    v_cvt_pk_bf16_f32 v146, v128, v129
    v_cvt_pk_bf16_f32 v147, v130, v131
    s_add_u32 s27, s29, 0
    buffer_store_dwordx4 v[144:147], v2, s[8:11], s27 offen offset:1024 sc1
    v_mul_f32 v116, s26, v116
    v_mul_f32 v117, s26, v117
    v_mul_f32 v118, s26, v118
    v_mul_f32 v119, s26, v119
    v_cvt_pk_bf16_f32 v148, v116, v117
    v_cvt_pk_bf16_f32 v149, v118, v119
    v_mul_f32 v132, s26, v132
    v_mul_f32 v133, s26, v133
    v_mul_f32 v134, s26, v134
    v_mul_f32 v135, s26, v135
    v_cvt_pk_bf16_f32 v150, v132, v133
    v_cvt_pk_bf16_f32 v151, v134, v135
    s_add_u32 s27, s29, 14336
    buffer_store_dwordx4 v[148:151], v2, s[8:11], s27 offen offset:1024 sc1
    v_mul_f32 v120, s26, v120
    v_mul_f32 v121, s26, v121
    v_mul_f32 v122, s26, v122
    v_mul_f32 v123, s26, v123
    v_cvt_pk_bf16_f32 v152, v120, v121
    v_cvt_pk_bf16_f32 v153, v122, v123
    v_mul_f32 v136, s26, v136
    v_mul_f32 v137, s26, v137
    v_mul_f32 v138, s26, v138
    v_mul_f32 v139, s26, v139
    v_cvt_pk_bf16_f32 v154, v136, v137
    v_cvt_pk_bf16_f32 v155, v138, v139
    s_add_u32 s27, s29, 28672
    buffer_store_dwordx4 v[152:155], v2, s[8:11], s27 offen offset:1024 sc1
    v_mul_f32 v124, s26, v124
    v_mul_f32 v125, s26, v125
    v_mul_f32 v126, s26, v126
    v_mul_f32 v127, s26, v127
    v_cvt_pk_bf16_f32 v156, v124, v125
    v_cvt_pk_bf16_f32 v157, v126, v127
    v_mul_f32 v140, s26, v140
    v_mul_f32 v141, s26, v141
    v_mul_f32 v142, s26, v142
    v_mul_f32 v143, s26, v143
    v_cvt_pk_bf16_f32 v158, v140, v141
    v_cvt_pk_bf16_f32 v159, v142, v143
    s_add_u32 s27, s29, 43008
    buffer_store_dwordx4 v[156:159], v2, s[8:11], s27 offen offset:1024 sc1
    s_cmp_lg_u32 s13, 0
    s_cbranch_scc1 PFZ_173
    s_lshl_b32 s30, s16, 8
    s_lshl_b32 s34, s15, 5
    s_add_u32 s30, s30, s34
    s_add_u32 s30, s30, 116453376
    v_and_b32 v240, 7, v1
    v_lshlrev_b32 v240, 2, v240
    v_mov_b32 v243, 0
    buffer_load_dword v241, v240, s[8:11], s30 offen sc1
    global_load_dword v242, v243, s[4:5] offset:128 sc1
PFZ_173:
    s_waitcnt vmcnt(0)
    s_barrier
    s_cmp_lg_u32 s13, 1
    s_cbranch_scc1 PFL_174
    s_lshl_b32 s34, s16, 8
    s_lshl_b32 s24, s14, 4
    s_add_u32 s34, s34, s24
    s_add_u32 s34, s34, 116449280
    v_mov_b64 v[168:169], 1
    v_mov_b32 v169, 1
    v_mov_b64 v[170:171], v[168:169]
    s_mov_b64 exec, 1
    buffer_store_dwordx4 v[168:171], off, s[8:11], s34 sc1
    s_mov_b64 exec, -1
PFL_174:
    s_cmp_lg_u32 s13, 0
    s_cbranch_scc1 SWZ_176
    s_mov_b32 s35, 0
    s_branch SWC_177
SW_175:
    s_lshl_b32 s30, s16, 8
    s_lshl_b32 s34, s15, 5
    s_add_u32 s30, s30, s34
    s_add_u32 s30, s30, 116453376
    v_and_b32 v240, 7, v1
    v_lshlrev_b32 v240, 2, v240
    v_mov_b32 v243, 0
    buffer_load_dword v241, v240, s[8:11], s30 offen sc1
    global_load_dword v242, v243, s[4:5] offset:128 sc1
    s_add_u32 s35, s35, 1
    s_cmp_gt_u32 s35, 4000000
    s_cbranch_scc1 MEGA_EXIT
    s_sleep 2
    s_waitcnt vmcnt(0)
SWC_177:
    v_lshrrev_b32 v242, 5, v242
    v_and_b32 v241, v241, v242
    v_cmp_eq_u32 vcc, 0, v241
    s_cbranch_vccnz SW_175
SWZ_176:
    s_barrier
    s_lshr_b32 s24, s13, 1
    s_lshl_b32 s25, s24, 1
    s_add_u32 s25, s25, s31
    s_lshl_b32 s28, s25, 1
    s_and_b32 s17, s13, 1
    s_add_u32 s28, s28, s17
    s_mul_i32 s28, s28, 14336
    s_add_u32 s28, s28, 83886080
    s_mov_b32 s27, s21
    s_add_u32 s29, s28, 0
    s_add_u32 m0, s27, 0
    s_nop 0
    buffer_load_dwordx4 v2, s[8:11], s29 offen offset:0 sc1 lds
    buffer_load_dwordx4 v2, s[8:11], s29 offen offset:1024 sc1 lds
    buffer_load_dwordx4 v2, s[8:11], s29 offen offset:2048 sc1 lds
    buffer_load_dwordx4 v2, s[8:11], s29 offen offset:3072 sc1 lds
    s_add_u32 s29, s28, 4096
    s_add_u32 m0, s27, 4096
    s_nop 0
    buffer_load_dwordx4 v2, s[8:11], s29 offen offset:0 sc1 lds
    buffer_load_dwordx4 v2, s[8:11], s29 offen offset:1024 sc1 lds
    buffer_load_dwordx4 v2, s[8:11], s29 offen offset:2048 sc1 lds
    buffer_load_dwordx4 v2, s[8:11], s29 offen offset:3072 sc1 lds
    s_add_u32 s29, s28, 8192
    s_add_u32 m0, s27, 8192
    s_nop 0
    buffer_load_dwordx4 v2, s[8:11], s29 offen offset:0 sc1 lds
    buffer_load_dwordx4 v2, s[8:11], s29 offen offset:1024 sc1 lds
    buffer_load_dwordx4 v2, s[8:11], s29 offen offset:2048 sc1 lds
    buffer_load_dwordx4 v2, s[8:11], s29 offen offset:3072 sc1 lds
    s_add_u32 s29, s28, 12288
    s_add_u32 m0, s27, 12288
    s_nop 0
    buffer_load_dwordx4 v2, s[8:11], s29 offen offset:0 sc1 lds
    buffer_load_dwordx4 v2, s[8:11], s29 offen offset:1024 sc1 lds
    s_mul_i32 s18, s16, 401408
    s_mul_i32 s19, s15, 57344
    s_add_u32 s18, s18, s19
    s_mul_i32 s19, s13, 14336
    s_add_u32 s20, s18, s19
    s_mul_i32 s19, s17, 28672
    s_add_u32 s18, s18, s19
    s_add_u32 s19, s20, 6422528
    buffer_load_dwordx4 v[72:75], v2, s[8:11], s19 offen offset:0 sc1
    buffer_load_dwordx4 v[76:79], v2, s[8:11], s19 offen offset:1024 sc1
    buffer_load_dwordx4 v[80:83], v2, s[8:11], s19 offen offset:2048 sc1
    buffer_load_dwordx4 v[84:87], v2, s[8:11], s19 offen offset:3072 sc1
    s_add_u32 s19, s20, 6426624
    buffer_load_dwordx4 v[88:91], v2, s[8:11], s19 offen offset:0 sc1
    buffer_load_dwordx4 v[92:95], v2, s[8:11], s19 offen offset:1024 sc1
    buffer_load_dwordx4 v[96:99], v2, s[8:11], s19 offen offset:2048 sc1
    buffer_load_dwordx4 v[100:103], v2, s[8:11], s19 offen offset:3072 sc1
    s_add_u32 s19, s20, 6430720
    buffer_load_dwordx4 v[104:107], v2, s[8:11], s19 offen offset:0 sc1
    buffer_load_dwordx4 v[108:111], v2, s[8:11], s19 offen offset:1024 sc1
    buffer_load_dwordx4 v[112:115], v2, s[8:11], s19 offen offset:2048 sc1
    buffer_load_dwordx4 v[116:119], v2, s[8:11], s19 offen offset:3072 sc1
    s_add_u32 s19, s20, 6434816
    buffer_load_dwordx4 v[120:123], v2, s[8:11], s19 offen offset:0 sc1
    buffer_load_dwordx4 v[124:127], v2, s[8:11], s19 offen offset:1024 sc1
    s_add_u32 s29, s28, 114688
    s_add_u32 m0, s27, 16384
    s_nop 0
    buffer_load_dwordx4 v2, s[8:11], s29 offen offset:0 sc1 lds
    buffer_load_dwordx4 v2, s[8:11], s29 offen offset:1024 sc1 lds
    buffer_load_dwordx4 v2, s[8:11], s29 offen offset:2048 sc1 lds
    buffer_load_dwordx4 v2, s[8:11], s29 offen offset:3072 sc1 lds
    s_add_u32 s29, s28, 118784
    s_add_u32 m0, s27, 20480
    s_nop 0
    buffer_load_dwordx4 v2, s[8:11], s29 offen offset:0 sc1 lds
    buffer_load_dwordx4 v2, s[8:11], s29 offen offset:1024 sc1 lds
    buffer_load_dwordx4 v2, s[8:11], s29 offen offset:2048 sc1 lds
    buffer_load_dwordx4 v2, s[8:11], s29 offen offset:3072 sc1 lds
    s_add_u32 s29, s28, 122880
    s_add_u32 m0, s27, 24576
    s_nop 0
    buffer_load_dwordx4 v2, s[8:11], s29 offen offset:0 sc1 lds
    buffer_load_dwordx4 v2, s[8:11], s29 offen offset:1024 sc1 lds
    buffer_load_dwordx4 v2, s[8:11], s29 offen offset:2048 sc1 lds
    buffer_load_dwordx4 v2, s[8:11], s29 offen offset:3072 sc1 lds
    s_add_u32 s29, s28, 126976
    s_add_u32 m0, s27, 28672
    s_nop 0
    buffer_load_dwordx4 v2, s[8:11], s29 offen offset:0 sc1 lds
    buffer_load_dwordx4 v2, s[8:11], s29 offen offset:1024 sc1 lds
    s_cmp_lg_u32 s13, 0
    s_cbranch_scc1 SWZ_179
    s_mov_b32 s35, 0
SW_178:
    s_lshl_b32 s30, s16, 8
    s_lshl_b32 s34, s15, 5
    s_add_u32 s30, s30, s34
    s_add_u32 s30, s30, 116449280
    v_and_b32 v240, 7, v1
    v_lshlrev_b32 v240, 2, v240
    v_mov_b32 v243, 0
    buffer_load_dword v241, v240, s[8:11], s30 offen sc1
    s_add_u32 s35, s35, 1
    s_cmp_gt_u32 s35, 4000000
    s_cbranch_scc1 MEGA_EXIT
    s_sleep 2
    s_waitcnt vmcnt(0)
SWC_180:
    v_cmp_eq_u32 vcc, 0, v241
    s_cbranch_vccnz SW_178
SWZ_179:
    s_barrier
    s_add_u32 s19, s18, 0
    buffer_load_dwordx4 a[0:3], v2, s[8:11], s19 offen offset:0 sc1
    buffer_load_dwordx4 a[4:7], v2, s[8:11], s19 offen offset:1024 sc1
    s_add_u32 s19, s18, 14336
    buffer_load_dwordx4 a[56:59], v2, s[8:11], s19 offen offset:0 sc1
    buffer_load_dwordx4 a[60:63], v2, s[8:11], s19 offen offset:1024 sc1
    s_add_u32 s19, s18, 2048
    buffer_load_dwordx4 a[8:11], v2, s[8:11], s19 offen offset:0 sc1
    buffer_load_dwordx4 a[12:15], v2, s[8:11], s19 offen offset:1024 sc1
    s_add_u32 s19, s18, 16384
    buffer_load_dwordx4 a[64:67], v2, s[8:11], s19 offen offset:0 sc1
    buffer_load_dwordx4 a[68:71], v2, s[8:11], s19 offen offset:1024 sc1
    s_add_u32 s19, s18, 4096
    buffer_load_dwordx4 a[16:19], v2, s[8:11], s19 offen offset:0 sc1
    buffer_load_dwordx4 a[20:23], v2, s[8:11], s19 offen offset:1024 sc1
    s_add_u32 s19, s18, 18432
    buffer_load_dwordx4 a[72:75], v2, s[8:11], s19 offen offset:0 sc1
    buffer_load_dwordx4 a[76:79], v2, s[8:11], s19 offen offset:1024 sc1
    s_add_u32 s19, s18, 6144
    buffer_load_dwordx4 a[24:27], v2, s[8:11], s19 offen offset:0 sc1
    buffer_load_dwordx4 a[28:31], v2, s[8:11], s19 offen offset:1024 sc1
    s_add_u32 s19, s18, 20480
    buffer_load_dwordx4 a[80:83], v2, s[8:11], s19 offen offset:0 sc1
    buffer_load_dwordx4 a[84:87], v2, s[8:11], s19 offen offset:1024 sc1
    s_add_u32 s19, s18, 8192
    buffer_load_dwordx4 a[32:35], v2, s[8:11], s19 offen offset:0 sc1
    buffer_load_dwordx4 a[36:39], v2, s[8:11], s19 offen offset:1024 sc1
    s_add_u32 s19, s18, 22528
    buffer_load_dwordx4 a[88:91], v2, s[8:11], s19 offen offset:0 sc1
    buffer_load_dwordx4 a[92:95], v2, s[8:11], s19 offen offset:1024 sc1
    s_add_u32 s19, s18, 10240
    buffer_load_dwordx4 a[40:43], v2, s[8:11], s19 offen offset:0 sc1
    buffer_load_dwordx4 a[44:47], v2, s[8:11], s19 offen offset:1024 sc1
    s_add_u32 s19, s18, 24576
    buffer_load_dwordx4 a[96:99], v2, s[8:11], s19 offen offset:0 sc1
    buffer_load_dwordx4 a[100:103], v2, s[8:11], s19 offen offset:1024 sc1
    s_add_u32 s19, s18, 12288
    buffer_load_dwordx4 a[48:51], v2, s[8:11], s19 offen offset:0 sc1
    buffer_load_dwordx4 a[52:55], v2, s[8:11], s19 offen offset:1024 sc1
    s_add_u32 s19, s18, 26624
    buffer_load_dwordx4 a[104:107], v2, s[8:11], s19 offen offset:0 sc1
    buffer_load_dwordx4 a[108:111], v2, s[8:11], s19 offen offset:1024 sc1
    s_lshl_b32 s19, s24, 16
    v_add_u32 v5, s19, v2
    v_xor_b32 v6, 65536, v5
    s_mul_i32 s21, s16, 28672
    s_mul_i32 s22, s25, 458752
    s_add_u32 s21, s21, s22
    s_lshl_b32 s22, s15, 1
    s_add_u32 s22, s22, s17
    s_lshl_b32 s22, s22, 10
    s_add_u32 s21, s21, s22
    s_add_u32 s21, s21, 16777216
    s_lshl_b32 s22, s15, 2
    s_add_u32 s22, s22, s13
    s_mul_i32 s22, s22, 16384
    s_lshl_b32 s23, s16, 10
    s_add_u32 s22, s22, s23
    s_add_u32 s22, s22, 46137344
    s_xor_b32 s23, s25, 2
    s_mul_i32 s23, s23, 458752
    s_add_u32 s23, s23, s22
    s_mul_i32 s19, s25, 458752
    s_add_u32 s22, s22, s19
    s_waitcnt vmcnt(28)
    s_barrier
    ds_read_b128 v[128:131], v5 offset:0
    ds_read_b128 v[132:135], v5 offset:32768
    ds_read_b128 v[136:139], v6 offset:0
    ds_read_b128 v[140:143], v6 offset:32768
    ds_read_b128 v[144:147], v5 offset:1024
    ds_read_b128 v[148:151], v5 offset:33792
    ds_read_b128 v[152:155], v6 offset:1024
    ds_read_b128 v[156:159], v6 offset:33792
    ds_read_b128 v[160:163], v5 offset:2048
    ds_read_b128 v[164:167], v5 offset:34816
    ds_read_b128 v[168:171], v6 offset:2048
    ds_read_b128 v[172:175], v6 offset:34816
    s_waitcnt vmcnt(24) lgkmcnt(8)
    v_mfma_f32_16x16x32_bf16 v[208:211], v[128:131], v[72:75], 0
    v_mfma_f32_16x16x32_bf16 v[192:195], a[0:3], v[128:131], 0
    v_mfma_f32_16x16x32_bf16 v[212:215], v[132:135], v[72:75], 0
    v_mfma_f32_16x16x32_bf16 v[196:199], a[56:59], v[128:131], 0
    v_mfma_f32_16x16x32_bf16 v[216:219], v[136:139], v[72:75], 0
    v_mfma_f32_16x16x32_bf16 v[200:203], a[0:3], v[132:135], 0
    v_mfma_f32_16x16x32_bf16 v[220:223], v[140:143], v[72:75], 0
    v_mfma_f32_16x16x32_bf16 v[204:207], a[56:59], v[132:135], 0
    ds_read_b128 v[128:131], v5 offset:3072
    ds_read_b128 v[132:135], v5 offset:35840
    ds_read_b128 v[136:139], v6 offset:3072
    ds_read_b128 v[140:143], v6 offset:35840
    s_waitcnt lgkmcnt(8)
    v_mfma_f32_16x16x32_bf16 v[208:211], v[144:147], v[76:79], v[208:211]
    v_mfma_f32_16x16x32_bf16 v[192:195], a[4:7], v[144:147], v[192:195]
    v_mfma_f32_16x16x32_bf16 v[212:215], v[148:151], v[76:79], v[212:215]
    v_mfma_f32_16x16x32_bf16 v[196:199], a[60:63], v[144:147], v[196:199]
    v_mfma_f32_16x16x32_bf16 v[216:219], v[152:155], v[76:79], v[216:219]
    v_mfma_f32_16x16x32_bf16 v[200:203], a[4:7], v[148:151], v[200:203]
    v_mfma_f32_16x16x32_bf16 v[220:223], v[156:159], v[76:79], v[220:223]
    v_mfma_f32_16x16x32_bf16 v[204:207], a[60:63], v[148:151], v[204:207]
    ds_read_b128 v[144:147], v5 offset:4096
    ds_read_b128 v[148:151], v5 offset:36864
    ds_read_b128 v[152:155], v6 offset:4096
    ds_read_b128 v[156:159], v6 offset:36864
    s_waitcnt vmcnt(20) lgkmcnt(8)
    v_mfma_f32_16x16x32_bf16 v[208:211], v[160:163], v[80:83], v[208:211]
    v_mfma_f32_16x16x32_bf16 v[192:195], a[8:11], v[160:163], v[192:195]
    v_mfma_f32_16x16x32_bf16 v[212:215], v[164:167], v[80:83], v[212:215]
    v_mfma_f32_16x16x32_bf16 v[196:199], a[64:67], v[160:163], v[196:199]
    v_mfma_f32_16x16x32_bf16 v[216:219], v[168:171], v[80:83], v[216:219]
    v_mfma_f32_16x16x32_bf16 v[200:203], a[8:11], v[164:167], v[200:203]
    v_mfma_f32_16x16x32_bf16 v[220:223], v[172:175], v[80:83], v[220:223]
    v_mfma_f32_16x16x32_bf16 v[204:207], a[64:67], v[164:167], v[204:207]
    ds_read_b128 v[160:163], v5 offset:5120
    ds_read_b128 v[164:167], v5 offset:37888
    ds_read_b128 v[168:171], v6 offset:5120
    ds_read_b128 v[172:175], v6 offset:37888
    s_waitcnt lgkmcnt(8)
    v_mfma_f32_16x16x32_bf16 v[208:211], v[128:131], v[84:87], v[208:211]
    v_mfma_f32_16x16x32_bf16 v[192:195], a[12:15], v[128:131], v[192:195]
    v_mfma_f32_16x16x32_bf16 v[212:215], v[132:135], v[84:87], v[212:215]
    v_mfma_f32_16x16x32_bf16 v[196:199], a[68:71], v[128:131], v[196:199]
    v_mfma_f32_16x16x32_bf16 v[216:219], v[136:139], v[84:87], v[216:219]
    v_mfma_f32_16x16x32_bf16 v[200:203], a[12:15], v[132:135], v[200:203]
    v_mfma_f32_16x16x32_bf16 v[220:223], v[140:143], v[84:87], v[220:223]
    v_mfma_f32_16x16x32_bf16 v[204:207], a[68:71], v[132:135], v[204:207]
    ds_read_b128 v[128:131], v5 offset:6144
    ds_read_b128 v[132:135], v5 offset:38912
    ds_read_b128 v[136:139], v6 offset:6144
    ds_read_b128 v[140:143], v6 offset:38912
    s_waitcnt vmcnt(16) lgkmcnt(8)
    v_mfma_f32_16x16x32_bf16 v[208:211], v[144:147], v[88:91], v[208:211]
    v_mfma_f32_16x16x32_bf16 v[192:195], a[16:19], v[144:147], v[192:195]
    v_mfma_f32_16x16x32_bf16 v[212:215], v[148:151], v[88:91], v[212:215]
    v_mfma_f32_16x16x32_bf16 v[196:199], a[72:75], v[144:147], v[196:199]
    v_mfma_f32_16x16x32_bf16 v[216:219], v[152:155], v[88:91], v[216:219]
    v_mfma_f32_16x16x32_bf16 v[200:203], a[16:19], v[148:151], v[200:203]
    v_mfma_f32_16x16x32_bf16 v[220:223], v[156:159], v[88:91], v[220:223]
    v_mfma_f32_16x16x32_bf16 v[204:207], a[72:75], v[148:151], v[204:207]
    ds_read_b128 v[144:147], v5 offset:7168
    ds_read_b128 v[148:151], v5 offset:39936
    ds_read_b128 v[152:155], v6 offset:7168
    ds_read_b128 v[156:159], v6 offset:39936
    s_waitcnt lgkmcnt(8)
    v_mfma_f32_16x16x32_bf16 v[208:211], v[160:163], v[92:95], v[208:211]
    v_mfma_f32_16x16x32_bf16 v[192:195], a[20:23], v[160:163], v[192:195]
    v_mfma_f32_16x16x32_bf16 v[212:215], v[164:167], v[92:95], v[212:215]
    v_mfma_f32_16x16x32_bf16 v[196:199], a[76:79], v[160:163], v[196:199]
    v_mfma_f32_16x16x32_bf16 v[216:219], v[168:171], v[92:95], v[216:219]
    v_mfma_f32_16x16x32_bf16 v[200:203], a[20:23], v[164:167], v[200:203]
    v_mfma_f32_16x16x32_bf16 v[220:223], v[172:175], v[92:95], v[220:223]
    v_mfma_f32_16x16x32_bf16 v[204:207], a[76:79], v[164:167], v[204:207]
    ds_read_b128 v[160:163], v5 offset:8192
    ds_read_b128 v[164:167], v5 offset:40960
    ds_read_b128 v[168:171], v6 offset:8192
    ds_read_b128 v[172:175], v6 offset:40960
    s_waitcnt vmcnt(12) lgkmcnt(8)
    v_mfma_f32_16x16x32_bf16 v[208:211], v[128:131], v[96:99], v[208:211]
    v_mfma_f32_16x16x32_bf16 v[192:195], a[24:27], v[128:131], v[192:195]
    v_mfma_f32_16x16x32_bf16 v[212:215], v[132:135], v[96:99], v[212:215]
    v_mfma_f32_16x16x32_bf16 v[196:199], a[80:83], v[128:131], v[196:199]
    v_mfma_f32_16x16x32_bf16 v[216:219], v[136:139], v[96:99], v[216:219]
    v_mfma_f32_16x16x32_bf16 v[200:203], a[24:27], v[132:135], v[200:203]
    v_mfma_f32_16x16x32_bf16 v[220:223], v[140:143], v[96:99], v[220:223]
    v_mfma_f32_16x16x32_bf16 v[204:207], a[80:83], v[132:135], v[204:207]
    ds_read_b128 v[128:131], v5 offset:9216
    ds_read_b128 v[132:135], v5 offset:41984
    ds_read_b128 v[136:139], v6 offset:9216
    ds_read_b128 v[140:143], v6 offset:41984
    s_waitcnt lgkmcnt(8)
    v_mfma_f32_16x16x32_bf16 v[208:211], v[144:147], v[100:103], v[208:211]
    v_mfma_f32_16x16x32_bf16 v[192:195], a[28:31], v[144:147], v[192:195]
    v_mfma_f32_16x16x32_bf16 v[212:215], v[148:151], v[100:103], v[212:215]
    v_mfma_f32_16x16x32_bf16 v[196:199], a[84:87], v[144:147], v[196:199]
    v_mfma_f32_16x16x32_bf16 v[216:219], v[152:155], v[100:103], v[216:219]
    v_mfma_f32_16x16x32_bf16 v[200:203], a[28:31], v[148:151], v[200:203]
    v_mfma_f32_16x16x32_bf16 v[220:223], v[156:159], v[100:103], v[220:223]
    v_mfma_f32_16x16x32_bf16 v[204:207], a[84:87], v[148:151], v[204:207]
    ds_read_b128 v[144:147], v5 offset:10240
    ds_read_b128 v[148:151], v5 offset:43008
    ds_read_b128 v[152:155], v6 offset:10240
    ds_read_b128 v[156:159], v6 offset:43008
    s_waitcnt vmcnt(8) lgkmcnt(8)
    v_mfma_f32_16x16x32_bf16 v[208:211], v[160:163], v[104:107], v[208:211]
    v_mfma_f32_16x16x32_bf16 v[192:195], a[32:35], v[160:163], v[192:195]
    v_mfma_f32_16x16x32_bf16 v[212:215], v[164:167], v[104:107], v[212:215]
    v_mfma_f32_16x16x32_bf16 v[196:199], a[88:91], v[160:163], v[196:199]
    v_mfma_f32_16x16x32_bf16 v[216:219], v[168:171], v[104:107], v[216:219]
    v_mfma_f32_16x16x32_bf16 v[200:203], a[32:35], v[164:167], v[200:203]
    v_mfma_f32_16x16x32_bf16 v[220:223], v[172:175], v[104:107], v[220:223]
    v_mfma_f32_16x16x32_bf16 v[204:207], a[88:91], v[164:167], v[204:207]
    ds_read_b128 v[160:163], v5 offset:11264
    ds_read_b128 v[164:167], v5 offset:44032
    ds_read_b128 v[168:171], v6 offset:11264
    ds_read_b128 v[172:175], v6 offset:44032
    s_waitcnt lgkmcnt(8)
    v_mfma_f32_16x16x32_bf16 v[208:211], v[128:131], v[108:111], v[208:211]
    v_mfma_f32_16x16x32_bf16 v[192:195], a[36:39], v[128:131], v[192:195]
    v_mfma_f32_16x16x32_bf16 v[212:215], v[132:135], v[108:111], v[212:215]
    v_mfma_f32_16x16x32_bf16 v[196:199], a[92:95], v[128:131], v[196:199]
    v_mfma_f32_16x16x32_bf16 v[216:219], v[136:139], v[108:111], v[216:219]
    v_mfma_f32_16x16x32_bf16 v[200:203], a[36:39], v[132:135], v[200:203]
    v_mfma_f32_16x16x32_bf16 v[220:223], v[140:143], v[108:111], v[220:223]
    v_mfma_f32_16x16x32_bf16 v[204:207], a[92:95], v[132:135], v[204:207]
    ds_read_b128 v[128:131], v5 offset:12288
    ds_read_b128 v[132:135], v5 offset:45056
    ds_read_b128 v[136:139], v6 offset:12288
    ds_read_b128 v[140:143], v6 offset:45056
    s_waitcnt vmcnt(4) lgkmcnt(8)
    v_mfma_f32_16x16x32_bf16 v[208:211], v[144:147], v[112:115], v[208:211]
    v_mfma_f32_16x16x32_bf16 v[192:195], a[40:43], v[144:147], v[192:195]
    v_mfma_f32_16x16x32_bf16 v[212:215], v[148:151], v[112:115], v[212:215]
    v_mfma_f32_16x16x32_bf16 v[196:199], a[96:99], v[144:147], v[196:199]
    v_mfma_f32_16x16x32_bf16 v[216:219], v[152:155], v[112:115], v[216:219]
    v_mfma_f32_16x16x32_bf16 v[200:203], a[40:43], v[148:151], v[200:203]
    v_mfma_f32_16x16x32_bf16 v[220:223], v[156:159], v[112:115], v[220:223]
    v_mfma_f32_16x16x32_bf16 v[204:207], a[96:99], v[148:151], v[204:207]
    ds_read_b128 v[144:147], v5 offset:13312
    ds_read_b128 v[148:151], v5 offset:46080
    ds_read_b128 v[152:155], v6 offset:13312
    ds_read_b128 v[156:159], v6 offset:46080
    s_waitcnt lgkmcnt(8)
    v_mfma_f32_16x16x32_bf16 v[208:211], v[160:163], v[116:119], v[208:211]
    v_mfma_f32_16x16x32_bf16 v[192:195], a[44:47], v[160:163], v[192:195]
    v_mfma_f32_16x16x32_bf16 v[212:215], v[164:167], v[116:119], v[212:215]
    v_mfma_f32_16x16x32_bf16 v[196:199], a[100:103], v[160:163], v[196:199]
    v_mfma_f32_16x16x32_bf16 v[216:219], v[168:171], v[116:119], v[216:219]
    v_mfma_f32_16x16x32_bf16 v[200:203], a[44:47], v[164:167], v[200:203]
    v_mfma_f32_16x16x32_bf16 v[220:223], v[172:175], v[116:119], v[220:223]
    v_mfma_f32_16x16x32_bf16 v[204:207], a[100:103], v[164:167], v[204:207]
    s_waitcnt vmcnt(0) lgkmcnt(4)
    v_mfma_f32_16x16x32_bf16 v[208:211], v[128:131], v[120:123], v[208:211]
    v_mfma_f32_16x16x32_bf16 v[192:195], a[48:51], v[128:131], v[192:195]
    v_mfma_f32_16x16x32_bf16 v[212:215], v[132:135], v[120:123], v[212:215]
    v_mfma_f32_16x16x32_bf16 v[196:199], a[104:107], v[128:131], v[196:199]
    v_mfma_f32_16x16x32_bf16 v[216:219], v[136:139], v[120:123], v[216:219]
    v_mfma_f32_16x16x32_bf16 v[200:203], a[48:51], v[132:135], v[200:203]
    v_mfma_f32_16x16x32_bf16 v[220:223], v[140:143], v[120:123], v[220:223]
    v_mfma_f32_16x16x32_bf16 v[204:207], a[104:107], v[132:135], v[204:207]
    s_waitcnt lgkmcnt(0)
    v_mfma_f32_16x16x32_bf16 v[208:211], v[144:147], v[124:127], v[208:211]
    v_mfma_f32_16x16x32_bf16 v[192:195], a[52:55], v[144:147], v[192:195]
    v_mfma_f32_16x16x32_bf16 v[212:215], v[148:151], v[124:127], v[212:215]
    v_mfma_f32_16x16x32_bf16 v[196:199], a[108:111], v[144:147], v[196:199]
    v_mfma_f32_16x16x32_bf16 v[216:219], v[152:155], v[124:127], v[216:219]
    v_mfma_f32_16x16x32_bf16 v[200:203], a[52:55], v[148:151], v[200:203]
    v_mfma_f32_16x16x32_bf16 v[220:223], v[156:159], v[124:127], v[220:223]
    v_mfma_f32_16x16x32_bf16 v[204:207], a[108:111], v[148:151], v[204:207]
    v_cvt_pk_bf16_f32 v232, v208, v212
    v_cvt_pk_bf16_f32 v233, v209, v213
    v_cvt_pk_bf16_f32 v234, v210, v214
    v_cvt_pk_bf16_f32 v235, v211, v215
    s_add_u32 s19, s22, 0
    buffer_store_dwordx4 v[232:235], v2, s[8:11], s19 offen sc1
    v_cvt_pk_bf16_f32 v236, v216, v220
    v_cvt_pk_bf16_f32 v237, v217, v221
    v_cvt_pk_bf16_f32 v238, v218, v222
    v_cvt_pk_bf16_f32 v239, v219, v223
    s_add_u32 s19, s23, 0
    buffer_store_dwordx4 v[236:239], v2, s[8:11], s19 offen sc1
    v_cvt_pk_bf16_f32 v224, v192, v193
    v_cvt_pk_bf16_f32 v225, v194, v195
    v_cvt_pk_bf16_f32 v226, v196, v197
    v_cvt_pk_bf16_f32 v227, v198, v199
    s_add_u32 s19, s21, 0
    buffer_store_dwordx4 v[224:227], v2, s[8:11], s19 offen sc1
    v_cvt_pk_bf16_f32 v228, v200, v201
    v_cvt_pk_bf16_f32 v229, v202, v203
    v_cvt_pk_bf16_f32 v230, v204, v205
    v_cvt_pk_bf16_f32 v231, v206, v207
    s_add_u32 s19, s21, 14336
    buffer_store_dwordx4 v[228:231], v2, s[8:11], s19 offen sc1
    ds_read_b128 v[128:131], v5 offset:16384
    ds_read_b128 v[132:135], v5 offset:49152
    ds_read_b128 v[136:139], v6 offset:16384
    ds_read_b128 v[140:143], v6 offset:49152
    ds_read_b128 v[144:147], v5 offset:17408
    ds_read_b128 v[148:151], v5 offset:50176
    ds_read_b128 v[152:155], v6 offset:17408
    ds_read_b128 v[156:159], v6 offset:50176
    ds_read_b128 v[160:163], v5 offset:18432
    ds_read_b128 v[164:167], v5 offset:51200
    ds_read_b128 v[168:171], v6 offset:18432
    ds_read_b128 v[172:175], v6 offset:51200
    s_waitcnt lgkmcnt(8)
    v_mfma_f32_16x16x32_bf16 v[208:211], v[128:131], v[72:75], 0
    v_mfma_f32_16x16x32_bf16 v[192:195], a[0:3], v[128:131], 0
    v_mfma_f32_16x16x32_bf16 v[212:215], v[132:135], v[72:75], 0
    v_mfma_f32_16x16x32_bf16 v[196:199], a[56:59], v[128:131], 0
    v_mfma_f32_16x16x32_bf16 v[216:219], v[136:139], v[72:75], 0
    v_mfma_f32_16x16x32_bf16 v[200:203], a[0:3], v[132:135], 0
    v_mfma_f32_16x16x32_bf16 v[220:223], v[140:143], v[72:75], 0
    v_mfma_f32_16x16x32_bf16 v[204:207], a[56:59], v[132:135], 0
    ds_read_b128 v[128:131], v5 offset:19456
    ds_read_b128 v[132:135], v5 offset:52224
    ds_read_b128 v[136:139], v6 offset:19456
    ds_read_b128 v[140:143], v6 offset:52224
    s_waitcnt lgkmcnt(8)
    v_mfma_f32_16x16x32_bf16 v[208:211], v[144:147], v[76:79], v[208:211]
    v_mfma_f32_16x16x32_bf16 v[192:195], a[4:7], v[144:147], v[192:195]
    v_mfma_f32_16x16x32_bf16 v[212:215], v[148:151], v[76:79], v[212:215]
    v_mfma_f32_16x16x32_bf16 v[196:199], a[60:63], v[144:147], v[196:199]
    v_mfma_f32_16x16x32_bf16 v[216:219], v[152:155], v[76:79], v[216:219]
    v_mfma_f32_16x16x32_bf16 v[200:203], a[4:7], v[148:151], v[200:203]
    v_mfma_f32_16x16x32_bf16 v[220:223], v[156:159], v[76:79], v[220:223]
    v_mfma_f32_16x16x32_bf16 v[204:207], a[60:63], v[148:151], v[204:207]
    ds_read_b128 v[144:147], v5 offset:20480
    ds_read_b128 v[148:151], v5 offset:53248
    ds_read_b128 v[152:155], v6 offset:20480
    ds_read_b128 v[156:159], v6 offset:53248
    s_waitcnt lgkmcnt(8)
    v_mfma_f32_16x16x32_bf16 v[208:211], v[160:163], v[80:83], v[208:211]
    v_mfma_f32_16x16x32_bf16 v[192:195], a[8:11], v[160:163], v[192:195]
    v_mfma_f32_16x16x32_bf16 v[212:215], v[164:167], v[80:83], v[212:215]
    v_mfma_f32_16x16x32_bf16 v[196:199], a[64:67], v[160:163], v[196:199]
    v_mfma_f32_16x16x32_bf16 v[216:219], v[168:171], v[80:83], v[216:219]
    v_mfma_f32_16x16x32_bf16 v[200:203], a[8:11], v[164:167], v[200:203]
    v_mfma_f32_16x16x32_bf16 v[220:223], v[172:175], v[80:83], v[220:223]
    v_mfma_f32_16x16x32_bf16 v[204:207], a[64:67], v[164:167], v[204:207]
    ds_read_b128 v[160:163], v5 offset:21504
    ds_read_b128 v[164:167], v5 offset:54272
    ds_read_b128 v[168:171], v6 offset:21504
    ds_read_b128 v[172:175], v6 offset:54272
    s_waitcnt lgkmcnt(8)
    v_mfma_f32_16x16x32_bf16 v[208:211], v[128:131], v[84:87], v[208:211]
    v_mfma_f32_16x16x32_bf16 v[192:195], a[12:15], v[128:131], v[192:195]
    v_mfma_f32_16x16x32_bf16 v[212:215], v[132:135], v[84:87], v[212:215]
    v_mfma_f32_16x16x32_bf16 v[196:199], a[68:71], v[128:131], v[196:199]
    v_mfma_f32_16x16x32_bf16 v[216:219], v[136:139], v[84:87], v[216:219]
    v_mfma_f32_16x16x32_bf16 v[200:203], a[12:15], v[132:135], v[200:203]
    v_mfma_f32_16x16x32_bf16 v[220:223], v[140:143], v[84:87], v[220:223]
    v_mfma_f32_16x16x32_bf16 v[204:207], a[68:71], v[132:135], v[204:207]
    ds_read_b128 v[128:131], v5 offset:22528
    ds_read_b128 v[132:135], v5 offset:55296
    ds_read_b128 v[136:139], v6 offset:22528
    ds_read_b128 v[140:143], v6 offset:55296
    s_waitcnt lgkmcnt(8)
    v_mfma_f32_16x16x32_bf16 v[208:211], v[144:147], v[88:91], v[208:211]
    v_mfma_f32_16x16x32_bf16 v[192:195], a[16:19], v[144:147], v[192:195]
    v_mfma_f32_16x16x32_bf16 v[212:215], v[148:151], v[88:91], v[212:215]
    v_mfma_f32_16x16x32_bf16 v[196:199], a[72:75], v[144:147], v[196:199]
    v_mfma_f32_16x16x32_bf16 v[216:219], v[152:155], v[88:91], v[216:219]
    v_mfma_f32_16x16x32_bf16 v[200:203], a[16:19], v[148:151], v[200:203]
    v_mfma_f32_16x16x32_bf16 v[220:223], v[156:159], v[88:91], v[220:223]
    v_mfma_f32_16x16x32_bf16 v[204:207], a[72:75], v[148:151], v[204:207]
    ds_read_b128 v[144:147], v5 offset:23552
    ds_read_b128 v[148:151], v5 offset:56320
    ds_read_b128 v[152:155], v6 offset:23552
    ds_read_b128 v[156:159], v6 offset:56320
    s_waitcnt lgkmcnt(8)
    v_mfma_f32_16x16x32_bf16 v[208:211], v[160:163], v[92:95], v[208:211]
    v_mfma_f32_16x16x32_bf16 v[192:195], a[20:23], v[160:163], v[192:195]
    v_mfma_f32_16x16x32_bf16 v[212:215], v[164:167], v[92:95], v[212:215]
    v_mfma_f32_16x16x32_bf16 v[196:199], a[76:79], v[160:163], v[196:199]
    v_mfma_f32_16x16x32_bf16 v[216:219], v[168:171], v[92:95], v[216:219]
    v_mfma_f32_16x16x32_bf16 v[200:203], a[20:23], v[164:167], v[200:203]
    v_mfma_f32_16x16x32_bf16 v[220:223], v[172:175], v[92:95], v[220:223]
    v_mfma_f32_16x16x32_bf16 v[204:207], a[76:79], v[164:167], v[204:207]
    ds_read_b128 v[160:163], v5 offset:24576
    ds_read_b128 v[164:167], v5 offset:57344
    ds_read_b128 v[168:171], v6 offset:24576
    ds_read_b128 v[172:175], v6 offset:57344
    s_waitcnt lgkmcnt(8)
    v_mfma_f32_16x16x32_bf16 v[208:211], v[128:131], v[96:99], v[208:211]
    v_mfma_f32_16x16x32_bf16 v[192:195], a[24:27], v[128:131], v[192:195]
    v_mfma_f32_16x16x32_bf16 v[212:215], v[132:135], v[96:99], v[212:215]
    v_mfma_f32_16x16x32_bf16 v[196:199], a[80:83], v[128:131], v[196:199]
    v_mfma_f32_16x16x32_bf16 v[216:219], v[136:139], v[96:99], v[216:219]
    v_mfma_f32_16x16x32_bf16 v[200:203], a[24:27], v[132:135], v[200:203]
    v_mfma_f32_16x16x32_bf16 v[220:223], v[140:143], v[96:99], v[220:223]
    v_mfma_f32_16x16x32_bf16 v[204:207], a[80:83], v[132:135], v[204:207]
    ds_read_b128 v[128:131], v5 offset:25600
    ds_read_b128 v[132:135], v5 offset:58368
    ds_read_b128 v[136:139], v6 offset:25600
    ds_read_b128 v[140:143], v6 offset:58368
    s_waitcnt lgkmcnt(8)
    v_mfma_f32_16x16x32_bf16 v[208:211], v[144:147], v[100:103], v[208:211]
    v_mfma_f32_16x16x32_bf16 v[192:195], a[28:31], v[144:147], v[192:195]
    v_mfma_f32_16x16x32_bf16 v[212:215], v[148:151], v[100:103], v[212:215]
    v_mfma_f32_16x16x32_bf16 v[196:199], a[84:87], v[144:147], v[196:199]
    v_mfma_f32_16x16x32_bf16 v[216:219], v[152:155], v[100:103], v[216:219]
    v_mfma_f32_16x16x32_bf16 v[200:203], a[28:31], v[148:151], v[200:203]
    v_mfma_f32_16x16x32_bf16 v[220:223], v[156:159], v[100:103], v[220:223]
    v_mfma_f32_16x16x32_bf16 v[204:207], a[84:87], v[148:151], v[204:207]
    ds_read_b128 v[144:147], v5 offset:26624
    ds_read_b128 v[148:151], v5 offset:59392
    ds_read_b128 v[152:155], v6 offset:26624
    ds_read_b128 v[156:159], v6 offset:59392
    s_waitcnt lgkmcnt(8)
    v_mfma_f32_16x16x32_bf16 v[208:211], v[160:163], v[104:107], v[208:211]
    v_mfma_f32_16x16x32_bf16 v[192:195], a[32:35], v[160:163], v[192:195]
    v_mfma_f32_16x16x32_bf16 v[212:215], v[164:167], v[104:107], v[212:215]
    v_mfma_f32_16x16x32_bf16 v[196:199], a[88:91], v[160:163], v[196:199]
    v_mfma_f32_16x16x32_bf16 v[216:219], v[168:171], v[104:107], v[216:219]
    v_mfma_f32_16x16x32_bf16 v[200:203], a[32:35], v[164:167], v[200:203]
    v_mfma_f32_16x16x32_bf16 v[220:223], v[172:175], v[104:107], v[220:223]
    v_mfma_f32_16x16x32_bf16 v[204:207], a[88:91], v[164:167], v[204:207]
    ds_read_b128 v[160:163], v5 offset:27648
    ds_read_b128 v[164:167], v5 offset:60416
    ds_read_b128 v[168:171], v6 offset:27648
    ds_read_b128 v[172:175], v6 offset:60416
    s_lshl_b32 s34, s12, 2
    s_add_u32 s34, s34, 116395008
    s_waitcnt vmcnt(0)
    s_barrier
    s_cmp_lg_u32 s13, 1
    s_cbranch_scc1 NOFF_181
    v_mov_b32 v15, 1
    s_mov_b64 exec, 1
    buffer_store_dword v15, off, s[8:11], s34 sc1
    s_mov_b64 exec, -1
NOFF_181:
    s_waitcnt lgkmcnt(8)
    v_mfma_f32_16x16x32_bf16 v[208:211], v[128:131], v[108:111], v[208:211]
    v_mfma_f32_16x16x32_bf16 v[192:195], a[36:39], v[128:131], v[192:195]
    v_mfma_f32_16x16x32_bf16 v[212:215], v[132:135], v[108:111], v[212:215]
    v_mfma_f32_16x16x32_bf16 v[196:199], a[92:95], v[128:131], v[196:199]
    v_mfma_f32_16x16x32_bf16 v[216:219], v[136:139], v[108:111], v[216:219]
    v_mfma_f32_16x16x32_bf16 v[200:203], a[36:39], v[132:135], v[200:203]
    v_mfma_f32_16x16x32_bf16 v[220:223], v[140:143], v[108:111], v[220:223]
    v_mfma_f32_16x16x32_bf16 v[204:207], a[92:95], v[132:135], v[204:207]
    ds_read_b128 v[128:131], v5 offset:28672
    ds_read_b128 v[132:135], v5 offset:61440
    ds_read_b128 v[136:139], v6 offset:28672
    ds_read_b128 v[140:143], v6 offset:61440
    s_waitcnt lgkmcnt(8)
    v_mfma_f32_16x16x32_bf16 v[208:211], v[144:147], v[112:115], v[208:211]
    v_mfma_f32_16x16x32_bf16 v[192:195], a[40:43], v[144:147], v[192:195]
    v_mfma_f32_16x16x32_bf16 v[212:215], v[148:151], v[112:115], v[212:215]
    v_mfma_f32_16x16x32_bf16 v[196:199], a[96:99], v[144:147], v[196:199]
    v_mfma_f32_16x16x32_bf16 v[216:219], v[152:155], v[112:115], v[216:219]
    v_mfma_f32_16x16x32_bf16 v[200:203], a[40:43], v[148:151], v[200:203]
    v_mfma_f32_16x16x32_bf16 v[220:223], v[156:159], v[112:115], v[220:223]
    v_mfma_f32_16x16x32_bf16 v[204:207], a[96:99], v[148:151], v[204:207]
    ds_read_b128 v[144:147], v5 offset:29696
    ds_read_b128 v[148:151], v5 offset:62464
    ds_read_b128 v[152:155], v6 offset:29696
    ds_read_b128 v[156:159], v6 offset:62464
    s_waitcnt lgkmcnt(8)
    v_mfma_f32_16x16x32_bf16 v[208:211], v[160:163], v[116:119], v[208:211]
    v_mfma_f32_16x16x32_bf16 v[192:195], a[44:47], v[160:163], v[192:195]
    v_mfma_f32_16x16x32_bf16 v[212:215], v[164:167], v[116:119], v[212:215]
    v_mfma_f32_16x16x32_bf16 v[196:199], a[100:103], v[160:163], v[196:199]
    v_mfma_f32_16x16x32_bf16 v[216:219], v[168:171], v[116:119], v[216:219]
    v_mfma_f32_16x16x32_bf16 v[200:203], a[44:47], v[164:167], v[200:203]
    v_mfma_f32_16x16x32_bf16 v[220:223], v[172:175], v[116:119], v[220:223]
    v_mfma_f32_16x16x32_bf16 v[204:207], a[100:103], v[164:167], v[204:207]
    s_waitcnt lgkmcnt(4)
    v_mfma_f32_16x16x32_bf16 v[208:211], v[128:131], v[120:123], v[208:211]
    v_mfma_f32_16x16x32_bf16 v[192:195], a[48:51], v[128:131], v[192:195]
    v_mfma_f32_16x16x32_bf16 v[212:215], v[132:135], v[120:123], v[212:215]
    v_mfma_f32_16x16x32_bf16 v[196:199], a[104:107], v[128:131], v[196:199]
    v_mfma_f32_16x16x32_bf16 v[216:219], v[136:139], v[120:123], v[216:219]
    v_mfma_f32_16x16x32_bf16 v[200:203], a[48:51], v[132:135], v[200:203]
    v_mfma_f32_16x16x32_bf16 v[220:223], v[140:143], v[120:123], v[220:223]
    v_mfma_f32_16x16x32_bf16 v[204:207], a[104:107], v[132:135], v[204:207]
    s_waitcnt lgkmcnt(0)
    v_mfma_f32_16x16x32_bf16 v[208:211], v[144:147], v[124:127], v[208:211]
    v_mfma_f32_16x16x32_bf16 v[192:195], a[52:55], v[144:147], v[192:195]
    v_mfma_f32_16x16x32_bf16 v[212:215], v[148:151], v[124:127], v[212:215]
    v_mfma_f32_16x16x32_bf16 v[196:199], a[108:111], v[144:147], v[196:199]
    v_mfma_f32_16x16x32_bf16 v[216:219], v[152:155], v[124:127], v[216:219]
    v_mfma_f32_16x16x32_bf16 v[200:203], a[52:55], v[148:151], v[200:203]
    v_mfma_f32_16x16x32_bf16 v[220:223], v[156:159], v[124:127], v[220:223]
    v_mfma_f32_16x16x32_bf16 v[204:207], a[108:111], v[148:151], v[204:207]
    v_cvt_pk_bf16_f32 v232, v208, v212
    v_cvt_pk_bf16_f32 v233, v209, v213
    v_cvt_pk_bf16_f32 v234, v210, v214
    v_cvt_pk_bf16_f32 v235, v211, v215
    s_add_u32 s19, s22, 1835008
    buffer_store_dwordx4 v[232:235], v2, s[8:11], s19 offen sc1
    v_cvt_pk_bf16_f32 v236, v216, v220
    v_cvt_pk_bf16_f32 v237, v217, v221
    v_cvt_pk_bf16_f32 v238, v218, v222
    v_cvt_pk_bf16_f32 v239, v219, v223
    s_add_u32 s19, s23, 1835008
    buffer_store_dwordx4 v[236:239], v2, s[8:11], s19 offen sc1
    v_cvt_pk_bf16_f32 v224, v192, v193
    v_cvt_pk_bf16_f32 v225, v194, v195
    v_cvt_pk_bf16_f32 v226, v196, v197
    v_cvt_pk_bf16_f32 v227, v198, v199
    s_add_u32 s19, s21, 1835008
    buffer_store_dwordx4 v[224:227], v2, s[8:11], s19 offen sc1
    v_cvt_pk_bf16_f32 v228, v200, v201
    v_cvt_pk_bf16_f32 v229, v202, v203
    v_cvt_pk_bf16_f32 v230, v204, v205
    v_cvt_pk_bf16_f32 v231, v206, v207
    s_add_u32 s19, s21, 1849344
    buffer_store_dwordx4 v[228:231], v2, s[8:11], s19 offen sc1
    s_lshl_b32 s34, s12, 2
    s_add_u32 s34, s34, 116395008
    s_waitcnt vmcnt(0)
    s_barrier
    s_cmp_lg_u32 s13, 1
    s_cbranch_scc1 NOFF_182
    v_mov_b32 v15, 2
    s_mov_b64 exec, 1
    buffer_store_dword v15, off, s[8:11], s34 sc1
    s_mov_b64 exec, -1
NOFF_182:
    v_and_b32 v1, 63, v0
    v_lshlrev_b32 v2, 4, v1
    v_and_b32 v3, 15, v1
    v_lshrrev_b32 v4, 4, v1
    s_mul_i32 s14, s12, 9363
    s_lshr_b32 s14, s14, 16
    s_mul_i32 s15, s14, 7
    s_sub_u32 s15, s12, s15
    s_and_b32 s16, s14, 15
    s_cmp_lt_u32 s15, 2
    s_cbranch_scc1 W_PROD
    s_cmp_lt_u32 s15, 5
    s_cbranch_scc1 W_H
    s_sub_u32 s38, s15, 5
    s_mov_b32 s39, s38
    s_mov_b32 s43, 2
    s_mov_b32 s59, 8
    s_cmp_lg_u32 s13, 0
    s_cbranch_scc1 WFZ_184
    s_mov_b32 s35, 0
    s_lshl_b32 s30, s14, 4
    s_add_u32 s30, s30, 116400128
    v_mov_b32 v16, 0
    s_branch WF0_185
WF_183:
    s_sleep 32
WF0_185:
    buffer_load_dword v18, v16, s[8:11], s30 offen sc1
    s_add_u32 s35, s35, 1
    s_cmp_gt_u32 s35, 4000000
    s_cbranch_scc1 MEGA_EXIT
    s_waitcnt vmcnt(0)
    v_cmp_eq_u32 vcc, 0, v18
    s_cbranch_vccnz WF_183
WFZ_184:
    s_branch W_KV
W_PROD:
    s_add_u32 s39, s15, 8
    s_mov_b32 s43, 2
    s_mov_b32 s59, 64
    s_cmp_lg_u32 s13, 0
    s_cbranch_scc1 WFZ_187
    s_mov_b32 s35, 0
    s_lshl_b32 s30, s14, 8
    s_add_u32 s30, s30, 116449280
    v_min_u32 v16, 55, v1
    v_lshlrev_b32 v16, 2, v16
    s_branch WF0_188
WF_186:
    s_sleep 4
WF0_188:
    buffer_load_dword v18, v16, s[8:11], s30 offen sc1
    s_add_u32 s35, s35, 1
    s_cmp_gt_u32 s35, 4000000
    s_cbranch_scc1 MEGA_EXIT
    s_waitcnt vmcnt(0)
    v_cmp_eq_u32 vcc, 0, v18
    s_cbranch_vccnz WF_186
WFZ_187:
    s_barrier
W_KV:
    s_barrier
    s_and_b32 s17, s13, 1
    s_mul_i32 s18, s13, 7
    s_add_u32 s19, s18, s17
    s_xor_b32 s20, s17, 1
    s_mul_i32 s20, s20, 6
    s_add_u32 s20, s20, s18
    s_mul_i32 s21, s14, 401408
    s_mov_b32 s29, 0
    s_mov_b32 s28, s39
    s_mul_i32 s26, s28, 28672
    s_mul_i32 s27, s13, 7168
    s_add_u32 s26, s26, s27
    s_add_u32 s26, s26, 83886080
    s_add_u32 m0, s29, s27
    s_nop 0
    buffer_load_dwordx4 v2, s[8:11], s26 offen offset:0 sc1 lds
    buffer_load_dwordx4 v2, s[8:11], s26 offen offset:1024 sc1 lds
    buffer_load_dwordx4 v2, s[8:11], s26 offen offset:2048 sc1 lds
    buffer_load_dwordx4 v2, s[8:11], s26 offen offset:3072 sc1 lds
    s_add_u32 s26, s26, 4096
    s_add_u32 m0, m0, 4096
    s_nop 0
    buffer_load_dwordx4 v2, s[8:11], s26 offen offset:0 sc1 lds
    buffer_load_dwordx4 v2, s[8:11], s26 offen offset:1024 sc1 lds
    buffer_load_dwordx4 v2, s[8:11], s26 offen offset:2048 sc1 lds
    s_mul_i32 s22, s19, 14336
    s_add_u32 s22, s22, s21
    s_mul_i32 s23, s20, 14336
    s_add_u32 s23, s23, s21
    s_add_u32 s24, s22, 0
    buffer_load_dwordx4 v[120:123], v2, s[8:11], s24 offen offset:0 sc1
    buffer_load_dwordx4 v[124:127], v2, s[8:11], s24 offen offset:1024 sc1
    s_add_u32 s24, s22, 14336
    buffer_load_dwordx4 v[176:179], v2, s[8:11], s24 offen offset:0 sc1
    buffer_load_dwordx4 v[180:183], v2, s[8:11], s24 offen offset:1024 sc1
    s_add_u32 s24, s22, 28672
    buffer_load_dwordx4 v[232:235], v2, s[8:11], s24 offen offset:0 sc1
    buffer_load_dwordx4 v[236:239], v2, s[8:11], s24 offen offset:1024 sc1
    s_add_u32 s24, s22, 43008
    buffer_load_dwordx4 a[32:35], v2, s[8:11], s24 offen offset:0 sc1
    buffer_load_dwordx4 a[36:39], v2, s[8:11], s24 offen offset:1024 sc1
    s_add_u32 s24, s22, 57344
    buffer_load_dwordx4 a[88:91], v2, s[8:11], s24 offen offset:0 sc1
    buffer_load_dwordx4 a[92:95], v2, s[8:11], s24 offen offset:1024 sc1
    s_add_u32 s24, s22, 71680
    buffer_load_dwordx4 a[144:147], v2, s[8:11], s24 offen offset:0 sc1
    buffer_load_dwordx4 a[148:151], v2, s[8:11], s24 offen offset:1024 sc1
    s_add_u32 s24, s23, 0
    buffer_load_dwordx4 a[200:203], v2, s[8:11], s24 offen offset:0 sc1
    buffer_load_dwordx4 a[204:207], v2, s[8:11], s24 offen offset:1024 sc1
    s_add_u32 s24, s22, 2048
    buffer_load_dwordx4 v[128:131], v2, s[8:11], s24 offen offset:0 sc1
    buffer_load_dwordx4 v[132:135], v2, s[8:11], s24 offen offset:1024 sc1
    s_add_u32 s24, s22, 16384
    buffer_load_dwordx4 v[184:187], v2, s[8:11], s24 offen offset:0 sc1
    buffer_load_dwordx4 v[188:191], v2, s[8:11], s24 offen offset:1024 sc1
    s_add_u32 s24, s22, 30720
    buffer_load_dwordx4 v[240:243], v2, s[8:11], s24 offen offset:0 sc1
    buffer_load_dwordx4 v[244:247], v2, s[8:11], s24 offen offset:1024 sc1
    s_add_u32 s24, s22, 45056
    buffer_load_dwordx4 a[40:43], v2, s[8:11], s24 offen offset:0 sc1
    buffer_load_dwordx4 a[44:47], v2, s[8:11], s24 offen offset:1024 sc1
    s_add_u32 s24, s22, 59392
    buffer_load_dwordx4 a[96:99], v2, s[8:11], s24 offen offset:0 sc1
    buffer_load_dwordx4 a[100:103], v2, s[8:11], s24 offen offset:1024 sc1
    s_add_u32 s24, s22, 73728
    buffer_load_dwordx4 a[152:155], v2, s[8:11], s24 offen offset:0 sc1
    buffer_load_dwordx4 a[156:159], v2, s[8:11], s24 offen offset:1024 sc1
    s_add_u32 s24, s23, 2048
    buffer_load_dwordx4 a[208:211], v2, s[8:11], s24 offen offset:0 sc1
    buffer_load_dwordx4 a[212:215], v2, s[8:11], s24 offen offset:1024 sc1
    s_add_u32 s24, s22, 4096
    buffer_load_dwordx4 v[136:139], v2, s[8:11], s24 offen offset:0 sc1
    buffer_load_dwordx4 v[140:143], v2, s[8:11], s24 offen offset:1024 sc1
    s_add_u32 s24, s22, 18432
    buffer_load_dwordx4 v[192:195], v2, s[8:11], s24 offen offset:0 sc1
    buffer_load_dwordx4 v[196:199], v2, s[8:11], s24 offen offset:1024 sc1
    s_add_u32 s24, s22, 32768
    buffer_load_dwordx4 v[248:251], v2, s[8:11], s24 offen offset:0 sc1
    buffer_load_dwordx4 v[252:255], v2, s[8:11], s24 offen offset:1024 sc1
    s_add_u32 s24, s22, 47104
    buffer_load_dwordx4 a[48:51], v2, s[8:11], s24 offen offset:0 sc1
    buffer_load_dwordx4 a[52:55], v2, s[8:11], s24 offen offset:1024 sc1
    s_add_u32 s24, s22, 61440
    buffer_load_dwordx4 a[104:107], v2, s[8:11], s24 offen offset:0 sc1
    buffer_load_dwordx4 a[108:111], v2, s[8:11], s24 offen offset:1024 sc1
    s_add_u32 s24, s22, 75776
    buffer_load_dwordx4 a[160:163], v2, s[8:11], s24 offen offset:0 sc1
    buffer_load_dwordx4 a[164:167], v2, s[8:11], s24 offen offset:1024 sc1
    s_add_u32 s24, s23, 4096
    buffer_load_dwordx4 a[216:219], v2, s[8:11], s24 offen offset:0 sc1
    buffer_load_dwordx4 a[220:223], v2, s[8:11], s24 offen offset:1024 sc1
    s_add_u32 s24, s22, 6144
    buffer_load_dwordx4 v[144:147], v2, s[8:11], s24 offen offset:0 sc1
    buffer_load_dwordx4 v[148:151], v2, s[8:11], s24 offen offset:1024 sc1
    s_add_u32 s24, s22, 20480
    buffer_load_dwordx4 v[200:203], v2, s[8:11], s24 offen offset:0 sc1
    buffer_load_dwordx4 v[204:207], v2, s[8:11], s24 offen offset:1024 sc1
    s_add_u32 s24, s22, 34816
    buffer_load_dwordx4 a[0:3], v2, s[8:11], s24 offen offset:0 sc1
    buffer_load_dwordx4 a[4:7], v2, s[8:11], s24 offen offset:1024 sc1
    s_add_u32 s24, s22, 49152
    buffer_load_dwordx4 a[56:59], v2, s[8:11], s24 offen offset:0 sc1
    buffer_load_dwordx4 a[60:63], v2, s[8:11], s24 offen offset:1024 sc1
    s_add_u32 s24, s22, 63488
    buffer_load_dwordx4 a[112:115], v2, s[8:11], s24 offen offset:0 sc1
    buffer_load_dwordx4 a[116:119], v2, s[8:11], s24 offen offset:1024 sc1
    s_add_u32 s24, s22, 77824
    buffer_load_dwordx4 a[168:171], v2, s[8:11], s24 offen offset:0 sc1
    buffer_load_dwordx4 a[172:175], v2, s[8:11], s24 offen offset:1024 sc1
    s_add_u32 s24, s23, 6144
    buffer_load_dwordx4 a[224:227], v2, s[8:11], s24 offen offset:0 sc1
    buffer_load_dwordx4 a[228:231], v2, s[8:11], s24 offen offset:1024 sc1
    s_add_u32 s24, s22, 8192
    buffer_load_dwordx4 v[152:155], v2, s[8:11], s24 offen offset:0 sc1
    buffer_load_dwordx4 v[156:159], v2, s[8:11], s24 offen offset:1024 sc1
    s_add_u32 s24, s22, 22528
    buffer_load_dwordx4 v[208:211], v2, s[8:11], s24 offen offset:0 sc1
    buffer_load_dwordx4 v[212:215], v2, s[8:11], s24 offen offset:1024 sc1
    s_add_u32 s24, s22, 36864
    buffer_load_dwordx4 a[8:11], v2, s[8:11], s24 offen offset:0 sc1
    buffer_load_dwordx4 a[12:15], v2, s[8:11], s24 offen offset:1024 sc1
    s_add_u32 s24, s22, 51200
    buffer_load_dwordx4 a[64:67], v2, s[8:11], s24 offen offset:0 sc1
    buffer_load_dwordx4 a[68:71], v2, s[8:11], s24 offen offset:1024 sc1
    s_add_u32 s24, s22, 65536
    buffer_load_dwordx4 a[120:123], v2, s[8:11], s24 offen offset:0 sc1
    buffer_load_dwordx4 a[124:127], v2, s[8:11], s24 offen offset:1024 sc1
    s_add_u32 s24, s22, 79872
    buffer_load_dwordx4 a[176:179], v2, s[8:11], s24 offen offset:0 sc1
    buffer_load_dwordx4 a[180:183], v2, s[8:11], s24 offen offset:1024 sc1
    s_add_u32 s24, s23, 8192
    buffer_load_dwordx4 a[232:235], v2, s[8:11], s24 offen offset:0 sc1
    buffer_load_dwordx4 a[236:239], v2, s[8:11], s24 offen offset:1024 sc1
    s_add_u32 s24, s22, 10240
    buffer_load_dwordx4 v[160:163], v2, s[8:11], s24 offen offset:0 sc1
    buffer_load_dwordx4 v[164:167], v2, s[8:11], s24 offen offset:1024 sc1
    s_add_u32 s24, s22, 24576
    buffer_load_dwordx4 v[216:219], v2, s[8:11], s24 offen offset:0 sc1
    buffer_load_dwordx4 v[220:223], v2, s[8:11], s24 offen offset:1024 sc1
    s_add_u32 s24, s22, 38912
    buffer_load_dwordx4 a[16:19], v2, s[8:11], s24 offen offset:0 sc1
    buffer_load_dwordx4 a[20:23], v2, s[8:11], s24 offen offset:1024 sc1
    s_add_u32 s24, s22, 53248
    buffer_load_dwordx4 a[72:75], v2, s[8:11], s24 offen offset:0 sc1
    buffer_load_dwordx4 a[76:79], v2, s[8:11], s24 offen offset:1024 sc1
    s_add_u32 s24, s22, 67584
    buffer_load_dwordx4 a[128:131], v2, s[8:11], s24 offen offset:0 sc1
    buffer_load_dwordx4 a[132:135], v2, s[8:11], s24 offen offset:1024 sc1
    s_add_u32 s24, s22, 81920
    buffer_load_dwordx4 a[184:187], v2, s[8:11], s24 offen offset:0 sc1
    buffer_load_dwordx4 a[188:191], v2, s[8:11], s24 offen offset:1024 sc1
    s_add_u32 s24, s23, 10240
    buffer_load_dwordx4 a[240:243], v2, s[8:11], s24 offen offset:0 sc1
    buffer_load_dwordx4 a[244:247], v2, s[8:11], s24 offen offset:1024 sc1
    s_add_u32 s24, s22, 12288
    buffer_load_dwordx4 v[168:171], v2, s[8:11], s24 offen offset:0 sc1
    buffer_load_dwordx4 v[172:175], v2, s[8:11], s24 offen offset:1024 sc1
    s_add_u32 s24, s22, 26624
    buffer_load_dwordx4 v[224:227], v2, s[8:11], s24 offen offset:0 sc1
    buffer_load_dwordx4 v[228:231], v2, s[8:11], s24 offen offset:1024 sc1
    s_add_u32 s24, s22, 40960
    buffer_load_dwordx4 a[24:27], v2, s[8:11], s24 offen offset:0 sc1
    buffer_load_dwordx4 a[28:31], v2, s[8:11], s24 offen offset:1024 sc1
    s_add_u32 s24, s22, 55296
    buffer_load_dwordx4 a[80:83], v2, s[8:11], s24 offen offset:0 sc1
    buffer_load_dwordx4 a[84:87], v2, s[8:11], s24 offen offset:1024 sc1
    s_add_u32 s24, s22, 69632
    buffer_load_dwordx4 a[136:139], v2, s[8:11], s24 offen offset:0 sc1
    buffer_load_dwordx4 a[140:143], v2, s[8:11], s24 offen offset:1024 sc1
    s_add_u32 s24, s22, 83968
    buffer_load_dwordx4 a[192:195], v2, s[8:11], s24 offen offset:0 sc1
    buffer_load_dwordx4 a[196:199], v2, s[8:11], s24 offen offset:1024 sc1
    s_add_u32 s24, s23, 12288
    buffer_load_dwordx4 a[248:251], v2, s[8:11], s24 offen offset:0 sc1
    buffer_load_dwordx4 a[252:255], v2, s[8:11], s24 offen offset:1024 sc1
    s_lshr_b32 s23, s19, 1
    s_lshl_b32 s23, s23, 10
    s_lshr_b32 s24, s20, 1
    s_lshl_b32 s24, s24, 10
    s_lshl_b32 s25, s17, 3
    s_add_u32 s24, s24, s25
    s_cmp_ge_u32 s14, 16
    s_cbranch_scc1 W_V
    s_mov_b32 s34, 0
    s_mov_b32 s84, s8
    s_mov_b32 s85, s9
    s_cmp_lt_u32 s15, 7
    s_cselect_b32 s86, 268435456, 0
    s_mov_b32 s87, 0x20000
    v_lshrrev_b32 v8, 5, v1
    v_mul_u32_u24 v8, 14336, v8
    v_and_b32 v9, 31, v1
    v_lshl_add_u32 v8, v9, 7, v8
    s_lshr_b32 s32, s18, 1
    s_lshl_b32 s32, s32, 10
    v_add_u32 v8, s32, v8
    s_waitcnt vmcnt(63)
KVL_189:
    s_barrier
    s_add_u32 s30, s28, s43
    s_sub_u32 s31, 28672, s29
    s_cmp_ge_u32 s30, s59
    s_cbranch_scc1 KVN_190
    s_mul_i32 s26, s30, 28672
    s_mul_i32 s27, s13, 7168
    s_add_u32 s26, s26, s27
    s_add_u32 s26, s26, 83886080
    s_add_u32 m0, s31, s27
    s_nop 0
    buffer_load_dwordx4 v2, s[8:11], s26 offen offset:0 sc1 lds
    buffer_load_dwordx4 v2, s[8:11], s26 offen offset:1024 sc1 lds
    buffer_load_dwordx4 v2, s[8:11], s26 offen offset:2048 sc1 lds
    buffer_load_dwordx4 v2, s[8:11], s26 offen offset:3072 sc1 lds
    s_add_u32 s26, s26, 4096
    s_add_u32 m0, m0, 4096
    s_nop 0
    buffer_load_dwordx4 v2, s[8:11], s26 offen offset:0 sc1 lds
    buffer_load_dwordx4 v2, s[8:11], s26 offen offset:1024 sc1 lds
    buffer_load_dwordx4 v2, s[8:11], s26 offen offset:2048 sc1 lds
KVN_190:
    v_add_u32 v7, s29, v2
    ds_read_b128 v[16:19], v7 offset:0
    ds_read_b128 v[20:23], v7 offset:14336
    ds_read_b128 v[24:27], v7 offset:1024
    ds_read_b128 v[28:31], v7 offset:15360
    s_waitcnt vmcnt(63) lgkmcnt(2)
    v_mfma_f32_16x16x32_bf16 v[64:67], v[120:123], v[16:19], 0
    v_mfma_f32_16x16x32_bf16 v[68:71], v[176:179], v[16:19], 0
    v_mfma_f32_16x16x32_bf16 v[72:75], v[232:235], v[16:19], 0
    v_mfma_f32_16x16x32_bf16 v[76:79], a[32:35], v[16:19], 0
    v_mfma_f32_16x16x32_bf16 v[80:83], a[88:91], v[16:19], 0
    v_mfma_f32_16x16x32_bf16 v[84:87], a[144:147], v[16:19], 0
    v_mfma_f32_16x16x32_bf16 v[88:91], a[200:203], v[16:19], 0
    v_mfma_f32_16x16x32_bf16 v[92:95], v[120:123], v[20:23], 0
    v_mfma_f32_16x16x32_bf16 v[96:99], v[176:179], v[20:23], 0
    v_mfma_f32_16x16x32_bf16 v[100:103], v[232:235], v[20:23], 0
    v_mfma_f32_16x16x32_bf16 v[104:107], a[32:35], v[20:23], 0
    v_mfma_f32_16x16x32_bf16 v[108:111], a[88:91], v[20:23], 0
    v_mfma_f32_16x16x32_bf16 v[112:115], a[144:147], v[20:23], 0
    v_mfma_f32_16x16x32_bf16 v[116:119], a[200:203], v[20:23], 0
    ds_read_b128 v[16:19], v7 offset:2048
    ds_read_b128 v[20:23], v7 offset:16384
    s_waitcnt lgkmcnt(2)
    v_mfma_f32_16x16x32_bf16 v[64:67], v[124:127], v[24:27], v[64:67]
    v_mfma_f32_16x16x32_bf16 v[68:71], v[180:183], v[24:27], v[68:71]
    v_mfma_f32_16x16x32_bf16 v[72:75], v[236:239], v[24:27], v[72:75]
    v_mfma_f32_16x16x32_bf16 v[76:79], a[36:39], v[24:27], v[76:79]
    v_mfma_f32_16x16x32_bf16 v[80:83], a[92:95], v[24:27], v[80:83]
    v_mfma_f32_16x16x32_bf16 v[84:87], a[148:151], v[24:27], v[84:87]
    v_mfma_f32_16x16x32_bf16 v[88:91], a[204:207], v[24:27], v[88:91]
    v_mfma_f32_16x16x32_bf16 v[92:95], v[124:127], v[28:31], v[92:95]
    v_mfma_f32_16x16x32_bf16 v[96:99], v[180:183], v[28:31], v[96:99]
    v_mfma_f32_16x16x32_bf16 v[100:103], v[236:239], v[28:31], v[100:103]
    v_mfma_f32_16x16x32_bf16 v[104:107], a[36:39], v[28:31], v[104:107]
    v_mfma_f32_16x16x32_bf16 v[108:111], a[92:95], v[28:31], v[108:111]
    v_mfma_f32_16x16x32_bf16 v[112:115], a[148:151], v[28:31], v[112:115]
    v_mfma_f32_16x16x32_bf16 v[116:119], a[204:207], v[28:31], v[116:119]
    ds_read_b128 v[24:27], v7 offset:3072
    ds_read_b128 v[28:31], v7 offset:17408
    s_waitcnt vmcnt(63) lgkmcnt(2)
    v_mfma_f32_16x16x32_bf16 v[64:67], v[128:131], v[16:19], v[64:67]
    v_mfma_f32_16x16x32_bf16 v[68:71], v[184:187], v[16:19], v[68:71]
    v_mfma_f32_16x16x32_bf16 v[72:75], v[240:243], v[16:19], v[72:75]
    v_mfma_f32_16x16x32_bf16 v[76:79], a[40:43], v[16:19], v[76:79]
    v_mfma_f32_16x16x32_bf16 v[80:83], a[96:99], v[16:19], v[80:83]
    v_mfma_f32_16x16x32_bf16 v[84:87], a[152:155], v[16:19], v[84:87]
    v_mfma_f32_16x16x32_bf16 v[88:91], a[208:211], v[16:19], v[88:91]
    v_mfma_f32_16x16x32_bf16 v[92:95], v[128:131], v[20:23], v[92:95]
    v_mfma_f32_16x16x32_bf16 v[96:99], v[184:187], v[20:23], v[96:99]
    v_mfma_f32_16x16x32_bf16 v[100:103], v[240:243], v[20:23], v[100:103]
    v_mfma_f32_16x16x32_bf16 v[104:107], a[40:43], v[20:23], v[104:107]
    v_mfma_f32_16x16x32_bf16 v[108:111], a[96:99], v[20:23], v[108:111]
    v_mfma_f32_16x16x32_bf16 v[112:115], a[152:155], v[20:23], v[112:115]
    v_mfma_f32_16x16x32_bf16 v[116:119], a[208:211], v[20:23], v[116:119]
    ds_read_b128 v[16:19], v7 offset:4096
    ds_read_b128 v[20:23], v7 offset:18432
    s_waitcnt lgkmcnt(2)
    v_mfma_f32_16x16x32_bf16 v[64:67], v[132:135], v[24:27], v[64:67]
    v_mfma_f32_16x16x32_bf16 v[68:71], v[188:191], v[24:27], v[68:71]
    v_mfma_f32_16x16x32_bf16 v[72:75], v[244:247], v[24:27], v[72:75]
    v_mfma_f32_16x16x32_bf16 v[76:79], a[44:47], v[24:27], v[76:79]
    v_mfma_f32_16x16x32_bf16 v[80:83], a[100:103], v[24:27], v[80:83]
    v_mfma_f32_16x16x32_bf16 v[84:87], a[156:159], v[24:27], v[84:87]
    v_mfma_f32_16x16x32_bf16 v[88:91], a[212:215], v[24:27], v[88:91]
    v_mfma_f32_16x16x32_bf16 v[92:95], v[132:135], v[28:31], v[92:95]
    v_mfma_f32_16x16x32_bf16 v[96:99], v[188:191], v[28:31], v[96:99]
    v_mfma_f32_16x16x32_bf16 v[100:103], v[244:247], v[28:31], v[100:103]
    v_mfma_f32_16x16x32_bf16 v[104:107], a[44:47], v[28:31], v[104:107]
    v_mfma_f32_16x16x32_bf16 v[108:111], a[100:103], v[28:31], v[108:111]
    v_mfma_f32_16x16x32_bf16 v[112:115], a[156:159], v[28:31], v[112:115]
    v_mfma_f32_16x16x32_bf16 v[116:119], a[212:215], v[28:31], v[116:119]
    ds_read_b128 v[24:27], v7 offset:5120
    ds_read_b128 v[28:31], v7 offset:19456
    s_waitcnt vmcnt(63) lgkmcnt(2)
    v_mfma_f32_16x16x32_bf16 v[64:67], v[136:139], v[16:19], v[64:67]
    v_mfma_f32_16x16x32_bf16 v[68:71], v[192:195], v[16:19], v[68:71]
    v_mfma_f32_16x16x32_bf16 v[72:75], v[248:251], v[16:19], v[72:75]
    v_mfma_f32_16x16x32_bf16 v[76:79], a[48:51], v[16:19], v[76:79]
    v_mfma_f32_16x16x32_bf16 v[80:83], a[104:107], v[16:19], v[80:83]
    v_mfma_f32_16x16x32_bf16 v[84:87], a[160:163], v[16:19], v[84:87]
    v_mfma_f32_16x16x32_bf16 v[88:91], a[216:219], v[16:19], v[88:91]
    v_mfma_f32_16x16x32_bf16 v[92:95], v[136:139], v[20:23], v[92:95]
    v_mfma_f32_16x16x32_bf16 v[96:99], v[192:195], v[20:23], v[96:99]
    v_mfma_f32_16x16x32_bf16 v[100:103], v[248:251], v[20:23], v[100:103]
    v_mfma_f32_16x16x32_bf16 v[104:107], a[48:51], v[20:23], v[104:107]
    v_mfma_f32_16x16x32_bf16 v[108:111], a[104:107], v[20:23], v[108:111]
    v_mfma_f32_16x16x32_bf16 v[112:115], a[160:163], v[20:23], v[112:115]
    v_mfma_f32_16x16x32_bf16 v[116:119], a[216:219], v[20:23], v[116:119]
    ds_read_b128 v[16:19], v7 offset:6144
    ds_read_b128 v[20:23], v7 offset:20480
    s_waitcnt lgkmcnt(2)
    v_mfma_f32_16x16x32_bf16 v[64:67], v[140:143], v[24:27], v[64:67]
    v_mfma_f32_16x16x32_bf16 v[68:71], v[196:199], v[24:27], v[68:71]
    v_mfma_f32_16x16x32_bf16 v[72:75], v[252:255], v[24:27], v[72:75]
    v_mfma_f32_16x16x32_bf16 v[76:79], a[52:55], v[24:27], v[76:79]
    v_mfma_f32_16x16x32_bf16 v[80:83], a[108:111], v[24:27], v[80:83]
    v_mfma_f32_16x16x32_bf16 v[84:87], a[164:167], v[24:27], v[84:87]
    v_mfma_f32_16x16x32_bf16 v[88:91], a[220:223], v[24:27], v[88:91]
    v_mfma_f32_16x16x32_bf16 v[92:95], v[140:143], v[28:31], v[92:95]
    v_mfma_f32_16x16x32_bf16 v[96:99], v[196:199], v[28:31], v[96:99]
    v_mfma_f32_16x16x32_bf16 v[100:103], v[252:255], v[28:31], v[100:103]
    v_mfma_f32_16x16x32_bf16 v[104:107], a[52:55], v[28:31], v[104:107]
    v_mfma_f32_16x16x32_bf16 v[108:111], a[108:111], v[28:31], v[108:111]
    v_mfma_f32_16x16x32_bf16 v[112:115], a[164:167], v[28:31], v[112:115]
    v_mfma_f32_16x16x32_bf16 v[116:119], a[220:223], v[28:31], v[116:119]
    ds_read_b128 v[24:27], v7 offset:7168
    ds_read_b128 v[28:31], v7 offset:21504
    s_waitcnt vmcnt(49) lgkmcnt(2)
    v_mfma_f32_16x16x32_bf16 v[64:67], v[144:147], v[16:19], v[64:67]
    v_mfma_f32_16x16x32_bf16 v[68:71], v[200:203], v[16:19], v[68:71]
    v_mfma_f32_16x16x32_bf16 v[72:75], a[0:3], v[16:19], v[72:75]
    v_mfma_f32_16x16x32_bf16 v[76:79], a[56:59], v[16:19], v[76:79]
    v_mfma_f32_16x16x32_bf16 v[80:83], a[112:115], v[16:19], v[80:83]
    v_mfma_f32_16x16x32_bf16 v[84:87], a[168:171], v[16:19], v[84:87]
    v_mfma_f32_16x16x32_bf16 v[88:91], a[224:227], v[16:19], v[88:91]
    v_mfma_f32_16x16x32_bf16 v[92:95], v[144:147], v[20:23], v[92:95]
    v_mfma_f32_16x16x32_bf16 v[96:99], v[200:203], v[20:23], v[96:99]
    v_mfma_f32_16x16x32_bf16 v[100:103], a[0:3], v[20:23], v[100:103]
    v_mfma_f32_16x16x32_bf16 v[104:107], a[56:59], v[20:23], v[104:107]
    v_mfma_f32_16x16x32_bf16 v[108:111], a[112:115], v[20:23], v[108:111]
    v_mfma_f32_16x16x32_bf16 v[112:115], a[168:171], v[20:23], v[112:115]
    v_mfma_f32_16x16x32_bf16 v[116:119], a[224:227], v[20:23], v[116:119]
    ds_read_b128 v[16:19], v7 offset:8192
    ds_read_b128 v[20:23], v7 offset:22528
    s_cmp_eq_u32 s34, 0
    s_cbranch_scc1 NF_192
    s_waitcnt vmcnt(0)
    v_mov_b32 v15, 1
    s_mov_b64 exec, 1
    buffer_store_dword v15, off, s[8:11], s34 sc1
    s_mov_b64 exec, -1
    s_mov_b32 s34, 0
NF_192:
    s_waitcnt lgkmcnt(2)
    v_mfma_f32_16x16x32_bf16 v[64:67], v[148:151], v[24:27], v[64:67]
    v_mfma_f32_16x16x32_bf16 v[68:71], v[204:207], v[24:27], v[68:71]
    v_mfma_f32_16x16x32_bf16 v[72:75], a[4:7], v[24:27], v[72:75]
    v_mfma_f32_16x16x32_bf16 v[76:79], a[60:63], v[24:27], v[76:79]
    v_mfma_f32_16x16x32_bf16 v[80:83], a[116:119], v[24:27], v[80:83]
    v_mfma_f32_16x16x32_bf16 v[84:87], a[172:175], v[24:27], v[84:87]
    v_mfma_f32_16x16x32_bf16 v[88:91], a[228:231], v[24:27], v[88:91]
    v_mfma_f32_16x16x32_bf16 v[92:95], v[148:151], v[28:31], v[92:95]
    v_mfma_f32_16x16x32_bf16 v[96:99], v[204:207], v[28:31], v[96:99]
    v_mfma_f32_16x16x32_bf16 v[100:103], a[4:7], v[28:31], v[100:103]
    v_mfma_f32_16x16x32_bf16 v[104:107], a[60:63], v[28:31], v[104:107]
    v_mfma_f32_16x16x32_bf16 v[108:111], a[116:119], v[28:31], v[108:111]
    v_mfma_f32_16x16x32_bf16 v[112:115], a[172:175], v[28:31], v[112:115]
    v_mfma_f32_16x16x32_bf16 v[116:119], a[228:231], v[28:31], v[116:119]
    ds_read_b128 v[24:27], v7 offset:9216
    ds_read_b128 v[28:31], v7 offset:23552
    s_waitcnt vmcnt(35) lgkmcnt(2)
    v_mfma_f32_16x16x32_bf16 v[64:67], v[152:155], v[16:19], v[64:67]
    v_mfma_f32_16x16x32_bf16 v[68:71], v[208:211], v[16:19], v[68:71]
    v_mfma_f32_16x16x32_bf16 v[72:75], a[8:11], v[16:19], v[72:75]
    v_mfma_f32_16x16x32_bf16 v[76:79], a[64:67], v[16:19], v[76:79]
    v_mfma_f32_16x16x32_bf16 v[80:83], a[120:123], v[16:19], v[80:83]
    v_mfma_f32_16x16x32_bf16 v[84:87], a[176:179], v[16:19], v[84:87]
    v_mfma_f32_16x16x32_bf16 v[88:91], a[232:235], v[16:19], v[88:91]
    v_mfma_f32_16x16x32_bf16 v[92:95], v[152:155], v[20:23], v[92:95]
    v_mfma_f32_16x16x32_bf16 v[96:99], v[208:211], v[20:23], v[96:99]
    v_mfma_f32_16x16x32_bf16 v[100:103], a[8:11], v[20:23], v[100:103]
    v_mfma_f32_16x16x32_bf16 v[104:107], a[64:67], v[20:23], v[104:107]
    v_mfma_f32_16x16x32_bf16 v[108:111], a[120:123], v[20:23], v[108:111]
    v_mfma_f32_16x16x32_bf16 v[112:115], a[176:179], v[20:23], v[112:115]
    v_mfma_f32_16x16x32_bf16 v[116:119], a[232:235], v[20:23], v[116:119]
    ds_read_b128 v[16:19], v7 offset:10240
    ds_read_b128 v[20:23], v7 offset:24576
    s_waitcnt lgkmcnt(2)
    v_mfma_f32_16x16x32_bf16 v[64:67], v[156:159], v[24:27], v[64:67]
    v_mfma_f32_16x16x32_bf16 v[68:71], v[212:215], v[24:27], v[68:71]
    v_mfma_f32_16x16x32_bf16 v[72:75], a[12:15], v[24:27], v[72:75]
    v_mfma_f32_16x16x32_bf16 v[76:79], a[68:71], v[24:27], v[76:79]
    v_mfma_f32_16x16x32_bf16 v[80:83], a[124:127], v[24:27], v[80:83]
    v_mfma_f32_16x16x32_bf16 v[84:87], a[180:183], v[24:27], v[84:87]
    v_mfma_f32_16x16x32_bf16 v[88:91], a[236:239], v[24:27], v[88:91]
    v_mfma_f32_16x16x32_bf16 v[92:95], v[156:159], v[28:31], v[92:95]
    v_mfma_f32_16x16x32_bf16 v[96:99], v[212:215], v[28:31], v[96:99]
    v_mfma_f32_16x16x32_bf16 v[100:103], a[12:15], v[28:31], v[100:103]
    v_mfma_f32_16x16x32_bf16 v[104:107], a[68:71], v[28:31], v[104:107]
    v_mfma_f32_16x16x32_bf16 v[108:111], a[124:127], v[28:31], v[108:111]
    v_mfma_f32_16x16x32_bf16 v[112:115], a[180:183], v[28:31], v[112:115]
    v_mfma_f32_16x16x32_bf16 v[116:119], a[236:239], v[28:31], v[116:119]
    ds_read_b128 v[24:27], v7 offset:11264
    ds_read_b128 v[28:31], v7 offset:25600
    s_waitcnt vmcnt(21) lgkmcnt(2)
    v_mfma_f32_16x16x32_bf16 v[64:67], v[160:163], v[16:19], v[64:67]
    v_mfma_f32_16x16x32_bf16 v[68:71], v[216:219], v[16:19], v[68:71]
    v_mfma_f32_16x16x32_bf16 v[72:75], a[16:19], v[16:19], v[72:75]
    v_mfma_f32_16x16x32_bf16 v[76:79], a[72:75], v[16:19], v[76:79]
    v_mfma_f32_16x16x32_bf16 v[80:83], a[128:131], v[16:19], v[80:83]
    v_mfma_f32_16x16x32_bf16 v[84:87], a[184:187], v[16:19], v[84:87]
    v_mfma_f32_16x16x32_bf16 v[88:91], a[240:243], v[16:19], v[88:91]
    v_mfma_f32_16x16x32_bf16 v[92:95], v[160:163], v[20:23], v[92:95]
    v_mfma_f32_16x16x32_bf16 v[96:99], v[216:219], v[20:23], v[96:99]
    v_mfma_f32_16x16x32_bf16 v[100:103], a[16:19], v[20:23], v[100:103]
    v_mfma_f32_16x16x32_bf16 v[104:107], a[72:75], v[20:23], v[104:107]
    v_mfma_f32_16x16x32_bf16 v[108:111], a[128:131], v[20:23], v[108:111]
    v_mfma_f32_16x16x32_bf16 v[112:115], a[184:187], v[20:23], v[112:115]
    v_mfma_f32_16x16x32_bf16 v[116:119], a[240:243], v[20:23], v[116:119]
    ds_read_b128 v[16:19], v7 offset:12288
    ds_read_b128 v[20:23], v7 offset:26624
    s_waitcnt lgkmcnt(2)
    v_mfma_f32_16x16x32_bf16 v[64:67], v[164:167], v[24:27], v[64:67]
    v_mfma_f32_16x16x32_bf16 v[68:71], v[220:223], v[24:27], v[68:71]
    v_mfma_f32_16x16x32_bf16 v[72:75], a[20:23], v[24:27], v[72:75]
    v_mfma_f32_16x16x32_bf16 v[76:79], a[76:79], v[24:27], v[76:79]
    v_mfma_f32_16x16x32_bf16 v[80:83], a[132:135], v[24:27], v[80:83]
    v_mfma_f32_16x16x32_bf16 v[84:87], a[188:191], v[24:27], v[84:87]
    v_mfma_f32_16x16x32_bf16 v[88:91], a[244:247], v[24:27], v[88:91]
    v_mfma_f32_16x16x32_bf16 v[92:95], v[164:167], v[28:31], v[92:95]
    v_mfma_f32_16x16x32_bf16 v[96:99], v[220:223], v[28:31], v[96:99]
    v_mfma_f32_16x16x32_bf16 v[100:103], a[20:23], v[28:31], v[100:103]
    v_mfma_f32_16x16x32_bf16 v[104:107], a[76:79], v[28:31], v[104:107]
    v_mfma_f32_16x16x32_bf16 v[108:111], a[132:135], v[28:31], v[108:111]
    v_mfma_f32_16x16x32_bf16 v[112:115], a[188:191], v[28:31], v[112:115]
    v_mfma_f32_16x16x32_bf16 v[116:119], a[244:247], v[28:31], v[116:119]
    ds_read_b128 v[24:27], v7 offset:13312
    ds_read_b128 v[28:31], v7 offset:27648
    s_waitcnt vmcnt(7) lgkmcnt(2)
    v_mfma_f32_16x16x32_bf16 v[64:67], v[168:171], v[16:19], v[64:67]
    v_mfma_f32_16x16x32_bf16 v[68:71], v[224:227], v[16:19], v[68:71]
    v_mfma_f32_16x16x32_bf16 v[72:75], a[24:27], v[16:19], v[72:75]
    v_mfma_f32_16x16x32_bf16 v[76:79], a[80:83], v[16:19], v[76:79]
    v_mfma_f32_16x16x32_bf16 v[80:83], a[136:139], v[16:19], v[80:83]
    v_mfma_f32_16x16x32_bf16 v[84:87], a[192:195], v[16:19], v[84:87]
    v_mfma_f32_16x16x32_bf16 v[88:91], a[248:251], v[16:19], v[88:91]
    v_mfma_f32_16x16x32_bf16 v[92:95], v[168:171], v[20:23], v[92:95]
    v_mfma_f32_16x16x32_bf16 v[96:99], v[224:227], v[20:23], v[96:99]
    v_mfma_f32_16x16x32_bf16 v[100:103], a[24:27], v[20:23], v[100:103]
    v_mfma_f32_16x16x32_bf16 v[104:107], a[80:83], v[20:23], v[104:107]
    v_mfma_f32_16x16x32_bf16 v[108:111], a[136:139], v[20:23], v[108:111]
    v_mfma_f32_16x16x32_bf16 v[112:115], a[192:195], v[20:23], v[112:115]
    v_mfma_f32_16x16x32_bf16 v[116:119], a[248:251], v[20:23], v[116:119]
    s_waitcnt lgkmcnt(0)
    v_mfma_f32_16x16x32_bf16 v[64:67], v[172:175], v[24:27], v[64:67]
    v_mfma_f32_16x16x32_bf16 v[68:71], v[228:231], v[24:27], v[68:71]
    v_mfma_f32_16x16x32_bf16 v[72:75], a[28:31], v[24:27], v[72:75]
    v_mfma_f32_16x16x32_bf16 v[76:79], a[84:87], v[24:27], v[76:79]
    v_mfma_f32_16x16x32_bf16 v[80:83], a[140:143], v[24:27], v[80:83]
    v_mfma_f32_16x16x32_bf16 v[84:87], a[196:199], v[24:27], v[84:87]
    v_mfma_f32_16x16x32_bf16 v[88:91], a[252:255], v[24:27], v[88:91]
    v_mfma_f32_16x16x32_bf16 v[92:95], v[172:175], v[28:31], v[92:95]
    v_mfma_f32_16x16x32_bf16 v[96:99], v[228:231], v[28:31], v[96:99]
    v_mfma_f32_16x16x32_bf16 v[100:103], a[28:31], v[28:31], v[100:103]
    v_mfma_f32_16x16x32_bf16 v[104:107], a[84:87], v[28:31], v[104:107]
    v_mfma_f32_16x16x32_bf16 v[108:111], a[140:143], v[28:31], v[108:111]
    v_mfma_f32_16x16x32_bf16 v[112:115], a[196:199], v[28:31], v[112:115]
    v_mfma_f32_16x16x32_bf16 v[116:119], a[252:255], v[28:31], v[116:119]
    s_lshl_b32 s26, s28, 4
    s_add_u32 s26, s26, s16
    s_mul_i32 s27, s26, 3072
    s_add_u32 s27, s27, 101711872
    s_mul_i32 s26, s16, 28672
    s_mul_i32 s32, s28, 458752
    s_add_u32 s26, s26, s32
    s_add_u32 s26, s26, 16777216
    s_mov_b32 s42, s26
    v_add_u32 v5, s23, v7
    v_add_u32 v6, s24, v7
    v_cvt_pk_bf16_f32 v36, v64, v65
    v_cvt_pk_bf16_f32 v37, v66, v67
    v_cvt_pk_bf16_f32 v38, v68, v69
    v_cvt_pk_bf16_f32 v39, v70, v71
    v_cvt_pk_bf16_f32 v40, v72, v73
    v_cvt_pk_bf16_f32 v41, v74, v75
    v_cvt_pk_bf16_f32 v42, v76, v77
    v_cvt_pk_bf16_f32 v43, v78, v79
    v_cvt_pk_bf16_f32 v44, v80, v81
    v_cvt_pk_bf16_f32 v45, v82, v83
    v_cvt_pk_bf16_f32 v46, v84, v85
    v_cvt_pk_bf16_f32 v47, v86, v87
    v_cvt_pk_bf16_f32 v48, v88, v89
    v_cvt_pk_bf16_f32 v49, v90, v91
    ds_read_b128 v[64:67], v5 offset:0
    ds_read_b128 v[68:71], v5 offset:1024
    ds_read_b128 v[72:75], v5 offset:2048
    ds_read_b64 v[76:77], v6 offset:0
    s_add_u32 s32, s26, s23
    s_add_u32 s33, s26, s24
    buffer_store_dwordx4 v[36:39], v2, s[84:87], s32 offen offset:0 sc1
    buffer_store_dwordx4 v[40:43], v2, s[84:87], s32 offen offset:1024 sc1
    buffer_store_dwordx4 v[44:47], v2, s[84:87], s32 offen offset:2048 sc1
    buffer_store_dwordx2 v[48:49], v2, s[84:87], s33 offen sc1
    s_add_u32 s26, s26, 14336
    v_cvt_pk_bf16_f32 v50, v92, v93
    v_cvt_pk_bf16_f32 v51, v94, v95
    v_cvt_pk_bf16_f32 v52, v96, v97
    v_cvt_pk_bf16_f32 v53, v98, v99
    v_cvt_pk_bf16_f32 v54, v100, v101
    v_cvt_pk_bf16_f32 v55, v102, v103
    v_cvt_pk_bf16_f32 v56, v104, v105
    v_cvt_pk_bf16_f32 v57, v106, v107
    v_cvt_pk_bf16_f32 v58, v108, v109
    v_cvt_pk_bf16_f32 v59, v110, v111
    v_cvt_pk_bf16_f32 v60, v112, v113
    v_cvt_pk_bf16_f32 v61, v114, v115
    v_cvt_pk_bf16_f32 v62, v116, v117
    v_cvt_pk_bf16_f32 v63, v118, v119
    ds_read_b128 v[92:95], v5 offset:14336
    ds_read_b128 v[96:99], v5 offset:15360
    ds_read_b128 v[100:103], v5 offset:16384
    ds_read_b64 v[104:105], v6 offset:14336
    s_add_u32 s32, s26, s23
    s_add_u32 s33, s26, s24
    buffer_store_dwordx4 v[50:53], v2, s[84:87], s32 offen offset:0 sc1
    buffer_store_dwordx4 v[54:57], v2, s[84:87], s32 offen offset:1024 sc1
    buffer_store_dwordx4 v[58:61], v2, s[84:87], s32 offen offset:2048 sc1
    buffer_store_dwordx2 v[62:63], v2, s[84:87], s33 offen sc1
    s_waitcnt lgkmcnt(0)
    v_mfma_f32_16x16x32_bf16 v[16:19], v[36:39], v[64:67], 0
    v_mfma_f32_16x16x32_bf16 v[20:23], v[36:39], v[92:95], 0
    v_mfma_f32_16x16x32_bf16 v[24:27], v[50:53], v[92:95], 0
    v_mfma_f32_16x16x32_bf16 v[16:19], v[40:43], v[68:71], v[16:19]
    v_mfma_f32_16x16x32_bf16 v[20:23], v[40:43], v[96:99], v[20:23]
    v_mfma_f32_16x16x32_bf16 v[24:27], v[54:57], v[96:99], v[24:27]
    v_mfma_f32_16x16x32_bf16 v[16:19], v[44:47], v[72:75], v[16:19]
    v_mfma_f32_16x16x32_bf16 v[20:23], v[44:47], v[100:103], v[20:23]
    v_mfma_f32_16x16x32_bf16 v[24:27], v[58:61], v[100:103], v[24:27]
    v_mfma_f32_16x16x16_bf16 v[16:19], v[48:49], v[76:77], v[16:19]
    s_nop 1
    v_mfma_f32_16x16x16_bf16 v[20:23], v[48:49], v[104:105], v[20:23]
    s_nop 1
    v_mfma_f32_16x16x16_bf16 v[24:27], v[62:63], v[104:105], v[24:27]
    s_mul_i32 s32, s13, 3072
    s_add_u32 s32, s32, 114688
    v_add_u32 v5, s32, v2
    ds_write_b128 v5, v[16:19] offset:0
    s_nop 0
    ds_write_b128 v5, v[20:23] offset:1024
    s_nop 1
    ds_write_b128 v5, v[24:27] offset:2048
    s_waitcnt lgkmcnt(0)
    s_barrier
    s_min_u32 s32, s13, 2
    s_lshl_b32 s32, s32, 10
    v_add_u32 v5, s32, v2
    v_add_u32 v6, 114688, v5
    ds_read_b128 v[64:67], v6 offset:0
    ds_read_b128 v[68:71], v6 offset:3072
    ds_read_b128 v[72:75], v6 offset:6144
    ds_read_b128 v[76:79], v6 offset:9216
    s_waitcnt lgkmcnt(0)
    v_add_f32 v64, v64, v68
    v_add_f32 v72, v72, v76
    v_add_f32 v65, v65, v69
    v_add_f32 v73, v73, v77
    v_add_f32 v66, v66, v70
    v_add_f32 v74, v74, v78
    v_add_f32 v67, v67, v71
    v_add_f32 v75, v75, v79
    v_add_f32 v32, v64, v72
    v_add_f32 v33, v65, v73
    v_add_f32 v34, v66, v74
    v_add_f32 v35, v67, v75
    buffer_store_dwordx4 v[32:35], v5, s[8:11], s27 offen sc1
    s_lshl_b32 s34, s28, 9
    s_lshl_b32 s33, s14, 4
    s_add_u32 s34, s34, s33
    s_lshl_b32 s33, s13, 2
    s_add_u32 s34, s34, s33
    s_add_u32 s34, s34, 116396032
    s_cmp_lg_u32 s39, s28
    s_cbranch_scc1 KVF_194
    s_cmp_eq_u32 s34, 0
    s_cbranch_scc1 NF_195
    s_waitcnt vmcnt(0)
    v_mov_b32 v15, 1
    s_mov_b64 exec, 1
    buffer_store_dword v15, off, s[8:11], s34 sc1
    s_mov_b64 exec, -1
    s_mov_b32 s34, 0
NF_195:
KVF_194:
    s_waitcnt vmcnt(9)
    s_mov_b32 s28, s30
    s_mov_b32 s29, s31
    s_cmp_lt_u32 s28, s59
    s_cbranch_scc1 KVL_189
    s_cmp_eq_u32 s34, 0
    s_cbranch_scc1 NF_196
    s_waitcnt vmcnt(0)
    v_mov_b32 v15, 1
    s_mov_b64 exec, 1
    buffer_store_dword v15, off, s[8:11], s34 sc1
    s_mov_b64 exec, -1
    s_mov_b32 s34, 0
NF_196:
    s_cmp_lt_u32 s15, 5
    s_cbranch_scc1 MEGA_EXIT
    v_add_u32 v12, 4096, v2
    v_add_u32 v13, 8192, v2
    v_add_u32 v14, 12288, v2
    s_lshl_b32 s32, s13, 12
    s_add_u32 s32, s32, 114688
    v_add_u32 v7, s32, v2
    s_lshl_b32 s32, s13, 10
    s_add_u32 s32, s32, 114688
    v_add_u32 v8, s32, v2
    s_mov_b32 s28, s38
    v_add_u32 v5, s23, v2
    v_add_u32 v6, s24, v2
    v_and_b32 v9, 0x1f0, v2
    v_lshrrev_b32 v10, 1, v4
    s_lshr_b32 s26, s13, 1
    v_cmp_eq_u32 vcc, s26, v10
    v_mov_b32 v10, 0x80000000
    s_nop 0
    v_cndmask_b32 v9, v10, v9, vcc
MIR_197:
    s_barrier
    s_lshr_b32 s40, s13, 1
    s_lshl_b32 s27, s28, 1
    s_add_u32 s40, s40, s27
    s_lshl_b32 s40, s40, 4
    s_add_u32 s40, s40, s16
    s_lshl_b32 s40, s40, 1
    s_add_u32 s40, s40, s17
    s_lshl_b32 s40, s40, 9
    s_add_u32 s40, s40, 105381888
    v_mov_b64 v[116:117], -1
    v_mov_b64 v[118:119], -1
    buffer_store_dwordx4 v[116:119], v9, s[8:11], s40 offen sc1
    s_lshl_b32 s30, s28, 1
    s_mov_b32 s31, 0
    s_mul_i32 s26, s30, 28672
    s_mul_i32 s27, s13, 7168
    s_add_u32 s26, s26, s27
    s_add_u32 s26, s26, 83886080
    s_add_u32 m0, s31, s27
    s_nop 0
    buffer_load_dwordx4 v2, s[8:11], s26 offen offset:0 sc1 lds
    buffer_load_dwordx4 v2, s[8:11], s26 offen offset:1024 sc1 lds
    buffer_load_dwordx4 v2, s[8:11], s26 offen offset:2048 sc1 lds
    buffer_load_dwordx4 v2, s[8:11], s26 offen offset:3072 sc1 lds
    s_add_u32 s26, s26, 4096
    s_add_u32 m0, m0, 4096
    s_nop 0
    buffer_load_dwordx4 v2, s[8:11], s26 offen offset:0 sc1 lds
    buffer_load_dwordx4 v2, s[8:11], s26 offen offset:1024 sc1 lds
    buffer_load_dwordx4 v2, s[8:11], s26 offen offset:2048 sc1 lds
    s_lshl_b32 s30, s28, 1
    s_add_u32 s30, s30, 1
    s_mov_b32 s31, 28672
    s_mul_i32 s26, s30, 28672
    s_mul_i32 s27, s13, 7168
    s_add_u32 s26, s26, s27
    s_add_u32 s26, s26, 83886080
    s_add_u32 m0, s31, s27
    s_nop 0
    buffer_load_dwordx4 v2, s[8:11], s26 offen offset:0 sc1 lds
    buffer_load_dwordx4 v2, s[8:11], s26 offen offset:1024 sc1 lds
    buffer_load_dwordx4 v2, s[8:11], s26 offen offset:2048 sc1 lds
    buffer_load_dwordx4 v2, s[8:11], s26 offen offset:3072 sc1 lds
    s_add_u32 s26, s26, 4096
    s_add_u32 m0, m0, 4096
    s_nop 0
    buffer_load_dwordx4 v2, s[8:11], s26 offen offset:0 sc1 lds
    buffer_load_dwordx4 v2, s[8:11], s26 offen offset:1024 sc1 lds
    buffer_load_dwordx4 v2, s[8:11], s26 offen offset:2048 sc1 lds
    s_lshl_b32 s34, s28, 8
    s_lshl_b32 s33, s14, 2
    s_add_u32 s34, s34, s33
    s_add_u32 s34, s34, 116428800
    s_waitcnt vmcnt(0)
    s_barrier
    s_cmp_lg_u32 s13, 0
    s_cbranch_scc1 NF_198
    v_mov_b32 v15, 1
    s_mov_b64 exec, 1
    buffer_store_dword v15, off, s[8:11], s34 sc1
    s_mov_b64 exec, -1
NF_198:
    s_mov_b32 s34, 0
    s_mul_i32 s26, s28, 14336
    s_add_u32 s26, s26, 115343360
    s_cmp_lg_u32 s13, 0
    s_cbranch_scc1 WMK_201
    s_lshl_b32 s37, s28, 1
    s_add_u32 s37, s37, 2
    s_mov_b32 s35, 0
    s_lshr_b32 s30, s83, 5
    s_lshl_b32 s30, s30, 1
    s_add_u32 s30, s30, s38
    s_lshl_b32 s30, s30, 7
    s_add_u32 s30, s30, 116391936
    s_mov_b64 exec, 1
    s_branch WM0_200
WM_199:
    s_sleep 2
WM0_200:
    buffer_load_dword v15, off, s[8:11], s30 sc1
    s_add_u32 s35, s35, 1
    s_cmp_gt_u32 s35, 4000000
    s_cbranch_scc1 MEGA_EXIT
    s_waitcnt vmcnt(0)
    v_readfirstlane_b32 s36, v15
    s_nop 0
    s_cmp_lt_u32 s36, s37
    s_cbranch_scc1 WM_199
    s_mov_b64 exec, -1
WMK_201:
    s_barrier
    buffer_load_dwordx4 v[16:19], v2, s[8:11], s26 offen offset:0 sc1
    buffer_load_dwordx4 v[20:23], v2, s[8:11], s26 offen offset:1024 sc1
    buffer_load_dwordx4 v[24:27], v2, s[8:11], s26 offen offset:2048 sc1
    buffer_load_dwordx4 v[28:31], v2, s[8:11], s26 offen offset:3072 sc1
    buffer_load_dwordx4 v[32:35], v12, s[8:11], s26 offen offset:0 sc1
    buffer_load_dwordx4 v[36:39], v12, s[8:11], s26 offen offset:1024 sc1
    buffer_load_dwordx4 v[40:43], v12, s[8:11], s26 offen offset:2048 sc1
    buffer_load_dwordx4 v[44:47], v12, s[8:11], s26 offen offset:3072 sc1
    buffer_load_dwordx4 v[48:51], v13, s[8:11], s26 offen offset:0 sc1
    buffer_load_dwordx4 v[52:55], v13, s[8:11], s26 offen offset:1024 sc1
    buffer_load_dwordx4 v[56:59], v13, s[8:11], s26 offen offset:2048 sc1
    buffer_load_dwordx4 v[60:63], v13, s[8:11], s26 offen offset:3072 sc1
    buffer_load_dwordx4 v[92:95], v14, s[8:11], s26 offen offset:0 sc1
    buffer_load_dwordx4 v[96:99], v14, s[8:11], s26 offen offset:1024 sc1
    s_waitcnt vmcnt(13)
    v_mfma_f32_16x16x32_bf16 v[64:67], v[120:123], v[16:19], 0
    v_mfma_f32_16x16x32_bf16 v[68:71], v[176:179], v[16:19], 0
    v_mfma_f32_16x16x32_bf16 v[72:75], v[232:235], v[16:19], 0
    v_mfma_f32_16x16x32_bf16 v[76:79], a[32:35], v[16:19], 0
    v_mfma_f32_16x16x32_bf16 v[80:83], a[88:91], v[16:19], 0
    v_mfma_f32_16x16x32_bf16 v[84:87], a[144:147], v[16:19], 0
    v_mfma_f32_16x16x32_bf16 v[88:91], a[200:203], v[16:19], 0
    s_waitcnt vmcnt(12)
    v_mfma_f32_16x16x32_bf16 v[64:67], v[124:127], v[20:23], v[64:67]
    v_mfma_f32_16x16x32_bf16 v[68:71], v[180:183], v[20:23], v[68:71]
    v_mfma_f32_16x16x32_bf16 v[72:75], v[236:239], v[20:23], v[72:75]
    v_mfma_f32_16x16x32_bf16 v[76:79], a[36:39], v[20:23], v[76:79]
    v_mfma_f32_16x16x32_bf16 v[80:83], a[92:95], v[20:23], v[80:83]
    v_mfma_f32_16x16x32_bf16 v[84:87], a[148:151], v[20:23], v[84:87]
    v_mfma_f32_16x16x32_bf16 v[88:91], a[204:207], v[20:23], v[88:91]
    s_waitcnt vmcnt(11)
    v_mfma_f32_16x16x32_bf16 v[64:67], v[128:131], v[24:27], v[64:67]
    v_mfma_f32_16x16x32_bf16 v[68:71], v[184:187], v[24:27], v[68:71]
    v_mfma_f32_16x16x32_bf16 v[72:75], v[240:243], v[24:27], v[72:75]
    v_mfma_f32_16x16x32_bf16 v[76:79], a[40:43], v[24:27], v[76:79]
    v_mfma_f32_16x16x32_bf16 v[80:83], a[96:99], v[24:27], v[80:83]
    v_mfma_f32_16x16x32_bf16 v[84:87], a[152:155], v[24:27], v[84:87]
    v_mfma_f32_16x16x32_bf16 v[88:91], a[208:211], v[24:27], v[88:91]
    s_waitcnt vmcnt(10)
    v_mfma_f32_16x16x32_bf16 v[64:67], v[132:135], v[28:31], v[64:67]
    v_mfma_f32_16x16x32_bf16 v[68:71], v[188:191], v[28:31], v[68:71]
    v_mfma_f32_16x16x32_bf16 v[72:75], v[244:247], v[28:31], v[72:75]
    v_mfma_f32_16x16x32_bf16 v[76:79], a[44:47], v[28:31], v[76:79]
    v_mfma_f32_16x16x32_bf16 v[80:83], a[100:103], v[28:31], v[80:83]
    v_mfma_f32_16x16x32_bf16 v[84:87], a[156:159], v[28:31], v[84:87]
    v_mfma_f32_16x16x32_bf16 v[88:91], a[212:215], v[28:31], v[88:91]
    s_waitcnt vmcnt(9)
    v_mfma_f32_16x16x32_bf16 v[64:67], v[136:139], v[32:35], v[64:67]
    v_mfma_f32_16x16x32_bf16 v[68:71], v[192:195], v[32:35], v[68:71]
    v_mfma_f32_16x16x32_bf16 v[72:75], v[248:251], v[32:35], v[72:75]
    v_mfma_f32_16x16x32_bf16 v[76:79], a[48:51], v[32:35], v[76:79]
    v_mfma_f32_16x16x32_bf16 v[80:83], a[104:107], v[32:35], v[80:83]
    v_mfma_f32_16x16x32_bf16 v[84:87], a[160:163], v[32:35], v[84:87]
    v_mfma_f32_16x16x32_bf16 v[88:91], a[216:219], v[32:35], v[88:91]
    s_waitcnt vmcnt(8)
    v_mfma_f32_16x16x32_bf16 v[64:67], v[140:143], v[36:39], v[64:67]
    v_mfma_f32_16x16x32_bf16 v[68:71], v[196:199], v[36:39], v[68:71]
    v_mfma_f32_16x16x32_bf16 v[72:75], v[252:255], v[36:39], v[72:75]
    v_mfma_f32_16x16x32_bf16 v[76:79], a[52:55], v[36:39], v[76:79]
    v_mfma_f32_16x16x32_bf16 v[80:83], a[108:111], v[36:39], v[80:83]
    v_mfma_f32_16x16x32_bf16 v[84:87], a[164:167], v[36:39], v[84:87]
    v_mfma_f32_16x16x32_bf16 v[88:91], a[220:223], v[36:39], v[88:91]
    s_waitcnt vmcnt(7)
    v_mfma_f32_16x16x32_bf16 v[64:67], v[144:147], v[40:43], v[64:67]
    v_mfma_f32_16x16x32_bf16 v[68:71], v[200:203], v[40:43], v[68:71]
    v_mfma_f32_16x16x32_bf16 v[72:75], a[0:3], v[40:43], v[72:75]
    v_mfma_f32_16x16x32_bf16 v[76:79], a[56:59], v[40:43], v[76:79]
    v_mfma_f32_16x16x32_bf16 v[80:83], a[112:115], v[40:43], v[80:83]
    v_mfma_f32_16x16x32_bf16 v[84:87], a[168:171], v[40:43], v[84:87]
    v_mfma_f32_16x16x32_bf16 v[88:91], a[224:227], v[40:43], v[88:91]
    s_waitcnt vmcnt(6)
    v_mfma_f32_16x16x32_bf16 v[64:67], v[148:151], v[44:47], v[64:67]
    v_mfma_f32_16x16x32_bf16 v[68:71], v[204:207], v[44:47], v[68:71]
    v_mfma_f32_16x16x32_bf16 v[72:75], a[4:7], v[44:47], v[72:75]
    v_mfma_f32_16x16x32_bf16 v[76:79], a[60:63], v[44:47], v[76:79]
    v_mfma_f32_16x16x32_bf16 v[80:83], a[116:119], v[44:47], v[80:83]
    v_mfma_f32_16x16x32_bf16 v[84:87], a[172:175], v[44:47], v[84:87]
    v_mfma_f32_16x16x32_bf16 v[88:91], a[228:231], v[44:47], v[88:91]
    s_waitcnt vmcnt(5)
    v_mfma_f32_16x16x32_bf16 v[64:67], v[152:155], v[48:51], v[64:67]
    v_mfma_f32_16x16x32_bf16 v[68:71], v[208:211], v[48:51], v[68:71]
    v_mfma_f32_16x16x32_bf16 v[72:75], a[8:11], v[48:51], v[72:75]
    v_mfma_f32_16x16x32_bf16 v[76:79], a[64:67], v[48:51], v[76:79]
    v_mfma_f32_16x16x32_bf16 v[80:83], a[120:123], v[48:51], v[80:83]
    v_mfma_f32_16x16x32_bf16 v[84:87], a[176:179], v[48:51], v[84:87]
    v_mfma_f32_16x16x32_bf16 v[88:91], a[232:235], v[48:51], v[88:91]
    s_waitcnt vmcnt(4)
    v_mfma_f32_16x16x32_bf16 v[64:67], v[156:159], v[52:55], v[64:67]
    v_mfma_f32_16x16x32_bf16 v[68:71], v[212:215], v[52:55], v[68:71]
    v_mfma_f32_16x16x32_bf16 v[72:75], a[12:15], v[52:55], v[72:75]
    v_mfma_f32_16x16x32_bf16 v[76:79], a[68:71], v[52:55], v[76:79]
    v_mfma_f32_16x16x32_bf16 v[80:83], a[124:127], v[52:55], v[80:83]
    v_mfma_f32_16x16x32_bf16 v[84:87], a[180:183], v[52:55], v[84:87]
    v_mfma_f32_16x16x32_bf16 v[88:91], a[236:239], v[52:55], v[88:91]
    ds_read_b128 v[16:19], v5 offset:0
    ds_read_b128 v[20:23], v5 offset:1024
    ds_read_b128 v[24:27], v5 offset:2048
    ds_read_b64 v[28:29], v6 offset:0
    ds_read_b128 v[100:103], v5 offset:14336
    ds_read_b128 v[104:107], v5 offset:15360
    ds_read_b128 v[108:111], v5 offset:16384
    ds_read_b64 v[112:113], v6 offset:14336
    s_waitcnt vmcnt(3)
    v_mfma_f32_16x16x32_bf16 v[64:67], v[160:163], v[56:59], v[64:67]
    v_mfma_f32_16x16x32_bf16 v[68:71], v[216:219], v[56:59], v[68:71]
    v_mfma_f32_16x16x32_bf16 v[72:75], a[16:19], v[56:59], v[72:75]
    v_mfma_f32_16x16x32_bf16 v[76:79], a[72:75], v[56:59], v[76:79]
    v_mfma_f32_16x16x32_bf16 v[80:83], a[128:131], v[56:59], v[80:83]
    v_mfma_f32_16x16x32_bf16 v[84:87], a[184:187], v[56:59], v[84:87]
    v_mfma_f32_16x16x32_bf16 v[88:91], a[240:243], v[56:59], v[88:91]
    s_waitcnt vmcnt(2)
    v_mfma_f32_16x16x32_bf16 v[64:67], v[164:167], v[60:63], v[64:67]
    v_mfma_f32_16x16x32_bf16 v[68:71], v[220:223], v[60:63], v[68:71]
    v_mfma_f32_16x16x32_bf16 v[72:75], a[20:23], v[60:63], v[72:75]
    v_mfma_f32_16x16x32_bf16 v[76:79], a[76:79], v[60:63], v[76:79]
    v_mfma_f32_16x16x32_bf16 v[80:83], a[132:135], v[60:63], v[80:83]
    v_mfma_f32_16x16x32_bf16 v[84:87], a[188:191], v[60:63], v[84:87]
    v_mfma_f32_16x16x32_bf16 v[88:91], a[244:247], v[60:63], v[88:91]
    s_waitcnt vmcnt(1)
    v_mfma_f32_16x16x32_bf16 v[64:67], v[168:171], v[92:95], v[64:67]
    v_mfma_f32_16x16x32_bf16 v[68:71], v[224:227], v[92:95], v[68:71]
    v_mfma_f32_16x16x32_bf16 v[72:75], a[24:27], v[92:95], v[72:75]
    v_mfma_f32_16x16x32_bf16 v[76:79], a[80:83], v[92:95], v[76:79]
    v_mfma_f32_16x16x32_bf16 v[80:83], a[136:139], v[92:95], v[80:83]
    v_mfma_f32_16x16x32_bf16 v[84:87], a[192:195], v[92:95], v[84:87]
    v_mfma_f32_16x16x32_bf16 v[88:91], a[248:251], v[92:95], v[88:91]
    s_waitcnt vmcnt(0)
    v_mfma_f32_16x16x32_bf16 v[64:67], v[172:175], v[96:99], v[64:67]
    v_mfma_f32_16x16x32_bf16 v[68:71], v[228:231], v[96:99], v[68:71]
    v_mfma_f32_16x16x32_bf16 v[72:75], a[28:31], v[96:99], v[72:75]
    v_mfma_f32_16x16x32_bf16 v[76:79], a[84:87], v[96:99], v[76:79]
    v_mfma_f32_16x16x32_bf16 v[80:83], a[140:143], v[96:99], v[80:83]
    v_mfma_f32_16x16x32_bf16 v[84:87], a[196:199], v[96:99], v[84:87]
    v_mfma_f32_16x16x32_bf16 v[88:91], a[252:255], v[96:99], v[88:91]
    v_cvt_pk_bf16_f32 v36, v64, v65
    v_cvt_pk_bf16_f32 v37, v66, v67
    v_cvt_pk_bf16_f32 v38, v68, v69
    v_cvt_pk_bf16_f32 v39, v70, v71
    v_cvt_pk_bf16_f32 v40, v72, v73
    v_cvt_pk_bf16_f32 v41, v74, v75
    v_cvt_pk_bf16_f32 v42, v76, v77
    v_cvt_pk_bf16_f32 v43, v78, v79
    v_cvt_pk_bf16_f32 v44, v80, v81
    v_cvt_pk_bf16_f32 v45, v82, v83
    v_cvt_pk_bf16_f32 v46, v84, v85
    v_cvt_pk_bf16_f32 v47, v86, v87
    v_cvt_pk_bf16_f32 v48, v88, v89
    v_cvt_pk_bf16_f32 v49, v90, v91
    ds_read_b128 v[64:67], v5 offset:28672
    ds_read_b128 v[68:71], v5 offset:29696
    ds_read_b128 v[72:75], v5 offset:30720
    ds_read_b64 v[76:77], v6 offset:28672
    ds_read_b128 v[78:81], v5 offset:43008
    ds_read_b128 v[82:85], v5 offset:44032
    ds_read_b128 v[86:89], v5 offset:45056
    ds_read_b64 v[90:91], v6 offset:43008
    s_waitcnt lgkmcnt(8)
    v_mfma_f32_16x16x32_bf16 v[52:55], v[36:39], v[16:19], 0
    v_mfma_f32_16x16x32_bf16 v[56:59], v[36:39], v[100:103], 0
    v_mfma_f32_16x16x32_bf16 v[52:55], v[40:43], v[20:23], v[52:55]
    v_mfma_f32_16x16x32_bf16 v[56:59], v[40:43], v[104:107], v[56:59]
    v_mfma_f32_16x16x32_bf16 v[52:55], v[44:47], v[24:27], v[52:55]
    v_mfma_f32_16x16x32_bf16 v[56:59], v[44:47], v[108:111], v[56:59]
    s_nop 2
    v_mfma_f32_16x16x16_bf16 v[52:55], v[48:49], v[28:29], v[52:55]
    s_nop 1
    v_mfma_f32_16x16x16_bf16 v[56:59], v[48:49], v[112:113], v[56:59]
    s_waitcnt lgkmcnt(0)
    v_mfma_f32_16x16x32_bf16 v[60:63], v[36:39], v[64:67], 0
    v_mfma_f32_16x16x32_bf16 v[92:95], v[36:39], v[78:81], 0
    v_mfma_f32_16x16x32_bf16 v[60:63], v[40:43], v[68:71], v[60:63]
    v_mfma_f32_16x16x32_bf16 v[92:95], v[40:43], v[82:85], v[92:95]
    v_mfma_f32_16x16x32_bf16 v[60:63], v[44:47], v[72:75], v[60:63]
    v_mfma_f32_16x16x32_bf16 v[92:95], v[44:47], v[86:89], v[92:95]
    s_nop 2
    v_mfma_f32_16x16x16_bf16 v[60:63], v[48:49], v[76:77], v[60:63]
    s_nop 1
    v_mfma_f32_16x16x16_bf16 v[92:95], v[48:49], v[90:91], v[92:95]
    ds_write_b128 v7, v[52:55] offset:0
    ds_write_b128 v7, v[56:59] offset:1024
    s_nop 2
    ds_write_b128 v7, v[60:63] offset:2048
    s_nop 1
    ds_write_b128 v7, v[92:95] offset:3072
    s_waitcnt lgkmcnt(0)
    s_barrier
    ds_read_b128 v[64:67], v8 offset:0
    ds_read_b128 v[68:71], v8 offset:4096
    ds_read_b128 v[72:75], v8 offset:8192
    ds_read_b128 v[76:79], v8 offset:12288
    s_waitcnt lgkmcnt(0)
    v_add_f32 v64, v64, v68
    v_add_f32 v72, v72, v76
    v_add_f32 v65, v65, v69
    v_add_f32 v73, v73, v77
    v_add_f32 v66, v66, v70
    v_add_f32 v74, v74, v78
    v_add_f32 v67, v67, v71
    v_add_f32 v75, v75, v79
    v_add_f32 v96, v64, v72
    v_add_f32 v97, v65, v73
    v_add_f32 v98, v66, v74
    v_add_f32 v99, v67, v75
    v_min_u32 v96, -2, v96
    v_min_u32 v97, -2, v97
    v_min_u32 v98, -2, v98
    v_min_u32 v99, -2, v99
    buffer_store_dwordx4 v[96:99], v9, s[8:11], s40 offen sc1
    s_add_u32 s28, s28, 2
    s_cmp_lt_u32 s28, 31
    s_cbranch_scc1 MIR_197
    s_branch MEGA_EXIT
W_V:
    s_mov_b32 s34, 0
    v_lshrrev_b32 v8, 3, v1
    v_min_u32 v8, 6, v8
    v_add_u32 v8, s18, v8
    v_mul_u32_u24 v8, 16384, v8
    v_and_b32 v9, 7, v1
    v_lshl_add_u32 v8, v9, 7, v8
    s_waitcnt vmcnt(63)
KVL_202:
    s_barrier
    s_add_u32 s30, s28, s43
    s_sub_u32 s31, 28672, s29
    s_cmp_ge_u32 s30, s59
    s_cbranch_scc1 KVN_203
    s_mul_i32 s26, s30, 28672
    s_mul_i32 s27, s13, 7168
    s_add_u32 s26, s26, s27
    s_add_u32 s26, s26, 83886080
    s_add_u32 m0, s31, s27
    s_nop 0
    buffer_load_dwordx4 v2, s[8:11], s26 offen offset:0 sc1 lds
    buffer_load_dwordx4 v2, s[8:11], s26 offen offset:1024 sc1 lds
    buffer_load_dwordx4 v2, s[8:11], s26 offen offset:2048 sc1 lds
    buffer_load_dwordx4 v2, s[8:11], s26 offen offset:3072 sc1 lds
    s_add_u32 s26, s26, 4096
    s_add_u32 m0, m0, 4096
    s_nop 0
    buffer_load_dwordx4 v2, s[8:11], s26 offen offset:0 sc1 lds
    buffer_load_dwordx4 v2, s[8:11], s26 offen offset:1024 sc1 lds
    buffer_load_dwordx4 v2, s[8:11], s26 offen offset:2048 sc1 lds
KVN_203:
    v_add_u32 v7, s29, v2
    ds_read_b128 v[16:19], v7 offset:0
    ds_read_b128 v[20:23], v7 offset:14336
    ds_read_b128 v[24:27], v7 offset:1024
    ds_read_b128 v[28:31], v7 offset:15360
    s_waitcnt vmcnt(63) lgkmcnt(2)
    v_mfma_f32_16x16x32_bf16 v[64:67], v[16:19], v[120:123], 0
    v_mfma_f32_16x16x32_bf16 v[68:71], v[16:19], v[176:179], 0
    v_mfma_f32_16x16x32_bf16 v[72:75], v[16:19], v[232:235], 0
    v_mfma_f32_16x16x32_bf16 v[76:79], v[16:19], a[32:35], 0
    v_mfma_f32_16x16x32_bf16 v[80:83], v[16:19], a[88:91], 0
    v_mfma_f32_16x16x32_bf16 v[84:87], v[16:19], a[144:147], 0
    v_mfma_f32_16x16x32_bf16 v[88:91], v[16:19], a[200:203], 0
    v_mfma_f32_16x16x32_bf16 v[92:95], v[20:23], v[120:123], 0
    v_mfma_f32_16x16x32_bf16 v[96:99], v[20:23], v[176:179], 0
    v_mfma_f32_16x16x32_bf16 v[100:103], v[20:23], v[232:235], 0
    v_mfma_f32_16x16x32_bf16 v[104:107], v[20:23], a[32:35], 0
    v_mfma_f32_16x16x32_bf16 v[108:111], v[20:23], a[88:91], 0
    v_mfma_f32_16x16x32_bf16 v[112:115], v[20:23], a[144:147], 0
    v_mfma_f32_16x16x32_bf16 v[116:119], v[20:23], a[200:203], 0
    ds_read_b128 v[16:19], v7 offset:2048
    ds_read_b128 v[20:23], v7 offset:16384
    s_waitcnt lgkmcnt(2)
    v_mfma_f32_16x16x32_bf16 v[64:67], v[24:27], v[124:127], v[64:67]
    v_mfma_f32_16x16x32_bf16 v[68:71], v[24:27], v[180:183], v[68:71]
    v_mfma_f32_16x16x32_bf16 v[72:75], v[24:27], v[236:239], v[72:75]
    v_mfma_f32_16x16x32_bf16 v[76:79], v[24:27], a[36:39], v[76:79]
    v_mfma_f32_16x16x32_bf16 v[80:83], v[24:27], a[92:95], v[80:83]
    v_mfma_f32_16x16x32_bf16 v[84:87], v[24:27], a[148:151], v[84:87]
    v_mfma_f32_16x16x32_bf16 v[88:91], v[24:27], a[204:207], v[88:91]
    v_mfma_f32_16x16x32_bf16 v[92:95], v[28:31], v[124:127], v[92:95]
    v_mfma_f32_16x16x32_bf16 v[96:99], v[28:31], v[180:183], v[96:99]
    v_mfma_f32_16x16x32_bf16 v[100:103], v[28:31], v[236:239], v[100:103]
    v_mfma_f32_16x16x32_bf16 v[104:107], v[28:31], a[36:39], v[104:107]
    v_mfma_f32_16x16x32_bf16 v[108:111], v[28:31], a[92:95], v[108:111]
    v_mfma_f32_16x16x32_bf16 v[112:115], v[28:31], a[148:151], v[112:115]
    v_mfma_f32_16x16x32_bf16 v[116:119], v[28:31], a[204:207], v[116:119]
    ds_read_b128 v[24:27], v7 offset:3072
    ds_read_b128 v[28:31], v7 offset:17408
    s_waitcnt vmcnt(63) lgkmcnt(2)
    v_mfma_f32_16x16x32_bf16 v[64:67], v[16:19], v[128:131], v[64:67]
    v_mfma_f32_16x16x32_bf16 v[68:71], v[16:19], v[184:187], v[68:71]
    v_mfma_f32_16x16x32_bf16 v[72:75], v[16:19], v[240:243], v[72:75]
    v_mfma_f32_16x16x32_bf16 v[76:79], v[16:19], a[40:43], v[76:79]
    v_mfma_f32_16x16x32_bf16 v[80:83], v[16:19], a[96:99], v[80:83]
    v_mfma_f32_16x16x32_bf16 v[84:87], v[16:19], a[152:155], v[84:87]
    v_mfma_f32_16x16x32_bf16 v[88:91], v[16:19], a[208:211], v[88:91]
    v_mfma_f32_16x16x32_bf16 v[92:95], v[20:23], v[128:131], v[92:95]
    v_mfma_f32_16x16x32_bf16 v[96:99], v[20:23], v[184:187], v[96:99]
    v_mfma_f32_16x16x32_bf16 v[100:103], v[20:23], v[240:243], v[100:103]
    v_mfma_f32_16x16x32_bf16 v[104:107], v[20:23], a[40:43], v[104:107]
    v_mfma_f32_16x16x32_bf16 v[108:111], v[20:23], a[96:99], v[108:111]
    v_mfma_f32_16x16x32_bf16 v[112:115], v[20:23], a[152:155], v[112:115]
    v_mfma_f32_16x16x32_bf16 v[116:119], v[20:23], a[208:211], v[116:119]
    ds_read_b128 v[16:19], v7 offset:4096
    ds_read_b128 v[20:23], v7 offset:18432
    s_waitcnt lgkmcnt(2)
    v_mfma_f32_16x16x32_bf16 v[64:67], v[24:27], v[132:135], v[64:67]
    v_mfma_f32_16x16x32_bf16 v[68:71], v[24:27], v[188:191], v[68:71]
    v_mfma_f32_16x16x32_bf16 v[72:75], v[24:27], v[244:247], v[72:75]
    v_mfma_f32_16x16x32_bf16 v[76:79], v[24:27], a[44:47], v[76:79]
    v_mfma_f32_16x16x32_bf16 v[80:83], v[24:27], a[100:103], v[80:83]
    v_mfma_f32_16x16x32_bf16 v[84:87], v[24:27], a[156:159], v[84:87]
    v_mfma_f32_16x16x32_bf16 v[88:91], v[24:27], a[212:215], v[88:91]
    v_mfma_f32_16x16x32_bf16 v[92:95], v[28:31], v[132:135], v[92:95]
    v_mfma_f32_16x16x32_bf16 v[96:99], v[28:31], v[188:191], v[96:99]
    v_mfma_f32_16x16x32_bf16 v[100:103], v[28:31], v[244:247], v[100:103]
    v_mfma_f32_16x16x32_bf16 v[104:107], v[28:31], a[44:47], v[104:107]
    v_mfma_f32_16x16x32_bf16 v[108:111], v[28:31], a[100:103], v[108:111]
    v_mfma_f32_16x16x32_bf16 v[112:115], v[28:31], a[156:159], v[112:115]
    v_mfma_f32_16x16x32_bf16 v[116:119], v[28:31], a[212:215], v[116:119]
    ds_read_b128 v[24:27], v7 offset:5120
    ds_read_b128 v[28:31], v7 offset:19456
    s_waitcnt vmcnt(63) lgkmcnt(2)
    v_mfma_f32_16x16x32_bf16 v[64:67], v[16:19], v[136:139], v[64:67]
    v_mfma_f32_16x16x32_bf16 v[68:71], v[16:19], v[192:195], v[68:71]
    v_mfma_f32_16x16x32_bf16 v[72:75], v[16:19], v[248:251], v[72:75]
    v_mfma_f32_16x16x32_bf16 v[76:79], v[16:19], a[48:51], v[76:79]
    v_mfma_f32_16x16x32_bf16 v[80:83], v[16:19], a[104:107], v[80:83]
    v_mfma_f32_16x16x32_bf16 v[84:87], v[16:19], a[160:163], v[84:87]
    v_mfma_f32_16x16x32_bf16 v[88:91], v[16:19], a[216:219], v[88:91]
    v_mfma_f32_16x16x32_bf16 v[92:95], v[20:23], v[136:139], v[92:95]
    v_mfma_f32_16x16x32_bf16 v[96:99], v[20:23], v[192:195], v[96:99]
    v_mfma_f32_16x16x32_bf16 v[100:103], v[20:23], v[248:251], v[100:103]
    v_mfma_f32_16x16x32_bf16 v[104:107], v[20:23], a[48:51], v[104:107]
    v_mfma_f32_16x16x32_bf16 v[108:111], v[20:23], a[104:107], v[108:111]
    v_mfma_f32_16x16x32_bf16 v[112:115], v[20:23], a[160:163], v[112:115]
    v_mfma_f32_16x16x32_bf16 v[116:119], v[20:23], a[216:219], v[116:119]
    ds_read_b128 v[16:19], v7 offset:6144
    ds_read_b128 v[20:23], v7 offset:20480
    s_waitcnt lgkmcnt(2)
    v_mfma_f32_16x16x32_bf16 v[64:67], v[24:27], v[140:143], v[64:67]
    v_mfma_f32_16x16x32_bf16 v[68:71], v[24:27], v[196:199], v[68:71]
    v_mfma_f32_16x16x32_bf16 v[72:75], v[24:27], v[252:255], v[72:75]
    v_mfma_f32_16x16x32_bf16 v[76:79], v[24:27], a[52:55], v[76:79]
    v_mfma_f32_16x16x32_bf16 v[80:83], v[24:27], a[108:111], v[80:83]
    v_mfma_f32_16x16x32_bf16 v[84:87], v[24:27], a[164:167], v[84:87]
    v_mfma_f32_16x16x32_bf16 v[88:91], v[24:27], a[220:223], v[88:91]
    v_mfma_f32_16x16x32_bf16 v[92:95], v[28:31], v[140:143], v[92:95]
    v_mfma_f32_16x16x32_bf16 v[96:99], v[28:31], v[196:199], v[96:99]
    v_mfma_f32_16x16x32_bf16 v[100:103], v[28:31], v[252:255], v[100:103]
    v_mfma_f32_16x16x32_bf16 v[104:107], v[28:31], a[52:55], v[104:107]
    v_mfma_f32_16x16x32_bf16 v[108:111], v[28:31], a[108:111], v[108:111]
    v_mfma_f32_16x16x32_bf16 v[112:115], v[28:31], a[164:167], v[112:115]
    v_mfma_f32_16x16x32_bf16 v[116:119], v[28:31], a[220:223], v[116:119]
    ds_read_b128 v[24:27], v7 offset:7168
    ds_read_b128 v[28:31], v7 offset:21504
    s_waitcnt vmcnt(49) lgkmcnt(2)
    v_mfma_f32_16x16x32_bf16 v[64:67], v[16:19], v[144:147], v[64:67]
    v_mfma_f32_16x16x32_bf16 v[68:71], v[16:19], v[200:203], v[68:71]
    v_mfma_f32_16x16x32_bf16 v[72:75], v[16:19], a[0:3], v[72:75]
    v_mfma_f32_16x16x32_bf16 v[76:79], v[16:19], a[56:59], v[76:79]
    v_mfma_f32_16x16x32_bf16 v[80:83], v[16:19], a[112:115], v[80:83]
    v_mfma_f32_16x16x32_bf16 v[84:87], v[16:19], a[168:171], v[84:87]
    v_mfma_f32_16x16x32_bf16 v[88:91], v[16:19], a[224:227], v[88:91]
    v_mfma_f32_16x16x32_bf16 v[92:95], v[20:23], v[144:147], v[92:95]
    v_mfma_f32_16x16x32_bf16 v[96:99], v[20:23], v[200:203], v[96:99]
    v_mfma_f32_16x16x32_bf16 v[100:103], v[20:23], a[0:3], v[100:103]
    v_mfma_f32_16x16x32_bf16 v[104:107], v[20:23], a[56:59], v[104:107]
    v_mfma_f32_16x16x32_bf16 v[108:111], v[20:23], a[112:115], v[108:111]
    v_mfma_f32_16x16x32_bf16 v[112:115], v[20:23], a[168:171], v[112:115]
    v_mfma_f32_16x16x32_bf16 v[116:119], v[20:23], a[224:227], v[116:119]
    ds_read_b128 v[16:19], v7 offset:8192
    ds_read_b128 v[20:23], v7 offset:22528
    s_cmp_eq_u32 s34, 0
    s_cbranch_scc1 NF_205
    s_waitcnt vmcnt(0)
    v_mov_b32 v15, 1
    s_mov_b64 exec, 1
    buffer_store_dword v15, off, s[8:11], s34 sc1
    s_mov_b64 exec, -1
    s_mov_b32 s34, 0
NF_205:
    s_waitcnt lgkmcnt(2)
    v_mfma_f32_16x16x32_bf16 v[64:67], v[24:27], v[148:151], v[64:67]
    v_mfma_f32_16x16x32_bf16 v[68:71], v[24:27], v[204:207], v[68:71]
    v_mfma_f32_16x16x32_bf16 v[72:75], v[24:27], a[4:7], v[72:75]
    v_mfma_f32_16x16x32_bf16 v[76:79], v[24:27], a[60:63], v[76:79]
    v_mfma_f32_16x16x32_bf16 v[80:83], v[24:27], a[116:119], v[80:83]
    v_mfma_f32_16x16x32_bf16 v[84:87], v[24:27], a[172:175], v[84:87]
    v_mfma_f32_16x16x32_bf16 v[88:91], v[24:27], a[228:231], v[88:91]
    v_mfma_f32_16x16x32_bf16 v[92:95], v[28:31], v[148:151], v[92:95]
    v_mfma_f32_16x16x32_bf16 v[96:99], v[28:31], v[204:207], v[96:99]
    v_mfma_f32_16x16x32_bf16 v[100:103], v[28:31], a[4:7], v[100:103]
    v_mfma_f32_16x16x32_bf16 v[104:107], v[28:31], a[60:63], v[104:107]
    v_mfma_f32_16x16x32_bf16 v[108:111], v[28:31], a[116:119], v[108:111]
    v_mfma_f32_16x16x32_bf16 v[112:115], v[28:31], a[172:175], v[112:115]
    v_mfma_f32_16x16x32_bf16 v[116:119], v[28:31], a[228:231], v[116:119]
    ds_read_b128 v[24:27], v7 offset:9216
    ds_read_b128 v[28:31], v7 offset:23552
    s_waitcnt vmcnt(35) lgkmcnt(2)
    v_mfma_f32_16x16x32_bf16 v[64:67], v[16:19], v[152:155], v[64:67]
    v_mfma_f32_16x16x32_bf16 v[68:71], v[16:19], v[208:211], v[68:71]
    v_mfma_f32_16x16x32_bf16 v[72:75], v[16:19], a[8:11], v[72:75]
    v_mfma_f32_16x16x32_bf16 v[76:79], v[16:19], a[64:67], v[76:79]
    v_mfma_f32_16x16x32_bf16 v[80:83], v[16:19], a[120:123], v[80:83]
    v_mfma_f32_16x16x32_bf16 v[84:87], v[16:19], a[176:179], v[84:87]
    v_mfma_f32_16x16x32_bf16 v[88:91], v[16:19], a[232:235], v[88:91]
    v_mfma_f32_16x16x32_bf16 v[92:95], v[20:23], v[152:155], v[92:95]
    v_mfma_f32_16x16x32_bf16 v[96:99], v[20:23], v[208:211], v[96:99]
    v_mfma_f32_16x16x32_bf16 v[100:103], v[20:23], a[8:11], v[100:103]
    v_mfma_f32_16x16x32_bf16 v[104:107], v[20:23], a[64:67], v[104:107]
    v_mfma_f32_16x16x32_bf16 v[108:111], v[20:23], a[120:123], v[108:111]
    v_mfma_f32_16x16x32_bf16 v[112:115], v[20:23], a[176:179], v[112:115]
    v_mfma_f32_16x16x32_bf16 v[116:119], v[20:23], a[232:235], v[116:119]
    ds_read_b128 v[16:19], v7 offset:10240
    ds_read_b128 v[20:23], v7 offset:24576
    s_waitcnt lgkmcnt(2)
    v_mfma_f32_16x16x32_bf16 v[64:67], v[24:27], v[156:159], v[64:67]
    v_mfma_f32_16x16x32_bf16 v[68:71], v[24:27], v[212:215], v[68:71]
    v_mfma_f32_16x16x32_bf16 v[72:75], v[24:27], a[12:15], v[72:75]
    v_mfma_f32_16x16x32_bf16 v[76:79], v[24:27], a[68:71], v[76:79]
    v_mfma_f32_16x16x32_bf16 v[80:83], v[24:27], a[124:127], v[80:83]
    v_mfma_f32_16x16x32_bf16 v[84:87], v[24:27], a[180:183], v[84:87]
    v_mfma_f32_16x16x32_bf16 v[88:91], v[24:27], a[236:239], v[88:91]
    v_mfma_f32_16x16x32_bf16 v[92:95], v[28:31], v[156:159], v[92:95]
    v_mfma_f32_16x16x32_bf16 v[96:99], v[28:31], v[212:215], v[96:99]
    v_mfma_f32_16x16x32_bf16 v[100:103], v[28:31], a[12:15], v[100:103]
    v_mfma_f32_16x16x32_bf16 v[104:107], v[28:31], a[68:71], v[104:107]
    v_mfma_f32_16x16x32_bf16 v[108:111], v[28:31], a[124:127], v[108:111]
    v_mfma_f32_16x16x32_bf16 v[112:115], v[28:31], a[180:183], v[112:115]
    v_mfma_f32_16x16x32_bf16 v[116:119], v[28:31], a[236:239], v[116:119]
    ds_read_b128 v[24:27], v7 offset:11264
    ds_read_b128 v[28:31], v7 offset:25600
    s_waitcnt vmcnt(21) lgkmcnt(2)
    v_mfma_f32_16x16x32_bf16 v[64:67], v[16:19], v[160:163], v[64:67]
    v_mfma_f32_16x16x32_bf16 v[68:71], v[16:19], v[216:219], v[68:71]
    v_mfma_f32_16x16x32_bf16 v[72:75], v[16:19], a[16:19], v[72:75]
    v_mfma_f32_16x16x32_bf16 v[76:79], v[16:19], a[72:75], v[76:79]
    v_mfma_f32_16x16x32_bf16 v[80:83], v[16:19], a[128:131], v[80:83]
    v_mfma_f32_16x16x32_bf16 v[84:87], v[16:19], a[184:187], v[84:87]
    v_mfma_f32_16x16x32_bf16 v[88:91], v[16:19], a[240:243], v[88:91]
    v_mfma_f32_16x16x32_bf16 v[92:95], v[20:23], v[160:163], v[92:95]
    v_mfma_f32_16x16x32_bf16 v[96:99], v[20:23], v[216:219], v[96:99]
    v_mfma_f32_16x16x32_bf16 v[100:103], v[20:23], a[16:19], v[100:103]
    v_mfma_f32_16x16x32_bf16 v[104:107], v[20:23], a[72:75], v[104:107]
    v_mfma_f32_16x16x32_bf16 v[108:111], v[20:23], a[128:131], v[108:111]
    v_mfma_f32_16x16x32_bf16 v[112:115], v[20:23], a[184:187], v[112:115]
    v_mfma_f32_16x16x32_bf16 v[116:119], v[20:23], a[240:243], v[116:119]
    ds_read_b128 v[16:19], v7 offset:12288
    ds_read_b128 v[20:23], v7 offset:26624
    s_waitcnt lgkmcnt(2)
    v_mfma_f32_16x16x32_bf16 v[64:67], v[24:27], v[164:167], v[64:67]
    v_mfma_f32_16x16x32_bf16 v[68:71], v[24:27], v[220:223], v[68:71]
    v_mfma_f32_16x16x32_bf16 v[72:75], v[24:27], a[20:23], v[72:75]
    v_mfma_f32_16x16x32_bf16 v[76:79], v[24:27], a[76:79], v[76:79]
    v_mfma_f32_16x16x32_bf16 v[80:83], v[24:27], a[132:135], v[80:83]
    v_mfma_f32_16x16x32_bf16 v[84:87], v[24:27], a[188:191], v[84:87]
    v_mfma_f32_16x16x32_bf16 v[88:91], v[24:27], a[244:247], v[88:91]
    v_mfma_f32_16x16x32_bf16 v[92:95], v[28:31], v[164:167], v[92:95]
    v_mfma_f32_16x16x32_bf16 v[96:99], v[28:31], v[220:223], v[96:99]
    v_mfma_f32_16x16x32_bf16 v[100:103], v[28:31], a[20:23], v[100:103]
    v_mfma_f32_16x16x32_bf16 v[104:107], v[28:31], a[76:79], v[104:107]
    v_mfma_f32_16x16x32_bf16 v[108:111], v[28:31], a[132:135], v[108:111]
    v_mfma_f32_16x16x32_bf16 v[112:115], v[28:31], a[188:191], v[112:115]
    v_mfma_f32_16x16x32_bf16 v[116:119], v[28:31], a[244:247], v[116:119]
    ds_read_b128 v[24:27], v7 offset:13312
    ds_read_b128 v[28:31], v7 offset:27648
    s_waitcnt vmcnt(7) lgkmcnt(2)
    v_mfma_f32_16x16x32_bf16 v[64:67], v[16:19], v[168:171], v[64:67]
    v_mfma_f32_16x16x32_bf16 v[68:71], v[16:19], v[224:227], v[68:71]
    v_mfma_f32_16x16x32_bf16 v[72:75], v[16:19], a[24:27], v[72:75]
    v_mfma_f32_16x16x32_bf16 v[76:79], v[16:19], a[80:83], v[76:79]
    v_mfma_f32_16x16x32_bf16 v[80:83], v[16:19], a[136:139], v[80:83]
    v_mfma_f32_16x16x32_bf16 v[84:87], v[16:19], a[192:195], v[84:87]
    v_mfma_f32_16x16x32_bf16 v[88:91], v[16:19], a[248:251], v[88:91]
    v_mfma_f32_16x16x32_bf16 v[92:95], v[20:23], v[168:171], v[92:95]
    v_mfma_f32_16x16x32_bf16 v[96:99], v[20:23], v[224:227], v[96:99]
    v_mfma_f32_16x16x32_bf16 v[100:103], v[20:23], a[24:27], v[100:103]
    v_mfma_f32_16x16x32_bf16 v[104:107], v[20:23], a[80:83], v[104:107]
    v_mfma_f32_16x16x32_bf16 v[108:111], v[20:23], a[136:139], v[108:111]
    v_mfma_f32_16x16x32_bf16 v[112:115], v[20:23], a[192:195], v[112:115]
    v_mfma_f32_16x16x32_bf16 v[116:119], v[20:23], a[248:251], v[116:119]
    s_waitcnt lgkmcnt(0)
    v_mfma_f32_16x16x32_bf16 v[64:67], v[24:27], v[172:175], v[64:67]
    v_mfma_f32_16x16x32_bf16 v[68:71], v[24:27], v[228:231], v[68:71]
    v_mfma_f32_16x16x32_bf16 v[72:75], v[24:27], a[28:31], v[72:75]
    v_mfma_f32_16x16x32_bf16 v[76:79], v[24:27], a[84:87], v[76:79]
    v_mfma_f32_16x16x32_bf16 v[80:83], v[24:27], a[140:143], v[80:83]
    v_mfma_f32_16x16x32_bf16 v[84:87], v[24:27], a[196:199], v[84:87]
    v_mfma_f32_16x16x32_bf16 v[88:91], v[24:27], a[252:255], v[88:91]
    v_mfma_f32_16x16x32_bf16 v[92:95], v[28:31], v[172:175], v[92:95]
    v_mfma_f32_16x16x32_bf16 v[96:99], v[28:31], v[228:231], v[96:99]
    v_mfma_f32_16x16x32_bf16 v[100:103], v[28:31], a[28:31], v[100:103]
    v_mfma_f32_16x16x32_bf16 v[104:107], v[28:31], a[84:87], v[104:107]
    v_mfma_f32_16x16x32_bf16 v[108:111], v[28:31], a[140:143], v[108:111]
    v_mfma_f32_16x16x32_bf16 v[112:115], v[28:31], a[196:199], v[112:115]
    v_mfma_f32_16x16x32_bf16 v[116:119], v[28:31], a[252:255], v[116:119]
    s_lshl_b32 s32, s16, 10
    s_mul_i32 s26, s28, 458752
    s_add_u32 s32, s32, s26
    s_add_u32 s32, s32, 46137344
    s_mov_b32 s42, s32
    s_mul_i32 s26, s19, 16384
    s_mul_i32 s27, s20, 16384
    s_add_u32 s26, s26, s32
    s_add_u32 s27, s27, s32
    v_cvt_pk_bf16_f32 v36, v64, v92
    v_cvt_pk_bf16_f32 v37, v65, v93
    v_cvt_pk_bf16_f32 v38, v66, v94
    v_cvt_pk_bf16_f32 v39, v67, v95
    buffer_store_dwordx4 v[36:39], v2, s[8:11], s26 offen sc1
    s_add_u32 s26, s26, 16384
    v_cvt_pk_bf16_f32 v40, v68, v96
    v_cvt_pk_bf16_f32 v41, v69, v97
    v_cvt_pk_bf16_f32 v42, v70, v98
    v_cvt_pk_bf16_f32 v43, v71, v99
    buffer_store_dwordx4 v[40:43], v2, s[8:11], s26 offen sc1
    s_add_u32 s26, s26, 16384
    v_cvt_pk_bf16_f32 v44, v72, v100
    v_cvt_pk_bf16_f32 v45, v73, v101
    v_cvt_pk_bf16_f32 v46, v74, v102
    v_cvt_pk_bf16_f32 v47, v75, v103
    buffer_store_dwordx4 v[44:47], v2, s[8:11], s26 offen sc1
    s_add_u32 s26, s26, 16384
    v_cvt_pk_bf16_f32 v48, v76, v104
    v_cvt_pk_bf16_f32 v49, v77, v105
    v_cvt_pk_bf16_f32 v50, v78, v106
    v_cvt_pk_bf16_f32 v51, v79, v107
    buffer_store_dwordx4 v[48:51], v2, s[8:11], s26 offen sc1
    s_add_u32 s26, s26, 16384
    v_cvt_pk_bf16_f32 v52, v80, v108
    v_cvt_pk_bf16_f32 v53, v81, v109
    v_cvt_pk_bf16_f32 v54, v82, v110
    v_cvt_pk_bf16_f32 v55, v83, v111
    buffer_store_dwordx4 v[52:55], v2, s[8:11], s26 offen sc1
    s_add_u32 s26, s26, 16384
    v_cvt_pk_bf16_f32 v56, v84, v112
    v_cvt_pk_bf16_f32 v57, v85, v113
    v_cvt_pk_bf16_f32 v58, v86, v114
    v_cvt_pk_bf16_f32 v59, v87, v115
    buffer_store_dwordx4 v[56:59], v2, s[8:11], s26 offen sc1
    v_cvt_pk_bf16_f32 v60, v88, v116
    v_cvt_pk_bf16_f32 v61, v89, v117
    v_cvt_pk_bf16_f32 v62, v90, v118
    v_cvt_pk_bf16_f32 v63, v91, v119
    buffer_store_dwordx4 v[60:63], v2, s[8:11], s27 offen sc1
    s_lshl_b32 s34, s28, 9
    s_lshl_b32 s33, s14, 4
    s_add_u32 s34, s34, s33
    s_lshl_b32 s33, s13, 2
    s_add_u32 s34, s34, s33
    s_add_u32 s34, s34, 116396032
    s_cmp_lg_u32 s39, s28
    s_cbranch_scc1 KVF_206
    s_cmp_eq_u32 s34, 0
    s_cbranch_scc1 NF_207
    s_waitcnt vmcnt(0)
    v_mov_b32 v15, 1
    s_mov_b64 exec, 1
    buffer_store_dword v15, off, s[8:11], s34 sc1
    s_mov_b64 exec, -1
    s_mov_b32 s34, 0
NF_207:
KVF_206:
    s_waitcnt vmcnt(7)
    s_mov_b32 s28, s30
    s_mov_b32 s29, s31
    s_cmp_lt_u32 s28, s59
    s_cbranch_scc1 KVL_202
    s_cmp_eq_u32 s34, 0
    s_cbranch_scc1 NF_208
    s_waitcnt vmcnt(0)
    v_mov_b32 v15, 1
    s_mov_b64 exec, 1
    buffer_store_dword v15, off, s[8:11], s34 sc1
    s_mov_b64 exec, -1
    s_mov_b32 s34, 0
NF_208:
    s_cmp_lt_u32 s15, 5
    s_cbranch_scc1 MEGA_EXIT
W_VM:
    v_add_u32 v12, 4096, v2
    v_add_u32 v13, 8192, v2
    v_add_u32 v14, 12288, v2
    s_lshl_b32 s32, s13, 12
    s_add_u32 s32, s32, 114688
    v_add_u32 v7, s32, v2
    s_lshl_b32 s32, s13, 10
    s_add_u32 s32, s32, 114688
    v_add_u32 v8, s32, v2
    s_mov_b32 s28, s38
    v_lshrrev_b32 v9, 1, v4
    v_mul_u32_u24 v9, 114688, v9
    v_and_b32 v10, 31, v1
    v_lshl_add_u32 v9, v10, 4, v9
    v_cmp_gt_u32 vcc, 16, v10
    v_mov_b32 v10, 0x80000000
    s_nop 0
    v_cndmask_b32 v10, v10, v9, vcc
MIR_209:
    s_barrier
    s_lshl_b32 s40, s28, 5
    s_add_u32 s40, s40, s16
    s_mul_i32 s40, s40, 28
    s_add_u32 s41, s40, s20
    s_add_u32 s40, s40, s19
    s_lshl_b32 s40, s40, 8
    s_lshl_b32 s41, s41, 8
    s_add_u32 s40, s40, 106954752
    s_add_u32 s41, s41, 106954752
    v_mov_b64 v[116:117], -1
    v_mov_b64 v[118:119], -1
    buffer_store_dwordx4 v[116:119], v9, s[8:11], s40 offen offset:0 sc1
    buffer_store_dwordx4 v[116:119], v9, s[8:11], s40 offen offset:512 sc1
    buffer_store_dwordx4 v[116:119], v9, s[8:11], s40 offen offset:1024 sc1
    buffer_store_dwordx4 v[116:119], v10, s[8:11], s41 offen sc1
    s_lshl_b32 s34, s28, 8
    s_lshl_b32 s33, s14, 2
    s_add_u32 s34, s34, s33
    s_add_u32 s34, s34, 116428800
    s_waitcnt vmcnt(0)
    s_barrier
    s_cmp_lg_u32 s13, 0
    s_cbranch_scc1 NF_210
    v_mov_b32 v15, 1
    s_mov_b64 exec, 1
    buffer_store_dword v15, off, s[8:11], s34 sc1
    s_mov_b64 exec, -1
NF_210:
    s_mov_b32 s34, 0
    s_mul_i32 s26, s28, 14336
    s_add_u32 s26, s26, 115343360
    s_cmp_lg_u32 s13, 0
    s_cbranch_scc1 WMK_213
    s_lshl_b32 s37, s28, 1
    s_add_u32 s37, s37, 2
    s_mov_b32 s35, 0
    s_lshr_b32 s30, s83, 5
    s_lshl_b32 s30, s30, 1
    s_add_u32 s30, s30, s38
    s_lshl_b32 s30, s30, 7
    s_add_u32 s30, s30, 116391936
    s_mov_b64 exec, 1
    s_branch WM0_212
WM_211:
    s_sleep 2
WM0_212:
    buffer_load_dword v15, off, s[8:11], s30 sc1
    s_add_u32 s35, s35, 1
    s_cmp_gt_u32 s35, 4000000
    s_cbranch_scc1 MEGA_EXIT
    s_waitcnt vmcnt(0)
    v_readfirstlane_b32 s36, v15
    s_nop 0
    s_cmp_lt_u32 s36, s37
    s_cbranch_scc1 WM_211
    s_mov_b64 exec, -1
WMK_213:
    s_barrier
    buffer_load_dwordx4 v[16:19], v2, s[8:11], s26 offen offset:0 sc1
    buffer_load_dwordx4 v[20:23], v2, s[8:11], s26 offen offset:1024 sc1
    buffer_load_dwordx4 v[24:27], v2, s[8:11], s26 offen offset:2048 sc1
    buffer_load_dwordx4 v[28:31], v2, s[8:11], s26 offen offset:3072 sc1
    buffer_load_dwordx4 v[32:35], v12, s[8:11], s26 offen offset:0 sc1
    buffer_load_dwordx4 v[36:39], v12, s[8:11], s26 offen offset:1024 sc1
    buffer_load_dwordx4 v[40:43], v12, s[8:11], s26 offen offset:2048 sc1
    buffer_load_dwordx4 v[44:47], v12, s[8:11], s26 offen offset:3072 sc1
    buffer_load_dwordx4 v[48:51], v13, s[8:11], s26 offen offset:0 sc1
    buffer_load_dwordx4 v[52:55], v13, s[8:11], s26 offen offset:1024 sc1
    buffer_load_dwordx4 v[56:59], v13, s[8:11], s26 offen offset:2048 sc1
    buffer_load_dwordx4 v[60:63], v13, s[8:11], s26 offen offset:3072 sc1
    buffer_load_dwordx4 v[92:95], v14, s[8:11], s26 offen offset:0 sc1
    buffer_load_dwordx4 v[96:99], v14, s[8:11], s26 offen offset:1024 sc1
    s_waitcnt vmcnt(13)
    v_mfma_f32_16x16x32_bf16 v[64:67], v[16:19], v[120:123], 0
    v_mfma_f32_16x16x32_bf16 v[68:71], v[16:19], v[176:179], 0
    v_mfma_f32_16x16x32_bf16 v[72:75], v[16:19], v[232:235], 0
    v_mfma_f32_16x16x32_bf16 v[76:79], v[16:19], a[32:35], 0
    v_mfma_f32_16x16x32_bf16 v[80:83], v[16:19], a[88:91], 0
    v_mfma_f32_16x16x32_bf16 v[84:87], v[16:19], a[144:147], 0
    v_mfma_f32_16x16x32_bf16 v[88:91], v[16:19], a[200:203], 0
    s_waitcnt vmcnt(12)
    v_mfma_f32_16x16x32_bf16 v[64:67], v[20:23], v[124:127], v[64:67]
    v_mfma_f32_16x16x32_bf16 v[68:71], v[20:23], v[180:183], v[68:71]
    v_mfma_f32_16x16x32_bf16 v[72:75], v[20:23], v[236:239], v[72:75]
    v_mfma_f32_16x16x32_bf16 v[76:79], v[20:23], a[36:39], v[76:79]
    v_mfma_f32_16x16x32_bf16 v[80:83], v[20:23], a[92:95], v[80:83]
    v_mfma_f32_16x16x32_bf16 v[84:87], v[20:23], a[148:151], v[84:87]
    v_mfma_f32_16x16x32_bf16 v[88:91], v[20:23], a[204:207], v[88:91]
    s_waitcnt vmcnt(11)
    v_mfma_f32_16x16x32_bf16 v[64:67], v[24:27], v[128:131], v[64:67]
    v_mfma_f32_16x16x32_bf16 v[68:71], v[24:27], v[184:187], v[68:71]
    v_mfma_f32_16x16x32_bf16 v[72:75], v[24:27], v[240:243], v[72:75]
    v_mfma_f32_16x16x32_bf16 v[76:79], v[24:27], a[40:43], v[76:79]
    v_mfma_f32_16x16x32_bf16 v[80:83], v[24:27], a[96:99], v[80:83]
    v_mfma_f32_16x16x32_bf16 v[84:87], v[24:27], a[152:155], v[84:87]
    v_mfma_f32_16x16x32_bf16 v[88:91], v[24:27], a[208:211], v[88:91]
    s_waitcnt vmcnt(10)
    v_mfma_f32_16x16x32_bf16 v[64:67], v[28:31], v[132:135], v[64:67]
    v_mfma_f32_16x16x32_bf16 v[68:71], v[28:31], v[188:191], v[68:71]
    v_mfma_f32_16x16x32_bf16 v[72:75], v[28:31], v[244:247], v[72:75]
    v_mfma_f32_16x16x32_bf16 v[76:79], v[28:31], a[44:47], v[76:79]
    v_mfma_f32_16x16x32_bf16 v[80:83], v[28:31], a[100:103], v[80:83]
    v_mfma_f32_16x16x32_bf16 v[84:87], v[28:31], a[156:159], v[84:87]
    v_mfma_f32_16x16x32_bf16 v[88:91], v[28:31], a[212:215], v[88:91]
    s_waitcnt vmcnt(9)
    v_mfma_f32_16x16x32_bf16 v[64:67], v[32:35], v[136:139], v[64:67]
    v_mfma_f32_16x16x32_bf16 v[68:71], v[32:35], v[192:195], v[68:71]
    v_mfma_f32_16x16x32_bf16 v[72:75], v[32:35], v[248:251], v[72:75]
    v_mfma_f32_16x16x32_bf16 v[76:79], v[32:35], a[48:51], v[76:79]
    v_mfma_f32_16x16x32_bf16 v[80:83], v[32:35], a[104:107], v[80:83]
    v_mfma_f32_16x16x32_bf16 v[84:87], v[32:35], a[160:163], v[84:87]
    v_mfma_f32_16x16x32_bf16 v[88:91], v[32:35], a[216:219], v[88:91]
    s_waitcnt vmcnt(8)
    v_mfma_f32_16x16x32_bf16 v[64:67], v[36:39], v[140:143], v[64:67]
    v_mfma_f32_16x16x32_bf16 v[68:71], v[36:39], v[196:199], v[68:71]
    v_mfma_f32_16x16x32_bf16 v[72:75], v[36:39], v[252:255], v[72:75]
    v_mfma_f32_16x16x32_bf16 v[76:79], v[36:39], a[52:55], v[76:79]
    v_mfma_f32_16x16x32_bf16 v[80:83], v[36:39], a[108:111], v[80:83]
    v_mfma_f32_16x16x32_bf16 v[84:87], v[36:39], a[164:167], v[84:87]
    v_mfma_f32_16x16x32_bf16 v[88:91], v[36:39], a[220:223], v[88:91]
    s_waitcnt vmcnt(7)
    v_mfma_f32_16x16x32_bf16 v[64:67], v[40:43], v[144:147], v[64:67]
    v_mfma_f32_16x16x32_bf16 v[68:71], v[40:43], v[200:203], v[68:71]
    v_mfma_f32_16x16x32_bf16 v[72:75], v[40:43], a[0:3], v[72:75]
    v_mfma_f32_16x16x32_bf16 v[76:79], v[40:43], a[56:59], v[76:79]
    v_mfma_f32_16x16x32_bf16 v[80:83], v[40:43], a[112:115], v[80:83]
    v_mfma_f32_16x16x32_bf16 v[84:87], v[40:43], a[168:171], v[84:87]
    v_mfma_f32_16x16x32_bf16 v[88:91], v[40:43], a[224:227], v[88:91]
    s_waitcnt vmcnt(6)
    v_mfma_f32_16x16x32_bf16 v[64:67], v[44:47], v[148:151], v[64:67]
    v_mfma_f32_16x16x32_bf16 v[68:71], v[44:47], v[204:207], v[68:71]
    v_mfma_f32_16x16x32_bf16 v[72:75], v[44:47], a[4:7], v[72:75]
    v_mfma_f32_16x16x32_bf16 v[76:79], v[44:47], a[60:63], v[76:79]
    v_mfma_f32_16x16x32_bf16 v[80:83], v[44:47], a[116:119], v[80:83]
    v_mfma_f32_16x16x32_bf16 v[84:87], v[44:47], a[172:175], v[84:87]
    v_mfma_f32_16x16x32_bf16 v[88:91], v[44:47], a[228:231], v[88:91]
    s_waitcnt vmcnt(5)
    v_mfma_f32_16x16x32_bf16 v[64:67], v[48:51], v[152:155], v[64:67]
    v_mfma_f32_16x16x32_bf16 v[68:71], v[48:51], v[208:211], v[68:71]
    v_mfma_f32_16x16x32_bf16 v[72:75], v[48:51], a[8:11], v[72:75]
    v_mfma_f32_16x16x32_bf16 v[76:79], v[48:51], a[64:67], v[76:79]
    v_mfma_f32_16x16x32_bf16 v[80:83], v[48:51], a[120:123], v[80:83]
    v_mfma_f32_16x16x32_bf16 v[84:87], v[48:51], a[176:179], v[84:87]
    v_mfma_f32_16x16x32_bf16 v[88:91], v[48:51], a[232:235], v[88:91]
    s_waitcnt vmcnt(4)
    v_mfma_f32_16x16x32_bf16 v[64:67], v[52:55], v[156:159], v[64:67]
    v_mfma_f32_16x16x32_bf16 v[68:71], v[52:55], v[212:215], v[68:71]
    v_mfma_f32_16x16x32_bf16 v[72:75], v[52:55], a[12:15], v[72:75]
    v_mfma_f32_16x16x32_bf16 v[76:79], v[52:55], a[68:71], v[76:79]
    v_mfma_f32_16x16x32_bf16 v[80:83], v[52:55], a[124:127], v[80:83]
    v_mfma_f32_16x16x32_bf16 v[84:87], v[52:55], a[180:183], v[84:87]
    v_mfma_f32_16x16x32_bf16 v[88:91], v[52:55], a[236:239], v[88:91]
    s_waitcnt vmcnt(3)
    v_mfma_f32_16x16x32_bf16 v[64:67], v[56:59], v[160:163], v[64:67]
    v_mfma_f32_16x16x32_bf16 v[68:71], v[56:59], v[216:219], v[68:71]
    v_mfma_f32_16x16x32_bf16 v[72:75], v[56:59], a[16:19], v[72:75]
    v_mfma_f32_16x16x32_bf16 v[76:79], v[56:59], a[72:75], v[76:79]
    v_mfma_f32_16x16x32_bf16 v[80:83], v[56:59], a[128:131], v[80:83]
    v_mfma_f32_16x16x32_bf16 v[84:87], v[56:59], a[184:187], v[84:87]
    v_mfma_f32_16x16x32_bf16 v[88:91], v[56:59], a[240:243], v[88:91]
    s_waitcnt vmcnt(2)
    v_mfma_f32_16x16x32_bf16 v[64:67], v[60:63], v[164:167], v[64:67]
    v_mfma_f32_16x16x32_bf16 v[68:71], v[60:63], v[220:223], v[68:71]
    v_mfma_f32_16x16x32_bf16 v[72:75], v[60:63], a[20:23], v[72:75]
    v_mfma_f32_16x16x32_bf16 v[76:79], v[60:63], a[76:79], v[76:79]
    v_mfma_f32_16x16x32_bf16 v[80:83], v[60:63], a[132:135], v[80:83]
    v_mfma_f32_16x16x32_bf16 v[84:87], v[60:63], a[188:191], v[84:87]
    v_mfma_f32_16x16x32_bf16 v[88:91], v[60:63], a[244:247], v[88:91]
    s_waitcnt vmcnt(1)
    v_mfma_f32_16x16x32_bf16 v[64:67], v[92:95], v[168:171], v[64:67]
    v_mfma_f32_16x16x32_bf16 v[68:71], v[92:95], v[224:227], v[68:71]
    v_mfma_f32_16x16x32_bf16 v[72:75], v[92:95], a[24:27], v[72:75]
    v_mfma_f32_16x16x32_bf16 v[76:79], v[92:95], a[80:83], v[76:79]
    v_mfma_f32_16x16x32_bf16 v[80:83], v[92:95], a[136:139], v[80:83]
    v_mfma_f32_16x16x32_bf16 v[84:87], v[92:95], a[192:195], v[84:87]
    v_mfma_f32_16x16x32_bf16 v[88:91], v[92:95], a[248:251], v[88:91]
    s_waitcnt vmcnt(0)
    v_mfma_f32_16x16x32_bf16 v[64:67], v[96:99], v[172:175], v[64:67]
    v_mfma_f32_16x16x32_bf16 v[68:71], v[96:99], v[228:231], v[68:71]
    v_mfma_f32_16x16x32_bf16 v[72:75], v[96:99], a[28:31], v[72:75]
    v_mfma_f32_16x16x32_bf16 v[76:79], v[96:99], a[84:87], v[76:79]
    v_mfma_f32_16x16x32_bf16 v[80:83], v[96:99], a[140:143], v[80:83]
    v_mfma_f32_16x16x32_bf16 v[84:87], v[96:99], a[196:199], v[84:87]
    v_mfma_f32_16x16x32_bf16 v[88:91], v[96:99], a[252:255], v[88:91]
    v_cvt_pk_bf16_f32 v100, v64, v65
    v_cvt_pk_bf16_f32 v101, v66, v67
    v_cvt_pk_bf16_f32 v102, v68, v69
    v_cvt_pk_bf16_f32 v103, v70, v71
    v_min_u32 v100, -2, v100
    v_min_u32 v101, -2, v101
    v_min_u32 v102, -2, v102
    v_min_u32 v103, -2, v103
    s_nop 0
    v_permlane16_swap_b32 v100, v102
    v_permlane16_swap_b32 v101, v103
    buffer_store_dwordx4 v[100:103], v9, s[8:11], s40 offen offset:0 sc1
    v_cvt_pk_bf16_f32 v104, v72, v73
    v_cvt_pk_bf16_f32 v105, v74, v75
    v_cvt_pk_bf16_f32 v106, v76, v77
    v_cvt_pk_bf16_f32 v107, v78, v79
    v_min_u32 v104, -2, v104
    v_min_u32 v105, -2, v105
    v_min_u32 v106, -2, v106
    v_min_u32 v107, -2, v107
    s_nop 0
    v_permlane16_swap_b32 v104, v106
    v_permlane16_swap_b32 v105, v107
    buffer_store_dwordx4 v[104:107], v9, s[8:11], s40 offen offset:512 sc1
    v_cvt_pk_bf16_f32 v108, v80, v81
    v_cvt_pk_bf16_f32 v109, v82, v83
    v_cvt_pk_bf16_f32 v110, v84, v85
    v_cvt_pk_bf16_f32 v111, v86, v87
    v_min_u32 v108, -2, v108
    v_min_u32 v109, -2, v109
    v_min_u32 v110, -2, v110
    v_min_u32 v111, -2, v111
    s_nop 0
    v_permlane16_swap_b32 v108, v110
    v_permlane16_swap_b32 v109, v111
    buffer_store_dwordx4 v[108:111], v9, s[8:11], s40 offen offset:1024 sc1
    v_cvt_pk_bf16_f32 v112, v88, v89
    v_cvt_pk_bf16_f32 v113, v90, v91
    v_cvt_pk_bf16_f32 v114, v88, v89
    v_cvt_pk_bf16_f32 v115, v90, v91
    v_min_u32 v112, -2, v112
    v_min_u32 v113, -2, v113
    v_min_u32 v114, -2, v114
    v_min_u32 v115, -2, v115
    s_nop 0
    v_permlane16_swap_b32 v112, v114
    v_permlane16_swap_b32 v113, v115
    buffer_store_dwordx4 v[112:115], v10, s[8:11], s41 offen sc1
    s_add_u32 s28, s28, 2
    s_cmp_lt_u32 s28, 31
    s_cbranch_scc1 MIR_209
    s_branch MEGA_EXIT
W_H:
    s_nop 11
    s_mul_i32 s12, s14, 3
    s_add_u32 s12, s12, s15
    s_sub_u32 s12, s12, 2
    s_mov_b32 s58, s12
W_HL:
    v_and_b32 v1, 63, v0
    v_lshlrev_b32 v2, 4, v1
    v_and_b32 v3, 15, v1
    v_lshrrev_b32 v4, 4, v1
    s_mul_i32 s14, s58, 2341
    s_lshr_b32 s14, s14, 16
    s_mul_i32 s15, s14, 28
    s_sub_u32 s15, s58, s15
    s_and_b32 s17, s13, 1
    s_lshl_b32 s16, s15, 1
    s_add_u32 s16, s16, s17
    s_load_dwordx2 s[44:45], s[0:1], 64
    s_mov_b32 s46, 1605632
    s_mov_b32 s47, 0x20000
    s_load_dwordx2 s[48:49], s[0:1], 72
    s_mov_b32 s50, 1605632
    s_mov_b32 s51, 0x20000
    v_lshrrev_b32 v7, 3, v1
    v_mul_u32_u24 v6, 3584, v7
    v_bfe_u32 v7, v1, 4, 1
    v_lshlrev_b32 v7, 2, v7
    v_xor_b32 v7, v7, v1
    v_and_b32 v7, 7, v7
    v_lshl_add_u32 v6, v7, 4, v6
    s_mul_i32 s18, s13, 401408
    s_lshl_b32 s19, s15, 7
    s_add_u32 s18, s18, s19
    s_mul_i32 s25, s13, 14336
    s_waitcnt lgkmcnt(0)
    s_barrier
    s_add_u32 m0, s25, 0
    s_add_u32 s19, s18, 0
    buffer_load_dwordx4 v6, s[44:47], s19 offen lds
    s_add_u32 m0, s25, 1024
    s_add_u32 s19, s18, 28672
    buffer_load_dwordx4 v6, s[44:47], s19 offen lds
    s_add_u32 m0, s25, 2048
    s_add_u32 s19, s18, 57344
    buffer_load_dwordx4 v6, s[44:47], s19 offen lds
    s_add_u32 m0, s25, 3072
    s_add_u32 s19, s18, 86016
    buffer_load_dwordx4 v6, s[44:47], s19 offen lds
    s_add_u32 m0, s25, 4096
    s_add_u32 s19, s18, 114688
    buffer_load_dwordx4 v6, s[44:47], s19 offen lds
    s_add_u32 m0, s25, 5120
    s_add_u32 s19, s18, 143360
    buffer_load_dwordx4 v6, s[44:47], s19 offen lds
    s_add_u32 m0, s25, 6144
    s_add_u32 s19, s18, 172032
    buffer_load_dwordx4 v6, s[44:47], s19 offen lds
    s_add_u32 m0, s25, 7168
    s_add_u32 s19, s18, 200704
    buffer_load_dwordx4 v6, s[44:47], s19 offen lds
    s_add_u32 m0, s25, 8192
    s_add_u32 s19, s18, 229376
    buffer_load_dwordx4 v6, s[44:47], s19 offen lds
    s_add_u32 m0, s25, 9216
    s_add_u32 s19, s18, 258048
    buffer_load_dwordx4 v6, s[44:47], s19 offen lds
    s_add_u32 m0, s25, 10240
    s_add_u32 s19, s18, 286720
    buffer_load_dwordx4 v6, s[44:47], s19 offen lds
    s_add_u32 m0, s25, 11264
    s_add_u32 s19, s18, 315392
    buffer_load_dwordx4 v6, s[44:47], s19 offen lds
    s_add_u32 m0, s25, 12288
    s_add_u32 s19, s18, 344064
    buffer_load_dwordx4 v6, s[44:47], s19 offen lds
    s_add_u32 m0, s25, 13312
    s_add_u32 s19, s18, 372736
    buffer_load_dwordx4 v6, s[44:47], s19 offen lds
    s_add_u32 m0, s25, 57344
    s_add_u32 s19, s18, 0
    buffer_load_dwordx4 v6, s[48:51], s19 offen lds
    s_add_u32 m0, s25, 58368
    s_add_u32 s19, s18, 28672
    buffer_load_dwordx4 v6, s[48:51], s19 offen lds
    s_add_u32 m0, s25, 59392
    s_add_u32 s19, s18, 57344
    buffer_load_dwordx4 v6, s[48:51], s19 offen lds
    s_add_u32 m0, s25, 60416
    s_add_u32 s19, s18, 86016
    buffer_load_dwordx4 v6, s[48:51], s19 offen lds
    s_add_u32 m0, s25, 61440
    s_add_u32 s19, s18, 114688
    buffer_load_dwordx4 v6, s[48:51], s19 offen lds
    s_add_u32 m0, s25, 62464
    s_add_u32 s19, s18, 143360
    buffer_load_dwordx4 v6, s[48:51], s19 offen lds
    s_add_u32 m0, s25, 63488
    s_add_u32 s19, s18, 172032
    buffer_load_dwordx4 v6, s[48:51], s19 offen lds
    s_add_u32 m0, s25, 64512
    s_add_u32 s19, s18, 200704
    buffer_load_dwordx4 v6, s[48:51], s19 offen lds
    s_add_u32 m0, s25, 65536
    s_add_u32 s19, s18, 229376
    buffer_load_dwordx4 v6, s[48:51], s19 offen lds
    s_add_u32 m0, s25, 66560
    s_add_u32 s19, s18, 258048
    buffer_load_dwordx4 v6, s[48:51], s19 offen lds
    s_add_u32 m0, s25, 67584
    s_add_u32 s19, s18, 286720
    buffer_load_dwordx4 v6, s[48:51], s19 offen lds
    s_add_u32 m0, s25, 68608
    s_add_u32 s19, s18, 315392
    buffer_load_dwordx4 v6, s[48:51], s19 offen lds
    s_add_u32 m0, s25, 69632
    s_add_u32 s19, s18, 344064
    buffer_load_dwordx4 v6, s[48:51], s19 offen lds
    s_add_u32 m0, s25, 70656
    s_add_u32 s19, s18, 372736
    buffer_load_dwordx4 v6, s[48:51], s19 offen lds
    v_lshrrev_b32 v7, 2, v3
    v_and_b32 v8, 3, v3
    v_lshlrev_b32 v8, 4, v8
    v_lshl_add_u32 v8, v7, 7, v8
    v_lshl_add_u32 v8, v4, 10, v8
    v_bfe_u32 v7, v3, 3, 1
    v_xor_b32 v7, s17, v7
    v_lshl_add_u32 v8, v7, 6, v8
    s_lshr_b32 s20, s13, 1
    s_lshl_b32 s20, s20, 3
    s_lshl_b32 s21, s14, 4
    s_add_u32 s20, s20, s21
    s_mul_i32 s21, s20, 14336
    s_add_u32 s21, s21, 83886080
    s_mul_i32 s22, s20, 57344
    s_lshl_b32 s23, s16, 10
    s_add_u32 s22, s22, s23
    s_add_u32 s22, s22, 93323264
    s_lshl_b32 s23, s20, 6
    s_add_u32 s23, s23, 92274688
    v_lshlrev_b32 v5, 2, v3
    s_mov_b32 s24, 3216550459
    s_add_u32 s19, s21, 0
    buffer_load_dwordx4 v[16:19], v2, s[8:11], s19 offen offset:0 sc1
    buffer_load_dwordx4 v[20:23], v2, s[8:11], s19 offen offset:1024 sc1
    buffer_load_dwordx4 v[24:27], v2, s[8:11], s19 offen offset:2048 sc1
    buffer_load_dwordx4 v[28:31], v2, s[8:11], s19 offen offset:3072 sc1
    s_add_u32 s19, s21, 4096
    buffer_load_dwordx4 v[32:35], v2, s[8:11], s19 offen offset:0 sc1
    buffer_load_dwordx4 v[36:39], v2, s[8:11], s19 offen offset:1024 sc1
    buffer_load_dwordx4 v[40:43], v2, s[8:11], s19 offen offset:2048 sc1
    buffer_load_dwordx4 v[44:47], v2, s[8:11], s19 offen offset:3072 sc1
    s_add_u32 s19, s21, 8192
    buffer_load_dwordx4 v[48:51], v2, s[8:11], s19 offen offset:0 sc1
    buffer_load_dwordx4 v[52:55], v2, s[8:11], s19 offen offset:1024 sc1
    buffer_load_dwordx4 v[56:59], v2, s[8:11], s19 offen offset:2048 sc1
    buffer_load_dwordx4 v[60:63], v2, s[8:11], s19 offen offset:3072 sc1
    s_add_u32 s19, s21, 12288
    buffer_load_dwordx4 v[64:67], v2, s[8:11], s19 offen offset:0 sc1
    buffer_load_dwordx4 v[68:71], v2, s[8:11], s19 offen offset:1024 sc1
    buffer_load_dword v72, v5, s[8:11], s23 offen offset:0 sc1
    s_add_u32 s19, s21, 14336
    buffer_load_dwordx4 v[76:79], v2, s[8:11], s19 offen offset:0 sc1
    buffer_load_dwordx4 v[80:83], v2, s[8:11], s19 offen offset:1024 sc1
    buffer_load_dwordx4 v[84:87], v2, s[8:11], s19 offen offset:2048 sc1
    buffer_load_dwordx4 v[88:91], v2, s[8:11], s19 offen offset:3072 sc1
    s_add_u32 s19, s21, 18432
    buffer_load_dwordx4 v[92:95], v2, s[8:11], s19 offen offset:0 sc1
    buffer_load_dwordx4 v[96:99], v2, s[8:11], s19 offen offset:1024 sc1
    buffer_load_dwordx4 v[100:103], v2, s[8:11], s19 offen offset:2048 sc1
    buffer_load_dwordx4 v[104:107], v2, s[8:11], s19 offen offset:3072 sc1
    s_add_u32 s19, s21, 22528
    buffer_load_dwordx4 v[108:111], v2, s[8:11], s19 offen offset:0 sc1
    buffer_load_dwordx4 v[112:115], v2, s[8:11], s19 offen offset:1024 sc1
    buffer_load_dwordx4 v[116:119], v2, s[8:11], s19 offen offset:2048 sc1
    buffer_load_dwordx4 v[120:123], v2, s[8:11], s19 offen offset:3072 sc1
    s_add_u32 s19, s21, 26624
    buffer_load_dwordx4 v[124:127], v2, s[8:11], s19 offen offset:0 sc1
    buffer_load_dwordx4 v[128:131], v2, s[8:11], s19 offen offset:1024 sc1
    buffer_load_dword v132, v5, s[8:11], s23 offen offset:64 sc1
    s_waitcnt vmcnt(30)
    s_barrier
    ds_read_b64_tr_b16 a[0:1], v8 offset:0
    ds_read_b64_tr_b16 a[2:3], v8 offset:512
    ds_read_b64_tr_b16 a[56:57], v8 offset:8
    ds_read_b64_tr_b16 a[58:59], v8 offset:520
    ds_read_b64_tr_b16 a[4:5], v8 offset:4096
    ds_read_b64_tr_b16 a[6:7], v8 offset:4608
    ds_read_b64_tr_b16 a[60:61], v8 offset:4104
    ds_read_b64_tr_b16 a[62:63], v8 offset:4616
    ds_read_b64_tr_b16 a[8:9], v8 offset:8192
    ds_read_b64_tr_b16 a[10:11], v8 offset:8704
    ds_read_b64_tr_b16 a[64:65], v8 offset:8200
    ds_read_b64_tr_b16 a[66:67], v8 offset:8712
    ds_read_b64_tr_b16 a[12:13], v8 offset:12288
    ds_read_b64_tr_b16 a[14:15], v8 offset:12800
    ds_read_b64_tr_b16 a[68:69], v8 offset:12296
    ds_read_b64_tr_b16 a[70:71], v8 offset:12808
    ds_read_b64_tr_b16 a[16:17], v8 offset:16384
    ds_read_b64_tr_b16 a[18:19], v8 offset:16896
    ds_read_b64_tr_b16 a[72:73], v8 offset:16392
    ds_read_b64_tr_b16 a[74:75], v8 offset:16904
    ds_read_b64_tr_b16 a[20:21], v8 offset:20480
    ds_read_b64_tr_b16 a[22:23], v8 offset:20992
    ds_read_b64_tr_b16 a[76:77], v8 offset:20488
    ds_read_b64_tr_b16 a[78:79], v8 offset:21000
    ds_read_b64_tr_b16 a[24:25], v8 offset:24576
    ds_read_b64_tr_b16 a[26:27], v8 offset:25088
    ds_read_b64_tr_b16 a[80:81], v8 offset:24584
    ds_read_b64_tr_b16 a[82:83], v8 offset:25096
    ds_read_b64_tr_b16 a[28:29], v8 offset:28672
    ds_read_b64_tr_b16 a[30:31], v8 offset:29184
    ds_read_b64_tr_b16 a[84:85], v8 offset:28680
    ds_read_b64_tr_b16 a[86:87], v8 offset:29192
    ds_read_b64_tr_b16 a[32:33], v8 offset:32768
    ds_read_b64_tr_b16 a[34:35], v8 offset:33280
    ds_read_b64_tr_b16 a[88:89], v8 offset:32776
    ds_read_b64_tr_b16 a[90:91], v8 offset:33288
    ds_read_b64_tr_b16 a[36:37], v8 offset:36864
    ds_read_b64_tr_b16 a[38:39], v8 offset:37376
    ds_read_b64_tr_b16 a[92:93], v8 offset:36872
    ds_read_b64_tr_b16 a[94:95], v8 offset:37384
    ds_read_b64_tr_b16 a[40:41], v8 offset:40960
    ds_read_b64_tr_b16 a[42:43], v8 offset:41472
    ds_read_b64_tr_b16 a[96:97], v8 offset:40968
    ds_read_b64_tr_b16 a[98:99], v8 offset:41480
    ds_read_b64_tr_b16 a[44:45], v8 offset:45056
    ds_read_b64_tr_b16 a[46:47], v8 offset:45568
    ds_read_b64_tr_b16 a[100:101], v8 offset:45064
    ds_read_b64_tr_b16 a[102:103], v8 offset:45576
    ds_read_b64_tr_b16 a[48:49], v8 offset:49152
    ds_read_b64_tr_b16 a[50:51], v8 offset:49664
    ds_read_b64_tr_b16 a[104:105], v8 offset:49160
    ds_read_b64_tr_b16 a[106:107], v8 offset:49672
    ds_read_b64_tr_b16 a[52:53], v8 offset:53248
    ds_read_b64_tr_b16 a[54:55], v8 offset:53760
    ds_read_b64_tr_b16 a[108:109], v8 offset:53256
    ds_read_b64_tr_b16 a[110:111], v8 offset:53768
    v_add_u32 v8, 57344, v8
    ds_read_b64_tr_b16 a[112:113], v8 offset:0
    ds_read_b64_tr_b16 a[114:115], v8 offset:512
    ds_read_b64_tr_b16 a[168:169], v8 offset:8
    ds_read_b64_tr_b16 a[170:171], v8 offset:520
    ds_read_b64_tr_b16 a[116:117], v8 offset:4096
    ds_read_b64_tr_b16 a[118:119], v8 offset:4608
    ds_read_b64_tr_b16 a[172:173], v8 offset:4104
    ds_read_b64_tr_b16 a[174:175], v8 offset:4616
    ds_read_b64_tr_b16 a[120:121], v8 offset:8192
    ds_read_b64_tr_b16 a[122:123], v8 offset:8704
    ds_read_b64_tr_b16 a[176:177], v8 offset:8200
    ds_read_b64_tr_b16 a[178:179], v8 offset:8712
    ds_read_b64_tr_b16 a[124:125], v8 offset:12288
    ds_read_b64_tr_b16 a[126:127], v8 offset:12800
    ds_read_b64_tr_b16 a[180:181], v8 offset:12296
    ds_read_b64_tr_b16 a[182:183], v8 offset:12808
    ds_read_b64_tr_b16 a[128:129], v8 offset:16384
    ds_read_b64_tr_b16 a[130:131], v8 offset:16896
    ds_read_b64_tr_b16 a[184:185], v8 offset:16392
    ds_read_b64_tr_b16 a[186:187], v8 offset:16904
    ds_read_b64_tr_b16 a[132:133], v8 offset:20480
    ds_read_b64_tr_b16 a[134:135], v8 offset:20992
    ds_read_b64_tr_b16 a[188:189], v8 offset:20488
    ds_read_b64_tr_b16 a[190:191], v8 offset:21000
    ds_read_b64_tr_b16 a[136:137], v8 offset:24576
    ds_read_b64_tr_b16 a[138:139], v8 offset:25088
    ds_read_b64_tr_b16 a[192:193], v8 offset:24584
    ds_read_b64_tr_b16 a[194:195], v8 offset:25096
    ds_read_b64_tr_b16 a[140:141], v8 offset:28672
    ds_read_b64_tr_b16 a[142:143], v8 offset:29184
    ds_read_b64_tr_b16 a[196:197], v8 offset:28680
    ds_read_b64_tr_b16 a[198:199], v8 offset:29192
    ds_read_b64_tr_b16 a[144:145], v8 offset:32768
    ds_read_b64_tr_b16 a[146:147], v8 offset:33280
    ds_read_b64_tr_b16 a[200:201], v8 offset:32776
    ds_read_b64_tr_b16 a[202:203], v8 offset:33288
    ds_read_b64_tr_b16 a[148:149], v8 offset:36864
    ds_read_b64_tr_b16 a[150:151], v8 offset:37376
    ds_read_b64_tr_b16 a[204:205], v8 offset:36872
    ds_read_b64_tr_b16 a[206:207], v8 offset:37384
    ds_read_b64_tr_b16 a[152:153], v8 offset:40960
    ds_read_b64_tr_b16 a[154:155], v8 offset:41472
    ds_read_b64_tr_b16 a[208:209], v8 offset:40968
    ds_read_b64_tr_b16 a[210:211], v8 offset:41480
    ds_read_b64_tr_b16 a[156:157], v8 offset:45056
    ds_read_b64_tr_b16 a[158:159], v8 offset:45568
    ds_read_b64_tr_b16 a[212:213], v8 offset:45064
    ds_read_b64_tr_b16 a[214:215], v8 offset:45576
    ds_read_b64_tr_b16 a[160:161], v8 offset:49152
    ds_read_b64_tr_b16 a[162:163], v8 offset:49664
    ds_read_b64_tr_b16 a[216:217], v8 offset:49160
    ds_read_b64_tr_b16 a[218:219], v8 offset:49672
    ds_read_b64_tr_b16 a[164:165], v8 offset:53248
    ds_read_b64_tr_b16 a[166:167], v8 offset:53760
    ds_read_b64_tr_b16 a[220:221], v8 offset:53256
    ds_read_b64_tr_b16 a[222:223], v8 offset:53768
    s_waitcnt lgkmcnt(0)
    s_add_u32 s19, s21, 28672
    buffer_load_dwordx4 v[136:139], v2, s[8:11], s19 offen offset:0 sc1
    buffer_load_dwordx4 v[140:143], v2, s[8:11], s19 offen offset:1024 sc1
    buffer_load_dwordx4 v[144:147], v2, s[8:11], s19 offen offset:2048 sc1
    buffer_load_dwordx4 v[148:151], v2, s[8:11], s19 offen offset:3072 sc1
    s_add_u32 s19, s21, 32768
    buffer_load_dwordx4 v[152:155], v2, s[8:11], s19 offen offset:0 sc1
    buffer_load_dwordx4 v[156:159], v2, s[8:11], s19 offen offset:1024 sc1
    buffer_load_dwordx4 v[160:163], v2, s[8:11], s19 offen offset:2048 sc1
    buffer_load_dwordx4 v[164:167], v2, s[8:11], s19 offen offset:3072 sc1
    s_add_u32 s19, s21, 36864
    buffer_load_dwordx4 v[168:171], v2, s[8:11], s19 offen offset:0 sc1
    buffer_load_dwordx4 v[172:175], v2, s[8:11], s19 offen offset:1024 sc1
    buffer_load_dwordx4 v[176:179], v2, s[8:11], s19 offen offset:2048 sc1
    buffer_load_dwordx4 v[180:183], v2, s[8:11], s19 offen offset:3072 sc1
    s_add_u32 s19, s21, 40960
    buffer_load_dwordx4 v[184:187], v2, s[8:11], s19 offen offset:0 sc1
    buffer_load_dwordx4 v[188:191], v2, s[8:11], s19 offen offset:1024 sc1
    buffer_load_dword v192, v5, s[8:11], s23 offen offset:128 sc1
    s_waitcnt vmcnt(30)
    v_mfma_f32_16x16x32_bf16 v[200:203], a[0:3], v[16:19], 0
    v_mfma_f32_16x16x32_bf16 v[204:207], a[56:59], v[16:19], 0
    v_mfma_f32_16x16x32_bf16 v[208:211], a[112:115], v[16:19], 0
    v_mfma_f32_16x16x32_bf16 v[212:215], a[168:171], v[16:19], 0
    v_mfma_f32_16x16x32_bf16 v[200:203], a[4:7], v[20:23], v[200:203]
    v_mfma_f32_16x16x32_bf16 v[204:207], a[60:63], v[20:23], v[204:207]
    v_mfma_f32_16x16x32_bf16 v[208:211], a[116:119], v[20:23], v[208:211]
    v_mfma_f32_16x16x32_bf16 v[212:215], a[172:175], v[20:23], v[212:215]
    v_mfma_f32_16x16x32_bf16 v[200:203], a[8:11], v[24:27], v[200:203]
    v_mfma_f32_16x16x32_bf16 v[204:207], a[64:67], v[24:27], v[204:207]
    v_mfma_f32_16x16x32_bf16 v[208:211], a[120:123], v[24:27], v[208:211]
    v_mfma_f32_16x16x32_bf16 v[212:215], a[176:179], v[24:27], v[212:215]
    v_mfma_f32_16x16x32_bf16 v[200:203], a[12:15], v[28:31], v[200:203]
    v_mfma_f32_16x16x32_bf16 v[204:207], a[68:71], v[28:31], v[204:207]
    v_mfma_f32_16x16x32_bf16 v[208:211], a[124:127], v[28:31], v[208:211]
    v_mfma_f32_16x16x32_bf16 v[212:215], a[180:183], v[28:31], v[212:215]
    v_mfma_f32_16x16x32_bf16 v[200:203], a[16:19], v[32:35], v[200:203]
    v_mfma_f32_16x16x32_bf16 v[204:207], a[72:75], v[32:35], v[204:207]
    v_mfma_f32_16x16x32_bf16 v[208:211], a[128:131], v[32:35], v[208:211]
    v_mfma_f32_16x16x32_bf16 v[212:215], a[184:187], v[32:35], v[212:215]
    v_mfma_f32_16x16x32_bf16 v[200:203], a[20:23], v[36:39], v[200:203]
    v_mfma_f32_16x16x32_bf16 v[204:207], a[76:79], v[36:39], v[204:207]
    v_mfma_f32_16x16x32_bf16 v[208:211], a[132:135], v[36:39], v[208:211]
    v_mfma_f32_16x16x32_bf16 v[212:215], a[188:191], v[36:39], v[212:215]
    v_mfma_f32_16x16x32_bf16 v[200:203], a[24:27], v[40:43], v[200:203]
    v_mfma_f32_16x16x32_bf16 v[204:207], a[80:83], v[40:43], v[204:207]
    v_mfma_f32_16x16x32_bf16 v[208:211], a[136:139], v[40:43], v[208:211]
    v_mfma_f32_16x16x32_bf16 v[212:215], a[192:195], v[40:43], v[212:215]
    v_mfma_f32_16x16x32_bf16 v[200:203], a[28:31], v[44:47], v[200:203]
    v_mfma_f32_16x16x32_bf16 v[204:207], a[84:87], v[44:47], v[204:207]
    v_mfma_f32_16x16x32_bf16 v[208:211], a[140:143], v[44:47], v[208:211]
    v_mfma_f32_16x16x32_bf16 v[212:215], a[196:199], v[44:47], v[212:215]
    v_mfma_f32_16x16x32_bf16 v[200:203], a[32:35], v[48:51], v[200:203]
    v_mfma_f32_16x16x32_bf16 v[204:207], a[88:91], v[48:51], v[204:207]
    v_mfma_f32_16x16x32_bf16 v[208:211], a[144:147], v[48:51], v[208:211]
    v_mfma_f32_16x16x32_bf16 v[212:215], a[200:203], v[48:51], v[212:215]
    v_mfma_f32_16x16x32_bf16 v[200:203], a[36:39], v[52:55], v[200:203]
    v_mfma_f32_16x16x32_bf16 v[204:207], a[92:95], v[52:55], v[204:207]
    v_mfma_f32_16x16x32_bf16 v[208:211], a[148:151], v[52:55], v[208:211]
    v_mfma_f32_16x16x32_bf16 v[212:215], a[204:207], v[52:55], v[212:215]
    v_mfma_f32_16x16x32_bf16 v[200:203], a[40:43], v[56:59], v[200:203]
    v_mfma_f32_16x16x32_bf16 v[204:207], a[96:99], v[56:59], v[204:207]
    v_mfma_f32_16x16x32_bf16 v[208:211], a[152:155], v[56:59], v[208:211]
    v_mfma_f32_16x16x32_bf16 v[212:215], a[208:211], v[56:59], v[212:215]
    v_mfma_f32_16x16x32_bf16 v[200:203], a[44:47], v[60:63], v[200:203]
    v_mfma_f32_16x16x32_bf16 v[204:207], a[100:103], v[60:63], v[204:207]
    v_mfma_f32_16x16x32_bf16 v[208:211], a[156:159], v[60:63], v[208:211]
    v_mfma_f32_16x16x32_bf16 v[212:215], a[212:215], v[60:63], v[212:215]
    v_mfma_f32_16x16x32_bf16 v[200:203], a[48:51], v[64:67], v[200:203]
    v_mfma_f32_16x16x32_bf16 v[204:207], a[104:107], v[64:67], v[204:207]
    v_mfma_f32_16x16x32_bf16 v[208:211], a[160:163], v[64:67], v[208:211]
    v_mfma_f32_16x16x32_bf16 v[212:215], a[216:219], v[64:67], v[212:215]
    v_mfma_f32_16x16x32_bf16 v[200:203], a[52:55], v[68:71], v[200:203]
    v_mfma_f32_16x16x32_bf16 v[204:207], a[108:111], v[68:71], v[204:207]
    v_mfma_f32_16x16x32_bf16 v[208:211], a[164:167], v[68:71], v[208:211]
    v_mfma_f32_16x16x32_bf16 v[212:215], a[220:223], v[68:71], v[212:215]
    v_sub_f32 v72, 1.0, v72
    v_mul_f32 v216, s24, v200
    v_mul_f32 v217, s24, v201
    v_mul_f32 v218, s24, v202
    v_mul_f32 v219, s24, v203
    v_mul_f32 v220, s24, v204
    v_mul_f32 v221, s24, v205
    v_mul_f32 v222, s24, v206
    v_mul_f32 v223, s24, v207
    v_exp_f32 v216, v216
    v_exp_f32 v217, v217
    v_exp_f32 v218, v218
    v_exp_f32 v219, v219
    v_exp_f32 v220, v220
    v_exp_f32 v221, v221
    v_exp_f32 v222, v222
    v_exp_f32 v223, v223
    v_mul_f32 v224, v200, v208
    v_mul_f32 v225, v201, v209
    v_mul_f32 v226, v202, v210
    v_mul_f32 v227, v203, v211
    v_mul_f32 v228, v204, v212
    v_mul_f32 v229, v205, v213
    v_mul_f32 v230, v206, v214
    v_mul_f32 v231, v207, v215
    v_add_f32 v216, 1.0, v216
    v_add_f32 v217, 1.0, v217
    v_add_f32 v218, 1.0, v218
    v_add_f32 v219, 1.0, v219
    v_add_f32 v220, 1.0, v220
    v_add_f32 v221, 1.0, v221
    v_add_f32 v222, 1.0, v222
    v_add_f32 v223, 1.0, v223
    v_rcp_f32 v216, v216
    v_rcp_f32 v217, v217
    v_rcp_f32 v218, v218
    v_rcp_f32 v219, v219
    v_rcp_f32 v220, v220
    v_rcp_f32 v221, v221
    v_rcp_f32 v222, v222
    v_rcp_f32 v223, v223
    v_mul_f32 v224, v224, v72
    v_mul_f32 v225, v225, v72
    v_mul_f32 v226, v226, v72
    v_mul_f32 v227, v227, v72
    v_mul_f32 v228, v228, v72
    v_mul_f32 v229, v229, v72
    v_mul_f32 v230, v230, v72
    v_mul_f32 v231, v231, v72
    v_mul_f32 v216, v216, v224
    v_mul_f32 v217, v217, v225
    v_mul_f32 v218, v218, v226
    v_mul_f32 v219, v219, v227
    v_mul_f32 v220, v220, v228
    v_mul_f32 v221, v221, v229
    v_mul_f32 v222, v222, v230
    v_mul_f32 v223, v223, v231
    v_cvt_pk_bf16_f32 v232, v216, v217
    v_cvt_pk_bf16_f32 v233, v218, v219
    v_cvt_pk_bf16_f32 v234, v220, v221
    v_cvt_pk_bf16_f32 v235, v222, v223
    buffer_store_dwordx4 v[232:235], v2, s[8:11], s22 offen sc1
    s_add_u32 s22, s22, 57344
    s_add_u32 s19, s21, 43008
    buffer_load_dwordx4 v[16:19], v2, s[8:11], s19 offen offset:0 sc1
    buffer_load_dwordx4 v[20:23], v2, s[8:11], s19 offen offset:1024 sc1
    buffer_load_dwordx4 v[24:27], v2, s[8:11], s19 offen offset:2048 sc1
    buffer_load_dwordx4 v[28:31], v2, s[8:11], s19 offen offset:3072 sc1
    s_add_u32 s19, s21, 47104
    buffer_load_dwordx4 v[32:35], v2, s[8:11], s19 offen offset:0 sc1
    buffer_load_dwordx4 v[36:39], v2, s[8:11], s19 offen offset:1024 sc1
    buffer_load_dwordx4 v[40:43], v2, s[8:11], s19 offen offset:2048 sc1
    buffer_load_dwordx4 v[44:47], v2, s[8:11], s19 offen offset:3072 sc1
    s_add_u32 s19, s21, 51200
    buffer_load_dwordx4 v[48:51], v2, s[8:11], s19 offen offset:0 sc1
    buffer_load_dwordx4 v[52:55], v2, s[8:11], s19 offen offset:1024 sc1
    buffer_load_dwordx4 v[56:59], v2, s[8:11], s19 offen offset:2048 sc1
    buffer_load_dwordx4 v[60:63], v2, s[8:11], s19 offen offset:3072 sc1
    s_add_u32 s19, s21, 55296
    buffer_load_dwordx4 v[64:67], v2, s[8:11], s19 offen offset:0 sc1
    buffer_load_dwordx4 v[68:71], v2, s[8:11], s19 offen offset:1024 sc1
    buffer_load_dword v72, v5, s[8:11], s23 offen offset:192 sc1
    s_waitcnt vmcnt(31)
    v_mfma_f32_16x16x32_bf16 v[200:203], a[0:3], v[76:79], 0
    v_mfma_f32_16x16x32_bf16 v[204:207], a[56:59], v[76:79], 0
    v_mfma_f32_16x16x32_bf16 v[208:211], a[112:115], v[76:79], 0
    v_mfma_f32_16x16x32_bf16 v[212:215], a[168:171], v[76:79], 0
    v_mfma_f32_16x16x32_bf16 v[200:203], a[4:7], v[80:83], v[200:203]
    v_mfma_f32_16x16x32_bf16 v[204:207], a[60:63], v[80:83], v[204:207]
    v_mfma_f32_16x16x32_bf16 v[208:211], a[116:119], v[80:83], v[208:211]
    v_mfma_f32_16x16x32_bf16 v[212:215], a[172:175], v[80:83], v[212:215]
    v_mfma_f32_16x16x32_bf16 v[200:203], a[8:11], v[84:87], v[200:203]
    v_mfma_f32_16x16x32_bf16 v[204:207], a[64:67], v[84:87], v[204:207]
    v_mfma_f32_16x16x32_bf16 v[208:211], a[120:123], v[84:87], v[208:211]
    v_mfma_f32_16x16x32_bf16 v[212:215], a[176:179], v[84:87], v[212:215]
    v_mfma_f32_16x16x32_bf16 v[200:203], a[12:15], v[88:91], v[200:203]
    v_mfma_f32_16x16x32_bf16 v[204:207], a[68:71], v[88:91], v[204:207]
    v_mfma_f32_16x16x32_bf16 v[208:211], a[124:127], v[88:91], v[208:211]
    v_mfma_f32_16x16x32_bf16 v[212:215], a[180:183], v[88:91], v[212:215]
    v_mfma_f32_16x16x32_bf16 v[200:203], a[16:19], v[92:95], v[200:203]
    v_mfma_f32_16x16x32_bf16 v[204:207], a[72:75], v[92:95], v[204:207]
    v_mfma_f32_16x16x32_bf16 v[208:211], a[128:131], v[92:95], v[208:211]
    v_mfma_f32_16x16x32_bf16 v[212:215], a[184:187], v[92:95], v[212:215]
    v_mfma_f32_16x16x32_bf16 v[200:203], a[20:23], v[96:99], v[200:203]
    v_mfma_f32_16x16x32_bf16 v[204:207], a[76:79], v[96:99], v[204:207]
    v_mfma_f32_16x16x32_bf16 v[208:211], a[132:135], v[96:99], v[208:211]
    v_mfma_f32_16x16x32_bf16 v[212:215], a[188:191], v[96:99], v[212:215]
    v_mfma_f32_16x16x32_bf16 v[200:203], a[24:27], v[100:103], v[200:203]
    v_mfma_f32_16x16x32_bf16 v[204:207], a[80:83], v[100:103], v[204:207]
    v_mfma_f32_16x16x32_bf16 v[208:211], a[136:139], v[100:103], v[208:211]
    v_mfma_f32_16x16x32_bf16 v[212:215], a[192:195], v[100:103], v[212:215]
    v_mfma_f32_16x16x32_bf16 v[200:203], a[28:31], v[104:107], v[200:203]
    v_mfma_f32_16x16x32_bf16 v[204:207], a[84:87], v[104:107], v[204:207]
    v_mfma_f32_16x16x32_bf16 v[208:211], a[140:143], v[104:107], v[208:211]
    v_mfma_f32_16x16x32_bf16 v[212:215], a[196:199], v[104:107], v[212:215]
    v_mfma_f32_16x16x32_bf16 v[200:203], a[32:35], v[108:111], v[200:203]
    v_mfma_f32_16x16x32_bf16 v[204:207], a[88:91], v[108:111], v[204:207]
    v_mfma_f32_16x16x32_bf16 v[208:211], a[144:147], v[108:111], v[208:211]
    v_mfma_f32_16x16x32_bf16 v[212:215], a[200:203], v[108:111], v[212:215]
    v_mfma_f32_16x16x32_bf16 v[200:203], a[36:39], v[112:115], v[200:203]
    v_mfma_f32_16x16x32_bf16 v[204:207], a[92:95], v[112:115], v[204:207]
    v_mfma_f32_16x16x32_bf16 v[208:211], a[148:151], v[112:115], v[208:211]
    v_mfma_f32_16x16x32_bf16 v[212:215], a[204:207], v[112:115], v[212:215]
    v_mfma_f32_16x16x32_bf16 v[200:203], a[40:43], v[116:119], v[200:203]
    v_mfma_f32_16x16x32_bf16 v[204:207], a[96:99], v[116:119], v[204:207]
    v_mfma_f32_16x16x32_bf16 v[208:211], a[152:155], v[116:119], v[208:211]
    v_mfma_f32_16x16x32_bf16 v[212:215], a[208:211], v[116:119], v[212:215]
    v_mfma_f32_16x16x32_bf16 v[200:203], a[44:47], v[120:123], v[200:203]
    v_mfma_f32_16x16x32_bf16 v[204:207], a[100:103], v[120:123], v[204:207]
    v_mfma_f32_16x16x32_bf16 v[208:211], a[156:159], v[120:123], v[208:211]
    v_mfma_f32_16x16x32_bf16 v[212:215], a[212:215], v[120:123], v[212:215]
    v_mfma_f32_16x16x32_bf16 v[200:203], a[48:51], v[124:127], v[200:203]
    v_mfma_f32_16x16x32_bf16 v[204:207], a[104:107], v[124:127], v[204:207]
    v_mfma_f32_16x16x32_bf16 v[208:211], a[160:163], v[124:127], v[208:211]
    v_mfma_f32_16x16x32_bf16 v[212:215], a[216:219], v[124:127], v[212:215]
    v_mfma_f32_16x16x32_bf16 v[200:203], a[52:55], v[128:131], v[200:203]
    v_mfma_f32_16x16x32_bf16 v[204:207], a[108:111], v[128:131], v[204:207]
    v_mfma_f32_16x16x32_bf16 v[208:211], a[164:167], v[128:131], v[208:211]
    v_mfma_f32_16x16x32_bf16 v[212:215], a[220:223], v[128:131], v[212:215]
    v_sub_f32 v132, 1.0, v132
    v_mul_f32 v216, s24, v200
    v_mul_f32 v217, s24, v201
    v_mul_f32 v218, s24, v202
    v_mul_f32 v219, s24, v203
    v_mul_f32 v220, s24, v204
    v_mul_f32 v221, s24, v205
    v_mul_f32 v222, s24, v206
    v_mul_f32 v223, s24, v207
    v_exp_f32 v216, v216
    v_exp_f32 v217, v217
    v_exp_f32 v218, v218
    v_exp_f32 v219, v219
    v_exp_f32 v220, v220
    v_exp_f32 v221, v221
    v_exp_f32 v222, v222
    v_exp_f32 v223, v223
    v_mul_f32 v224, v200, v208
    v_mul_f32 v225, v201, v209
    v_mul_f32 v226, v202, v210
    v_mul_f32 v227, v203, v211
    v_mul_f32 v228, v204, v212
    v_mul_f32 v229, v205, v213
    v_mul_f32 v230, v206, v214
    v_mul_f32 v231, v207, v215
    v_add_f32 v216, 1.0, v216
    v_add_f32 v217, 1.0, v217
    v_add_f32 v218, 1.0, v218
    v_add_f32 v219, 1.0, v219
    v_add_f32 v220, 1.0, v220
    v_add_f32 v221, 1.0, v221
    v_add_f32 v222, 1.0, v222
    v_add_f32 v223, 1.0, v223
    v_rcp_f32 v216, v216
    v_rcp_f32 v217, v217
    v_rcp_f32 v218, v218
    v_rcp_f32 v219, v219
    v_rcp_f32 v220, v220
    v_rcp_f32 v221, v221
    v_rcp_f32 v222, v222
    v_rcp_f32 v223, v223
    v_mul_f32 v224, v224, v132
    v_mul_f32 v225, v225, v132
    v_mul_f32 v226, v226, v132
    v_mul_f32 v227, v227, v132
    v_mul_f32 v228, v228, v132
    v_mul_f32 v229, v229, v132
    v_mul_f32 v230, v230, v132
    v_mul_f32 v231, v231, v132
    v_mul_f32 v216, v216, v224
    v_mul_f32 v217, v217, v225
    v_mul_f32 v218, v218, v226
    v_mul_f32 v219, v219, v227
    v_mul_f32 v220, v220, v228
    v_mul_f32 v221, v221, v229
    v_mul_f32 v222, v222, v230
    v_mul_f32 v223, v223, v231
    v_cvt_pk_bf16_f32 v236, v216, v217
    v_cvt_pk_bf16_f32 v237, v218, v219
    v_cvt_pk_bf16_f32 v238, v220, v221
    v_cvt_pk_bf16_f32 v239, v222, v223
    buffer_store_dwordx4 v[236:239], v2, s[8:11], s22 offen sc1
    s_add_u32 s22, s22, 57344
    s_add_u32 s19, s21, 57344
    buffer_load_dwordx4 v[76:79], v2, s[8:11], s19 offen offset:0 sc1
    buffer_load_dwordx4 v[80:83], v2, s[8:11], s19 offen offset:1024 sc1
    buffer_load_dwordx4 v[84:87], v2, s[8:11], s19 offen offset:2048 sc1
    buffer_load_dwordx4 v[88:91], v2, s[8:11], s19 offen offset:3072 sc1
    s_add_u32 s19, s21, 61440
    buffer_load_dwordx4 v[92:95], v2, s[8:11], s19 offen offset:0 sc1
    buffer_load_dwordx4 v[96:99], v2, s[8:11], s19 offen offset:1024 sc1
    buffer_load_dwordx4 v[100:103], v2, s[8:11], s19 offen offset:2048 sc1
    buffer_load_dwordx4 v[104:107], v2, s[8:11], s19 offen offset:3072 sc1
    s_add_u32 s19, s21, 65536
    buffer_load_dwordx4 v[108:111], v2, s[8:11], s19 offen offset:0 sc1
    buffer_load_dwordx4 v[112:115], v2, s[8:11], s19 offen offset:1024 sc1
    buffer_load_dwordx4 v[116:119], v2, s[8:11], s19 offen offset:2048 sc1
    buffer_load_dwordx4 v[120:123], v2, s[8:11], s19 offen offset:3072 sc1
    s_add_u32 s19, s21, 69632
    buffer_load_dwordx4 v[124:127], v2, s[8:11], s19 offen offset:0 sc1
    buffer_load_dwordx4 v[128:131], v2, s[8:11], s19 offen offset:1024 sc1
    buffer_load_dword v132, v5, s[8:11], s23 offen offset:256 sc1
    s_waitcnt vmcnt(32)
    v_mfma_f32_16x16x32_bf16 v[200:203], a[0:3], v[136:139], 0
    v_mfma_f32_16x16x32_bf16 v[204:207], a[56:59], v[136:139], 0
    v_mfma_f32_16x16x32_bf16 v[208:211], a[112:115], v[136:139], 0
    v_mfma_f32_16x16x32_bf16 v[212:215], a[168:171], v[136:139], 0
    v_mfma_f32_16x16x32_bf16 v[200:203], a[4:7], v[140:143], v[200:203]
    v_mfma_f32_16x16x32_bf16 v[204:207], a[60:63], v[140:143], v[204:207]
    v_mfma_f32_16x16x32_bf16 v[208:211], a[116:119], v[140:143], v[208:211]
    v_mfma_f32_16x16x32_bf16 v[212:215], a[172:175], v[140:143], v[212:215]
    v_mfma_f32_16x16x32_bf16 v[200:203], a[8:11], v[144:147], v[200:203]
    v_mfma_f32_16x16x32_bf16 v[204:207], a[64:67], v[144:147], v[204:207]
    v_mfma_f32_16x16x32_bf16 v[208:211], a[120:123], v[144:147], v[208:211]
    v_mfma_f32_16x16x32_bf16 v[212:215], a[176:179], v[144:147], v[212:215]
    v_mfma_f32_16x16x32_bf16 v[200:203], a[12:15], v[148:151], v[200:203]
    v_mfma_f32_16x16x32_bf16 v[204:207], a[68:71], v[148:151], v[204:207]
    v_mfma_f32_16x16x32_bf16 v[208:211], a[124:127], v[148:151], v[208:211]
    v_mfma_f32_16x16x32_bf16 v[212:215], a[180:183], v[148:151], v[212:215]
    v_mfma_f32_16x16x32_bf16 v[200:203], a[16:19], v[152:155], v[200:203]
    v_mfma_f32_16x16x32_bf16 v[204:207], a[72:75], v[152:155], v[204:207]
    v_mfma_f32_16x16x32_bf16 v[208:211], a[128:131], v[152:155], v[208:211]
    v_mfma_f32_16x16x32_bf16 v[212:215], a[184:187], v[152:155], v[212:215]
    v_mfma_f32_16x16x32_bf16 v[200:203], a[20:23], v[156:159], v[200:203]
    v_mfma_f32_16x16x32_bf16 v[204:207], a[76:79], v[156:159], v[204:207]
    v_mfma_f32_16x16x32_bf16 v[208:211], a[132:135], v[156:159], v[208:211]
    v_mfma_f32_16x16x32_bf16 v[212:215], a[188:191], v[156:159], v[212:215]
    v_mfma_f32_16x16x32_bf16 v[200:203], a[24:27], v[160:163], v[200:203]
    v_mfma_f32_16x16x32_bf16 v[204:207], a[80:83], v[160:163], v[204:207]
    v_mfma_f32_16x16x32_bf16 v[208:211], a[136:139], v[160:163], v[208:211]
    v_mfma_f32_16x16x32_bf16 v[212:215], a[192:195], v[160:163], v[212:215]
    v_mfma_f32_16x16x32_bf16 v[200:203], a[28:31], v[164:167], v[200:203]
    v_mfma_f32_16x16x32_bf16 v[204:207], a[84:87], v[164:167], v[204:207]
    v_mfma_f32_16x16x32_bf16 v[208:211], a[140:143], v[164:167], v[208:211]
    v_mfma_f32_16x16x32_bf16 v[212:215], a[196:199], v[164:167], v[212:215]
    v_mfma_f32_16x16x32_bf16 v[200:203], a[32:35], v[168:171], v[200:203]
    v_mfma_f32_16x16x32_bf16 v[204:207], a[88:91], v[168:171], v[204:207]
    v_mfma_f32_16x16x32_bf16 v[208:211], a[144:147], v[168:171], v[208:211]
    v_mfma_f32_16x16x32_bf16 v[212:215], a[200:203], v[168:171], v[212:215]
    v_mfma_f32_16x16x32_bf16 v[200:203], a[36:39], v[172:175], v[200:203]
    v_mfma_f32_16x16x32_bf16 v[204:207], a[92:95], v[172:175], v[204:207]
    v_mfma_f32_16x16x32_bf16 v[208:211], a[148:151], v[172:175], v[208:211]
    v_mfma_f32_16x16x32_bf16 v[212:215], a[204:207], v[172:175], v[212:215]
    v_mfma_f32_16x16x32_bf16 v[200:203], a[40:43], v[176:179], v[200:203]
    v_mfma_f32_16x16x32_bf16 v[204:207], a[96:99], v[176:179], v[204:207]
    v_mfma_f32_16x16x32_bf16 v[208:211], a[152:155], v[176:179], v[208:211]
    v_mfma_f32_16x16x32_bf16 v[212:215], a[208:211], v[176:179], v[212:215]
    v_mfma_f32_16x16x32_bf16 v[200:203], a[44:47], v[180:183], v[200:203]
    v_mfma_f32_16x16x32_bf16 v[204:207], a[100:103], v[180:183], v[204:207]
    v_mfma_f32_16x16x32_bf16 v[208:211], a[156:159], v[180:183], v[208:211]
    v_mfma_f32_16x16x32_bf16 v[212:215], a[212:215], v[180:183], v[212:215]
    v_mfma_f32_16x16x32_bf16 v[200:203], a[48:51], v[184:187], v[200:203]
    v_mfma_f32_16x16x32_bf16 v[204:207], a[104:107], v[184:187], v[204:207]
    v_mfma_f32_16x16x32_bf16 v[208:211], a[160:163], v[184:187], v[208:211]
    v_mfma_f32_16x16x32_bf16 v[212:215], a[216:219], v[184:187], v[212:215]
    v_mfma_f32_16x16x32_bf16 v[200:203], a[52:55], v[188:191], v[200:203]
    v_mfma_f32_16x16x32_bf16 v[204:207], a[108:111], v[188:191], v[204:207]
    v_mfma_f32_16x16x32_bf16 v[208:211], a[164:167], v[188:191], v[208:211]
    v_mfma_f32_16x16x32_bf16 v[212:215], a[220:223], v[188:191], v[212:215]
    v_sub_f32 v192, 1.0, v192
    v_mul_f32 v216, s24, v200
    v_mul_f32 v217, s24, v201
    v_mul_f32 v218, s24, v202
    v_mul_f32 v219, s24, v203
    v_mul_f32 v220, s24, v204
    v_mul_f32 v221, s24, v205
    v_mul_f32 v222, s24, v206
    v_mul_f32 v223, s24, v207
    v_exp_f32 v216, v216
    v_exp_f32 v217, v217
    v_exp_f32 v218, v218
    v_exp_f32 v219, v219
    v_exp_f32 v220, v220
    v_exp_f32 v221, v221
    v_exp_f32 v222, v222
    v_exp_f32 v223, v223
    v_mul_f32 v224, v200, v208
    v_mul_f32 v225, v201, v209
    v_mul_f32 v226, v202, v210
    v_mul_f32 v227, v203, v211
    v_mul_f32 v228, v204, v212
    v_mul_f32 v229, v205, v213
    v_mul_f32 v230, v206, v214
    v_mul_f32 v231, v207, v215
    v_add_f32 v216, 1.0, v216
    v_add_f32 v217, 1.0, v217
    v_add_f32 v218, 1.0, v218
    v_add_f32 v219, 1.0, v219
    v_add_f32 v220, 1.0, v220
    v_add_f32 v221, 1.0, v221
    v_add_f32 v222, 1.0, v222
    v_add_f32 v223, 1.0, v223
    v_rcp_f32 v216, v216
    v_rcp_f32 v217, v217
    v_rcp_f32 v218, v218
    v_rcp_f32 v219, v219
    v_rcp_f32 v220, v220
    v_rcp_f32 v221, v221
    v_rcp_f32 v222, v222
    v_rcp_f32 v223, v223
    v_mul_f32 v224, v224, v192
    v_mul_f32 v225, v225, v192
    v_mul_f32 v226, v226, v192
    v_mul_f32 v227, v227, v192
    v_mul_f32 v228, v228, v192
    v_mul_f32 v229, v229, v192
    v_mul_f32 v230, v230, v192
    v_mul_f32 v231, v231, v192
    v_mul_f32 v216, v216, v224
    v_mul_f32 v217, v217, v225
    v_mul_f32 v218, v218, v226
    v_mul_f32 v219, v219, v227
    v_mul_f32 v220, v220, v228
    v_mul_f32 v221, v221, v229
    v_mul_f32 v222, v222, v230
    v_mul_f32 v223, v223, v231
    v_cvt_pk_bf16_f32 v232, v216, v217
    v_cvt_pk_bf16_f32 v233, v218, v219
    v_cvt_pk_bf16_f32 v234, v220, v221
    v_cvt_pk_bf16_f32 v235, v222, v223
    buffer_store_dwordx4 v[232:235], v2, s[8:11], s22 offen sc1
    s_add_u32 s22, s22, 57344
    s_add_u32 s19, s21, 71680
    buffer_load_dwordx4 v[136:139], v2, s[8:11], s19 offen offset:0 sc1
    buffer_load_dwordx4 v[140:143], v2, s[8:11], s19 offen offset:1024 sc1
    buffer_load_dwordx4 v[144:147], v2, s[8:11], s19 offen offset:2048 sc1
    buffer_load_dwordx4 v[148:151], v2, s[8:11], s19 offen offset:3072 sc1
    s_add_u32 s19, s21, 75776
    buffer_load_dwordx4 v[152:155], v2, s[8:11], s19 offen offset:0 sc1
    buffer_load_dwordx4 v[156:159], v2, s[8:11], s19 offen offset:1024 sc1
    buffer_load_dwordx4 v[160:163], v2, s[8:11], s19 offen offset:2048 sc1
    buffer_load_dwordx4 v[164:167], v2, s[8:11], s19 offen offset:3072 sc1
    s_add_u32 s19, s21, 79872
    buffer_load_dwordx4 v[168:171], v2, s[8:11], s19 offen offset:0 sc1
    buffer_load_dwordx4 v[172:175], v2, s[8:11], s19 offen offset:1024 sc1
    buffer_load_dwordx4 v[176:179], v2, s[8:11], s19 offen offset:2048 sc1
    buffer_load_dwordx4 v[180:183], v2, s[8:11], s19 offen offset:3072 sc1
    s_add_u32 s19, s21, 83968
    buffer_load_dwordx4 v[184:187], v2, s[8:11], s19 offen offset:0 sc1
    buffer_load_dwordx4 v[188:191], v2, s[8:11], s19 offen offset:1024 sc1
    buffer_load_dword v192, v5, s[8:11], s23 offen offset:320 sc1
    s_waitcnt vmcnt(32)
    v_mfma_f32_16x16x32_bf16 v[200:203], a[0:3], v[16:19], 0
    v_mfma_f32_16x16x32_bf16 v[204:207], a[56:59], v[16:19], 0
    v_mfma_f32_16x16x32_bf16 v[208:211], a[112:115], v[16:19], 0
    v_mfma_f32_16x16x32_bf16 v[212:215], a[168:171], v[16:19], 0
    v_mfma_f32_16x16x32_bf16 v[200:203], a[4:7], v[20:23], v[200:203]
    v_mfma_f32_16x16x32_bf16 v[204:207], a[60:63], v[20:23], v[204:207]
    v_mfma_f32_16x16x32_bf16 v[208:211], a[116:119], v[20:23], v[208:211]
    v_mfma_f32_16x16x32_bf16 v[212:215], a[172:175], v[20:23], v[212:215]
    v_mfma_f32_16x16x32_bf16 v[200:203], a[8:11], v[24:27], v[200:203]
    v_mfma_f32_16x16x32_bf16 v[204:207], a[64:67], v[24:27], v[204:207]
    v_mfma_f32_16x16x32_bf16 v[208:211], a[120:123], v[24:27], v[208:211]
    v_mfma_f32_16x16x32_bf16 v[212:215], a[176:179], v[24:27], v[212:215]
    v_mfma_f32_16x16x32_bf16 v[200:203], a[12:15], v[28:31], v[200:203]
    v_mfma_f32_16x16x32_bf16 v[204:207], a[68:71], v[28:31], v[204:207]
    v_mfma_f32_16x16x32_bf16 v[208:211], a[124:127], v[28:31], v[208:211]
    v_mfma_f32_16x16x32_bf16 v[212:215], a[180:183], v[28:31], v[212:215]
    v_mfma_f32_16x16x32_bf16 v[200:203], a[16:19], v[32:35], v[200:203]
    v_mfma_f32_16x16x32_bf16 v[204:207], a[72:75], v[32:35], v[204:207]
    v_mfma_f32_16x16x32_bf16 v[208:211], a[128:131], v[32:35], v[208:211]
    v_mfma_f32_16x16x32_bf16 v[212:215], a[184:187], v[32:35], v[212:215]
    v_mfma_f32_16x16x32_bf16 v[200:203], a[20:23], v[36:39], v[200:203]
    v_mfma_f32_16x16x32_bf16 v[204:207], a[76:79], v[36:39], v[204:207]
    v_mfma_f32_16x16x32_bf16 v[208:211], a[132:135], v[36:39], v[208:211]
    v_mfma_f32_16x16x32_bf16 v[212:215], a[188:191], v[36:39], v[212:215]
    v_mfma_f32_16x16x32_bf16 v[200:203], a[24:27], v[40:43], v[200:203]
    v_mfma_f32_16x16x32_bf16 v[204:207], a[80:83], v[40:43], v[204:207]
    v_mfma_f32_16x16x32_bf16 v[208:211], a[136:139], v[40:43], v[208:211]
    v_mfma_f32_16x16x32_bf16 v[212:215], a[192:195], v[40:43], v[212:215]
    v_mfma_f32_16x16x32_bf16 v[200:203], a[28:31], v[44:47], v[200:203]
    v_mfma_f32_16x16x32_bf16 v[204:207], a[84:87], v[44:47], v[204:207]
    v_mfma_f32_16x16x32_bf16 v[208:211], a[140:143], v[44:47], v[208:211]
    v_mfma_f32_16x16x32_bf16 v[212:215], a[196:199], v[44:47], v[212:215]
    v_mfma_f32_16x16x32_bf16 v[200:203], a[32:35], v[48:51], v[200:203]
    v_mfma_f32_16x16x32_bf16 v[204:207], a[88:91], v[48:51], v[204:207]
    v_mfma_f32_16x16x32_bf16 v[208:211], a[144:147], v[48:51], v[208:211]
    v_mfma_f32_16x16x32_bf16 v[212:215], a[200:203], v[48:51], v[212:215]
    v_mfma_f32_16x16x32_bf16 v[200:203], a[36:39], v[52:55], v[200:203]
    v_mfma_f32_16x16x32_bf16 v[204:207], a[92:95], v[52:55], v[204:207]
    v_mfma_f32_16x16x32_bf16 v[208:211], a[148:151], v[52:55], v[208:211]
    v_mfma_f32_16x16x32_bf16 v[212:215], a[204:207], v[52:55], v[212:215]
    v_mfma_f32_16x16x32_bf16 v[200:203], a[40:43], v[56:59], v[200:203]
    v_mfma_f32_16x16x32_bf16 v[204:207], a[96:99], v[56:59], v[204:207]
    v_mfma_f32_16x16x32_bf16 v[208:211], a[152:155], v[56:59], v[208:211]
    v_mfma_f32_16x16x32_bf16 v[212:215], a[208:211], v[56:59], v[212:215]
    v_mfma_f32_16x16x32_bf16 v[200:203], a[44:47], v[60:63], v[200:203]
    v_mfma_f32_16x16x32_bf16 v[204:207], a[100:103], v[60:63], v[204:207]
    v_mfma_f32_16x16x32_bf16 v[208:211], a[156:159], v[60:63], v[208:211]
    v_mfma_f32_16x16x32_bf16 v[212:215], a[212:215], v[60:63], v[212:215]
    v_mfma_f32_16x16x32_bf16 v[200:203], a[48:51], v[64:67], v[200:203]
    v_mfma_f32_16x16x32_bf16 v[204:207], a[104:107], v[64:67], v[204:207]
    v_mfma_f32_16x16x32_bf16 v[208:211], a[160:163], v[64:67], v[208:211]
    v_mfma_f32_16x16x32_bf16 v[212:215], a[216:219], v[64:67], v[212:215]
    v_mfma_f32_16x16x32_bf16 v[200:203], a[52:55], v[68:71], v[200:203]
    v_mfma_f32_16x16x32_bf16 v[204:207], a[108:111], v[68:71], v[204:207]
    v_mfma_f32_16x16x32_bf16 v[208:211], a[164:167], v[68:71], v[208:211]
    v_mfma_f32_16x16x32_bf16 v[212:215], a[220:223], v[68:71], v[212:215]
    v_sub_f32 v72, 1.0, v72
    v_mul_f32 v216, s24, v200
    v_mul_f32 v217, s24, v201
    v_mul_f32 v218, s24, v202
    v_mul_f32 v219, s24, v203
    v_mul_f32 v220, s24, v204
    v_mul_f32 v221, s24, v205
    v_mul_f32 v222, s24, v206
    v_mul_f32 v223, s24, v207
    v_exp_f32 v216, v216
    v_exp_f32 v217, v217
    v_exp_f32 v218, v218
    v_exp_f32 v219, v219
    v_exp_f32 v220, v220
    v_exp_f32 v221, v221
    v_exp_f32 v222, v222
    v_exp_f32 v223, v223
    v_mul_f32 v224, v200, v208
    v_mul_f32 v225, v201, v209
    v_mul_f32 v226, v202, v210
    v_mul_f32 v227, v203, v211
    v_mul_f32 v228, v204, v212
    v_mul_f32 v229, v205, v213
    v_mul_f32 v230, v206, v214
    v_mul_f32 v231, v207, v215
    v_add_f32 v216, 1.0, v216
    v_add_f32 v217, 1.0, v217
    v_add_f32 v218, 1.0, v218
    v_add_f32 v219, 1.0, v219
    v_add_f32 v220, 1.0, v220
    v_add_f32 v221, 1.0, v221
    v_add_f32 v222, 1.0, v222
    v_add_f32 v223, 1.0, v223
    v_rcp_f32 v216, v216
    v_rcp_f32 v217, v217
    v_rcp_f32 v218, v218
    v_rcp_f32 v219, v219
    v_rcp_f32 v220, v220
    v_rcp_f32 v221, v221
    v_rcp_f32 v222, v222
    v_rcp_f32 v223, v223
    v_mul_f32 v224, v224, v72
    v_mul_f32 v225, v225, v72
    v_mul_f32 v226, v226, v72
    v_mul_f32 v227, v227, v72
    v_mul_f32 v228, v228, v72
    v_mul_f32 v229, v229, v72
    v_mul_f32 v230, v230, v72
    v_mul_f32 v231, v231, v72
    v_mul_f32 v216, v216, v224
    v_mul_f32 v217, v217, v225
    v_mul_f32 v218, v218, v226
    v_mul_f32 v219, v219, v227
    v_mul_f32 v220, v220, v228
    v_mul_f32 v221, v221, v229
    v_mul_f32 v222, v222, v230
    v_mul_f32 v223, v223, v231
    v_cvt_pk_bf16_f32 v236, v216, v217
    v_cvt_pk_bf16_f32 v237, v218, v219
    v_cvt_pk_bf16_f32 v238, v220, v221
    v_cvt_pk_bf16_f32 v239, v222, v223
    buffer_store_dwordx4 v[236:239], v2, s[8:11], s22 offen sc1
    s_add_u32 s22, s22, 57344
    s_add_u32 s19, s21, 86016
    buffer_load_dwordx4 v[16:19], v2, s[8:11], s19 offen offset:0 sc1
    buffer_load_dwordx4 v[20:23], v2, s[8:11], s19 offen offset:1024 sc1
    buffer_load_dwordx4 v[24:27], v2, s[8:11], s19 offen offset:2048 sc1
    buffer_load_dwordx4 v[28:31], v2, s[8:11], s19 offen offset:3072 sc1
    s_add_u32 s19, s21, 90112
    buffer_load_dwordx4 v[32:35], v2, s[8:11], s19 offen offset:0 sc1
    buffer_load_dwordx4 v[36:39], v2, s[8:11], s19 offen offset:1024 sc1
    buffer_load_dwordx4 v[40:43], v2, s[8:11], s19 offen offset:2048 sc1
    buffer_load_dwordx4 v[44:47], v2, s[8:11], s19 offen offset:3072 sc1
    s_add_u32 s19, s21, 94208
    buffer_load_dwordx4 v[48:51], v2, s[8:11], s19 offen offset:0 sc1
    buffer_load_dwordx4 v[52:55], v2, s[8:11], s19 offen offset:1024 sc1
    buffer_load_dwordx4 v[56:59], v2, s[8:11], s19 offen offset:2048 sc1
    buffer_load_dwordx4 v[60:63], v2, s[8:11], s19 offen offset:3072 sc1
    s_add_u32 s19, s21, 98304
    buffer_load_dwordx4 v[64:67], v2, s[8:11], s19 offen offset:0 sc1
    buffer_load_dwordx4 v[68:71], v2, s[8:11], s19 offen offset:1024 sc1
    buffer_load_dword v72, v5, s[8:11], s23 offen offset:384 sc1
    s_waitcnt vmcnt(32)
    v_mfma_f32_16x16x32_bf16 v[200:203], a[0:3], v[76:79], 0
    v_mfma_f32_16x16x32_bf16 v[204:207], a[56:59], v[76:79], 0
    v_mfma_f32_16x16x32_bf16 v[208:211], a[112:115], v[76:79], 0
    v_mfma_f32_16x16x32_bf16 v[212:215], a[168:171], v[76:79], 0
    v_mfma_f32_16x16x32_bf16 v[200:203], a[4:7], v[80:83], v[200:203]
    v_mfma_f32_16x16x32_bf16 v[204:207], a[60:63], v[80:83], v[204:207]
    v_mfma_f32_16x16x32_bf16 v[208:211], a[116:119], v[80:83], v[208:211]
    v_mfma_f32_16x16x32_bf16 v[212:215], a[172:175], v[80:83], v[212:215]
    v_mfma_f32_16x16x32_bf16 v[200:203], a[8:11], v[84:87], v[200:203]
    v_mfma_f32_16x16x32_bf16 v[204:207], a[64:67], v[84:87], v[204:207]
    v_mfma_f32_16x16x32_bf16 v[208:211], a[120:123], v[84:87], v[208:211]
    v_mfma_f32_16x16x32_bf16 v[212:215], a[176:179], v[84:87], v[212:215]
    v_mfma_f32_16x16x32_bf16 v[200:203], a[12:15], v[88:91], v[200:203]
    v_mfma_f32_16x16x32_bf16 v[204:207], a[68:71], v[88:91], v[204:207]
    v_mfma_f32_16x16x32_bf16 v[208:211], a[124:127], v[88:91], v[208:211]
    v_mfma_f32_16x16x32_bf16 v[212:215], a[180:183], v[88:91], v[212:215]
    v_mfma_f32_16x16x32_bf16 v[200:203], a[16:19], v[92:95], v[200:203]
    v_mfma_f32_16x16x32_bf16 v[204:207], a[72:75], v[92:95], v[204:207]
    v_mfma_f32_16x16x32_bf16 v[208:211], a[128:131], v[92:95], v[208:211]
    v_mfma_f32_16x16x32_bf16 v[212:215], a[184:187], v[92:95], v[212:215]
    v_mfma_f32_16x16x32_bf16 v[200:203], a[20:23], v[96:99], v[200:203]
    v_mfma_f32_16x16x32_bf16 v[204:207], a[76:79], v[96:99], v[204:207]
    v_mfma_f32_16x16x32_bf16 v[208:211], a[132:135], v[96:99], v[208:211]
    v_mfma_f32_16x16x32_bf16 v[212:215], a[188:191], v[96:99], v[212:215]
    v_mfma_f32_16x16x32_bf16 v[200:203], a[24:27], v[100:103], v[200:203]
    v_mfma_f32_16x16x32_bf16 v[204:207], a[80:83], v[100:103], v[204:207]
    v_mfma_f32_16x16x32_bf16 v[208:211], a[136:139], v[100:103], v[208:211]
    v_mfma_f32_16x16x32_bf16 v[212:215], a[192:195], v[100:103], v[212:215]
    v_mfma_f32_16x16x32_bf16 v[200:203], a[28:31], v[104:107], v[200:203]
    v_mfma_f32_16x16x32_bf16 v[204:207], a[84:87], v[104:107], v[204:207]
    v_mfma_f32_16x16x32_bf16 v[208:211], a[140:143], v[104:107], v[208:211]
    v_mfma_f32_16x16x32_bf16 v[212:215], a[196:199], v[104:107], v[212:215]
    v_mfma_f32_16x16x32_bf16 v[200:203], a[32:35], v[108:111], v[200:203]
    v_mfma_f32_16x16x32_bf16 v[204:207], a[88:91], v[108:111], v[204:207]
    v_mfma_f32_16x16x32_bf16 v[208:211], a[144:147], v[108:111], v[208:211]
    v_mfma_f32_16x16x32_bf16 v[212:215], a[200:203], v[108:111], v[212:215]
    v_mfma_f32_16x16x32_bf16 v[200:203], a[36:39], v[112:115], v[200:203]
    v_mfma_f32_16x16x32_bf16 v[204:207], a[92:95], v[112:115], v[204:207]
    v_mfma_f32_16x16x32_bf16 v[208:211], a[148:151], v[112:115], v[208:211]
    v_mfma_f32_16x16x32_bf16 v[212:215], a[204:207], v[112:115], v[212:215]
    v_mfma_f32_16x16x32_bf16 v[200:203], a[40:43], v[116:119], v[200:203]
    v_mfma_f32_16x16x32_bf16 v[204:207], a[96:99], v[116:119], v[204:207]
    v_mfma_f32_16x16x32_bf16 v[208:211], a[152:155], v[116:119], v[208:211]
    v_mfma_f32_16x16x32_bf16 v[212:215], a[208:211], v[116:119], v[212:215]
    v_mfma_f32_16x16x32_bf16 v[200:203], a[44:47], v[120:123], v[200:203]
    v_mfma_f32_16x16x32_bf16 v[204:207], a[100:103], v[120:123], v[204:207]
    v_mfma_f32_16x16x32_bf16 v[208:211], a[156:159], v[120:123], v[208:211]
    v_mfma_f32_16x16x32_bf16 v[212:215], a[212:215], v[120:123], v[212:215]
    v_mfma_f32_16x16x32_bf16 v[200:203], a[48:51], v[124:127], v[200:203]
    v_mfma_f32_16x16x32_bf16 v[204:207], a[104:107], v[124:127], v[204:207]
    v_mfma_f32_16x16x32_bf16 v[208:211], a[160:163], v[124:127], v[208:211]
    v_mfma_f32_16x16x32_bf16 v[212:215], a[216:219], v[124:127], v[212:215]
    v_mfma_f32_16x16x32_bf16 v[200:203], a[52:55], v[128:131], v[200:203]
    v_mfma_f32_16x16x32_bf16 v[204:207], a[108:111], v[128:131], v[204:207]
    v_mfma_f32_16x16x32_bf16 v[208:211], a[164:167], v[128:131], v[208:211]
    v_mfma_f32_16x16x32_bf16 v[212:215], a[220:223], v[128:131], v[212:215]
    v_sub_f32 v132, 1.0, v132
    v_mul_f32 v216, s24, v200
    v_mul_f32 v217, s24, v201
    v_mul_f32 v218, s24, v202
    v_mul_f32 v219, s24, v203
    v_mul_f32 v220, s24, v204
    v_mul_f32 v221, s24, v205
    v_mul_f32 v222, s24, v206
    v_mul_f32 v223, s24, v207
    v_exp_f32 v216, v216
    v_exp_f32 v217, v217
    v_exp_f32 v218, v218
    v_exp_f32 v219, v219
    v_exp_f32 v220, v220
    v_exp_f32 v221, v221
    v_exp_f32 v222, v222
    v_exp_f32 v223, v223
    v_mul_f32 v224, v200, v208
    v_mul_f32 v225, v201, v209
    v_mul_f32 v226, v202, v210
    v_mul_f32 v227, v203, v211
    v_mul_f32 v228, v204, v212
    v_mul_f32 v229, v205, v213
    v_mul_f32 v230, v206, v214
    v_mul_f32 v231, v207, v215
    v_add_f32 v216, 1.0, v216
    v_add_f32 v217, 1.0, v217
    v_add_f32 v218, 1.0, v218
    v_add_f32 v219, 1.0, v219
    v_add_f32 v220, 1.0, v220
    v_add_f32 v221, 1.0, v221
    v_add_f32 v222, 1.0, v222
    v_add_f32 v223, 1.0, v223
    v_rcp_f32 v216, v216
    v_rcp_f32 v217, v217
    v_rcp_f32 v218, v218
    v_rcp_f32 v219, v219
    v_rcp_f32 v220, v220
    v_rcp_f32 v221, v221
    v_rcp_f32 v222, v222
    v_rcp_f32 v223, v223
    v_mul_f32 v224, v224, v132
    v_mul_f32 v225, v225, v132
    v_mul_f32 v226, v226, v132
    v_mul_f32 v227, v227, v132
    v_mul_f32 v228, v228, v132
    v_mul_f32 v229, v229, v132
    v_mul_f32 v230, v230, v132
    v_mul_f32 v231, v231, v132
    v_mul_f32 v216, v216, v224
    v_mul_f32 v217, v217, v225
    v_mul_f32 v218, v218, v226
    v_mul_f32 v219, v219, v227
    v_mul_f32 v220, v220, v228
    v_mul_f32 v221, v221, v229
    v_mul_f32 v222, v222, v230
    v_mul_f32 v223, v223, v231
    v_cvt_pk_bf16_f32 v232, v216, v217
    v_cvt_pk_bf16_f32 v233, v218, v219
    v_cvt_pk_bf16_f32 v234, v220, v221
    v_cvt_pk_bf16_f32 v235, v222, v223
    buffer_store_dwordx4 v[232:235], v2, s[8:11], s22 offen sc1
    s_add_u32 s22, s22, 57344
    s_add_u32 s19, s21, 100352
    buffer_load_dwordx4 v[76:79], v2, s[8:11], s19 offen offset:0 sc1
    buffer_load_dwordx4 v[80:83], v2, s[8:11], s19 offen offset:1024 sc1
    buffer_load_dwordx4 v[84:87], v2, s[8:11], s19 offen offset:2048 sc1
    buffer_load_dwordx4 v[88:91], v2, s[8:11], s19 offen offset:3072 sc1
    s_add_u32 s19, s21, 104448
    buffer_load_dwordx4 v[92:95], v2, s[8:11], s19 offen offset:0 sc1
    buffer_load_dwordx4 v[96:99], v2, s[8:11], s19 offen offset:1024 sc1
    buffer_load_dwordx4 v[100:103], v2, s[8:11], s19 offen offset:2048 sc1
    buffer_load_dwordx4 v[104:107], v2, s[8:11], s19 offen offset:3072 sc1
    s_add_u32 s19, s21, 108544
    buffer_load_dwordx4 v[108:111], v2, s[8:11], s19 offen offset:0 sc1
    buffer_load_dwordx4 v[112:115], v2, s[8:11], s19 offen offset:1024 sc1
    buffer_load_dwordx4 v[116:119], v2, s[8:11], s19 offen offset:2048 sc1
    buffer_load_dwordx4 v[120:123], v2, s[8:11], s19 offen offset:3072 sc1
    s_add_u32 s19, s21, 112640
    buffer_load_dwordx4 v[124:127], v2, s[8:11], s19 offen offset:0 sc1
    buffer_load_dwordx4 v[128:131], v2, s[8:11], s19 offen offset:1024 sc1
    buffer_load_dword v132, v5, s[8:11], s23 offen offset:448 sc1
    s_waitcnt vmcnt(32)
    v_mfma_f32_16x16x32_bf16 v[200:203], a[0:3], v[136:139], 0
    v_mfma_f32_16x16x32_bf16 v[204:207], a[56:59], v[136:139], 0
    v_mfma_f32_16x16x32_bf16 v[208:211], a[112:115], v[136:139], 0
    v_mfma_f32_16x16x32_bf16 v[212:215], a[168:171], v[136:139], 0
    v_mfma_f32_16x16x32_bf16 v[200:203], a[4:7], v[140:143], v[200:203]
    v_mfma_f32_16x16x32_bf16 v[204:207], a[60:63], v[140:143], v[204:207]
    v_mfma_f32_16x16x32_bf16 v[208:211], a[116:119], v[140:143], v[208:211]
    v_mfma_f32_16x16x32_bf16 v[212:215], a[172:175], v[140:143], v[212:215]
    v_mfma_f32_16x16x32_bf16 v[200:203], a[8:11], v[144:147], v[200:203]
    v_mfma_f32_16x16x32_bf16 v[204:207], a[64:67], v[144:147], v[204:207]
    v_mfma_f32_16x16x32_bf16 v[208:211], a[120:123], v[144:147], v[208:211]
    v_mfma_f32_16x16x32_bf16 v[212:215], a[176:179], v[144:147], v[212:215]
    v_mfma_f32_16x16x32_bf16 v[200:203], a[12:15], v[148:151], v[200:203]
    v_mfma_f32_16x16x32_bf16 v[204:207], a[68:71], v[148:151], v[204:207]
    v_mfma_f32_16x16x32_bf16 v[208:211], a[124:127], v[148:151], v[208:211]
    v_mfma_f32_16x16x32_bf16 v[212:215], a[180:183], v[148:151], v[212:215]
    v_mfma_f32_16x16x32_bf16 v[200:203], a[16:19], v[152:155], v[200:203]
    v_mfma_f32_16x16x32_bf16 v[204:207], a[72:75], v[152:155], v[204:207]
    v_mfma_f32_16x16x32_bf16 v[208:211], a[128:131], v[152:155], v[208:211]
    v_mfma_f32_16x16x32_bf16 v[212:215], a[184:187], v[152:155], v[212:215]
    v_mfma_f32_16x16x32_bf16 v[200:203], a[20:23], v[156:159], v[200:203]
    v_mfma_f32_16x16x32_bf16 v[204:207], a[76:79], v[156:159], v[204:207]
    v_mfma_f32_16x16x32_bf16 v[208:211], a[132:135], v[156:159], v[208:211]
    v_mfma_f32_16x16x32_bf16 v[212:215], a[188:191], v[156:159], v[212:215]
    v_mfma_f32_16x16x32_bf16 v[200:203], a[24:27], v[160:163], v[200:203]
    v_mfma_f32_16x16x32_bf16 v[204:207], a[80:83], v[160:163], v[204:207]
    v_mfma_f32_16x16x32_bf16 v[208:211], a[136:139], v[160:163], v[208:211]
    v_mfma_f32_16x16x32_bf16 v[212:215], a[192:195], v[160:163], v[212:215]
    v_mfma_f32_16x16x32_bf16 v[200:203], a[28:31], v[164:167], v[200:203]
    v_mfma_f32_16x16x32_bf16 v[204:207], a[84:87], v[164:167], v[204:207]
    v_mfma_f32_16x16x32_bf16 v[208:211], a[140:143], v[164:167], v[208:211]
    v_mfma_f32_16x16x32_bf16 v[212:215], a[196:199], v[164:167], v[212:215]
    v_mfma_f32_16x16x32_bf16 v[200:203], a[32:35], v[168:171], v[200:203]
    v_mfma_f32_16x16x32_bf16 v[204:207], a[88:91], v[168:171], v[204:207]
    v_mfma_f32_16x16x32_bf16 v[208:211], a[144:147], v[168:171], v[208:211]
    v_mfma_f32_16x16x32_bf16 v[212:215], a[200:203], v[168:171], v[212:215]
    v_mfma_f32_16x16x32_bf16 v[200:203], a[36:39], v[172:175], v[200:203]
    v_mfma_f32_16x16x32_bf16 v[204:207], a[92:95], v[172:175], v[204:207]
    v_mfma_f32_16x16x32_bf16 v[208:211], a[148:151], v[172:175], v[208:211]
    v_mfma_f32_16x16x32_bf16 v[212:215], a[204:207], v[172:175], v[212:215]
    v_mfma_f32_16x16x32_bf16 v[200:203], a[40:43], v[176:179], v[200:203]
    v_mfma_f32_16x16x32_bf16 v[204:207], a[96:99], v[176:179], v[204:207]
    v_mfma_f32_16x16x32_bf16 v[208:211], a[152:155], v[176:179], v[208:211]
    v_mfma_f32_16x16x32_bf16 v[212:215], a[208:211], v[176:179], v[212:215]
    v_mfma_f32_16x16x32_bf16 v[200:203], a[44:47], v[180:183], v[200:203]
    v_mfma_f32_16x16x32_bf16 v[204:207], a[100:103], v[180:183], v[204:207]
    v_mfma_f32_16x16x32_bf16 v[208:211], a[156:159], v[180:183], v[208:211]
    v_mfma_f32_16x16x32_bf16 v[212:215], a[212:215], v[180:183], v[212:215]
    v_mfma_f32_16x16x32_bf16 v[200:203], a[48:51], v[184:187], v[200:203]
    v_mfma_f32_16x16x32_bf16 v[204:207], a[104:107], v[184:187], v[204:207]
    v_mfma_f32_16x16x32_bf16 v[208:211], a[160:163], v[184:187], v[208:211]
    v_mfma_f32_16x16x32_bf16 v[212:215], a[216:219], v[184:187], v[212:215]
    v_mfma_f32_16x16x32_bf16 v[200:203], a[52:55], v[188:191], v[200:203]
    v_mfma_f32_16x16x32_bf16 v[204:207], a[108:111], v[188:191], v[204:207]
    v_mfma_f32_16x16x32_bf16 v[208:211], a[164:167], v[188:191], v[208:211]
    v_mfma_f32_16x16x32_bf16 v[212:215], a[220:223], v[188:191], v[212:215]
    v_sub_f32 v192, 1.0, v192
    v_mul_f32 v216, s24, v200
    v_mul_f32 v217, s24, v201
    v_mul_f32 v218, s24, v202
    v_mul_f32 v219, s24, v203
    v_mul_f32 v220, s24, v204
    v_mul_f32 v221, s24, v205
    v_mul_f32 v222, s24, v206
    v_mul_f32 v223, s24, v207
    v_exp_f32 v216, v216
    v_exp_f32 v217, v217
    v_exp_f32 v218, v218
    v_exp_f32 v219, v219
    v_exp_f32 v220, v220
    v_exp_f32 v221, v221
    v_exp_f32 v222, v222
    v_exp_f32 v223, v223
    v_mul_f32 v224, v200, v208
    v_mul_f32 v225, v201, v209
    v_mul_f32 v226, v202, v210
    v_mul_f32 v227, v203, v211
    v_mul_f32 v228, v204, v212
    v_mul_f32 v229, v205, v213
    v_mul_f32 v230, v206, v214
    v_mul_f32 v231, v207, v215
    v_add_f32 v216, 1.0, v216
    v_add_f32 v217, 1.0, v217
    v_add_f32 v218, 1.0, v218
    v_add_f32 v219, 1.0, v219
    v_add_f32 v220, 1.0, v220
    v_add_f32 v221, 1.0, v221
    v_add_f32 v222, 1.0, v222
    v_add_f32 v223, 1.0, v223
    v_rcp_f32 v216, v216
    v_rcp_f32 v217, v217
    v_rcp_f32 v218, v218
    v_rcp_f32 v219, v219
    v_rcp_f32 v220, v220
    v_rcp_f32 v221, v221
    v_rcp_f32 v222, v222
    v_rcp_f32 v223, v223
    v_mul_f32 v224, v224, v192
    v_mul_f32 v225, v225, v192
    v_mul_f32 v226, v226, v192
    v_mul_f32 v227, v227, v192
    v_mul_f32 v228, v228, v192
    v_mul_f32 v229, v229, v192
    v_mul_f32 v230, v230, v192
    v_mul_f32 v231, v231, v192
    v_mul_f32 v216, v216, v224
    v_mul_f32 v217, v217, v225
    v_mul_f32 v218, v218, v226
    v_mul_f32 v219, v219, v227
    v_mul_f32 v220, v220, v228
    v_mul_f32 v221, v221, v229
    v_mul_f32 v222, v222, v230
    v_mul_f32 v223, v223, v231
    v_cvt_pk_bf16_f32 v236, v216, v217
    v_cvt_pk_bf16_f32 v237, v218, v219
    v_cvt_pk_bf16_f32 v238, v220, v221
    v_cvt_pk_bf16_f32 v239, v222, v223
    buffer_store_dwordx4 v[236:239], v2, s[8:11], s22 offen sc1
    s_add_u32 s22, s22, 57344
    s_waitcnt vmcnt(17)
    v_mfma_f32_16x16x32_bf16 v[200:203], a[0:3], v[16:19], 0
    v_mfma_f32_16x16x32_bf16 v[204:207], a[56:59], v[16:19], 0
    v_mfma_f32_16x16x32_bf16 v[208:211], a[112:115], v[16:19], 0
    v_mfma_f32_16x16x32_bf16 v[212:215], a[168:171], v[16:19], 0
    v_mfma_f32_16x16x32_bf16 v[200:203], a[4:7], v[20:23], v[200:203]
    v_mfma_f32_16x16x32_bf16 v[204:207], a[60:63], v[20:23], v[204:207]
    v_mfma_f32_16x16x32_bf16 v[208:211], a[116:119], v[20:23], v[208:211]
    v_mfma_f32_16x16x32_bf16 v[212:215], a[172:175], v[20:23], v[212:215]
    v_mfma_f32_16x16x32_bf16 v[200:203], a[8:11], v[24:27], v[200:203]
    v_mfma_f32_16x16x32_bf16 v[204:207], a[64:67], v[24:27], v[204:207]
    v_mfma_f32_16x16x32_bf16 v[208:211], a[120:123], v[24:27], v[208:211]
    v_mfma_f32_16x16x32_bf16 v[212:215], a[176:179], v[24:27], v[212:215]
    v_mfma_f32_16x16x32_bf16 v[200:203], a[12:15], v[28:31], v[200:203]
    v_mfma_f32_16x16x32_bf16 v[204:207], a[68:71], v[28:31], v[204:207]
    v_mfma_f32_16x16x32_bf16 v[208:211], a[124:127], v[28:31], v[208:211]
    v_mfma_f32_16x16x32_bf16 v[212:215], a[180:183], v[28:31], v[212:215]
    v_mfma_f32_16x16x32_bf16 v[200:203], a[16:19], v[32:35], v[200:203]
    v_mfma_f32_16x16x32_bf16 v[204:207], a[72:75], v[32:35], v[204:207]
    v_mfma_f32_16x16x32_bf16 v[208:211], a[128:131], v[32:35], v[208:211]
    v_mfma_f32_16x16x32_bf16 v[212:215], a[184:187], v[32:35], v[212:215]
    v_mfma_f32_16x16x32_bf16 v[200:203], a[20:23], v[36:39], v[200:203]
    v_mfma_f32_16x16x32_bf16 v[204:207], a[76:79], v[36:39], v[204:207]
    v_mfma_f32_16x16x32_bf16 v[208:211], a[132:135], v[36:39], v[208:211]
    v_mfma_f32_16x16x32_bf16 v[212:215], a[188:191], v[36:39], v[212:215]
    v_mfma_f32_16x16x32_bf16 v[200:203], a[24:27], v[40:43], v[200:203]
    v_mfma_f32_16x16x32_bf16 v[204:207], a[80:83], v[40:43], v[204:207]
    v_mfma_f32_16x16x32_bf16 v[208:211], a[136:139], v[40:43], v[208:211]
    v_mfma_f32_16x16x32_bf16 v[212:215], a[192:195], v[40:43], v[212:215]
    v_mfma_f32_16x16x32_bf16 v[200:203], a[28:31], v[44:47], v[200:203]
    v_mfma_f32_16x16x32_bf16 v[204:207], a[84:87], v[44:47], v[204:207]
    v_mfma_f32_16x16x32_bf16 v[208:211], a[140:143], v[44:47], v[208:211]
    v_mfma_f32_16x16x32_bf16 v[212:215], a[196:199], v[44:47], v[212:215]
    v_mfma_f32_16x16x32_bf16 v[200:203], a[32:35], v[48:51], v[200:203]
    v_mfma_f32_16x16x32_bf16 v[204:207], a[88:91], v[48:51], v[204:207]
    v_mfma_f32_16x16x32_bf16 v[208:211], a[144:147], v[48:51], v[208:211]
    v_mfma_f32_16x16x32_bf16 v[212:215], a[200:203], v[48:51], v[212:215]
    v_mfma_f32_16x16x32_bf16 v[200:203], a[36:39], v[52:55], v[200:203]
    v_mfma_f32_16x16x32_bf16 v[204:207], a[92:95], v[52:55], v[204:207]
    v_mfma_f32_16x16x32_bf16 v[208:211], a[148:151], v[52:55], v[208:211]
    v_mfma_f32_16x16x32_bf16 v[212:215], a[204:207], v[52:55], v[212:215]
    v_mfma_f32_16x16x32_bf16 v[200:203], a[40:43], v[56:59], v[200:203]
    v_mfma_f32_16x16x32_bf16 v[204:207], a[96:99], v[56:59], v[204:207]
    v_mfma_f32_16x16x32_bf16 v[208:211], a[152:155], v[56:59], v[208:211]
    v_mfma_f32_16x16x32_bf16 v[212:215], a[208:211], v[56:59], v[212:215]
    v_mfma_f32_16x16x32_bf16 v[200:203], a[44:47], v[60:63], v[200:203]
    v_mfma_f32_16x16x32_bf16 v[204:207], a[100:103], v[60:63], v[204:207]
    v_mfma_f32_16x16x32_bf16 v[208:211], a[156:159], v[60:63], v[208:211]
    v_mfma_f32_16x16x32_bf16 v[212:215], a[212:215], v[60:63], v[212:215]
    v_mfma_f32_16x16x32_bf16 v[200:203], a[48:51], v[64:67], v[200:203]
    v_mfma_f32_16x16x32_bf16 v[204:207], a[104:107], v[64:67], v[204:207]
    v_mfma_f32_16x16x32_bf16 v[208:211], a[160:163], v[64:67], v[208:211]
    v_mfma_f32_16x16x32_bf16 v[212:215], a[216:219], v[64:67], v[212:215]
    v_mfma_f32_16x16x32_bf16 v[200:203], a[52:55], v[68:71], v[200:203]
    v_mfma_f32_16x16x32_bf16 v[204:207], a[108:111], v[68:71], v[204:207]
    v_mfma_f32_16x16x32_bf16 v[208:211], a[164:167], v[68:71], v[208:211]
    v_mfma_f32_16x16x32_bf16 v[212:215], a[220:223], v[68:71], v[212:215]
    v_sub_f32 v72, 1.0, v72
    v_mul_f32 v216, s24, v200
    v_mul_f32 v217, s24, v201
    v_mul_f32 v218, s24, v202
    v_mul_f32 v219, s24, v203
    v_mul_f32 v220, s24, v204
    v_mul_f32 v221, s24, v205
    v_mul_f32 v222, s24, v206
    v_mul_f32 v223, s24, v207
    v_exp_f32 v216, v216
    v_exp_f32 v217, v217
    v_exp_f32 v218, v218
    v_exp_f32 v219, v219
    v_exp_f32 v220, v220
    v_exp_f32 v221, v221
    v_exp_f32 v222, v222
    v_exp_f32 v223, v223
    v_mul_f32 v224, v200, v208
    v_mul_f32 v225, v201, v209
    v_mul_f32 v226, v202, v210
    v_mul_f32 v227, v203, v211
    v_mul_f32 v228, v204, v212
    v_mul_f32 v229, v205, v213
    v_mul_f32 v230, v206, v214
    v_mul_f32 v231, v207, v215
    v_add_f32 v216, 1.0, v216
    v_add_f32 v217, 1.0, v217
    v_add_f32 v218, 1.0, v218
    v_add_f32 v219, 1.0, v219
    v_add_f32 v220, 1.0, v220
    v_add_f32 v221, 1.0, v221
    v_add_f32 v222, 1.0, v222
    v_add_f32 v223, 1.0, v223
    v_rcp_f32 v216, v216
    v_rcp_f32 v217, v217
    v_rcp_f32 v218, v218
    v_rcp_f32 v219, v219
    v_rcp_f32 v220, v220
    v_rcp_f32 v221, v221
    v_rcp_f32 v222, v222
    v_rcp_f32 v223, v223
    v_mul_f32 v224, v224, v72
    v_mul_f32 v225, v225, v72
    v_mul_f32 v226, v226, v72
    v_mul_f32 v227, v227, v72
    v_mul_f32 v228, v228, v72
    v_mul_f32 v229, v229, v72
    v_mul_f32 v230, v230, v72
    v_mul_f32 v231, v231, v72
    v_mul_f32 v216, v216, v224
    v_mul_f32 v217, v217, v225
    v_mul_f32 v218, v218, v226
    v_mul_f32 v219, v219, v227
    v_mul_f32 v220, v220, v228
    v_mul_f32 v221, v221, v229
    v_mul_f32 v222, v222, v230
    v_mul_f32 v223, v223, v231
    v_cvt_pk_bf16_f32 v232, v216, v217
    v_cvt_pk_bf16_f32 v233, v218, v219
    v_cvt_pk_bf16_f32 v234, v220, v221
    v_cvt_pk_bf16_f32 v235, v222, v223
    buffer_store_dwordx4 v[232:235], v2, s[8:11], s22 offen sc1
    s_add_u32 s22, s22, 57344
    s_waitcnt vmcnt(2)
    v_mfma_f32_16x16x32_bf16 v[200:203], a[0:3], v[76:79], 0
    v_mfma_f32_16x16x32_bf16 v[204:207], a[56:59], v[76:79], 0
    v_mfma_f32_16x16x32_bf16 v[208:211], a[112:115], v[76:79], 0
    v_mfma_f32_16x16x32_bf16 v[212:215], a[168:171], v[76:79], 0
    v_mfma_f32_16x16x32_bf16 v[200:203], a[4:7], v[80:83], v[200:203]
    v_mfma_f32_16x16x32_bf16 v[204:207], a[60:63], v[80:83], v[204:207]
    v_mfma_f32_16x16x32_bf16 v[208:211], a[116:119], v[80:83], v[208:211]
    v_mfma_f32_16x16x32_bf16 v[212:215], a[172:175], v[80:83], v[212:215]
    v_mfma_f32_16x16x32_bf16 v[200:203], a[8:11], v[84:87], v[200:203]
    v_mfma_f32_16x16x32_bf16 v[204:207], a[64:67], v[84:87], v[204:207]
    v_mfma_f32_16x16x32_bf16 v[208:211], a[120:123], v[84:87], v[208:211]
    v_mfma_f32_16x16x32_bf16 v[212:215], a[176:179], v[84:87], v[212:215]
    v_mfma_f32_16x16x32_bf16 v[200:203], a[12:15], v[88:91], v[200:203]
    v_mfma_f32_16x16x32_bf16 v[204:207], a[68:71], v[88:91], v[204:207]
    v_mfma_f32_16x16x32_bf16 v[208:211], a[124:127], v[88:91], v[208:211]
    v_mfma_f32_16x16x32_bf16 v[212:215], a[180:183], v[88:91], v[212:215]
    v_mfma_f32_16x16x32_bf16 v[200:203], a[16:19], v[92:95], v[200:203]
    v_mfma_f32_16x16x32_bf16 v[204:207], a[72:75], v[92:95], v[204:207]
    v_mfma_f32_16x16x32_bf16 v[208:211], a[128:131], v[92:95], v[208:211]
    v_mfma_f32_16x16x32_bf16 v[212:215], a[184:187], v[92:95], v[212:215]
    v_mfma_f32_16x16x32_bf16 v[200:203], a[20:23], v[96:99], v[200:203]
    v_mfma_f32_16x16x32_bf16 v[204:207], a[76:79], v[96:99], v[204:207]
    v_mfma_f32_16x16x32_bf16 v[208:211], a[132:135], v[96:99], v[208:211]
    v_mfma_f32_16x16x32_bf16 v[212:215], a[188:191], v[96:99], v[212:215]
    v_mfma_f32_16x16x32_bf16 v[200:203], a[24:27], v[100:103], v[200:203]
    v_mfma_f32_16x16x32_bf16 v[204:207], a[80:83], v[100:103], v[204:207]
    v_mfma_f32_16x16x32_bf16 v[208:211], a[136:139], v[100:103], v[208:211]
    v_mfma_f32_16x16x32_bf16 v[212:215], a[192:195], v[100:103], v[212:215]
    v_mfma_f32_16x16x32_bf16 v[200:203], a[28:31], v[104:107], v[200:203]
    v_mfma_f32_16x16x32_bf16 v[204:207], a[84:87], v[104:107], v[204:207]
    v_mfma_f32_16x16x32_bf16 v[208:211], a[140:143], v[104:107], v[208:211]
    v_mfma_f32_16x16x32_bf16 v[212:215], a[196:199], v[104:107], v[212:215]
    v_mfma_f32_16x16x32_bf16 v[200:203], a[32:35], v[108:111], v[200:203]
    v_mfma_f32_16x16x32_bf16 v[204:207], a[88:91], v[108:111], v[204:207]
    v_mfma_f32_16x16x32_bf16 v[208:211], a[144:147], v[108:111], v[208:211]
    v_mfma_f32_16x16x32_bf16 v[212:215], a[200:203], v[108:111], v[212:215]
    v_mfma_f32_16x16x32_bf16 v[200:203], a[36:39], v[112:115], v[200:203]
    v_mfma_f32_16x16x32_bf16 v[204:207], a[92:95], v[112:115], v[204:207]
    v_mfma_f32_16x16x32_bf16 v[208:211], a[148:151], v[112:115], v[208:211]
    v_mfma_f32_16x16x32_bf16 v[212:215], a[204:207], v[112:115], v[212:215]
    v_mfma_f32_16x16x32_bf16 v[200:203], a[40:43], v[116:119], v[200:203]
    v_mfma_f32_16x16x32_bf16 v[204:207], a[96:99], v[116:119], v[204:207]
    v_mfma_f32_16x16x32_bf16 v[208:211], a[152:155], v[116:119], v[208:211]
    v_mfma_f32_16x16x32_bf16 v[212:215], a[208:211], v[116:119], v[212:215]
    v_mfma_f32_16x16x32_bf16 v[200:203], a[44:47], v[120:123], v[200:203]
    v_mfma_f32_16x16x32_bf16 v[204:207], a[100:103], v[120:123], v[204:207]
    v_mfma_f32_16x16x32_bf16 v[208:211], a[156:159], v[120:123], v[208:211]
    v_mfma_f32_16x16x32_bf16 v[212:215], a[212:215], v[120:123], v[212:215]
    v_mfma_f32_16x16x32_bf16 v[200:203], a[48:51], v[124:127], v[200:203]
    v_mfma_f32_16x16x32_bf16 v[204:207], a[104:107], v[124:127], v[204:207]
    v_mfma_f32_16x16x32_bf16 v[208:211], a[160:163], v[124:127], v[208:211]
    v_mfma_f32_16x16x32_bf16 v[212:215], a[216:219], v[124:127], v[212:215]
    v_mfma_f32_16x16x32_bf16 v[200:203], a[52:55], v[128:131], v[200:203]
    v_mfma_f32_16x16x32_bf16 v[204:207], a[108:111], v[128:131], v[204:207]
    v_mfma_f32_16x16x32_bf16 v[208:211], a[164:167], v[128:131], v[208:211]
    v_mfma_f32_16x16x32_bf16 v[212:215], a[220:223], v[128:131], v[212:215]
    v_sub_f32 v132, 1.0, v132
    v_mul_f32 v216, s24, v200
    v_mul_f32 v217, s24, v201
    v_mul_f32 v218, s24, v202
    v_mul_f32 v219, s24, v203
    v_mul_f32 v220, s24, v204
    v_mul_f32 v221, s24, v205
    v_mul_f32 v222, s24, v206
    v_mul_f32 v223, s24, v207
    v_exp_f32 v216, v216
    v_exp_f32 v217, v217
    v_exp_f32 v218, v218
    v_exp_f32 v219, v219
    v_exp_f32 v220, v220
    v_exp_f32 v221, v221
    v_exp_f32 v222, v222
    v_exp_f32 v223, v223
    v_mul_f32 v224, v200, v208
    v_mul_f32 v225, v201, v209
    v_mul_f32 v226, v202, v210
    v_mul_f32 v227, v203, v211
    v_mul_f32 v228, v204, v212
    v_mul_f32 v229, v205, v213
    v_mul_f32 v230, v206, v214
    v_mul_f32 v231, v207, v215
    v_add_f32 v216, 1.0, v216
    v_add_f32 v217, 1.0, v217
    v_add_f32 v218, 1.0, v218
    v_add_f32 v219, 1.0, v219
    v_add_f32 v220, 1.0, v220
    v_add_f32 v221, 1.0, v221
    v_add_f32 v222, 1.0, v222
    v_add_f32 v223, 1.0, v223
    v_rcp_f32 v216, v216
    v_rcp_f32 v217, v217
    v_rcp_f32 v218, v218
    v_rcp_f32 v219, v219
    v_rcp_f32 v220, v220
    v_rcp_f32 v221, v221
    v_rcp_f32 v222, v222
    v_rcp_f32 v223, v223
    v_mul_f32 v224, v224, v132
    v_mul_f32 v225, v225, v132
    v_mul_f32 v226, v226, v132
    v_mul_f32 v227, v227, v132
    v_mul_f32 v228, v228, v132
    v_mul_f32 v229, v229, v132
    v_mul_f32 v230, v230, v132
    v_mul_f32 v231, v231, v132
    v_mul_f32 v216, v216, v224
    v_mul_f32 v217, v217, v225
    v_mul_f32 v218, v218, v226
    v_mul_f32 v219, v219, v227
    v_mul_f32 v220, v220, v228
    v_mul_f32 v221, v221, v229
    v_mul_f32 v222, v222, v230
    v_mul_f32 v223, v223, v231
    v_cvt_pk_bf16_f32 v236, v216, v217
    v_cvt_pk_bf16_f32 v237, v218, v219
    v_cvt_pk_bf16_f32 v238, v220, v221
    v_cvt_pk_bf16_f32 v239, v222, v223
    buffer_store_dwordx4 v[236:239], v2, s[8:11], s22 offen sc1
    s_add_u32 s22, s22, 57344
    s_lshl_b32 s34, s14, 1
    s_lshr_b32 s33, s13, 1
    s_add_u32 s34, s34, s33
    s_lshl_b32 s34, s34, 8
    s_lshl_b32 s33, s16, 2
    s_add_u32 s34, s34, s33
    s_add_u32 s34, s34, 116445184
    s_waitcnt vmcnt(0)
    v_mov_b32 v15, 1
    s_mov_b64 exec, 1
    buffer_store_dword v15, off, s[8:11], s34 sc1
    s_mov_b64 exec, -1
    s_add_u32 s58, s58, 96
    s_cmp_lt_u32 s58, 224
    s_cbranch_scc1 W_HL
    s_cmp_ge_u32 s12, 91
    s_cbranch_scc1 MEGA_EXIT
    s_load_dwordx2 s[36:37], s[0:1], 96
    s_mov_b32 s38, 1835008
    s_mov_b32 s39, 0x20000
    s_mul_i32 s14, s12, 9363
    s_lshr_b32 s14, s14, 16
    s_mul_i32 s15, s14, 7
    s_sub_u32 s15, s12, s15
    s_waitcnt lgkmcnt(0)
    s_barrier
    v_and_b32 v1, 63, v0
    v_lshlrev_b32 v2, 4, v1
    v_and_b32 v3, 15, v1
    v_lshrrev_b32 v4, 4, v1
    s_load_dwordx2 s[44:45], s[0:1], 80
    s_mov_b32 s46, 1605632
    s_mov_b32 s47, 0x20000
    v_lshrrev_b32 v7, 3, v1
    v_mul_u32_u24 v6, 896, v7
    v_bfe_u32 v7, v1, 4, 1
    v_lshlrev_b32 v7, 2, v7
    v_xor_b32 v7, v7, v1
    v_and_b32 v7, 7, v7
    v_lshl_add_u32 v6, v7, 4, v6
    s_mul_i32 s18, s13, 401408
    s_lshl_b32 s20, s15, 7
    s_add_u32 s18, s18, s20
    s_mul_i32 s19, s13, 14336
    s_lshl_b32 s21, s19, 1
    v_lshrrev_b32 v9, 2, v3
    v_lshlrev_b32 v10, 7, v9
    v_lshl_add_u32 v10, v4, 10, v10
    v_bfe_u32 v9, v3, 3, 1
    v_lshl_add_u32 v10, v9, 6, v10
    v_and_b32 v9, 3, v3
    v_lshl_add_u32 v10, v9, 3, v10
    v_add_u32 v10, s21, v10
    v_xor_b32 v11, 64, v10
    s_waitcnt lgkmcnt(0)
    s_add_u32 m0, s21, 0
    s_add_u32 s20, s18, 0
    buffer_load_dwordx4 v6, s[44:47], s20 offen lds
    s_add_u32 m0, s21, 1024
    s_add_u32 s20, s18, 7168
    buffer_load_dwordx4 v6, s[44:47], s20 offen lds
    s_add_u32 m0, s21, 2048
    s_add_u32 s20, s18, 14336
    buffer_load_dwordx4 v6, s[44:47], s20 offen lds
    s_add_u32 m0, s21, 3072
    s_add_u32 s20, s18, 21504
    buffer_load_dwordx4 v6, s[44:47], s20 offen lds
    s_add_u32 m0, s21, 4096
    s_add_u32 s20, s18, 28672
    buffer_load_dwordx4 v6, s[44:47], s20 offen lds
    s_add_u32 m0, s21, 5120
    s_add_u32 s20, s18, 35840
    buffer_load_dwordx4 v6, s[44:47], s20 offen lds
    s_add_u32 m0, s21, 6144
    s_add_u32 s20, s18, 43008
    buffer_load_dwordx4 v6, s[44:47], s20 offen lds
    s_add_u32 m0, s21, 7168
    s_add_u32 s20, s18, 50176
    buffer_load_dwordx4 v6, s[44:47], s20 offen lds
    s_add_u32 m0, s21, 8192
    s_add_u32 s20, s18, 57344
    buffer_load_dwordx4 v6, s[44:47], s20 offen lds
    s_add_u32 m0, s21, 9216
    s_add_u32 s20, s18, 64512
    buffer_load_dwordx4 v6, s[44:47], s20 offen lds
    s_add_u32 m0, s21, 10240
    s_add_u32 s20, s18, 71680
    buffer_load_dwordx4 v6, s[44:47], s20 offen lds
    s_add_u32 m0, s21, 11264
    s_add_u32 s20, s18, 78848
    buffer_load_dwordx4 v6, s[44:47], s20 offen lds
    s_add_u32 m0, s21, 12288
    s_add_u32 s20, s18, 86016
    buffer_load_dwordx4 v6, s[44:47], s20 offen lds
    s_add_u32 m0, s21, 13312
    s_add_u32 s20, s18, 93184
    buffer_load_dwordx4 v6, s[44:47], s20 offen lds
    s_add_u32 m0, s21, 14336
    s_add_u32 s20, s18, 100352
    buffer_load_dwordx4 v6, s[44:47], s20 offen lds
    s_add_u32 m0, s21, 15360
    s_add_u32 s20, s18, 107520
    buffer_load_dwordx4 v6, s[44:47], s20 offen lds
    s_add_u32 m0, s21, 16384
    s_add_u32 s20, s18, 114688
    buffer_load_dwordx4 v6, s[44:47], s20 offen lds
    s_add_u32 m0, s21, 17408
    s_add_u32 s20, s18, 121856
    buffer_load_dwordx4 v6, s[44:47], s20 offen lds
    s_add_u32 m0, s21, 18432
    s_add_u32 s20, s18, 129024
    buffer_load_dwordx4 v6, s[44:47], s20 offen lds
    s_add_u32 m0, s21, 19456
    s_add_u32 s20, s18, 136192
    buffer_load_dwordx4 v6, s[44:47], s20 offen lds
    s_add_u32 m0, s21, 20480
    s_add_u32 s20, s18, 143360
    buffer_load_dwordx4 v6, s[44:47], s20 offen lds
    s_add_u32 m0, s21, 21504
    s_add_u32 s20, s18, 150528
    buffer_load_dwordx4 v6, s[44:47], s20 offen lds
    s_add_u32 m0, s21, 22528
    s_add_u32 s20, s18, 157696
    buffer_load_dwordx4 v6, s[44:47], s20 offen lds
    s_add_u32 m0, s21, 23552
    s_add_u32 s20, s18, 164864
    buffer_load_dwordx4 v6, s[44:47], s20 offen lds
    s_add_u32 m0, s21, 24576
    s_add_u32 s20, s18, 172032
    buffer_load_dwordx4 v6, s[44:47], s20 offen lds
    s_add_u32 m0, s21, 25600
    s_add_u32 s20, s18, 179200
    buffer_load_dwordx4 v6, s[44:47], s20 offen lds
    s_add_u32 m0, s21, 26624
    s_add_u32 s20, s18, 186368
    buffer_load_dwordx4 v6, s[44:47], s20 offen lds
    s_add_u32 m0, s21, 27648
    s_add_u32 s20, s18, 193536
    buffer_load_dwordx4 v6, s[44:47], s20 offen lds
    s_waitcnt vmcnt(0)
    ds_read_b64_tr_b16 a[0:1], v10 offset:0
    ds_read_b64_tr_b16 a[2:3], v10 offset:512
    ds_read_b64_tr_b16 a[56:57], v10 offset:32
    ds_read_b64_tr_b16 a[58:59], v10 offset:544
    ds_read_b64_tr_b16 a[112:113], v11 offset:0
    ds_read_b64_tr_b16 a[114:115], v11 offset:512
    ds_read_b64_tr_b16 a[168:169], v11 offset:32
    ds_read_b64_tr_b16 a[170:171], v11 offset:544
    ds_read_b64_tr_b16 a[4:5], v10 offset:4096
    ds_read_b64_tr_b16 a[6:7], v10 offset:4608
    ds_read_b64_tr_b16 a[60:61], v10 offset:4128
    ds_read_b64_tr_b16 a[62:63], v10 offset:4640
    ds_read_b64_tr_b16 a[116:117], v11 offset:4096
    ds_read_b64_tr_b16 a[118:119], v11 offset:4608
    ds_read_b64_tr_b16 a[172:173], v11 offset:4128
    ds_read_b64_tr_b16 a[174:175], v11 offset:4640
    ds_read_b64_tr_b16 a[8:9], v10 offset:8192
    ds_read_b64_tr_b16 a[10:11], v10 offset:8704
    ds_read_b64_tr_b16 a[64:65], v10 offset:8224
    ds_read_b64_tr_b16 a[66:67], v10 offset:8736
    ds_read_b64_tr_b16 a[120:121], v11 offset:8192
    ds_read_b64_tr_b16 a[122:123], v11 offset:8704
    ds_read_b64_tr_b16 a[176:177], v11 offset:8224
    ds_read_b64_tr_b16 a[178:179], v11 offset:8736
    ds_read_b64_tr_b16 a[12:13], v10 offset:12288
    ds_read_b64_tr_b16 a[14:15], v10 offset:12800
    ds_read_b64_tr_b16 a[68:69], v10 offset:12320
    ds_read_b64_tr_b16 a[70:71], v10 offset:12832
    ds_read_b64_tr_b16 a[124:125], v11 offset:12288
    ds_read_b64_tr_b16 a[126:127], v11 offset:12800
    ds_read_b64_tr_b16 a[180:181], v11 offset:12320
    ds_read_b64_tr_b16 a[182:183], v11 offset:12832
    ds_read_b64_tr_b16 a[16:17], v10 offset:16384
    ds_read_b64_tr_b16 a[18:19], v10 offset:16896
    ds_read_b64_tr_b16 a[72:73], v10 offset:16416
    ds_read_b64_tr_b16 a[74:75], v10 offset:16928
    ds_read_b64_tr_b16 a[128:129], v11 offset:16384
    ds_read_b64_tr_b16 a[130:131], v11 offset:16896
    ds_read_b64_tr_b16 a[184:185], v11 offset:16416
    ds_read_b64_tr_b16 a[186:187], v11 offset:16928
    ds_read_b64_tr_b16 a[20:21], v10 offset:20480
    ds_read_b64_tr_b16 a[22:23], v10 offset:20992
    ds_read_b64_tr_b16 a[76:77], v10 offset:20512
    ds_read_b64_tr_b16 a[78:79], v10 offset:21024
    ds_read_b64_tr_b16 a[132:133], v11 offset:20480
    ds_read_b64_tr_b16 a[134:135], v11 offset:20992
    ds_read_b64_tr_b16 a[188:189], v11 offset:20512
    ds_read_b64_tr_b16 a[190:191], v11 offset:21024
    ds_read_b64_tr_b16 a[24:25], v10 offset:24576
    ds_read_b64_tr_b16 a[26:27], v10 offset:25088
    ds_read_b64_tr_b16 a[80:81], v10 offset:24608
    ds_read_b64_tr_b16 a[82:83], v10 offset:25120
    ds_read_b64_tr_b16 a[136:137], v11 offset:24576
    ds_read_b64_tr_b16 a[138:139], v11 offset:25088
    ds_read_b64_tr_b16 a[192:193], v11 offset:24608
    ds_read_b64_tr_b16 a[194:195], v11 offset:25120
    s_waitcnt lgkmcnt(0)
    s_add_u32 m0, s21, 0
    s_add_u32 s20, s18, 200704
    buffer_load_dwordx4 v6, s[44:47], s20 offen lds
    s_add_u32 m0, s21, 1024
    s_add_u32 s20, s18, 207872
    buffer_load_dwordx4 v6, s[44:47], s20 offen lds
    s_add_u32 m0, s21, 2048
    s_add_u32 s20, s18, 215040
    buffer_load_dwordx4 v6, s[44:47], s20 offen lds
    s_add_u32 m0, s21, 3072
    s_add_u32 s20, s18, 222208
    buffer_load_dwordx4 v6, s[44:47], s20 offen lds
    s_add_u32 m0, s21, 4096
    s_add_u32 s20, s18, 229376
    buffer_load_dwordx4 v6, s[44:47], s20 offen lds
    s_add_u32 m0, s21, 5120
    s_add_u32 s20, s18, 236544
    buffer_load_dwordx4 v6, s[44:47], s20 offen lds
    s_add_u32 m0, s21, 6144
    s_add_u32 s20, s18, 243712
    buffer_load_dwordx4 v6, s[44:47], s20 offen lds
    s_add_u32 m0, s21, 7168
    s_add_u32 s20, s18, 250880
    buffer_load_dwordx4 v6, s[44:47], s20 offen lds
    s_add_u32 m0, s21, 8192
    s_add_u32 s20, s18, 258048
    buffer_load_dwordx4 v6, s[44:47], s20 offen lds
    s_add_u32 m0, s21, 9216
    s_add_u32 s20, s18, 265216
    buffer_load_dwordx4 v6, s[44:47], s20 offen lds
    s_add_u32 m0, s21, 10240
    s_add_u32 s20, s18, 272384
    buffer_load_dwordx4 v6, s[44:47], s20 offen lds
    s_add_u32 m0, s21, 11264
    s_add_u32 s20, s18, 279552
    buffer_load_dwordx4 v6, s[44:47], s20 offen lds
    s_add_u32 m0, s21, 12288
    s_add_u32 s20, s18, 286720
    buffer_load_dwordx4 v6, s[44:47], s20 offen lds
    s_add_u32 m0, s21, 13312
    s_add_u32 s20, s18, 293888
    buffer_load_dwordx4 v6, s[44:47], s20 offen lds
    s_add_u32 m0, s21, 14336
    s_add_u32 s20, s18, 301056
    buffer_load_dwordx4 v6, s[44:47], s20 offen lds
    s_add_u32 m0, s21, 15360
    s_add_u32 s20, s18, 308224
    buffer_load_dwordx4 v6, s[44:47], s20 offen lds
    s_add_u32 m0, s21, 16384
    s_add_u32 s20, s18, 315392
    buffer_load_dwordx4 v6, s[44:47], s20 offen lds
    s_add_u32 m0, s21, 17408
    s_add_u32 s20, s18, 322560
    buffer_load_dwordx4 v6, s[44:47], s20 offen lds
    s_add_u32 m0, s21, 18432
    s_add_u32 s20, s18, 329728
    buffer_load_dwordx4 v6, s[44:47], s20 offen lds
    s_add_u32 m0, s21, 19456
    s_add_u32 s20, s18, 336896
    buffer_load_dwordx4 v6, s[44:47], s20 offen lds
    s_add_u32 m0, s21, 20480
    s_add_u32 s20, s18, 344064
    buffer_load_dwordx4 v6, s[44:47], s20 offen lds
    s_add_u32 m0, s21, 21504
    s_add_u32 s20, s18, 351232
    buffer_load_dwordx4 v6, s[44:47], s20 offen lds
    s_add_u32 m0, s21, 22528
    s_add_u32 s20, s18, 358400
    buffer_load_dwordx4 v6, s[44:47], s20 offen lds
    s_add_u32 m0, s21, 23552
    s_add_u32 s20, s18, 365568
    buffer_load_dwordx4 v6, s[44:47], s20 offen lds
    s_add_u32 m0, s21, 24576
    s_add_u32 s20, s18, 372736
    buffer_load_dwordx4 v6, s[44:47], s20 offen lds
    s_add_u32 m0, s21, 25600
    s_add_u32 s20, s18, 379904
    buffer_load_dwordx4 v6, s[44:47], s20 offen lds
    s_add_u32 m0, s21, 26624
    s_add_u32 s20, s18, 387072
    buffer_load_dwordx4 v6, s[44:47], s20 offen lds
    s_add_u32 m0, s21, 27648
    s_add_u32 s20, s18, 394240
    buffer_load_dwordx4 v6, s[44:47], s20 offen lds
    s_waitcnt vmcnt(0)
    ds_read_b64_tr_b16 a[28:29], v10 offset:0
    ds_read_b64_tr_b16 a[30:31], v10 offset:512
    ds_read_b64_tr_b16 a[84:85], v10 offset:32
    ds_read_b64_tr_b16 a[86:87], v10 offset:544
    ds_read_b64_tr_b16 a[140:141], v11 offset:0
    ds_read_b64_tr_b16 a[142:143], v11 offset:512
    ds_read_b64_tr_b16 a[196:197], v11 offset:32
    ds_read_b64_tr_b16 a[198:199], v11 offset:544
    ds_read_b64_tr_b16 a[32:33], v10 offset:4096
    ds_read_b64_tr_b16 a[34:35], v10 offset:4608
    ds_read_b64_tr_b16 a[88:89], v10 offset:4128
    ds_read_b64_tr_b16 a[90:91], v10 offset:4640
    ds_read_b64_tr_b16 a[144:145], v11 offset:4096
    ds_read_b64_tr_b16 a[146:147], v11 offset:4608
    ds_read_b64_tr_b16 a[200:201], v11 offset:4128
    ds_read_b64_tr_b16 a[202:203], v11 offset:4640
    ds_read_b64_tr_b16 a[36:37], v10 offset:8192
    ds_read_b64_tr_b16 a[38:39], v10 offset:8704
    ds_read_b64_tr_b16 a[92:93], v10 offset:8224
    ds_read_b64_tr_b16 a[94:95], v10 offset:8736
    ds_read_b64_tr_b16 a[148:149], v11 offset:8192
    ds_read_b64_tr_b16 a[150:151], v11 offset:8704
    ds_read_b64_tr_b16 a[204:205], v11 offset:8224
    ds_read_b64_tr_b16 a[206:207], v11 offset:8736
    ds_read_b64_tr_b16 a[40:41], v10 offset:12288
    ds_read_b64_tr_b16 a[42:43], v10 offset:12800
    ds_read_b64_tr_b16 a[96:97], v10 offset:12320
    ds_read_b64_tr_b16 a[98:99], v10 offset:12832
    ds_read_b64_tr_b16 a[152:153], v11 offset:12288
    ds_read_b64_tr_b16 a[154:155], v11 offset:12800
    ds_read_b64_tr_b16 a[208:209], v11 offset:12320
    ds_read_b64_tr_b16 a[210:211], v11 offset:12832
    ds_read_b64_tr_b16 a[44:45], v10 offset:16384
    ds_read_b64_tr_b16 a[46:47], v10 offset:16896
    ds_read_b64_tr_b16 a[100:101], v10 offset:16416
    ds_read_b64_tr_b16 a[102:103], v10 offset:16928
    ds_read_b64_tr_b16 a[156:157], v11 offset:16384
    ds_read_b64_tr_b16 a[158:159], v11 offset:16896
    ds_read_b64_tr_b16 a[212:213], v11 offset:16416
    ds_read_b64_tr_b16 a[214:215], v11 offset:16928
    ds_read_b64_tr_b16 a[48:49], v10 offset:20480
    ds_read_b64_tr_b16 a[50:51], v10 offset:20992
    ds_read_b64_tr_b16 a[104:105], v10 offset:20512
    ds_read_b64_tr_b16 a[106:107], v10 offset:21024
    ds_read_b64_tr_b16 a[160:161], v11 offset:20480
    ds_read_b64_tr_b16 a[162:163], v11 offset:20992
    ds_read_b64_tr_b16 a[216:217], v11 offset:20512
    ds_read_b64_tr_b16 a[218:219], v11 offset:21024
    ds_read_b64_tr_b16 a[52:53], v10 offset:24576
    ds_read_b64_tr_b16 a[54:55], v10 offset:25088
    ds_read_b64_tr_b16 a[108:109], v10 offset:24608
    ds_read_b64_tr_b16 a[110:111], v10 offset:25120
    ds_read_b64_tr_b16 a[164:165], v11 offset:24576
    ds_read_b64_tr_b16 a[166:167], v11 offset:25088
    ds_read_b64_tr_b16 a[220:221], v11 offset:24608
    ds_read_b64_tr_b16 a[222:223], v11 offset:25120
    s_waitcnt lgkmcnt(0)
    s_barrier
    v_lshlrev_b32 v5, 2, v4
    v_add_u32 v6, 0, v5
    v_cmp_le_u32 s[48:49], v6, v3
    v_add_u32 v6, 1, v5
    v_cmp_le_u32 s[50:51], v6, v3
    v_add_u32 v6, 2, v5
    v_cmp_le_u32 s[52:53], v6, v3
    v_add_u32 v6, 3, v5
    v_cmp_le_u32 s[54:55], v6, v3
    v_cmp_eq_u32 s[60:61], 0, v4
    v_cmp_eq_u32 s[62:63], 1, v4
    v_cmp_eq_u32 s[64:65], 2, v4
    v_cmp_eq_u32 s[66:67], 3, v4
    v_lshlrev_b32 v7, 10, v4
    v_lshl_add_u32 v7, v3, 4, v7
    v_mul_u32_u24 v15, 7168, v4
    v_lshl_add_u32 v15, v3, 4, v15
    v_lshlrev_b32 v8, 2, v3
    v_lshrrev_b32 v9, 3, v0
    v_and_b32 v10, 7, v0
    v_mul_u32_u24 v11, 896, v9
    v_lshl_add_u32 v11, v10, 4, v11
    v_lshrrev_b32 v12, 4, v9
    v_lshlrev_b32 v12, 12, v12
    v_lshl_add_u32 v12, v10, 9, v12
    v_and_b32 v9, 15, v9
    v_lshl_add_u32 v12, v9, 4, v12
    s_lshl_b32 s20, s13, 13
    v_add_u32 v13, s20, v2
    v_mov_b32 v14, 4048155338
    s_mov_b32 s28, s14
    s_mov_b32 s29, 0
TOK_214:
    s_cmp_lg_u32 s13, 0
    s_cbranch_scc1 WFZ_216
    s_mov_b32 s35, 0
    s_lshr_b32 s30, s28, 2
    s_lshl_b32 s30, s30, 8
    s_add_u32 s30, s30, 116445184
    v_min_u32 v16, 55, v1
    v_lshlrev_b32 v16, 2, v16
    s_branch WF0_217
WF_215:
    s_sleep 16
WF0_217:
    buffer_load_dword v18, v16, s[8:11], s30 offen sc1
    s_add_u32 s35, s35, 1
    s_cmp_gt_u32 s35, 4000000
    s_cbranch_scc1 MEGA_EXIT
    s_waitcnt vmcnt(0)
    v_cmp_eq_u32 vcc, 0, v18
    s_cbranch_vccnz WF_215
WFZ_216:
    s_cmp_lg_u32 s13, 0
    s_cbranch_scc1 WFZ_219
    s_mov_b32 s35, 0
    s_lshl_b32 s30, s28, 9
    s_add_u32 s30, s30, 116396032
    v_lshlrev_b32 v16, 3, v1
    s_branch WF0_220
WF_218:
    s_sleep 16
WF0_220:
    buffer_load_dwordx2 v[18:19], v16, s[8:11], s30 offen sc1
    s_add_u32 s35, s35, 1
    s_cmp_gt_u32 s35, 4000000
    s_cbranch_scc1 MEGA_EXIT
    s_waitcnt vmcnt(0)
    v_min_u32 v18, v18, v19
    v_cmp_eq_u32 vcc, 0, v18
    s_cbranch_vccnz WF_218
WFZ_219:
    s_barrier
    s_mul_i32 s20, s28, 114688
    s_add_u32 s20, s20, s19
    s_add_u32 s20, s20, 93323264
    s_add_u32 s21, s20, 0
    buffer_load_dwordx4 v[16:19], v2, s[8:11], s21 offen offset:0 sc1
    buffer_load_dwordx4 v[20:23], v2, s[8:11], s21 offen offset:1024 sc1
    buffer_load_dwordx4 v[24:27], v2, s[8:11], s21 offen offset:2048 sc1
    buffer_load_dwordx4 v[28:31], v2, s[8:11], s21 offen offset:3072 sc1
    s_add_u32 s21, s20, 4096
    buffer_load_dwordx4 v[32:35], v2, s[8:11], s21 offen offset:0 sc1
    buffer_load_dwordx4 v[36:39], v2, s[8:11], s21 offen offset:1024 sc1
    buffer_load_dwordx4 v[40:43], v2, s[8:11], s21 offen offset:2048 sc1
    buffer_load_dwordx4 v[44:47], v2, s[8:11], s21 offen offset:3072 sc1
    s_add_u32 s21, s20, 8192
    buffer_load_dwordx4 v[48:51], v2, s[8:11], s21 offen offset:0 sc1
    buffer_load_dwordx4 v[52:55], v2, s[8:11], s21 offen offset:1024 sc1
    buffer_load_dwordx4 v[56:59], v2, s[8:11], s21 offen offset:2048 sc1
    buffer_load_dwordx4 v[60:63], v2, s[8:11], s21 offen offset:3072 sc1
    s_add_u32 s21, s20, 12288
    buffer_load_dwordx4 v[64:67], v2, s[8:11], s21 offen offset:0 sc1
    buffer_load_dwordx4 v[68:71], v2, s[8:11], s21 offen offset:1024 sc1
    s_add_u32 s21, s20, 57344
    buffer_load_dwordx4 v[72:75], v2, s[8:11], s21 offen offset:0 sc1
    buffer_load_dwordx4 v[76:79], v2, s[8:11], s21 offen offset:1024 sc1
    buffer_load_dwordx4 v[80:83], v2, s[8:11], s21 offen offset:2048 sc1
    buffer_load_dwordx4 v[84:87], v2, s[8:11], s21 offen offset:3072 sc1
    s_add_u32 s21, s20, 61440
    buffer_load_dwordx4 v[88:91], v2, s[8:11], s21 offen offset:0 sc1
    buffer_load_dwordx4 v[92:95], v2, s[8:11], s21 offen offset:1024 sc1
    buffer_load_dwordx4 v[96:99], v2, s[8:11], s21 offen offset:2048 sc1
    buffer_load_dwordx4 v[100:103], v2, s[8:11], s21 offen offset:3072 sc1
    s_add_u32 s21, s20, 65536
    buffer_load_dwordx4 v[104:107], v2, s[8:11], s21 offen offset:0 sc1
    buffer_load_dwordx4 v[108:111], v2, s[8:11], s21 offen offset:1024 sc1
    buffer_load_dwordx4 v[112:115], v2, s[8:11], s21 offen offset:2048 sc1
    buffer_load_dwordx4 v[116:119], v2, s[8:11], s21 offen offset:3072 sc1
    s_add_u32 s21, s20, 69632
    buffer_load_dwordx4 v[120:123], v2, s[8:11], s21 offen offset:0 sc1
    buffer_load_dwordx4 v[124:127], v2, s[8:11], s21 offen offset:1024 sc1
    s_mul_i32 s20, s28, 458752
    s_mul_i32 s21, s15, 65536
    s_add_u32 s20, s20, s21
    s_lshl_b32 s21, s13, 12
    s_add_u32 s20, s20, s21
    s_add_u32 s20, s20, 46137344
    buffer_load_dwordx4 v[128:131], v2, s[8:11], s20 offen offset:0 sc1
    buffer_load_dwordx4 v[132:135], v2, s[8:11], s20 offen offset:1024 sc1
    buffer_load_dwordx4 v[136:139], v2, s[8:11], s20 offen offset:2048 sc1
    buffer_load_dwordx4 v[140:143], v2, s[8:11], s20 offen offset:3072 sc1
    s_add_u32 s20, s20, 16384
    buffer_load_dwordx4 v[144:147], v2, s[8:11], s20 offen offset:0 sc1
    buffer_load_dwordx4 v[148:151], v2, s[8:11], s20 offen offset:1024 sc1
    buffer_load_dwordx4 v[152:155], v2, s[8:11], s20 offen offset:2048 sc1
    buffer_load_dwordx4 v[156:159], v2, s[8:11], s20 offen offset:3072 sc1
    s_add_u32 s20, s20, 16384
    buffer_load_dwordx4 v[160:163], v2, s[8:11], s20 offen offset:0 sc1
    buffer_load_dwordx4 v[164:167], v2, s[8:11], s20 offen offset:1024 sc1
    buffer_load_dwordx4 v[168:171], v2, s[8:11], s20 offen offset:2048 sc1
    buffer_load_dwordx4 v[172:175], v2, s[8:11], s20 offen offset:3072 sc1
    s_add_u32 s20, s20, 16384
    buffer_load_dwordx4 v[176:179], v2, s[8:11], s20 offen offset:0 sc1
    buffer_load_dwordx4 v[180:183], v2, s[8:11], s20 offen offset:1024 sc1
    buffer_load_dwordx4 v[184:187], v2, s[8:11], s20 offen offset:2048 sc1
    buffer_load_dwordx4 v[188:191], v2, s[8:11], s20 offen offset:3072 sc1
    s_add_u32 s20, s20, 16384
    s_lshl_b32 s23, s28, 4
    s_lshl_b32 s21, s13, 2
    s_add_u32 s23, s23, s21
    s_mul_i32 s20, s23, 3072
    s_add_u32 s20, s20, 101711872
    buffer_load_dwordx4 v[208:211], v2, s[8:11], s20 offen offset:0 sc1
    buffer_load_dwordx4 v[212:215], v2, s[8:11], s20 offen offset:1024 sc1
    buffer_load_dwordx4 v[216:219], v2, s[8:11], s20 offen offset:2048 sc1
    buffer_load_dwordx4 v[220:223], v2, s[8:11], s20 offen offset:3072 sc1
    s_add_u32 s20, s20, 4096
    buffer_load_dwordx4 v[224:227], v2, s[8:11], s20 offen offset:0 sc1
    buffer_load_dwordx4 v[228:231], v2, s[8:11], s20 offen offset:1024 sc1
    buffer_load_dwordx4 v[232:235], v2, s[8:11], s20 offen offset:2048 sc1
    buffer_load_dwordx4 v[236:239], v2, s[8:11], s20 offen offset:3072 sc1
    s_add_u32 s20, s20, 4096
    buffer_load_dwordx4 v[240:243], v2, s[8:11], s20 offen offset:0 sc1
    buffer_load_dwordx4 v[244:247], v2, s[8:11], s20 offen offset:1024 sc1
    buffer_load_dwordx4 v[248:251], v2, s[8:11], s20 offen offset:2048 sc1
    buffer_load_dwordx4 v[252:255], v2, s[8:11], s20 offen offset:3072 sc1
    s_lshl_b32 s20, s28, 7
    s_add_u32 s20, s20, 92274688
    buffer_load_dword v5, v8, s[8:11], s20 offen sc1
    buffer_load_dword v6, v8, s[8:11], s20 offen offset:64 sc1
    s_waitcnt vmcnt(30)
    v_mfma_f32_16x16x32_bf16 a[224:227], a[0:3], v[16:19], 0
    v_mfma_f32_16x16x32_bf16 a[228:231], a[56:59], v[16:19], 0
    v_mfma_f32_16x16x32_bf16 a[232:235], a[112:115], v[16:19], 0
    v_mfma_f32_16x16x32_bf16 a[236:239], a[168:171], v[16:19], 0
    v_mfma_f32_16x16x32_bf16 a[240:243], a[0:3], v[72:75], 0
    v_mfma_f32_16x16x32_bf16 a[244:247], a[56:59], v[72:75], 0
    v_mfma_f32_16x16x32_bf16 a[248:251], a[112:115], v[72:75], 0
    v_mfma_f32_16x16x32_bf16 a[252:255], a[168:171], v[72:75], 0
    v_mfma_f32_16x16x32_bf16 a[224:227], a[4:7], v[20:23], a[224:227]
    v_mfma_f32_16x16x32_bf16 a[228:231], a[60:63], v[20:23], a[228:231]
    v_mfma_f32_16x16x32_bf16 a[232:235], a[116:119], v[20:23], a[232:235]
    v_mfma_f32_16x16x32_bf16 a[236:239], a[172:175], v[20:23], a[236:239]
    v_mfma_f32_16x16x32_bf16 a[240:243], a[4:7], v[76:79], a[240:243]
    v_mfma_f32_16x16x32_bf16 a[244:247], a[60:63], v[76:79], a[244:247]
    v_mfma_f32_16x16x32_bf16 a[248:251], a[116:119], v[76:79], a[248:251]
    v_mfma_f32_16x16x32_bf16 a[252:255], a[172:175], v[76:79], a[252:255]
    v_mfma_f32_16x16x32_bf16 a[224:227], a[8:11], v[24:27], a[224:227]
    v_mfma_f32_16x16x32_bf16 a[228:231], a[64:67], v[24:27], a[228:231]
    v_mfma_f32_16x16x32_bf16 a[232:235], a[120:123], v[24:27], a[232:235]
    v_mfma_f32_16x16x32_bf16 a[236:239], a[176:179], v[24:27], a[236:239]
    v_mfma_f32_16x16x32_bf16 a[240:243], a[8:11], v[80:83], a[240:243]
    v_mfma_f32_16x16x32_bf16 a[244:247], a[64:67], v[80:83], a[244:247]
    v_mfma_f32_16x16x32_bf16 a[248:251], a[120:123], v[80:83], a[248:251]
    v_mfma_f32_16x16x32_bf16 a[252:255], a[176:179], v[80:83], a[252:255]
    v_mfma_f32_16x16x32_bf16 a[224:227], a[12:15], v[28:31], a[224:227]
    v_mfma_f32_16x16x32_bf16 a[228:231], a[68:71], v[28:31], a[228:231]
    v_mfma_f32_16x16x32_bf16 a[232:235], a[124:127], v[28:31], a[232:235]
    v_mfma_f32_16x16x32_bf16 a[236:239], a[180:183], v[28:31], a[236:239]
    v_mfma_f32_16x16x32_bf16 a[240:243], a[12:15], v[84:87], a[240:243]
    v_mfma_f32_16x16x32_bf16 a[244:247], a[68:71], v[84:87], a[244:247]
    v_mfma_f32_16x16x32_bf16 a[248:251], a[124:127], v[84:87], a[248:251]
    v_mfma_f32_16x16x32_bf16 a[252:255], a[180:183], v[84:87], a[252:255]
    v_mfma_f32_16x16x32_bf16 a[224:227], a[16:19], v[32:35], a[224:227]
    v_mfma_f32_16x16x32_bf16 a[228:231], a[72:75], v[32:35], a[228:231]
    v_mfma_f32_16x16x32_bf16 a[232:235], a[128:131], v[32:35], a[232:235]
    v_mfma_f32_16x16x32_bf16 a[236:239], a[184:187], v[32:35], a[236:239]
    v_mfma_f32_16x16x32_bf16 a[240:243], a[16:19], v[88:91], a[240:243]
    v_mfma_f32_16x16x32_bf16 a[244:247], a[72:75], v[88:91], a[244:247]
    v_mfma_f32_16x16x32_bf16 a[248:251], a[128:131], v[88:91], a[248:251]
    v_mfma_f32_16x16x32_bf16 a[252:255], a[184:187], v[88:91], a[252:255]
    v_mfma_f32_16x16x32_bf16 a[224:227], a[20:23], v[36:39], a[224:227]
    v_mfma_f32_16x16x32_bf16 a[228:231], a[76:79], v[36:39], a[228:231]
    v_mfma_f32_16x16x32_bf16 a[232:235], a[132:135], v[36:39], a[232:235]
    v_mfma_f32_16x16x32_bf16 a[236:239], a[188:191], v[36:39], a[236:239]
    v_mfma_f32_16x16x32_bf16 a[240:243], a[20:23], v[92:95], a[240:243]
    v_mfma_f32_16x16x32_bf16 a[244:247], a[76:79], v[92:95], a[244:247]
    v_mfma_f32_16x16x32_bf16 a[248:251], a[132:135], v[92:95], a[248:251]
    v_mfma_f32_16x16x32_bf16 a[252:255], a[188:191], v[92:95], a[252:255]
    v_mfma_f32_16x16x32_bf16 a[224:227], a[24:27], v[40:43], a[224:227]
    v_mfma_f32_16x16x32_bf16 a[228:231], a[80:83], v[40:43], a[228:231]
    v_mfma_f32_16x16x32_bf16 a[232:235], a[136:139], v[40:43], a[232:235]
    v_mfma_f32_16x16x32_bf16 a[236:239], a[192:195], v[40:43], a[236:239]
    v_mfma_f32_16x16x32_bf16 a[240:243], a[24:27], v[96:99], a[240:243]
    v_mfma_f32_16x16x32_bf16 a[244:247], a[80:83], v[96:99], a[244:247]
    v_mfma_f32_16x16x32_bf16 a[248:251], a[136:139], v[96:99], a[248:251]
    v_mfma_f32_16x16x32_bf16 a[252:255], a[192:195], v[96:99], a[252:255]
    v_mfma_f32_16x16x32_bf16 a[224:227], a[28:31], v[44:47], a[224:227]
    v_mfma_f32_16x16x32_bf16 a[228:231], a[84:87], v[44:47], a[228:231]
    v_mfma_f32_16x16x32_bf16 a[232:235], a[140:143], v[44:47], a[232:235]
    v_mfma_f32_16x16x32_bf16 a[236:239], a[196:199], v[44:47], a[236:239]
    v_mfma_f32_16x16x32_bf16 a[240:243], a[28:31], v[100:103], a[240:243]
    v_mfma_f32_16x16x32_bf16 a[244:247], a[84:87], v[100:103], a[244:247]
    v_mfma_f32_16x16x32_bf16 a[248:251], a[140:143], v[100:103], a[248:251]
    v_mfma_f32_16x16x32_bf16 a[252:255], a[196:199], v[100:103], a[252:255]
    v_mfma_f32_16x16x32_bf16 a[224:227], a[32:35], v[48:51], a[224:227]
    v_mfma_f32_16x16x32_bf16 a[228:231], a[88:91], v[48:51], a[228:231]
    v_mfma_f32_16x16x32_bf16 a[232:235], a[144:147], v[48:51], a[232:235]
    v_mfma_f32_16x16x32_bf16 a[236:239], a[200:203], v[48:51], a[236:239]
    v_mfma_f32_16x16x32_bf16 a[240:243], a[32:35], v[104:107], a[240:243]
    v_mfma_f32_16x16x32_bf16 a[244:247], a[88:91], v[104:107], a[244:247]
    v_mfma_f32_16x16x32_bf16 a[248:251], a[144:147], v[104:107], a[248:251]
    v_mfma_f32_16x16x32_bf16 a[252:255], a[200:203], v[104:107], a[252:255]
    v_mfma_f32_16x16x32_bf16 a[224:227], a[36:39], v[52:55], a[224:227]
    v_mfma_f32_16x16x32_bf16 a[228:231], a[92:95], v[52:55], a[228:231]
    v_mfma_f32_16x16x32_bf16 a[232:235], a[148:151], v[52:55], a[232:235]
    v_mfma_f32_16x16x32_bf16 a[236:239], a[204:207], v[52:55], a[236:239]
    v_mfma_f32_16x16x32_bf16 a[240:243], a[36:39], v[108:111], a[240:243]
    v_mfma_f32_16x16x32_bf16 a[244:247], a[92:95], v[108:111], a[244:247]
    v_mfma_f32_16x16x32_bf16 a[248:251], a[148:151], v[108:111], a[248:251]
    v_mfma_f32_16x16x32_bf16 a[252:255], a[204:207], v[108:111], a[252:255]
    v_mfma_f32_16x16x32_bf16 a[224:227], a[40:43], v[56:59], a[224:227]
    v_mfma_f32_16x16x32_bf16 a[228:231], a[96:99], v[56:59], a[228:231]
    v_mfma_f32_16x16x32_bf16 a[232:235], a[152:155], v[56:59], a[232:235]
    v_mfma_f32_16x16x32_bf16 a[236:239], a[208:211], v[56:59], a[236:239]
    v_mfma_f32_16x16x32_bf16 a[240:243], a[40:43], v[112:115], a[240:243]
    v_mfma_f32_16x16x32_bf16 a[244:247], a[96:99], v[112:115], a[244:247]
    v_mfma_f32_16x16x32_bf16 a[248:251], a[152:155], v[112:115], a[248:251]
    v_mfma_f32_16x16x32_bf16 a[252:255], a[208:211], v[112:115], a[252:255]
    v_mfma_f32_16x16x32_bf16 a[224:227], a[44:47], v[60:63], a[224:227]
    v_mfma_f32_16x16x32_bf16 a[228:231], a[100:103], v[60:63], a[228:231]
    v_mfma_f32_16x16x32_bf16 a[232:235], a[156:159], v[60:63], a[232:235]
    v_mfma_f32_16x16x32_bf16 a[236:239], a[212:215], v[60:63], a[236:239]
    v_mfma_f32_16x16x32_bf16 a[240:243], a[44:47], v[116:119], a[240:243]
    v_mfma_f32_16x16x32_bf16 a[244:247], a[100:103], v[116:119], a[244:247]
    v_mfma_f32_16x16x32_bf16 a[248:251], a[156:159], v[116:119], a[248:251]
    v_mfma_f32_16x16x32_bf16 a[252:255], a[212:215], v[116:119], a[252:255]
    v_mfma_f32_16x16x32_bf16 a[224:227], a[48:51], v[64:67], a[224:227]
    v_mfma_f32_16x16x32_bf16 a[228:231], a[104:107], v[64:67], a[228:231]
    v_mfma_f32_16x16x32_bf16 a[232:235], a[160:163], v[64:67], a[232:235]
    v_mfma_f32_16x16x32_bf16 a[236:239], a[216:219], v[64:67], a[236:239]
    v_mfma_f32_16x16x32_bf16 a[240:243], a[48:51], v[120:123], a[240:243]
    v_mfma_f32_16x16x32_bf16 a[244:247], a[104:107], v[120:123], a[244:247]
    v_mfma_f32_16x16x32_bf16 a[248:251], a[160:163], v[120:123], a[248:251]
    v_mfma_f32_16x16x32_bf16 a[252:255], a[216:219], v[120:123], a[252:255]
    v_mfma_f32_16x16x32_bf16 a[224:227], a[52:55], v[68:71], a[224:227]
    v_mfma_f32_16x16x32_bf16 a[228:231], a[108:111], v[68:71], a[228:231]
    v_mfma_f32_16x16x32_bf16 a[232:235], a[164:167], v[68:71], a[232:235]
    v_mfma_f32_16x16x32_bf16 a[236:239], a[220:223], v[68:71], a[236:239]
    v_mfma_f32_16x16x32_bf16 a[240:243], a[52:55], v[124:127], a[240:243]
    v_mfma_f32_16x16x32_bf16 a[244:247], a[108:111], v[124:127], a[244:247]
    v_mfma_f32_16x16x32_bf16 a[248:251], a[164:167], v[124:127], a[248:251]
    v_mfma_f32_16x16x32_bf16 a[252:255], a[220:223], v[124:127], a[252:255]
    s_waitcnt vmcnt(0)
    v_cndmask_b32 v208, v14, v208, s[48:49]
    v_cndmask_b32 v209, v14, v209, s[50:51]
    v_cndmask_b32 v210, v14, v210, s[52:53]
    v_cndmask_b32 v211, v14, v211, s[54:55]
    v_max3_f32 v104, v208, v209, v210
    v_max_f32 v104, v104, v211
    v_mov_b32 v106, v104
    s_nop 1
    v_permlane16_swap_b32 v104, v106
    v_max_f32 v104, v104, v106
    v_mov_b32 v106, v104
    s_nop 1
    v_permlane32_swap_b32 v104, v106
    v_max_f32 v104, v104, v106
    v_sub_f32 v208, v208, v104
    v_sub_f32 v209, v209, v104
    v_sub_f32 v210, v210, v104
    v_sub_f32 v211, v211, v104
    v_exp_f32 v208, v208
    v_exp_f32 v209, v209
    v_exp_f32 v210, v210
    v_exp_f32 v211, v211
    v_add_f32 v105, v208, v209
    v_add_f32 v105, v105, v210
    v_add_f32 v105, v105, v211
    v_mov_b32 v106, v105
    s_nop 1
    v_permlane16_swap_b32 v105, v106
    v_add_f32 v105, v105, v106
    v_mov_b32 v106, v105
    s_nop 1
    v_permlane32_swap_b32 v105, v106
    v_add_f32 v105, v105, v106
    v_cndmask_b32 v80, v80, v104, s[60:61]
    v_cndmask_b32 v82, v82, v105, s[60:61]
    v_cndmask_b32 v216, v14, v216, s[48:49]
    v_cndmask_b32 v217, v14, v217, s[50:51]
    v_cndmask_b32 v218, v14, v218, s[52:53]
    v_cndmask_b32 v219, v14, v219, s[54:55]
    v_max3_f32 v104, v212, v213, v214
    v_max3_f32 v104, v104, v215, v216
    v_max3_f32 v104, v104, v217, v218
    v_max_f32 v104, v104, v219
    v_mov_b32 v106, v104
    s_nop 1
    v_permlane16_swap_b32 v104, v106
    v_max_f32 v104, v104, v106
    v_mov_b32 v106, v104
    s_nop 1
    v_permlane32_swap_b32 v104, v106
    v_max_f32 v104, v104, v106
    v_sub_f32 v212, v212, v104
    v_sub_f32 v213, v213, v104
    v_sub_f32 v214, v214, v104
    v_sub_f32 v215, v215, v104
    v_sub_f32 v216, v216, v104
    v_sub_f32 v217, v217, v104
    v_sub_f32 v218, v218, v104
    v_sub_f32 v219, v219, v104
    v_exp_f32 v212, v212
    v_exp_f32 v213, v213
    v_exp_f32 v214, v214
    v_exp_f32 v215, v215
    v_exp_f32 v216, v216
    v_exp_f32 v217, v217
    v_exp_f32 v218, v218
    v_exp_f32 v219, v219
    v_add_f32 v105, v212, v213
    v_add_f32 v105, v105, v214
    v_add_f32 v105, v105, v215
    v_add_f32 v105, v105, v216
    v_add_f32 v105, v105, v217
    v_add_f32 v105, v105, v218
    v_add_f32 v105, v105, v219
    v_mov_b32 v106, v105
    s_nop 1
    v_permlane16_swap_b32 v105, v106
    v_add_f32 v105, v105, v106
    v_mov_b32 v106, v105
    s_nop 1
    v_permlane32_swap_b32 v105, v106
    v_add_f32 v105, v105, v106
    v_cndmask_b32 v81, v81, v104, s[60:61]
    v_cndmask_b32 v83, v83, v105, s[60:61]
    v_cndmask_b32 v220, v14, v220, s[48:49]
    v_cndmask_b32 v221, v14, v221, s[50:51]
    v_cndmask_b32 v222, v14, v222, s[52:53]
    v_cndmask_b32 v223, v14, v223, s[54:55]
    v_max3_f32 v104, v220, v221, v222
    v_max_f32 v104, v104, v223
    v_mov_b32 v106, v104
    s_nop 1
    v_permlane16_swap_b32 v104, v106
    v_max_f32 v104, v104, v106
    v_mov_b32 v106, v104
    s_nop 1
    v_permlane32_swap_b32 v104, v106
    v_max_f32 v104, v104, v106
    v_sub_f32 v220, v220, v104
    v_sub_f32 v221, v221, v104
    v_sub_f32 v222, v222, v104
    v_sub_f32 v223, v223, v104
    v_exp_f32 v220, v220
    v_exp_f32 v221, v221
    v_exp_f32 v222, v222
    v_exp_f32 v223, v223
    v_add_f32 v105, v220, v221
    v_add_f32 v105, v105, v222
    v_add_f32 v105, v105, v223
    v_mov_b32 v106, v105
    s_nop 1
    v_permlane16_swap_b32 v105, v106
    v_add_f32 v105, v105, v106
    v_mov_b32 v106, v105
    s_nop 1
    v_permlane32_swap_b32 v105, v106
    v_add_f32 v105, v105, v106
    v_cndmask_b32 v80, v80, v104, s[62:63]
    v_cndmask_b32 v82, v82, v105, s[62:63]
    v_cndmask_b32 v228, v14, v228, s[48:49]
    v_cndmask_b32 v229, v14, v229, s[50:51]
    v_cndmask_b32 v230, v14, v230, s[52:53]
    v_cndmask_b32 v231, v14, v231, s[54:55]
    v_max3_f32 v104, v224, v225, v226
    v_max3_f32 v104, v104, v227, v228
    v_max3_f32 v104, v104, v229, v230
    v_max_f32 v104, v104, v231
    v_mov_b32 v106, v104
    s_nop 1
    v_permlane16_swap_b32 v104, v106
    v_max_f32 v104, v104, v106
    v_mov_b32 v106, v104
    s_nop 1
    v_permlane32_swap_b32 v104, v106
    v_max_f32 v104, v104, v106
    v_sub_f32 v224, v224, v104
    v_sub_f32 v225, v225, v104
    v_sub_f32 v226, v226, v104
    v_sub_f32 v227, v227, v104
    v_sub_f32 v228, v228, v104
    v_sub_f32 v229, v229, v104
    v_sub_f32 v230, v230, v104
    v_sub_f32 v231, v231, v104
    v_exp_f32 v224, v224
    v_exp_f32 v225, v225
    v_exp_f32 v226, v226
    v_exp_f32 v227, v227
    v_exp_f32 v228, v228
    v_exp_f32 v229, v229
    v_exp_f32 v230, v230
    v_exp_f32 v231, v231
    v_add_f32 v105, v224, v225
    v_add_f32 v105, v105, v226
    v_add_f32 v105, v105, v227
    v_add_f32 v105, v105, v228
    v_add_f32 v105, v105, v229
    v_add_f32 v105, v105, v230
    v_add_f32 v105, v105, v231
    v_mov_b32 v106, v105
    s_nop 1
    v_permlane16_swap_b32 v105, v106
    v_add_f32 v105, v105, v106
    v_mov_b32 v106, v105
    s_nop 1
    v_permlane32_swap_b32 v105, v106
    v_add_f32 v105, v105, v106
    v_cndmask_b32 v81, v81, v104, s[62:63]
    v_cndmask_b32 v83, v83, v105, s[62:63]
    v_cndmask_b32 v232, v14, v232, s[48:49]
    v_cndmask_b32 v233, v14, v233, s[50:51]
    v_cndmask_b32 v234, v14, v234, s[52:53]
    v_cndmask_b32 v235, v14, v235, s[54:55]
    v_max3_f32 v104, v232, v233, v234
    v_max_f32 v104, v104, v235
    v_mov_b32 v106, v104
    s_nop 1
    v_permlane16_swap_b32 v104, v106
    v_max_f32 v104, v104, v106
    v_mov_b32 v106, v104
    s_nop 1
    v_permlane32_swap_b32 v104, v106
    v_max_f32 v104, v104, v106
    v_sub_f32 v232, v232, v104
    v_sub_f32 v233, v233, v104
    v_sub_f32 v234, v234, v104
    v_sub_f32 v235, v235, v104
    v_exp_f32 v232, v232
    v_exp_f32 v233, v233
    v_exp_f32 v234, v234
    v_exp_f32 v235, v235
    v_add_f32 v105, v232, v233
    v_add_f32 v105, v105, v234
    v_add_f32 v105, v105, v235
    v_mov_b32 v106, v105
    s_nop 1
    v_permlane16_swap_b32 v105, v106
    v_add_f32 v105, v105, v106
    v_mov_b32 v106, v105
    s_nop 1
    v_permlane32_swap_b32 v105, v106
    v_add_f32 v105, v105, v106
    v_cndmask_b32 v80, v80, v104, s[64:65]
    v_cndmask_b32 v82, v82, v105, s[64:65]
    v_cndmask_b32 v240, v14, v240, s[48:49]
    v_cndmask_b32 v241, v14, v241, s[50:51]
    v_cndmask_b32 v242, v14, v242, s[52:53]
    v_cndmask_b32 v243, v14, v243, s[54:55]
    v_max3_f32 v104, v236, v237, v238
    v_max3_f32 v104, v104, v239, v240
    v_max3_f32 v104, v104, v241, v242
    v_max_f32 v104, v104, v243
    v_mov_b32 v106, v104
    s_nop 1
    v_permlane16_swap_b32 v104, v106
    v_max_f32 v104, v104, v106
    v_mov_b32 v106, v104
    s_nop 1
    v_permlane32_swap_b32 v104, v106
    v_max_f32 v104, v104, v106
    v_sub_f32 v236, v236, v104
    v_sub_f32 v237, v237, v104
    v_sub_f32 v238, v238, v104
    v_sub_f32 v239, v239, v104
    v_sub_f32 v240, v240, v104
    v_sub_f32 v241, v241, v104
    v_sub_f32 v242, v242, v104
    v_sub_f32 v243, v243, v104
    v_exp_f32 v236, v236
    v_exp_f32 v237, v237
    v_exp_f32 v238, v238
    v_exp_f32 v239, v239
    v_exp_f32 v240, v240
    v_exp_f32 v241, v241
    v_exp_f32 v242, v242
    v_exp_f32 v243, v243
    v_add_f32 v105, v236, v237
    v_add_f32 v105, v105, v238
    v_add_f32 v105, v105, v239
    v_add_f32 v105, v105, v240
    v_add_f32 v105, v105, v241
    v_add_f32 v105, v105, v242
    v_add_f32 v105, v105, v243
    v_mov_b32 v106, v105
    s_nop 1
    v_permlane16_swap_b32 v105, v106
    v_add_f32 v105, v105, v106
    v_mov_b32 v106, v105
    s_nop 1
    v_permlane32_swap_b32 v105, v106
    v_add_f32 v105, v105, v106
    v_cndmask_b32 v81, v81, v104, s[64:65]
    v_cndmask_b32 v83, v83, v105, s[64:65]
    v_cndmask_b32 v244, v14, v244, s[48:49]
    v_cndmask_b32 v245, v14, v245, s[50:51]
    v_cndmask_b32 v246, v14, v246, s[52:53]
    v_cndmask_b32 v247, v14, v247, s[54:55]
    v_max3_f32 v104, v244, v245, v246
    v_max_f32 v104, v104, v247
    v_mov_b32 v106, v104
    s_nop 1
    v_permlane16_swap_b32 v104, v106
    v_max_f32 v104, v104, v106
    v_mov_b32 v106, v104
    s_nop 1
    v_permlane32_swap_b32 v104, v106
    v_max_f32 v104, v104, v106
    v_sub_f32 v244, v244, v104
    v_sub_f32 v245, v245, v104
    v_sub_f32 v246, v246, v104
    v_sub_f32 v247, v247, v104
    v_exp_f32 v244, v244
    v_exp_f32 v245, v245
    v_exp_f32 v246, v246
    v_exp_f32 v247, v247
    v_add_f32 v105, v244, v245
    v_add_f32 v105, v105, v246
    v_add_f32 v105, v105, v247
    v_mov_b32 v106, v105
    s_nop 1
    v_permlane16_swap_b32 v105, v106
    v_add_f32 v105, v105, v106
    v_mov_b32 v106, v105
    s_nop 1
    v_permlane32_swap_b32 v105, v106
    v_add_f32 v105, v105, v106
    v_cndmask_b32 v80, v80, v104, s[66:67]
    v_cndmask_b32 v82, v82, v105, s[66:67]
    v_cndmask_b32 v252, v14, v252, s[48:49]
    v_cndmask_b32 v253, v14, v253, s[50:51]
    v_cndmask_b32 v254, v14, v254, s[52:53]
    v_cndmask_b32 v255, v14, v255, s[54:55]
    v_max3_f32 v104, v248, v249, v250
    v_max3_f32 v104, v104, v251, v252
    v_max3_f32 v104, v104, v253, v254
    v_max_f32 v104, v104, v255
    v_mov_b32 v106, v104
    s_nop 1
    v_permlane16_swap_b32 v104, v106
    v_max_f32 v104, v104, v106
    v_mov_b32 v106, v104
    s_nop 1
    v_permlane32_swap_b32 v104, v106
    v_max_f32 v104, v104, v106
    v_sub_f32 v248, v248, v104
    v_sub_f32 v249, v249, v104
    v_sub_f32 v250, v250, v104
    v_sub_f32 v251, v251, v104
    v_sub_f32 v252, v252, v104
    v_sub_f32 v253, v253, v104
    v_sub_f32 v254, v254, v104
    v_sub_f32 v255, v255, v104
    v_exp_f32 v248, v248
    v_exp_f32 v249, v249
    v_exp_f32 v250, v250
    v_exp_f32 v251, v251
    v_exp_f32 v252, v252
    v_exp_f32 v253, v253
    v_exp_f32 v254, v254
    v_exp_f32 v255, v255
    v_add_f32 v105, v248, v249
    v_add_f32 v105, v105, v250
    v_add_f32 v105, v105, v251
    v_add_f32 v105, v105, v252
    v_add_f32 v105, v105, v253
    v_add_f32 v105, v105, v254
    v_add_f32 v105, v105, v255
    v_mov_b32 v106, v105
    s_nop 1
    v_permlane16_swap_b32 v105, v106
    v_add_f32 v105, v105, v106
    v_mov_b32 v106, v105
    s_nop 1
    v_permlane32_swap_b32 v105, v106
    v_add_f32 v105, v105, v106
    v_cndmask_b32 v81, v81, v104, s[66:67]
    v_cndmask_b32 v83, v83, v105, s[66:67]
    s_lshl_b32 s20, s23, 10
    s_add_u32 s20, s20, 105381888
    s_mul_i32 s21, s23, 7168
    s_lshl_b32 s22, s15, 10
    s_add_u32 s21, s21, s22
    s_add_u32 s21, s21, 106954752
    s_cmp_lg_u32 s13, 0
    s_cbranch_scc1 WFZ_222
    s_mov_b32 s35, 0
    s_lshr_b32 s30, s28, 1
    s_lshl_b32 s30, s30, 8
    s_add_u32 s30, s30, 116428800
    v_and_b32 v112, 31, v1
    v_lshlrev_b32 v112, 2, v112
    s_branch WF0_223
WF_221:
    s_sleep 16
WF0_223:
    buffer_load_dword v114, v112, s[8:11], s30 offen sc1
    s_add_u32 s35, s35, 1
    s_cmp_gt_u32 s35, 4000000
    s_cbranch_scc1 MEGA_EXIT
    s_waitcnt vmcnt(0)
    v_cmp_eq_u32 vcc, 0, v114
    s_cbranch_vccnz WF_221
WFZ_222:
    s_barrier
    s_mov_b32 s35, 0
    s_branch WD0_225
WD_224:
    s_sleep 2
WD0_225:
    buffer_load_dwordx4 v[16:19], v7, s[8:11], s20 offen offset:0 sc1
    buffer_load_dwordx4 v[20:23], v7, s[8:11], s20 offen offset:256 sc1
    buffer_load_dwordx4 v[24:27], v7, s[8:11], s20 offen offset:512 sc1
    buffer_load_dwordx4 v[28:31], v7, s[8:11], s20 offen offset:768 sc1
    s_add_u32 s35, s35, 1
    s_cmp_gt_u32 s35, 4000000
    s_cbranch_scc1 MEGA_EXIT
WDC_226:
    s_waitcnt vmcnt(0)
    v_max3_u32 v112, v16, v17, v18
    v_max3_u32 v112, v112, v19, v20
    v_max3_u32 v112, v112, v21, v22
    v_max3_u32 v112, v112, v23, v24
    v_max3_u32 v112, v112, v25, v26
    v_max3_u32 v112, v112, v27, v28
    v_max3_u32 v112, v112, v29, v30
    v_max_u32 v112, v112, v31
    v_cmp_eq_u32 vcc, -1, v112
    s_cbranch_vccnz WD_224
    buffer_load_dwordx4 v[192:195], v15, s[8:11], s21 offen offset:0 sc1
    buffer_load_dwordx4 v[196:199], v15, s[8:11], s21 offen offset:256 sc1
    buffer_load_dwordx4 v[200:203], v15, s[8:11], s21 offen offset:512 sc1
    buffer_load_dwordx4 v[204:207], v15, s[8:11], s21 offen offset:768 sc1
    v_max3_f32 v104, v16, v17, v18
    v_max3_f32 v104, v104, v19, v20
    v_max3_f32 v104, v104, v21, v22
    v_max3_f32 v104, v104, v23, v80
    v_sub_f32 v16, v16, v104
    v_sub_f32 v17, v17, v104
    v_sub_f32 v18, v18, v104
    v_sub_f32 v19, v19, v104
    v_sub_f32 v20, v20, v104
    v_sub_f32 v21, v21, v104
    v_sub_f32 v22, v22, v104
    v_sub_f32 v23, v23, v104
    v_sub_f32 v80, v80, v104
    v_exp_f32 v16, v16
    v_exp_f32 v17, v17
    v_exp_f32 v18, v18
    v_exp_f32 v19, v19
    v_exp_f32 v20, v20
    v_exp_f32 v21, v21
    v_exp_f32 v22, v22
    v_exp_f32 v23, v23
    v_exp_f32 v80, v80
    v_add_f32 v105, v16, v17
    v_add_f32 v107, v18, v19
    v_add_f32 v105, v105, v20
    v_add_f32 v107, v107, v21
    v_add_f32 v105, v105, v22
    v_add_f32 v107, v107, v23
    v_fma_f32 v105, v82, v80, v105
    v_add_f32 v105, v105, v107
    v_rcp_f32 v105, v105
    s_nop 0
    v_mul_f32 v105, v105, v5
    v_mul_f32 v80, v80, v105
    v_mov_b32 v84, v80
    v_mov_b32 v85, v80
    v_mul_f32 v16, v16, v105
    v_mul_f32 v17, v17, v105
    v_mul_f32 v18, v18, v105
    v_mul_f32 v19, v19, v105
    v_permlane16_swap_b32 v84, v85
    v_mov_b32 v86, v84
    v_mov_b32 v87, v85
    v_mul_f32 v20, v20, v105
    v_mul_f32 v21, v21, v105
    v_mul_f32 v22, v22, v105
    v_mul_f32 v23, v23, v105
    v_permlane32_swap_b32 v84, v86
    v_permlane32_swap_b32 v85, v87
    v_cvt_pk_bf16_f32 v96, v16, v17
    v_cvt_pk_bf16_f32 v97, v18, v19
    v_cvt_pk_bf16_f32 v98, v20, v21
    v_cvt_pk_bf16_f32 v99, v22, v23
    v_mul_f32 v208, v208, v84
    v_mul_f32 v209, v209, v84
    v_mul_f32 v210, v210, v84
    v_mul_f32 v211, v211, v84
    v_cvt_pk_bf16_f32 v48, v208, 0
    v_cvt_pk_bf16_f32 v49, v209, 0
    v_cvt_pk_bf16_f32 v50, v210, 0
    v_cvt_pk_bf16_f32 v51, v211, 0
    v_mul_f32 v220, v220, v85
    v_mul_f32 v221, v221, v85
    v_mfma_f32_16x16x32_bf16 a[224:227], v[128:131], v[48:51], a[224:227]
    v_mul_f32 v222, v222, v85
    v_mul_f32 v223, v223, v85
    v_mfma_f32_16x16x32_bf16 a[228:231], v[144:147], v[48:51], a[228:231]
    v_cvt_pk_bf16_f32 v56, v220, 0
    v_cvt_pk_bf16_f32 v57, v221, 0
    v_mfma_f32_16x16x32_bf16 a[232:235], v[160:163], v[48:51], a[232:235]
    v_cvt_pk_bf16_f32 v58, v222, 0
    v_cvt_pk_bf16_f32 v59, v223, 0
    v_mfma_f32_16x16x32_bf16 a[236:239], v[176:179], v[48:51], a[236:239]
    v_mul_f32 v232, v232, v86
    v_mul_f32 v233, v233, v86
    v_mfma_f32_16x16x32_bf16 a[224:227], v[132:135], v[56:59], a[224:227]
    v_mul_f32 v234, v234, v86
    v_mul_f32 v235, v235, v86
    v_mfma_f32_16x16x32_bf16 a[228:231], v[148:151], v[56:59], a[228:231]
    v_cvt_pk_bf16_f32 v64, v232, 0
    v_cvt_pk_bf16_f32 v65, v233, 0
    v_mfma_f32_16x16x32_bf16 a[232:235], v[164:167], v[56:59], a[232:235]
    v_cvt_pk_bf16_f32 v66, v234, 0
    v_cvt_pk_bf16_f32 v67, v235, 0
    v_mfma_f32_16x16x32_bf16 a[236:239], v[180:183], v[56:59], a[236:239]
    v_mul_f32 v244, v244, v87
    v_mul_f32 v245, v245, v87
    v_mfma_f32_16x16x32_bf16 a[224:227], v[136:139], v[64:67], a[224:227]
    v_mul_f32 v246, v246, v87
    v_mul_f32 v247, v247, v87
    v_mfma_f32_16x16x32_bf16 a[228:231], v[152:155], v[64:67], a[228:231]
    v_cvt_pk_bf16_f32 v72, v244, 0
    v_cvt_pk_bf16_f32 v73, v245, 0
    v_mfma_f32_16x16x32_bf16 a[232:235], v[168:171], v[64:67], a[232:235]
    v_cvt_pk_bf16_f32 v74, v246, 0
    v_cvt_pk_bf16_f32 v75, v247, 0
    v_mfma_f32_16x16x32_bf16 a[236:239], v[184:187], v[64:67], a[236:239]
    v_max3_f32 v104, v24, v25, v26
    v_max3_f32 v104, v104, v27, v28
    v_mfma_f32_16x16x32_bf16 a[224:227], v[140:143], v[72:75], a[224:227]
    v_max3_f32 v104, v104, v29, v30
    v_max3_f32 v104, v104, v31, v81
    v_mfma_f32_16x16x32_bf16 a[228:231], v[156:159], v[72:75], a[228:231]
    v_sub_f32 v24, v24, v104
    v_sub_f32 v25, v25, v104
    v_mfma_f32_16x16x32_bf16 a[232:235], v[172:175], v[72:75], a[232:235]
    v_sub_f32 v26, v26, v104
    v_sub_f32 v27, v27, v104
    v_mfma_f32_16x16x32_bf16 a[236:239], v[188:191], v[72:75], a[236:239]
    v_sub_f32 v28, v28, v104
    v_sub_f32 v29, v29, v104
    v_sub_f32 v30, v30, v104
    v_sub_f32 v31, v31, v104
    v_sub_f32 v81, v81, v104
    v_exp_f32 v24, v24
    v_exp_f32 v25, v25
    v_exp_f32 v26, v26
    v_exp_f32 v27, v27
    v_exp_f32 v28, v28
    v_exp_f32 v29, v29
    v_exp_f32 v30, v30
    v_exp_f32 v31, v31
    v_exp_f32 v81, v81
    v_add_f32 v105, v24, v25
    v_add_f32 v107, v26, v27
    v_add_f32 v105, v105, v28
    v_add_f32 v107, v107, v29
    v_add_f32 v105, v105, v30
    v_add_f32 v107, v107, v31
    v_fma_f32 v105, v83, v81, v105
    v_add_f32 v105, v105, v107
    v_rcp_f32 v105, v105
    s_nop 0
    v_mul_f32 v105, v105, v6
    v_mul_f32 v81, v81, v105
    v_mov_b32 v88, v81
    v_mov_b32 v89, v81
    v_mul_f32 v24, v24, v105
    v_mul_f32 v25, v25, v105
    v_mul_f32 v26, v26, v105
    v_mul_f32 v27, v27, v105
    v_permlane16_swap_b32 v88, v89
    v_mov_b32 v90, v88
    v_mov_b32 v91, v89
    v_mul_f32 v28, v28, v105
    v_mul_f32 v29, v29, v105
    v_mul_f32 v30, v30, v105
    v_mul_f32 v31, v31, v105
    v_permlane32_swap_b32 v88, v90
    v_permlane32_swap_b32 v89, v91
    v_cvt_pk_bf16_f32 v100, v24, v25
    v_cvt_pk_bf16_f32 v101, v26, v27
    v_cvt_pk_bf16_f32 v102, v28, v29
    v_cvt_pk_bf16_f32 v103, v30, v31
    v_mul_f32 v212, v212, v88
    v_mul_f32 v213, v213, v88
    v_mul_f32 v214, v214, v88
    v_mul_f32 v215, v215, v88
    v_mul_f32 v216, v216, v88
    v_mul_f32 v217, v217, v88
    v_mul_f32 v218, v218, v88
    v_mul_f32 v219, v219, v88
    v_cvt_pk_bf16_f32 v52, v212, v216
    v_cvt_pk_bf16_f32 v53, v213, v217
    v_cvt_pk_bf16_f32 v54, v214, v218
    v_cvt_pk_bf16_f32 v55, v215, v219
    v_mul_f32 v224, v224, v89
    v_mul_f32 v225, v225, v89
    v_mfma_f32_16x16x32_bf16 a[240:243], v[128:131], v[52:55], a[240:243]
    v_mul_f32 v226, v226, v89
    v_mul_f32 v227, v227, v89
    v_mfma_f32_16x16x32_bf16 a[244:247], v[144:147], v[52:55], a[244:247]
    v_mul_f32 v228, v228, v89
    v_mul_f32 v229, v229, v89
    v_mfma_f32_16x16x32_bf16 a[248:251], v[160:163], v[52:55], a[248:251]
    v_mul_f32 v230, v230, v89
    v_mul_f32 v231, v231, v89
    v_mfma_f32_16x16x32_bf16 a[252:255], v[176:179], v[52:55], a[252:255]
    v_cvt_pk_bf16_f32 v60, v224, v228
    v_cvt_pk_bf16_f32 v61, v225, v229
    v_cvt_pk_bf16_f32 v62, v226, v230
    v_cvt_pk_bf16_f32 v63, v227, v231
    v_mul_f32 v236, v236, v90
    v_mul_f32 v237, v237, v90
    v_mfma_f32_16x16x32_bf16 a[240:243], v[132:135], v[60:63], a[240:243]
    v_mul_f32 v238, v238, v90
    v_mul_f32 v239, v239, v90
    v_mfma_f32_16x16x32_bf16 a[244:247], v[148:151], v[60:63], a[244:247]
    v_mul_f32 v240, v240, v90
    v_mul_f32 v241, v241, v90
    v_mfma_f32_16x16x32_bf16 a[248:251], v[164:167], v[60:63], a[248:251]
    v_mul_f32 v242, v242, v90
    v_mul_f32 v243, v243, v90
    v_mfma_f32_16x16x32_bf16 a[252:255], v[180:183], v[60:63], a[252:255]
    v_cvt_pk_bf16_f32 v68, v236, v240
    v_cvt_pk_bf16_f32 v69, v237, v241
    v_cvt_pk_bf16_f32 v70, v238, v242
    v_cvt_pk_bf16_f32 v71, v239, v243
    v_mul_f32 v248, v248, v91
    v_mul_f32 v249, v249, v91
    v_mfma_f32_16x16x32_bf16 a[240:243], v[136:139], v[68:71], a[240:243]
    v_mul_f32 v250, v250, v91
    v_mul_f32 v251, v251, v91
    v_mfma_f32_16x16x32_bf16 a[244:247], v[152:155], v[68:71], a[244:247]
    v_mul_f32 v252, v252, v91
    v_mul_f32 v253, v253, v91
    v_mfma_f32_16x16x32_bf16 a[248:251], v[168:171], v[68:71], a[248:251]
    v_mul_f32 v254, v254, v91
    v_mul_f32 v255, v255, v91
    v_mfma_f32_16x16x32_bf16 a[252:255], v[184:187], v[68:71], a[252:255]
    v_cvt_pk_bf16_f32 v76, v248, v252
    v_cvt_pk_bf16_f32 v77, v249, v253
    v_cvt_pk_bf16_f32 v78, v250, v254
    v_cvt_pk_bf16_f32 v79, v251, v255
    s_nop 1
    v_mfma_f32_16x16x32_bf16 a[240:243], v[140:143], v[76:79], a[240:243]
    v_mfma_f32_16x16x32_bf16 a[244:247], v[156:159], v[76:79], a[244:247]
    v_mfma_f32_16x16x32_bf16 a[248:251], v[172:175], v[76:79], a[248:251]
    v_mfma_f32_16x16x32_bf16 a[252:255], v[188:191], v[76:79], a[252:255]
    s_mov_b32 s35, 0
    s_branch WDC_229
WD_227:
    s_sleep 2
WD0_228:
    buffer_load_dwordx4 v[192:195], v15, s[8:11], s21 offen offset:0 sc1
    buffer_load_dwordx4 v[196:199], v15, s[8:11], s21 offen offset:256 sc1
    buffer_load_dwordx4 v[200:203], v15, s[8:11], s21 offen offset:512 sc1
    buffer_load_dwordx4 v[204:207], v15, s[8:11], s21 offen offset:768 sc1
    s_add_u32 s35, s35, 1
    s_cmp_gt_u32 s35, 4000000
    s_cbranch_scc1 MEGA_EXIT
WDC_229:
    s_waitcnt vmcnt(0)
    v_max3_u32 v112, v192, v193, v194
    v_max3_u32 v112, v112, v195, v196
    v_max3_u32 v112, v112, v197, v198
    v_max3_u32 v112, v112, v199, v200
    v_max3_u32 v112, v112, v201, v202
    v_max3_u32 v112, v112, v203, v204
    v_max3_u32 v112, v112, v205, v206
    v_max_u32 v112, v112, v207
    v_cmp_eq_u32 vcc, -1, v112
    s_cbranch_vccnz WD_227
    v_mfma_f32_16x16x32_bf16 a[224:227], v[192:195], v[96:99], a[224:227]
    v_mfma_f32_16x16x32_bf16 a[228:231], v[196:199], v[96:99], a[228:231]
    v_mfma_f32_16x16x32_bf16 a[232:235], v[200:203], v[96:99], a[232:235]
    v_mfma_f32_16x16x32_bf16 a[236:239], v[204:207], v[96:99], a[236:239]
    v_mfma_f32_16x16x32_bf16 a[240:243], v[192:195], v[100:103], a[240:243]
    v_mfma_f32_16x16x32_bf16 a[244:247], v[196:199], v[100:103], a[244:247]
    v_mfma_f32_16x16x32_bf16 a[248:251], v[200:203], v[100:103], a[248:251]
    v_mfma_f32_16x16x32_bf16 a[252:255], v[204:207], v[100:103], a[252:255]
    ds_write_b128 v13, a[224:227] offset:0
    ds_write_b128 v13, a[228:231] offset:1024
    ds_write_b128 v13, a[232:235] offset:2048
    ds_write_b128 v13, a[236:239] offset:3072
    ds_write_b128 v13, a[240:243] offset:4096
    ds_write_b128 v13, a[244:247] offset:5120
    ds_write_b128 v13, a[248:251] offset:6144
    s_nop 0
    ds_write_b128 v13, a[252:255] offset:7168
    s_waitcnt lgkmcnt(0)
    s_barrier
    ds_read_b128 v[16:19], v12 offset:0
    ds_read_b128 v[20:23], v12 offset:256
    ds_read_b128 v[24:27], v12 offset:8192
    ds_read_b128 v[28:31], v12 offset:8448
    ds_read_b128 v[32:35], v12 offset:16384
    ds_read_b128 v[36:39], v12 offset:16640
    ds_read_b128 v[40:43], v12 offset:24576
    ds_read_b128 v[44:47], v12 offset:24832
    s_mul_i32 s20, s28, 28672
    s_lshl_b32 s21, s15, 7
    s_add_u32 s20, s20, s21
    s_waitcnt lgkmcnt(0)
    s_barrier
    v_add_f32 v16, v16, v24
    v_add_f32 v32, v32, v40
    v_add_f32 v17, v17, v25
    v_add_f32 v33, v33, v41
    v_add_f32 v18, v18, v26
    v_add_f32 v34, v34, v42
    v_add_f32 v19, v19, v27
    v_add_f32 v35, v35, v43
    v_add_f32 v20, v20, v28
    v_add_f32 v36, v36, v44
    v_add_f32 v21, v21, v29
    v_add_f32 v37, v37, v45
    v_add_f32 v22, v22, v30
    v_add_f32 v38, v38, v46
    v_add_f32 v23, v23, v31
    v_add_f32 v39, v39, v47
    v_add_f32 v16, v16, v32
    v_add_f32 v17, v17, v33
    v_add_f32 v18, v18, v34
    v_add_f32 v19, v19, v35
    v_add_f32 v20, v20, v36
    v_add_f32 v21, v21, v37
    v_add_f32 v22, v22, v38
    v_add_f32 v23, v23, v39
    v_cvt_pk_bf16_f32 v108, v16, v17
    v_cvt_pk_bf16_f32 v109, v18, v19
    v_cvt_pk_bf16_f32 v110, v20, v21
    v_cvt_pk_bf16_f32 v111, v22, v23
    buffer_store_dwordx4 v[108:111], v11, s[36:39], s20 offen
    s_add_u32 s28, s28, 13
    s_cmp_lt_u32 s28, 64
    s_cbranch_scc1 TOK_214
MEGA_EXIT:
    s_endpgm
CODE_END:
.set CODE_BYTES, CODE_END - CODE_BEGIN - 16
.section .rodata,"a"
.p2align 6
.amdhsa_kernel gated_mix__memory_aug_recurrent_mem_tr__swiglu_ffn__prompt_kernel
  .amdhsa_next_free_vgpr 512
  .amdhsa_next_free_sgpr 96
  .amdhsa_accum_offset 256
  .amdhsa_group_segment_fixed_size 0
  .amdhsa_kernarg_size 120
  .amdhsa_user_sgpr_count 2
  .amdhsa_user_sgpr_kernarg_segment_ptr 1
  .amdhsa_system_sgpr_workgroup_id_x 1
.end_amdhsa_kernel
```
